```python
import torch

def _softmax(x, axis=-1):
    return torch.softmax(x, dim=axis)

def _gelu(x):
    return torch.nn.functional.gelu(x, approximate='tanh')

def _silu(x):
    return torch.nn.functional.silu(x)

def _sigmoid(x):
    return torch.sigmoid(x)

def _layernorm(x, axis=-1, eps=1e-05):
    m = x.mean(dim=axis, keepdim=True)
    v = x.var(dim=axis, keepdim=True, unbiased=False)
    return (x - m) / torch.sqrt(v + eps)

def _scatter_add(tgt, idx, src, axis=0):
    return tgt.clone().index_add_(axis, idx, src)

def _segment_sum(src, seg, n):
    out = torch.zeros((n,) + src.shape[1:], dtype=src.dtype)
    return out.index_add_(0, seg, src)

def _pad(x, pw):
    flat = tuple((v for pair in reversed(pw) for v in pair))
    return torch.nn.functional.pad(x, flat)
kernel_name = 'adaLN_cond__gqa_block_cached__glu_gated_reglu__prompt'

def setup_inputs():

    _w = lambda a: (lambda t: t.to(torch.bfloat16) if t.is_floating_point() else t)(torch.as_tensor(a))

    def _A_setup():
        B, Sq, D = (1, 2048, 512)
        Hq, Hkv, Sk, Dh = (32, 8, 2048, 128)
        assert Hq % Hkv == 0, (Hq, Hkv)
        return {'x': _w((lambda *s: torch.randn(*s, dtype=torch.bfloat16) * 0.1)(B, Sq, D)), 'k_cache': _w((lambda *s: torch.randn(*s, dtype=torch.bfloat16) * 0.8)(B, Hkv, Sk, Dh)), 'v_cache': _w((lambda *s: torch.randn(*s, dtype=torch.bfloat16) * 3.2)(B, Hkv, Sk, Dh)), 'wq': _w((lambda *s: torch.randn(*s, dtype=torch.bfloat16) * 0.8)(D, Hq * Dh) * D ** (-0.5)), 'wo': _w((lambda *s: torch.randn(*s, dtype=torch.bfloat16) * 3.2)(Hq * Dh, D) * (Hq * Dh) ** (-0.5))}
    _A_in = _A_setup()

    def _B_setup():
        B, S, D, F = (1, 2048, 512, 1792)
        return {'x': _w((lambda *s: torch.randn(*s, dtype=torch.bfloat16) * 0.1)(B, S, D)), 'W_gate': _w((lambda *s: torch.randn(*s, dtype=torch.bfloat16) * 3.2)(D, F) * (2.0 / D) ** 0.5), 'W_up': _w((lambda *s: torch.randn(*s, dtype=torch.bfloat16) * 3.2)(D, F) * (2.0 / D) ** 0.5), 'W_down': _w((lambda *s: torch.randn(*s, dtype=torch.bfloat16) * 3.2)(F, D) * (1.0 / F) ** 0.5)}
    _B_in = _B_setup()
    return {'A_x': _A_in['x'], 'A_k_cache': _A_in['k_cache'], 'A_v_cache': _A_in['v_cache'], 'A_wq': _A_in['wq'], 'A_wo': _A_in['wo'], 'B_x': _B_in['x'], 'B_W_gate': _B_in['W_gate'], 'B_W_up': _B_in['W_up'], 'B_W_down': _B_in['W_down'], 'c': _w((lambda *s: torch.randn(*s, dtype=torch.bfloat16) * 0.2)(1, 512) * 8.0), 'w_mod': _w((lambda *s: torch.randn(*s, dtype=torch.bfloat16) * 0.2)(512, 6 * 512) * 512 ** (-0.5) * 8.0)}

def reference(A_x, A_k_cache, A_v_cache, A_wq, A_wo, B_x, B_W_gate, B_W_up, B_W_down, c, w_mod):

    def _A_ref(x, k_cache, v_cache, wq, wo):
        B, Sq, D = x.shape
        Hq, Dh = (32, 128)
        Hkv = k_cache.shape[1]
        rep = Hq // Hkv
        q = (lambda x, *d: x.permute(*d))((x @ wq).reshape(B, Sq, Hq, Dh), 0, 2, 1, 3)
        k = (lambda x, n, axis: torch.repeat_interleave(x, n, dim=axis))(k_cache, rep, axis=1)
        v = (lambda x, n, axis: torch.repeat_interleave(x, n, dim=axis))(v_cache, rep, axis=1)
        scores = torch.einsum('bhqd,bhkd->bhqk', q, k) * Dh ** (-0.5)
        p = _softmax(scores, axis=-1)
        o = torch.einsum('bhqk,bhkd->bhqd', p, v)
        return (lambda x, *d: x.permute(*d))(o, 0, 2, 1, 3).reshape(B, Sq, Hq * Dh) @ wo

    def _B_ref(x, W_gate, W_up, W_down):
        gate = torch.einsum('bsd,df->bsf', x, W_gate)
        up = torch.einsum('bsd,df->bsf', x, W_up)
        gate = gate * (lambda x, dt: x.to(dt))(gate > 0, gate.dtype)
        h = gate * up
        return torch.einsum('bsf,fd->bsd', h, W_down)
    x = A_x
    mod = (_silu(c) @ w_mod).reshape(c.shape[0], 6, 1, -1)
    sa, ca, ga, sb, cb, gb = (mod[:, 0].clone(), mod[:, 1].clone(), mod[:, 2].clone(), mod[:, 3].clone(), mod[:, 4].clone(), mod[:, 5].clone())
    h = _layernorm(x, axis=-1) * (1 + ca) + sa
    x = x + ga * _A_ref(h, A_k_cache, A_v_cache, A_wq, A_wo)
    h = _layernorm(x, axis=-1) * (1 + cb) + sb
    x = x + gb * _B_ref(h, B_W_gate, B_W_up, B_W_down)
    return x
```

```asm
; @launch grid=(256,1,1) block=(256,1,1) lds=163840
.amdgcn_target "amdgcn-amd-amdhsa--gfx950"
.text
.globl adaLN_cond__gqa_block_cached__glu_gated_reglu__prompt_kernel
.p2align 8
.type adaLN_cond__gqa_block_cached__glu_gated_reglu__prompt_kernel,@function
adaLN_cond__gqa_block_cached__glu_gated_reglu__prompt_kernel:
    s_cmp_ge_u32 s2, 256
    s_cbranch_scc1 L_end
    s_load_dwordx4 s[84:87], s[0:1], 72
    s_load_dwordx2 s[24:25], s[0:1], 104
    s_load_dwordx2 s[52:53], s[0:1], 0
    s_load_dwordx8 s[4:11], s[0:1], 8
    s_load_dwordx4 s[92:95], s[0:1], 48
    s_load_dwordx2 s[64:65], s[0:1], 64
    s_load_dwordx2 s[56:57], s[0:1], 88
    v_lshrrev_b32 v1, 6, v0
    v_and_b32 v0, 63, v0
    v_readfirstlane_b32 s19, v1
    s_getpc_b64 s[88:89]
L_pc:
    s_mov_b32 s20, s2
    s_mov_b32 s40, s88
    s_mov_b32 s41, s89
    s_mov_b32 s42, L_fallback-L_pc
    s_mov_b32 s43, 0x20000
    v_and_b32 v254, 7, v0
    v_lshlrev_b32 v254, 14, v254
    v_lshl_add_u32 v254, v1, 7, v254
    s_lshr_b32 s28, s20, 3
    s_lshl_b32 s28, s28, 9
    buffer_load_dword v255, v254, s[40:43], s28 offen
    s_and_b32 s22, s2, 6
    s_bfe_u32 s28, s2, 0x10003
    s_add_u32 s22, s22, s28
    s_and_b32 s3, s2, 1
    s_lshl_b32 s3, s3, 4
    s_lshr_b32 s28, s2, 4
    s_add_u32 s3, s3, s28
    s_lshl_b32 s2, s3, 3
    s_add_u32 s2, s2, s22
    s_lshl_b32 s17, s19, 12
    v_lshlrev_b32 v252, 4, v0
    s_lshr_b32 s28, s20, 5
    s_lshl_b32 s28, s28, 3
    s_and_b32 s29, s20, 7
    s_add_u32 s28, s28, s29
    s_and_b32 s34, s28, 15
    s_lshr_b32 s35, s28, 4
    s_bfe_u32 s29, s20, 0x20003
    s_lshl_b32 s34, s34, 2
    s_add_u32 s34, s34, s29
    s_mul_i32 s32, s35, 786432
    s_lshl_b32 s28, s34, 5
    s_add_u32 s32, s32, s28
    s_lshl_b32 s33, s35, 8
    v_lshl_add_u32 v102, v1, 6, v0
    v_lshrrev_b32 v102, 1, v102
    v_lshlrev_b32 v101, 1, v102
    v_mul_u32_u24 v100, 6144, v102
    v_and_b32 v102, 1, v0
    v_lshl_add_u32 v100, v102, 4, v100
    v_and_b32 v2, 15, v0
    v_lshrrev_b32 v3, 4, v0
    v_lshlrev_b32 v239, 10, v2
    v_lshl_add_u32 v239, v3, 4, v239
    s_lshl_b32 s21, s3, 16
    s_lshl_b32 s28, s19, 8
    s_add_u32 s21, s21, s28
    s_lshr_b32 s28, s22, 1
    s_lshl_b32 s28, s28, 14
    s_add_u32 s21, s21, s28
    v_and_b32 v5, 7, v0
    v_lshlrev_b32 v5, 7, v5
    v_lshrrev_b32 v4, 3, v0
    v_lshl_add_u32 v254, v4, 19, v5
    s_and_b32 s28, s3, 15
    s_lshl_b32 s28, s28, 2
    s_add_u32 s28, s28, s19
    s_lshl_b32 s28, s28, 13
    s_lshl_b32 s29, s22, 10
    s_add_u32 s36, s28, s29
    s_add_u32 s100, s22, s3
    s_and_b32 s100, s100, 7
    s_lshr_b32 s28, s22, 1
    s_xor_b32 s28, s28, s19
    s_lshl_b32 s29, s3, 2
    s_add_u32 s101, s29, s28
    s_lshl_b32 s39, s101, 14
    s_lshl_b32 s28, s100, 7
    s_add_u32 s39, s39, s28
    v_and_b32 v2, 15, v0
    v_lshlrev_b32 v4, 1, v3
    v_xor_b32 v4, v2, v4
    v_lshlrev_b32 v4, 4, v4
    v_lshl_add_u32 v248, v3, 13, v4
    v_xor_b32 v249, 128, v248
    v_add_u32 v249, 64512, v249
    v_add_u32 v250, 129024, v248
    v_add_u32 v251, 129024, v249
    s_lshl_b32 s31, s22, 2
    s_add_u32 s31, s31, s19
    s_lshl_b32 s31, s31, 8
    s_and_b32 s28, s100, 7
    s_lshl_b32 s28, s28, 1
    s_bfe_u32 s29, s3, 0x10003
    s_add_u32 s28, s28, s29
    s_lshl_b32 s28, s28, 18
    s_add_u32 s31, s31, s28
    s_lshl_b32 s29, s29, 19
    s_sub_u32 s96, 229376, s29
    s_add_u32 s97, s29, 229376
    s_waitcnt lgkmcnt(0)
    s_load_dword s45, s[24:25], 589824
    s_mov_b32 s26, 62914560
    s_mov_b32 s27, 0x20000
    s_mov_b32 s54, 0x200000
    s_mov_b32 s55, 0x20000
    s_mov_b32 s58, 0x200000
    s_mov_b32 s59, 0x20000
    s_mov_b32 s60, s84
    s_mov_b32 s61, s85
    s_mov_b32 s62, 1024
    s_mov_b32 s63, 0x20000
    s_mov_b32 s40, s86
    s_mov_b32 s41, s87
    s_mov_b32 s42, 3145728
    s_mov_b32 s43, 0x20000
    buffer_load_dwordx4 v[76:79], v100, s[40:43], s32 offen
    buffer_load_ushort v80, v101, s[60:63], s33 offen
    s_mov_b32 s40, s8
    s_mov_b32 s41, s9
    s_mov_b32 s42, 0x400000
    buffer_load_dwordx4 v[104:107], v239, s[52:55], s39 offen offset:0
    buffer_load_dwordx4 v[108:111], v239, s[52:55], s39 offen offset:64
    s_barrier
    s_add_u32 m0, s17, 32768
    s_nop 0
    buffer_load_dwordx4 v248, s[40:43], s31 offen offset:0  lds
    buffer_load_dwordx4 v249, s[40:43], s31 offen offset:1024  lds
    buffer_load_dwordx4 v250, s[40:43], s31 offen offset:2048  lds
    buffer_load_dwordx4 v251, s[40:43], s31 offen offset:3072  lds
    s_branch L_al
.p2align 12
L_al:
    s_lshr_b32 s29, s34, 5
    s_cmp_eq_u32 s29, 1
    s_cselect_b32 s32, 1.0, 0
    s_cmp_eq_u32 s35, 0
    s_cselect_b32 s32, s32, 0
    s_lshl_b32 s34, s34, 7
    s_lshl_b32 s35, s35, 13
    s_add_u32 s34, s34, s35
    s_add_u32 s34, s34, 524288
    s_cmp_eq_u32 s19, 0
    s_cselect_b32 s34, s34, 2147483648
    v_lshrrev_b32 v101, 4, v0
    v_lshlrev_b32 v101, 26, v101
    v_lshl_add_u32 v101, v0, 3, v101
    s_waitcnt vmcnt(6)
    v_lshlrev_b32 v80, 16, v80
    v_mul_f32 v92, 0xbfb8aa3b, v80
    v_exp_f32 v92, v92
    v_and_b32 v102, 1, v0
    v_add_f32 v92, 1.0, v92
    v_rcp_f32 v92, v92
    v_lshlrev_b32 v102, 5, v102
    v_mul_f32 v80, v80, v92
    v_lshlrev_b32 v92, 16, v76
    v_and_b32 v93, 0xffff0000, v76
    v_lshlrev_b32 v94, 16, v77
    v_and_b32 v95, 0xffff0000, v77
    v_lshlrev_b32 v96, 16, v78
    v_and_b32 v97, 0xffff0000, v78
    v_lshlrev_b32 v98, 16, v79
    v_and_b32 v99, 0xffff0000, v79
    v_mul_f32 v84, v92, v80
    v_mul_f32 v85, v93, v80
    v_mul_f32 v86, v94, v80
    v_mul_f32 v87, v95, v80
    v_mul_f32 v88, v96, v80
    v_mul_f32 v89, v97, v80
    v_mul_f32 v90, v98, v80
    v_mul_f32 v91, v99, v80
    v_permlane32_swap_b32 v84, v88
    v_permlane32_swap_b32 v85, v89
    v_permlane32_swap_b32 v86, v90
    v_permlane32_swap_b32 v87, v91
    v_add_f32 v84, v84, v88
    v_add_f32 v85, v85, v89
    v_add_f32 v86, v86, v90
    v_add_f32 v87, v87, v91
    v_lshrrev_b32 v92, 4, v0
    v_permlane16_swap_b32 v84, v86
    v_permlane16_swap_b32 v85, v87
    v_add_f32 v84, v84, v86
    v_add_f32 v85, v85, v87
    v_lshl_add_u32 v102, v92, 3, v102
    v_add_f32_dpp v84, v84, v84 row_ror:8 row_mask:0xf bank_mask:0xf
    v_add_f32_dpp v85, v85, v85 row_ror:8 row_mask:0xf bank_mask:0xf
    s_nop 0
    v_add_f32_dpp v84, v84, v84 row_ror:4 row_mask:0xf bank_mask:0xf
    v_add_f32_dpp v85, v85, v85 row_ror:4 row_mask:0xf bank_mask:0xf
    s_nop 0
    v_add_f32_dpp v84, v84, v84 row_ror:2 row_mask:0xf bank_mask:0xf
    v_add_f32_dpp v85, v85, v85 row_ror:2 row_mask:0xf bank_mask:0xf
    v_add_u32 v102, s17, v102
    ds_write_b64 v102, v[84:85] offset:49152
    s_waitcnt lgkmcnt(0)
    s_barrier
    v_lshlrev_b32 v102, 2, v0
    ds_read_b32 v92, v102 offset:49152
    ds_read_b32 v93, v102 offset:53248
    ds_read_b32 v94, v102 offset:57344
    ds_read_b32 v95, v102 offset:61440
    s_waitcnt lgkmcnt(0)
    s_add_u32 s45, s45, 0x9e3779b9
    v_add_f32 v92, v92, v93
    v_add_f32 v94, v94, v95
    v_add_f32 v92, v92, v94
    v_mov_b32 v93, s45
    v_add_f32 v92, s32, v92
    v_mul_f32 v92, 0x3e0293ee, v92
    buffer_store_dwordx2 v[92:93], v101, s[24:27], s34 offen sc1
    s_waitcnt vmcnt(5)
    v_lshlrev_b32 v112, 16, v104
    v_and_b32 v113, 0xffff0000, v104
    v_lshlrev_b32 v114, 16, v105
    v_and_b32 v115, 0xffff0000, v105
    v_lshlrev_b32 v116, 16, v106
    v_and_b32 v117, 0xffff0000, v106
    v_lshlrev_b32 v118, 16, v107
    v_and_b32 v119, 0xffff0000, v107
    v_lshlrev_b32 v120, 16, v108
    v_and_b32 v121, 0xffff0000, v108
    v_lshlrev_b32 v122, 16, v109
    v_and_b32 v123, 0xffff0000, v109
    v_lshlrev_b32 v124, 16, v110
    v_and_b32 v125, 0xffff0000, v110
    v_lshlrev_b32 v126, 16, v111
    v_and_b32 v127, 0xffff0000, v111
    v_pk_add_f32 v[128:129], v[112:113], v[114:115]
    v_pk_mul_f32 v[130:131], v[112:113], v[112:113]
    v_pk_fma_f32 v[130:131], v[114:115], v[114:115], v[130:131]
    v_pk_add_f32 v[128:129], v[128:129], v[116:117]
    v_pk_fma_f32 v[130:131], v[116:117], v[116:117], v[130:131]
    v_pk_add_f32 v[128:129], v[128:129], v[118:119]
    v_pk_fma_f32 v[130:131], v[118:119], v[118:119], v[130:131]
    v_pk_add_f32 v[128:129], v[128:129], v[120:121]
    v_pk_fma_f32 v[130:131], v[120:121], v[120:121], v[130:131]
    v_pk_add_f32 v[128:129], v[128:129], v[122:123]
    v_pk_fma_f32 v[130:131], v[122:123], v[122:123], v[130:131]
    v_pk_add_f32 v[128:129], v[128:129], v[124:125]
    v_pk_fma_f32 v[130:131], v[124:125], v[124:125], v[130:131]
    v_pk_add_f32 v[128:129], v[128:129], v[126:127]
    v_pk_fma_f32 v[130:131], v[126:127], v[126:127], v[130:131]
    v_add_f32 v128, v128, v129
    v_add_f32 v130, v130, v131
    v_and_b32 v132, 255, v252
    v_lshrrev_b32 v133, 5, v0
    v_permlane32_swap_b32 v128, v130
    v_add_f32 v128, v128, v130
    v_mov_b32 v129, v128
    v_lshl_add_u32 v132, v133, 3, v132
    v_bfe_u32 v133, v0, 4, 1
    v_permlane16_swap_b32 v128, v129
    v_add_f32 v128, v128, v129
    v_lshl_add_u32 v132, v133, 30, v132
    v_mov_b32 v129, s45
    s_lshl_b32 s34, s101, 11
    s_add_u32 s34, s34, 655360
    s_lshl_b32 s29, s22, 8
    s_add_u32 s29, s29, s34
    buffer_store_dwordx2 v[128:129], v132, s[24:27], s29 offen sc1
    s_barrier
    s_add_u32 s31, s31, 32768
    s_add_u32 m0, s17, 98304
    s_nop 0
    buffer_load_dwordx4 v248, s[40:43], s31 offen offset:0  lds
    buffer_load_dwordx4 v249, s[40:43], s31 offen offset:1024  lds
    buffer_load_dwordx4 v250, s[40:43], s31 offen offset:2048  lds
    buffer_load_dwordx4 v251, s[40:43], s31 offen offset:3072  lds
    s_lshl_b32 s23, s22, 19
    s_add_u32 s46, s4, s23
    s_addc_u32 s47, s5, 0
    s_add_u32 s48, s6, s23
    s_addc_u32 s49, s7, 0
    s_add_u32 s50, s10, s23
    s_addc_u32 s51, s11, 0
    s_mov_b32 s8, s46
    s_mov_b32 s9, s47
    s_mov_b32 s10, 0x80000
    s_mov_b32 s11, 0x20000
    s_mov_b32 s12, s48
    s_mov_b32 s13, s49
    s_mov_b32 s14, 0x80000
    s_mov_b32 s15, 0x20000
    s_mov_b32 s30, 16384
    s_mov_b32 s16, 0
    s_mov_b32 s44, 0
    v_add_u32 v253, 114688, v252
    v_lshrrev_b32 v4, 2, v0
    v_and_b32 v5, 7, v4
    v_lshlrev_b32 v5, 1, v5
    v_and_b32 v6, 3, v0
    v_xor_b32 v5, v5, v6
    v_lshlrev_b32 v5, 4, v5
    v_lshl_add_u32 v5, v4, 8, v5
    v_add_u32 v240, s17, v5
    v_add_u32 v241, 65536, v240
    v_add_u32 v9, s17, v252
    v_add_u32 v10, s17, v253
    v_add_u32 v11, s17, v10
    v_xor_b32 v12, 0, v240
    v_xor_b32 v28, 0, v241
    v_xor_b32 v13, 8, v240
    v_xor_b32 v29, 8, v241
    v_xor_b32 v14, 64, v240
    v_xor_b32 v30, 64, v241
    v_xor_b32 v15, 72, v240
    v_xor_b32 v31, 72, v241
    v_xor_b32 v16, 128, v240
    v_xor_b32 v32, 128, v241
    v_xor_b32 v17, 136, v240
    v_xor_b32 v33, 136, v241
    v_xor_b32 v18, 192, v240
    v_xor_b32 v34, 192, v241
    v_xor_b32 v19, 200, v240
    v_xor_b32 v35, 200, v241
    v_and_b32 v128, 7, v0
    v_lshrrev_b32 v129, 3, v0
    v_lshrrev_b32 v130, 2, v129
    v_lshl_add_u32 v130, v1, 2, v130
    v_and_b32 v131, 3, v129
    v_lshlrev_b32 v240, 10, v128
    v_lshl_add_u32 v240, v130, 6, v240
    v_lshl_add_u32 v240, v131, 3, v240
    v_lshlrev_b32 v241, 10, v130
    v_lshl_add_u32 v241, v131, 8, v241
    v_lshl_add_u32 v241, v128, 4, v241
    v_lshlrev_b32 v242, 7, v130
    v_lshl_add_u32 v242, v131, 5, v242
    v_add_u32 v242, 131072, v242
    v_and_b32 v128, 7, v0
    v_lshlrev_b32 v243, 10, v128
    v_lshrrev_b32 v129, 3, v0
    v_lshl_add_u32 v243, v129, 26, v243
    v_sub_u32 v244, s22, v128
    v_and_b32 v244, 7, v244
    v_lshl_add_u32 v243, v244, 7, v243
    v_xor_b32 v129, s22, v129
    v_not_b32 v129, v129
    v_and_b32 v129, 1, v129
    v_lshl_add_u32 v245, v129, 30, v252
    v_lshl_add_u32 v246, v1, 12, v252
    v_mov_b32 v129, s22
    v_and_b32 v129, 1, v129
    v_lshl_add_u32 v247, v129, 7, v241
    s_lshl_b32 s36, s3, 13
    s_add_u32 s36, s36, 65536
    s_lshl_b32 s37, s2, 10
    s_add_u32 s37, s37, 65536
    s_add_u32 s90, s24, s37
    s_addc_u32 s91, s25, 0
    s_lshr_b32 s38, s2, 1
    s_lshl_b32 s38, s38, 14
    s_and_b32 s28, s2, 1
    s_lshl_b32 s28, s28, 7
    s_add_u32 s38, s38, s28
    s_lshl_b32 s39, s2, 13
    s_mov_b32 s4, s86
    s_mov_b32 s5, s87
    v_lshlrev_b32 v4, 3, v0
    v_lshl_add_u32 v4, v1, 13, v4
    v_add_u32 v4, 131072, v4
    v_lshrrev_b32 v5, 4, v0
    v_lshlrev_b32 v5, 5, v5
    v_lshl_add_u32 v5, v1, 13, v5
    v_add_u32 v5, 131072, v5
    s_lshl_b32 s33, s100, 9
    s_add_u32 s33, s33, 524288
    v_lshrrev_b32 v6, 5, v0
    v_mul_u32_u24 v6, 3584, v6
    v_add_u32 v6, v6, v252
    v_and_b32 v7, 255, v252
    s_add_u32 s31, s31, s96
    s_and_b32 s31, s31, 0x3fffff
    s_add_u32 m0, s17, 0
    s_nop 0
    buffer_load_dwordx4 v248, s[40:43], s31 offen offset:0  lds
    buffer_load_dwordx4 v249, s[40:43], s31 offen offset:1024  lds
    buffer_load_dwordx4 v250, s[40:43], s31 offen offset:2048  lds
    buffer_load_dwordx4 v251, s[40:43], s31 offen offset:3072  lds
    s_add_u32 s31, s31, 32768
    s_add_u32 m0, s17, 65536
    s_nop 0
    buffer_load_dwordx4 v248, s[40:43], s31 offen offset:0  lds
    buffer_load_dwordx4 v249, s[40:43], s31 offen offset:1024  lds
    buffer_load_dwordx4 v250, s[40:43], s31 offen offset:2048  lds
    buffer_load_dwordx4 v251, s[40:43], s31 offen offset:3072  lds
    s_mov_b64 exec, 0
    s_cmp_eq_u32 s19, 0
    s_cbranch_scc1 L_pg0
    s_cmp_eq_u32 s19, 1
    s_cbranch_scc1 L_pg1
    s_cmp_eq_u32 s19, 2
    s_cbranch_scc1 L_pg2
    s_branch L_jm
L_pgret:
    s_mov_b64 exec, -1
    buffer_load_dwordx4 v[156:159], v252, s[24:27], s34 offen offset:0 sc1
    buffer_load_dwordx4 v[160:163], v252, s[24:27], s34 offen offset:1024 sc1
    s_add_u32 s32, s33, 0
    buffer_load_dwordx4 v[140:143], v6, s[24:27], s32 offen sc1
    s_add_u32 s32, s33, 8192
    buffer_load_dwordx4 v[144:147], v6, s[24:27], s32 offen sc1
    s_add_u32 s32, s33, 16384
    buffer_load_dwordx4 v[148:151], v6, s[24:27], s32 offen sc1
    s_add_u32 s32, s33, 24576
    buffer_load_dwordx4 v[152:155], v6, s[24:27], s32 offen sc1
    s_add_u32 s31, s31, s97
    s_and_b32 s31, s31, 0x3fffff
    s_add_u32 m0, s17, 16384
    s_nop 0
    buffer_load_dwordx4 v248, s[40:43], s31 offen offset:0  lds
    buffer_load_dwordx4 v249, s[40:43], s31 offen offset:1024  lds
    buffer_load_dwordx4 v250, s[40:43], s31 offen offset:2048  lds
    buffer_load_dwordx4 v251, s[40:43], s31 offen offset:3072  lds
    s_add_u32 s31, s31, 32768
    s_add_u32 m0, s17, 81920
    s_nop 0
    buffer_load_dwordx4 v248, s[40:43], s31 offen offset:0  lds
    buffer_load_dwordx4 v249, s[40:43], s31 offen offset:1024  lds
    buffer_load_dwordx4 v250, s[40:43], s31 offen offset:2048  lds
    buffer_load_dwordx4 v251, s[40:43], s31 offen offset:3072  lds
    s_waitcnt vmcnt(28)
    ds_read_b64_tr_b16 a[0:1], v12 offset:32768
    ds_read_b64_tr_b16 a[4:5], v13 offset:32768
    ds_read_b64_tr_b16 a[8:9], v14 offset:32768
    ds_read_b64_tr_b16 a[12:13], v15 offset:32768
    ds_read_b64_tr_b16 a[16:17], v16 offset:32768
    ds_read_b64_tr_b16 a[20:21], v17 offset:32768
    ds_read_b64_tr_b16 a[24:25], v18 offset:32768
    ds_read_b64_tr_b16 a[28:29], v19 offset:32768
    s_waitcnt vmcnt(22)
    ds_read_b64_tr_b16 a[2:3], v28 offset:32768
    ds_read_b64_tr_b16 a[6:7], v29 offset:32768
    ds_read_b64_tr_b16 a[10:11], v30 offset:32768
    ds_read_b64_tr_b16 a[14:15], v31 offset:32768
    ds_read_b64_tr_b16 a[18:19], v32 offset:32768
    ds_read_b64_tr_b16 a[22:23], v33 offset:32768
    ds_read_b64_tr_b16 a[26:27], v34 offset:32768
    ds_read_b64_tr_b16 a[30:31], v35 offset:32768
    s_waitcnt vmcnt(18)
    ds_read_b64_tr_b16 a[32:33], v12 offset:0
    ds_read_b64_tr_b16 a[36:37], v13 offset:0
    ds_read_b64_tr_b16 a[40:41], v14 offset:0
    ds_read_b64_tr_b16 a[44:45], v15 offset:0
    ds_read_b64_tr_b16 a[48:49], v16 offset:0
    ds_read_b64_tr_b16 a[52:53], v17 offset:0
    ds_read_b64_tr_b16 a[56:57], v18 offset:0
    ds_read_b64_tr_b16 a[60:61], v19 offset:0
    s_waitcnt vmcnt(14)
    ds_read_b64_tr_b16 a[34:35], v28 offset:0
    ds_read_b64_tr_b16 a[38:39], v29 offset:0
    ds_read_b64_tr_b16 a[42:43], v30 offset:0
    ds_read_b64_tr_b16 a[46:47], v31 offset:0
    ds_read_b64_tr_b16 a[50:51], v32 offset:0
    ds_read_b64_tr_b16 a[54:55], v33 offset:0
    ds_read_b64_tr_b16 a[58:59], v34 offset:0
    ds_read_b64_tr_b16 a[62:63], v35 offset:0
    s_mov_b32 s28, 0
    s_waitcnt vmcnt(8)
L_gpoll:
    v_xor_b32 v2, s45, v141
    v_bitop3_b32 v2, v2, v143, s45 bitop3:0xf6
    v_bitop3_b32 v2, v2, v145, s45 bitop3:0xf6
    v_bitop3_b32 v2, v2, v147, s45 bitop3:0xf6
    v_bitop3_b32 v2, v2, v149, s45 bitop3:0xf6
    v_bitop3_b32 v2, v2, v151, s45 bitop3:0xf6
    v_bitop3_b32 v2, v2, v153, s45 bitop3:0xf6
    v_bitop3_b32 v2, v2, v155, s45 bitop3:0xf6
    v_bitop3_b32 v2, v2, v157, s45 bitop3:0xf6
    v_bitop3_b32 v2, v2, v159, s45 bitop3:0xf6
    v_bitop3_b32 v2, v2, v161, s45 bitop3:0xf6
    v_bitop3_b32 v2, v2, v163, s45 bitop3:0xf6
    v_cmp_ne_u32 vcc, 0, v2
    s_add_u32 s28, s28, 1
    s_cmp_gt_u32 s28, 262144
    s_cbranch_scc1 L_gok
    s_cbranch_vccz L_gok
    buffer_load_dwordx4 v[156:159], v252, s[24:27], s34 offen offset:0 sc1
    buffer_load_dwordx4 v[160:163], v252, s[24:27], s34 offen offset:1024 sc1
    s_add_u32 s32, s33, 0
    buffer_load_dwordx4 v[140:143], v6, s[24:27], s32 offen sc1
    s_add_u32 s32, s33, 8192
    buffer_load_dwordx4 v[144:147], v6, s[24:27], s32 offen sc1
    s_add_u32 s32, s33, 16384
    buffer_load_dwordx4 v[148:151], v6, s[24:27], s32 offen sc1
    s_add_u32 s32, s33, 24576
    buffer_load_dwordx4 v[152:155], v6, s[24:27], s32 offen sc1
    s_waitcnt vmcnt(0)
    s_branch L_gpoll
L_gok:
    v_add_f32 v140, v140, v144
    v_add_f32 v148, v148, v152
    v_add_f32 v142, v142, v146
    v_add_f32 v150, v150, v154
    v_add_f32 v140, v140, v148
    v_add_f32 v141, v142, v150
    ds_write_b64 v4, v[140:141]
    ds_read_b128 v[172:175], v5 offset:256
    ds_read_b128 v[188:191], v5 offset:0
    ds_read_b128 v[176:179], v5 offset:272
    ds_read_b128 v[192:195], v5 offset:16
    ds_read_b128 v[180:183], v5 offset:384
    ds_read_b128 v[196:199], v5 offset:128
    ds_read_b128 v[184:187], v5 offset:400
    ds_read_b128 v[200:203], v5 offset:144
    v_add_f32 v156, v156, v160
    v_add_f32 v158, v158, v162
    s_nop 1
    v_permlane32_swap_b32 v156, v158
    v_add_f32 v156, v156, v158
    v_mov_b32 v158, v156
    s_nop 1
    v_permlane16_swap_b32 v156, v158
    v_add_f32 v156, v156, v158
    v_mul_f32 v156, 0x3b000000, v156
    v_mov_b32 v158, v156
    s_nop 1
    v_permlane32_swap_b32 v156, v158
    v_fma_f32 v158, -v156, v156, v158
    v_max_f32 v158, 0, v158
    v_add_f32 v158, 0x3727c5ac, v158
    v_rsq_f32 v160, v158
    s_nop 0
    v_mul_f32 v158, -v156, v160
    v_mov_b32 v156, v160
    v_pk_fma_f32 v[112:113], v[112:113], v[156:157], v[158:159] op_sel_hi:[1,0,0]
    v_pk_fma_f32 v[114:115], v[114:115], v[156:157], v[158:159] op_sel_hi:[1,0,0]
    v_pk_fma_f32 v[116:117], v[116:117], v[156:157], v[158:159] op_sel_hi:[1,0,0]
    v_pk_fma_f32 v[118:119], v[118:119], v[156:157], v[158:159] op_sel_hi:[1,0,0]
    v_pk_fma_f32 v[120:121], v[120:121], v[156:157], v[158:159] op_sel_hi:[1,0,0]
    v_pk_fma_f32 v[122:123], v[122:123], v[156:157], v[158:159] op_sel_hi:[1,0,0]
    v_pk_fma_f32 v[124:125], v[124:125], v[156:157], v[158:159] op_sel_hi:[1,0,0]
    v_pk_fma_f32 v[126:127], v[126:127], v[156:157], v[158:159] op_sel_hi:[1,0,0]
    s_lshl_b32 s29, s101, 14
    s_lshl_b32 s28, s100, 11
    s_add_u32 s29, s29, s28
    s_add_u32 s29, s29, 1048576
    s_waitcnt lgkmcnt(0)
    v_pk_fma_f32 v[112:113], v[112:113], v[172:173], v[188:189]
    v_pk_fma_f32 v[114:115], v[114:115], v[174:175], v[190:191]
    v_pk_fma_f32 v[116:117], v[116:117], v[176:177], v[192:193]
    v_pk_fma_f32 v[118:119], v[118:119], v[178:179], v[194:195]
    v_pk_fma_f32 v[120:121], v[120:121], v[180:181], v[196:197]
    v_pk_fma_f32 v[122:123], v[122:123], v[182:183], v[198:199]
    v_pk_fma_f32 v[124:125], v[124:125], v[184:185], v[200:201]
    v_pk_fma_f32 v[126:127], v[126:127], v[186:187], v[202:203]
    v_cvt_pk_bf16_f32 v104, v112, v113
    v_cvt_pk_bf16_f32 v105, v114, v115
    v_cvt_pk_bf16_f32 v106, v116, v117
    v_cvt_pk_bf16_f32 v107, v118, v119
    v_cvt_pk_bf16_f32 v108, v120, v121
    v_cvt_pk_bf16_f32 v109, v122, v123
    v_cvt_pk_bf16_f32 v110, v124, v125
    v_cvt_pk_bf16_f32 v111, v126, v127
    buffer_store_dwordx4 v[104:107], v252, s[24:27], s29 offen offset:0 sc1
    buffer_store_dwordx4 v[108:111], v252, s[24:27], s29 offen offset:1024 sc1
    s_bfe_u32 s28, s3, 0x10003
    s_lshl_b32 s28, s28, 16
    s_lshl_b32 s29, s19, 10
    s_add_u32 s28, s28, s29
    v_add_u32 v6, s28, v252
    v_xor_b32 v7, 0x10000, v6
    s_waitcnt lgkmcnt(0)
    ds_write_b128 v6, v[104:107] offset:49152
    ds_write_b128 v7, v[108:111] offset:49152
    v_mov_b32 v2, s45
    s_waitcnt lgkmcnt(0)
    s_barrier
    ds_read_b128 a[192:195], v252 offset:49152
    ds_read_b128 a[196:199], v252 offset:50176
    ds_read_b128 a[200:203], v252 offset:51200
    ds_read_b128 a[204:207], v252 offset:52224
    ds_read_b128 a[208:211], v253 offset:0
    ds_read_b128 a[212:215], v253 offset:1024
    ds_read_b128 a[216:219], v253 offset:2048
    ds_read_b128 a[220:223], v253 offset:3072
    s_add_u32 s31, s31, s96
    s_and_b32 s31, s31, 0x3fffff
    s_add_u32 m0, s17, 32768
    s_waitcnt lgkmcnt(7)
    v_mfma_f32_16x16x32_bf16 v[76:79], a[0:3], a[192:195], 0
    s_waitcnt vmcnt(6)
    ds_read_b64_tr_b16 a[64:65], v12 offset:16384
    s_waitcnt lgkmcnt(4)
    v_mfma_f32_16x16x32_bf16 v[76:79], a[32:35], a[208:211], v[76:79]
    ds_read_b64_tr_b16 a[68:69], v13 offset:16384
    s_waitcnt lgkmcnt(4)
    v_mfma_f32_16x16x32_bf16 v[80:83], a[32:35], a[212:215], 0
    buffer_load_dwordx4 v248, s[40:43], s31 offen offset:0  lds
    v_mfma_f32_16x16x32_bf16 v[80:83], a[0:3], a[196:199], v[80:83]
    ds_read_b64_tr_b16 a[72:73], v14 offset:16384
    v_mfma_f32_16x16x32_bf16 v[84:87], a[0:3], a[200:203], 0
    ds_read_b64_tr_b16 a[76:77], v15 offset:16384
    s_waitcnt lgkmcnt(5)
    v_mfma_f32_16x16x32_bf16 v[84:87], a[32:35], a[216:219], v[84:87]
    ds_read_b64_tr_b16 a[80:81], v16 offset:16384
    s_waitcnt lgkmcnt(5)
    v_mfma_f32_16x16x32_bf16 v[88:91], a[32:35], a[220:223], 0
    buffer_load_dwordx4 v249, s[40:43], s31 offen offset:1024  lds
    v_mfma_f32_16x16x32_bf16 v[88:91], a[0:3], a[204:207], v[88:91]
    ds_read_b64_tr_b16 a[84:85], v17 offset:16384
    v_mfma_f32_16x16x32_bf16 v[104:107], a[4:7], a[204:207], 0
    ds_read_b64_tr_b16 a[88:89], v18 offset:16384
    v_mfma_f32_16x16x32_bf16 v[104:107], a[36:39], a[220:223], v[104:107]
    ds_read_b64_tr_b16 a[92:93], v19 offset:16384
    v_mfma_f32_16x16x32_bf16 v[100:103], a[36:39], a[216:219], 0
    buffer_load_dwordx4 v250, s[40:43], s31 offen offset:2048  lds
    v_mfma_f32_16x16x32_bf16 v[100:103], a[4:7], a[200:203], v[100:103]
    v_mfma_f32_16x16x32_bf16 v[96:99], a[4:7], a[196:199], 0
    v_mfma_f32_16x16x32_bf16 v[96:99], a[36:39], a[212:215], v[96:99]
    v_mfma_f32_16x16x32_bf16 v[92:95], a[36:39], a[208:211], 0
    buffer_load_dwordx4 v251, s[40:43], s31 offen offset:3072  lds
    v_mfma_f32_16x16x32_bf16 v[92:95], a[4:7], a[192:195], v[92:95]
    s_add_u32 s31, s31, 32768
    s_add_u32 m0, s17, 98304
    v_mfma_f32_16x16x32_bf16 v[108:111], a[8:11], a[192:195], 0
    s_waitcnt vmcnt(6)
    ds_read_b64_tr_b16 a[66:67], v28 offset:16384
    v_mfma_f32_16x16x32_bf16 v[108:111], a[40:43], a[208:211], v[108:111]
    ds_read_b64_tr_b16 a[70:71], v29 offset:16384
    v_mfma_f32_16x16x32_bf16 v[112:115], a[40:43], a[212:215], 0
    buffer_load_dwordx4 v248, s[40:43], s31 offen offset:0  lds
    v_mfma_f32_16x16x32_bf16 v[112:115], a[8:11], a[196:199], v[112:115]
    ds_read_b64_tr_b16 a[74:75], v30 offset:16384
    v_mfma_f32_16x16x32_bf16 v[116:119], a[8:11], a[200:203], 0
    ds_read_b64_tr_b16 a[78:79], v31 offset:16384
    v_mfma_f32_16x16x32_bf16 v[116:119], a[40:43], a[216:219], v[116:119]
    ds_read_b64_tr_b16 a[82:83], v32 offset:16384
    v_mfma_f32_16x16x32_bf16 v[120:123], a[40:43], a[220:223], 0
    buffer_load_dwordx4 v249, s[40:43], s31 offen offset:1024  lds
    v_mfma_f32_16x16x32_bf16 v[120:123], a[8:11], a[204:207], v[120:123]
    ds_read_b64_tr_b16 a[86:87], v33 offset:16384
    v_mfma_f32_16x16x32_bf16 v[136:139], a[12:15], a[204:207], 0
    ds_read_b64_tr_b16 a[90:91], v34 offset:16384
    v_mfma_f32_16x16x32_bf16 v[136:139], a[44:47], a[220:223], v[136:139]
    ds_read_b64_tr_b16 a[94:95], v35 offset:16384
    v_mfma_f32_16x16x32_bf16 v[132:135], a[44:47], a[216:219], 0
    buffer_load_dwordx4 v250, s[40:43], s31 offen offset:2048  lds
    v_mfma_f32_16x16x32_bf16 v[132:135], a[12:15], a[200:203], v[132:135]
    v_mfma_f32_16x16x32_bf16 v[128:131], a[12:15], a[196:199], 0
    v_mfma_f32_16x16x32_bf16 v[128:131], a[44:47], a[212:215], v[128:131]
    s_waitcnt vmcnt(7)
    s_barrier
    s_cmp_lg_u32 s19, 0
    s_cbranch_scc1 L_nfh
    buffer_store_dword v2, v243, s[24:27], s36 offen offset:16 sc1
L_nfh:
    v_mfma_f32_16x16x32_bf16 v[124:127], a[44:47], a[208:211], 0
    buffer_load_dwordx4 v251, s[40:43], s31 offen offset:3072  lds
    v_mfma_f32_16x16x32_bf16 v[124:127], a[12:15], a[192:195], v[124:127]
    s_add_u32 s31, s31, s97
    s_and_b32 s31, s31, 0x3fffff
    s_add_u32 m0, s17, 0
    v_mfma_f32_16x16x32_bf16 v[140:143], a[16:19], a[192:195], 0
    v_mfma_f32_16x16x32_bf16 v[140:143], a[48:51], a[208:211], v[140:143]
    v_mfma_f32_16x16x32_bf16 v[144:147], a[48:51], a[212:215], 0
    buffer_load_dwordx4 v248, s[40:43], s31 offen offset:0  lds
    v_mfma_f32_16x16x32_bf16 v[144:147], a[16:19], a[196:199], v[144:147]
    v_mfma_f32_16x16x32_bf16 v[148:151], a[16:19], a[200:203], 0
    v_mfma_f32_16x16x32_bf16 v[148:151], a[48:51], a[216:219], v[148:151]
    v_mfma_f32_16x16x32_bf16 v[152:155], a[48:51], a[220:223], 0
    buffer_load_dwordx4 v249, s[40:43], s31 offen offset:1024  lds
    v_mfma_f32_16x16x32_bf16 v[152:155], a[16:19], a[204:207], v[152:155]
    v_mfma_f32_16x16x32_bf16 v[168:171], a[20:23], a[204:207], 0
    v_mfma_f32_16x16x32_bf16 v[168:171], a[52:55], a[220:223], v[168:171]
    v_mfma_f32_16x16x32_bf16 v[164:167], a[52:55], a[216:219], 0
    buffer_load_dwordx4 v250, s[40:43], s31 offen offset:2048  lds
    v_mfma_f32_16x16x32_bf16 v[164:167], a[20:23], a[200:203], v[164:167]
    v_mfma_f32_16x16x32_bf16 v[160:163], a[20:23], a[196:199], 0
    v_mfma_f32_16x16x32_bf16 v[160:163], a[52:55], a[212:215], v[160:163]
    v_mfma_f32_16x16x32_bf16 v[156:159], a[52:55], a[208:211], 0
    buffer_load_dwordx4 v251, s[40:43], s31 offen offset:3072  lds
    v_mfma_f32_16x16x32_bf16 v[156:159], a[20:23], a[192:195], v[156:159]
    s_add_u32 s31, s31, 32768
    s_add_u32 m0, s17, 65536
    v_mfma_f32_16x16x32_bf16 v[172:175], a[24:27], a[192:195], 0
    v_mfma_f32_16x16x32_bf16 v[172:175], a[56:59], a[208:211], v[172:175]
    v_mfma_f32_16x16x32_bf16 v[176:179], a[56:59], a[212:215], 0
    buffer_load_dwordx4 v248, s[40:43], s31 offen offset:0  lds
    v_mfma_f32_16x16x32_bf16 v[176:179], a[24:27], a[196:199], v[176:179]
    v_mfma_f32_16x16x32_bf16 v[180:183], a[24:27], a[200:203], 0
    v_mfma_f32_16x16x32_bf16 v[180:183], a[56:59], a[216:219], v[180:183]
    v_mfma_f32_16x16x32_bf16 v[184:187], a[56:59], a[220:223], 0
    buffer_load_dwordx4 v249, s[40:43], s31 offen offset:1024  lds
    v_mfma_f32_16x16x32_bf16 v[184:187], a[24:27], a[204:207], v[184:187]
    v_mfma_f32_16x16x32_bf16 v[200:203], a[28:31], a[204:207], 0
    v_mfma_f32_16x16x32_bf16 v[200:203], a[60:63], a[220:223], v[200:203]
    v_mfma_f32_16x16x32_bf16 v[196:199], a[60:63], a[216:219], 0
    buffer_load_dwordx4 v250, s[40:43], s31 offen offset:2048  lds
    v_mfma_f32_16x16x32_bf16 v[196:199], a[28:31], a[200:203], v[196:199]
    v_mfma_f32_16x16x32_bf16 v[192:195], a[28:31], a[196:199], 0
    v_mfma_f32_16x16x32_bf16 v[192:195], a[60:63], a[212:215], v[192:195]
    v_mfma_f32_16x16x32_bf16 v[188:191], a[60:63], a[208:211], 0
    buffer_load_dwordx4 v251, s[40:43], s31 offen offset:3072  lds
    v_mfma_f32_16x16x32_bf16 v[188:191], a[28:31], a[192:195], v[188:191]
    s_waitcnt vmcnt(12)
    ds_read_b64_tr_b16 a[96:97], v12 offset:32768
    ds_read_b64_tr_b16 a[100:101], v13 offset:32768
    ds_read_b64_tr_b16 a[104:105], v14 offset:32768
    ds_read_b64_tr_b16 a[108:109], v15 offset:32768
    ds_read_b64_tr_b16 a[112:113], v16 offset:32768
    ds_read_b64_tr_b16 a[116:117], v17 offset:32768
    ds_read_b64_tr_b16 a[120:121], v18 offset:32768
    ds_read_b64_tr_b16 a[124:125], v19 offset:32768
    s_waitcnt lgkmcnt(15)
    s_add_u32 s31, s31, s96
    s_and_b32 s31, s31, 0x3fffff
    s_add_u32 m0, s17, 16384
    s_nop 0
    buffer_load_dwordx4 v248, s[40:43], s31 offen offset:0  lds
    buffer_load_dwordx4 v249, s[40:43], s31 offen offset:1024  lds
    buffer_load_dwordx4 v250, s[40:43], s31 offen offset:2048  lds
    buffer_load_dwordx4 v251, s[40:43], s31 offen offset:3072  lds
    s_waitcnt vmcnt(12)
    ds_read_b64_tr_b16 a[98:99], v28 offset:32768
    ds_read_b64_tr_b16 a[102:103], v29 offset:32768
    ds_read_b64_tr_b16 a[106:107], v30 offset:32768
    ds_read_b64_tr_b16 a[110:111], v31 offset:32768
    ds_read_b64_tr_b16 a[114:115], v32 offset:32768
    ds_read_b64_tr_b16 a[118:119], v33 offset:32768
    ds_read_b64_tr_b16 a[122:123], v34 offset:32768
    ds_read_b64_tr_b16 a[126:127], v35 offset:32768
    s_waitcnt lgkmcnt(15)
    s_add_u32 s31, s31, 32768
    s_add_u32 m0, s17, 81920
    s_nop 0
    buffer_load_dwordx4 v248, s[40:43], s31 offen offset:0  lds
    buffer_load_dwordx4 v249, s[40:43], s31 offen offset:1024  lds
    buffer_load_dwordx4 v250, s[40:43], s31 offen offset:2048  lds
    buffer_load_dwordx4 v251, s[40:43], s31 offen offset:3072  lds
    s_waitcnt lgkmcnt(0)
    s_cmp_lg_u32 s19, 0
    s_cbranch_scc1 L_pfh
    s_load_dword s81, s[90:91], 144 glc
    s_load_dword s82, s[90:91], 272 glc
    s_load_dword s83, s[90:91], 400 glc
    s_load_dword s84, s[90:91], 528 glc
    s_load_dword s85, s[90:91], 656 glc
    s_load_dword s86, s[90:91], 784 glc
    s_load_dword s87, s[90:91], 912 glc
L_pfh:
    s_add_u32 s31, s31, s97
    s_and_b32 s31, s31, 0x3fffff
    s_add_u32 m0, s17, 32768
    s_nop 0
    buffer_load_dwordx4 v248, s[40:43], s31 offen offset:0  lds
    buffer_load_dwordx4 v249, s[40:43], s31 offen offset:1024  lds
    buffer_load_dwordx4 v250, s[40:43], s31 offen offset:2048  lds
    buffer_load_dwordx4 v251, s[40:43], s31 offen offset:3072  lds
    s_add_u32 s31, s31, 32768
    s_add_u32 m0, s17, 98304
    s_nop 0
    buffer_load_dwordx4 v248, s[40:43], s31 offen offset:0  lds
    buffer_load_dwordx4 v249, s[40:43], s31 offen offset:1024  lds
    buffer_load_dwordx4 v250, s[40:43], s31 offen offset:2048  lds
    buffer_load_dwordx4 v251, s[40:43], s31 offen offset:3072  lds
    s_waitcnt lgkmcnt(0)
    s_cmp_lg_u32 s19, 0
    s_cbranch_scc1 L_pouth
    s_mov_b32 s28, 0
    s_branch L_pch
L_pollh:
    s_load_dword s81, s[90:91], 144 glc
    s_load_dword s82, s[90:91], 272 glc
    s_load_dword s83, s[90:91], 400 glc
    s_load_dword s84, s[90:91], 528 glc
    s_load_dword s85, s[90:91], 656 glc
    s_load_dword s86, s[90:91], 784 glc
    s_load_dword s87, s[90:91], 912 glc
L_pch:
L_pg0:
    s_cbranch_execz L_pg4
    s_add_u32 s28, s28, 1
    s_cmp_gt_u32 s28, 0x80000
    s_waitcnt lgkmcnt(0)
    s_cbranch_scc1 L_pouth
    s_cmp_lg_u32 s81, s45
    s_cbranch_scc1 L_pollh
    s_cmp_lg_u32 s82, s45
    s_cbranch_scc1 L_pollh
    s_cmp_lg_u32 s83, s45
    s_cbranch_scc1 L_pollh
    s_cmp_lg_u32 s84, s45
    s_cbranch_scc1 L_pollh
    s_cmp_lg_u32 s85, s45
    s_cbranch_scc1 L_pollh
    s_cmp_lg_u32 s86, s45
    s_cbranch_scc1 L_pollh
    s_cmp_lg_u32 s87, s45
    s_cbranch_scc1 L_pollh
L_pouth:
    s_barrier
    s_lshr_b32 s29, s22, 1
    s_xor_b32 s29, s29, s19
    s_lshl_b32 s101, s3, 2
    s_add_u32 s101, s101, s29
    s_lshl_b32 s101, s101, 14
    s_add_u32 s101, s101, 1047552
    s_lshl_b32 s37, s19, 10
    s_add_u32 s99, s101, 1024
    s_add_u32 s98, s3, 15
    s_lshl_b32 s98, s98, 10
    s_bfe_u32 s29, s3, 0x10003
    s_lshl_b32 s29, s29, 10
    s_add_u32 s99, s99, s29
    s_and_b32 s98, s100, 7
    s_lshl_b32 s98, s98, 11
    s_add_u32 s98, s98, 1024
    s_add_u32 s98, s98, 1024
    s_and_b32 s98, s98, 0x3fff
    s_xor_b32 s101, s99, s98
    s_add_u32 m0, s37, 131072
    s_nop 0
    buffer_load_dwordx4 v252, s[24:27], s101 offen sc1 lds
    s_add_u32 s98, s98, 1024
    s_and_b32 s98, s98, 0x3fff
    s_xor_b32 s101, s99, s98
    s_add_u32 m0, s37, 135168
    s_nop 0
    buffer_load_dwordx4 v252, s[24:27], s101 offen sc1 lds
    s_add_u32 s98, s98, 1024
    s_and_b32 s98, s98, 0x3fff
    s_xor_b32 s101, s99, s98
    s_add_u32 m0, s37, 53248
    s_nop 0
    buffer_load_dwordx4 v252, s[24:27], s101 offen sc1 lds
    s_add_u32 s98, s98, 1024
    s_and_b32 s98, s98, 0x3fff
    s_xor_b32 s101, s99, s98
    s_add_u32 m0, s37, 118784
    s_nop 0
    buffer_load_dwordx4 v252, s[24:27], s101 offen sc1 lds
    s_add_u32 s98, s98, 1024
    s_and_b32 s98, s98, 0x3fff
    s_xor_b32 s101, s99, s98
    s_add_u32 m0, s37, 139264
    s_nop 0
    buffer_load_dwordx4 v252, s[24:27], s101 offen sc1 lds
    s_add_u32 s98, s98, 1024
    s_and_b32 s98, s98, 0x3fff
    s_xor_b32 s101, s99, s98
    s_add_u32 m0, s37, 143360
    s_nop 0
    buffer_load_dwordx4 v252, s[24:27], s101 offen sc1 lds
    s_add_u32 s98, s98, 1024
    s_and_b32 s98, s98, 0x3fff
    s_xor_b32 s101, s99, s98
    s_add_u32 m0, s37, 57344
    s_nop 0
    buffer_load_dwordx4 v252, s[24:27], s101 offen sc1 lds
    s_add_u32 s98, s98, 1024
    s_and_b32 s98, s98, 0x3fff
    s_xor_b32 s101, s99, s98
    s_add_u32 m0, s37, 122880
    s_nop 0
    buffer_load_dwordx4 v252, s[24:27], s101 offen sc1 lds
    s_waitcnt vmcnt(4)
    s_barrier
    ds_read_b128 a[224:227], v253 offset:16384
    ds_read_b128 a[228:231], v253 offset:17408
    ds_read_b128 a[232:235], v253 offset:18432
    ds_read_b128 a[236:239], v253 offset:19456
    ds_read_b128 a[240:243], v253 offset:20480
    ds_read_b128 a[244:247], v253 offset:21504
    ds_read_b128 a[248:251], v253 offset:22528
    ds_read_b128 a[252:255], v253 offset:23552
    s_add_u32 s98, s98, 1024
    s_and_b32 s98, s98, 0x3fff
    s_xor_b32 s101, s99, s98
    s_add_u32 m0, s37, 147456
    s_waitcnt lgkmcnt(7)
    v_mfma_f32_16x16x32_bf16 v[76:79], a[64:67], a[224:227], v[76:79]
    ds_read_b128 a[192:195], v252 offset:53248
    s_lshl_b32 s82, s3, 2
    s_waitcnt lgkmcnt(4)
    v_mfma_f32_16x16x32_bf16 v[76:79], a[96:99], a[240:243], v[76:79]
    ds_read_b128 a[196:199], v252 offset:54272
    s_add_u32 s82, s82, s19
    s_waitcnt lgkmcnt(4)
    v_mfma_f32_16x16x32_bf16 v[80:83], a[96:99], a[244:247], v[80:83]
    buffer_load_dwordx4 v252, s[24:27], s101 offen sc1 lds
    v_mfma_f32_16x16x32_bf16 v[80:83], a[64:67], a[228:231], v[80:83]
    ds_read_b64_tr_b16 a[128:129], v12 offset:0
    s_lshl_b32 s80, s19, 13
    v_mfma_f32_16x16x32_bf16 v[84:87], a[64:67], a[232:235], v[84:87]
    ds_read_b64_tr_b16 a[132:133], v13 offset:0
    s_add_u32 s80, s80, 131072
    s_waitcnt lgkmcnt(5)
    v_mfma_f32_16x16x32_bf16 v[84:87], a[96:99], a[248:251], v[84:87]
    s_add_u32 s98, s98, 1024
    s_and_b32 s98, s98, 0x3fff
    s_xor_b32 s101, s99, s98
    s_add_u32 m0, s37, 151552
    ds_read_b64_tr_b16 a[136:137], v14 offset:0
    s_waitcnt lgkmcnt(5)
    v_mfma_f32_16x16x32_bf16 v[88:91], a[96:99], a[252:255], v[88:91]
    buffer_load_dwordx4 v252, s[24:27], s101 offen sc1 lds
    v_mfma_f32_16x16x32_bf16 v[88:91], a[64:67], a[236:239], v[88:91]
    ds_read_b64_tr_b16 a[140:141], v15 offset:0
    s_lshr_b32 s28, s20, 4
    v_mfma_f32_16x16x32_bf16 v[104:107], a[68:71], a[236:239], v[104:107]
    ds_read_b64_tr_b16 a[144:145], v16 offset:0
    s_lshl_b32 s28, s28, 3
    v_mfma_f32_16x16x32_bf16 v[104:107], a[100:103], a[252:255], v[104:107]
    s_add_u32 s98, s98, 1024
    s_and_b32 s98, s98, 0x3fff
    s_xor_b32 s101, s99, s98
    s_add_u32 m0, s37, 61440
    ds_read_b64_tr_b16 a[148:149], v17 offset:0
    v_mfma_f32_16x16x32_bf16 v[100:103], a[100:103], a[248:251], v[100:103]
    buffer_load_dwordx4 v252, s[24:27], s101 offen sc1 lds
    v_mfma_f32_16x16x32_bf16 v[100:103], a[68:71], a[232:235], v[100:103]
    ds_read_b64_tr_b16 a[152:153], v18 offset:0
    s_and_b32 s29, s20, 7
    v_mfma_f32_16x16x32_bf16 v[96:99], a[68:71], a[228:231], v[96:99]
    ds_read_b64_tr_b16 a[156:157], v19 offset:0
    s_add_u32 s28, s28, s29
    v_mfma_f32_16x16x32_bf16 v[96:99], a[100:103], a[244:247], v[96:99]
    s_add_u32 s98, s98, 1024
    s_and_b32 s98, s98, 0x3fff
    s_xor_b32 s101, s99, s98
    s_add_u32 m0, s37, 126976
    v_mfma_f32_16x16x32_bf16 v[92:95], a[100:103], a[240:243], v[92:95]
    buffer_load_dwordx4 v252, s[24:27], s101 offen sc1 lds
    v_mfma_f32_16x16x32_bf16 v[92:95], a[68:71], a[224:227], v[92:95]
    s_add_u32 s98, s98, 1024
    s_and_b32 s98, s98, 0x3fff
    s_xor_b32 s101, s99, s98
    s_add_u32 m0, s37, 155648
    v_mfma_f32_16x16x32_bf16 v[108:111], a[72:75], a[224:227], v[108:111]
    ds_read_b128 a[200:203], v252 offset:55296
    s_and_b32 s34, s28, 31
    v_mfma_f32_16x16x32_bf16 v[108:111], a[104:107], a[240:243], v[108:111]
    ds_read_b128 a[204:207], v252 offset:56320
    s_lshr_b32 s35, s28, 5
    v_mfma_f32_16x16x32_bf16 v[112:115], a[104:107], a[244:247], v[112:115]
    buffer_load_dwordx4 v252, s[24:27], s101 offen sc1 lds
    v_mfma_f32_16x16x32_bf16 v[112:115], a[72:75], a[228:231], v[112:115]
    ds_read_b64_tr_b16 a[130:131], v28 offset:0
    s_bfe_u32 s29, s20, 0x10003
    v_mfma_f32_16x16x32_bf16 v[116:119], a[72:75], a[232:235], v[116:119]
    ds_read_b64_tr_b16 a[134:135], v29 offset:0
    s_lshl_b32 s34, s34, 1
    v_mfma_f32_16x16x32_bf16 v[116:119], a[104:107], a[248:251], v[116:119]
    s_add_u32 s98, s98, 1024
    s_and_b32 s98, s98, 0x3fff
    s_xor_b32 s101, s99, s98
    s_add_u32 m0, s37, 159744
    ds_read_b64_tr_b16 a[138:139], v30 offset:0
    v_mfma_f32_16x16x32_bf16 v[120:123], a[104:107], a[252:255], v[120:123]
    buffer_load_dwordx4 v252, s[24:27], s101 offen sc1 lds
    v_mfma_f32_16x16x32_bf16 v[120:123], a[72:75], a[236:239], v[120:123]
    ds_read_b64_tr_b16 a[142:143], v31 offset:0
    s_add_u32 s34, s34, s29
    v_mfma_f32_16x16x32_bf16 v[136:139], a[76:79], a[236:239], v[136:139]
    ds_read_b64_tr_b16 a[146:147], v32 offset:0
    s_mul_i32 s32, s35, 786432
    v_mfma_f32_16x16x32_bf16 v[136:139], a[108:111], a[252:255], v[136:139]
    ds_read_b64_tr_b16 a[150:151], v33 offset:0
    s_lshl_b32 s28, s34, 6
    v_mfma_f32_16x16x32_bf16 v[132:135], a[108:111], a[248:251], v[132:135]
    s_add_u32 s32, s32, s28
    s_add_u32 s32, s32, 2048
    s_lshl_b32 s33, s35, 8
    v_mfma_f32_16x16x32_bf16 v[132:135], a[76:79], a[232:235], v[132:135]
    ds_read_b64_tr_b16 a[154:155], v34 offset:0
    s_mov_b32 s6, 3145728
    v_mfma_f32_16x16x32_bf16 v[128:131], a[76:79], a[228:231], v[128:131]
    ds_read_b64_tr_b16 a[158:159], v35 offset:0
    s_mov_b32 s7, 0x20000
    v_mfma_f32_16x16x32_bf16 v[128:131], a[108:111], a[244:247], v[128:131]
    s_add_u32 s18, s32, 6144
    s_lshr_b32 s29, s34, 4
    v_mfma_f32_16x16x32_bf16 v[124:127], a[108:111], a[240:243], v[124:127]
    s_cmp_eq_u32 s29, 2
    s_cselect_b32 s28, 1.0, 0
    v_mfma_f32_16x16x32_bf16 v[124:127], a[76:79], a[224:227], v[124:127]
    s_add_u32 s31, s31, s96
    s_and_b32 s31, s31, 0x3fffff
    s_add_u32 m0, s17, 0
    v_mfma_f32_16x16x32_bf16 v[140:143], a[80:83], a[224:227], v[140:143]
    ds_read_b128 a[208:211], v253 offset:4096
    v_mfma_f32_16x16x32_bf16 v[140:143], a[112:115], a[240:243], v[140:143]
    s_waitcnt lgkmcnt(11)
    ds_read_b128 a[212:215], v253 offset:5120
    v_mfma_f32_16x16x32_bf16 v[144:147], a[112:115], a[244:247], v[144:147]
    buffer_load_dwordx4 v248, s[40:43], s31 offen offset:0  lds
    v_mfma_f32_16x16x32_bf16 v[144:147], a[80:83], a[228:231], v[144:147]
    ds_read_b64_tr_b16 a[160:161], v12 offset:16384
    v_mfma_f32_16x16x32_bf16 v[148:151], a[80:83], a[232:235], v[148:151]
    ds_read_b64_tr_b16 a[164:165], v13 offset:16384
    v_mfma_f32_16x16x32_bf16 v[148:151], a[112:115], a[248:251], v[148:151]
    ds_read_b64_tr_b16 a[168:169], v14 offset:16384
    v_mfma_f32_16x16x32_bf16 v[152:155], a[112:115], a[252:255], v[152:155]
    buffer_load_dwordx4 v249, s[40:43], s31 offen offset:1024  lds
    v_mfma_f32_16x16x32_bf16 v[152:155], a[80:83], a[236:239], v[152:155]
    ds_read_b64_tr_b16 a[172:173], v15 offset:16384
    v_mfma_f32_16x16x32_bf16 v[168:171], a[84:87], a[236:239], v[168:171]
    ds_read_b64_tr_b16 a[176:177], v16 offset:16384
    v_mfma_f32_16x16x32_bf16 v[168:171], a[116:119], a[252:255], v[168:171]
    ds_read_b64_tr_b16 a[180:181], v17 offset:16384
    v_mfma_f32_16x16x32_bf16 v[164:167], a[116:119], a[248:251], v[164:167]
    buffer_load_dwordx4 v250, s[40:43], s31 offen offset:2048  lds
    v_mfma_f32_16x16x32_bf16 v[164:167], a[84:87], a[232:235], v[164:167]
    ds_read_b64_tr_b16 a[184:185], v18 offset:16384
    v_mfma_f32_16x16x32_bf16 v[160:163], a[84:87], a[228:231], v[160:163]
    ds_read_b64_tr_b16 a[188:189], v19 offset:16384
    v_mfma_f32_16x16x32_bf16 v[160:163], a[116:119], a[244:247], v[160:163]
    s_cmp_eq_u32 s35, 0
    s_cselect_b32 s28, s28, 0
    s_lshl_b32 s34, s34, 7
    v_mfma_f32_16x16x32_bf16 v[156:159], a[116:119], a[240:243], v[156:159]
    buffer_load_dwordx4 v251, s[40:43], s31 offen offset:3072  lds
    v_mfma_f32_16x16x32_bf16 v[156:159], a[84:87], a[224:227], v[156:159]
    s_add_u32 s31, s31, 32768
    s_add_u32 m0, s17, 65536
    s_lshl_b32 s35, s35, 13
    v_mfma_f32_16x16x32_bf16 v[172:175], a[88:91], a[224:227], v[172:175]
    ds_read_b128 a[216:219], v253 offset:6144
    s_add_u32 s34, s34, s35
    v_mfma_f32_16x16x32_bf16 v[172:175], a[120:123], a[240:243], v[172:175]
    s_waitcnt lgkmcnt(11)
    ds_read_b128 a[220:223], v253 offset:7168
    v_mfma_f32_16x16x32_bf16 v[176:179], a[120:123], a[244:247], v[176:179]
    buffer_load_dwordx4 v248, s[40:43], s31 offen offset:0  lds
    v_mfma_f32_16x16x32_bf16 v[176:179], a[88:91], a[228:231], v[176:179]
    ds_read_b64_tr_b16 a[162:163], v28 offset:16384
    s_add_u32 s34, s34, 557056
    v_mfma_f32_16x16x32_bf16 v[180:183], a[88:91], a[232:235], v[180:183]
    ds_read_b64_tr_b16 a[166:167], v29 offset:16384
    s_mov_b32 s35, s28
    v_mfma_f32_16x16x32_bf16 v[180:183], a[120:123], a[248:251], v[180:183]
    ds_read_b64_tr_b16 a[170:171], v30 offset:16384
    v_mfma_f32_16x16x32_bf16 v[184:187], a[120:123], a[252:255], v[184:187]
    buffer_load_dwordx4 v249, s[40:43], s31 offen offset:1024  lds
    v_mfma_f32_16x16x32_bf16 v[184:187], a[88:91], a[236:239], v[184:187]
    ds_read_b64_tr_b16 a[174:175], v31 offset:16384
    v_mfma_f32_16x16x32_bf16 v[200:203], a[92:95], a[236:239], v[200:203]
    ds_read_b64_tr_b16 a[178:179], v32 offset:16384
    v_mfma_f32_16x16x32_bf16 v[200:203], a[124:127], a[252:255], v[200:203]
    ds_read_b64_tr_b16 a[182:183], v33 offset:16384
    v_mfma_f32_16x16x32_bf16 v[196:199], a[124:127], a[248:251], v[196:199]
    buffer_load_dwordx4 v250, s[40:43], s31 offen offset:2048  lds
    v_mfma_f32_16x16x32_bf16 v[196:199], a[92:95], a[232:235], v[196:199]
    ds_read_b64_tr_b16 a[186:187], v34 offset:16384
    v_mfma_f32_16x16x32_bf16 v[192:195], a[92:95], a[228:231], v[192:195]
    ds_read_b64_tr_b16 a[190:191], v35 offset:16384
    v_mfma_f32_16x16x32_bf16 v[192:195], a[124:127], a[244:247], v[192:195]
    s_cmp_eq_u32 s19, 0
    s_cselect_b32 s34, s34, 2147483648
    s_lshr_b32 s28, s82, 3
    v_mfma_f32_16x16x32_bf16 v[188:191], a[124:127], a[240:243], v[188:191]
    buffer_load_dwordx4 v251, s[40:43], s31 offen offset:3072  lds
    v_mfma_f32_16x16x32_bf16 v[188:191], a[92:95], a[224:227], v[188:191]
    s_add_u32 s31, s31, s97
    s_and_b32 s31, s31, 0x3fffff
    s_add_u32 m0, s17, 16384
    v_mfma_f32_16x16x32_bf16 v[76:79], a[128:131], a[192:195], v[76:79]
    s_waitcnt vmcnt(14)
    s_barrier
    ds_read_b128 a[224:227], v253 offset:24576
    s_waitcnt lgkmcnt(8)
    v_mfma_f32_16x16x32_bf16 v[76:79], a[160:163], a[208:211], v[76:79]
    ds_read_b128 a[228:231], v253 offset:25600
    v_and_b32 v2, 15, v0
    v_mfma_f32_16x16x32_bf16 v[80:83], a[160:163], a[212:215], v[80:83]
    buffer_load_dwordx4 v248, s[40:43], s31 offen offset:0  lds
    v_mfma_f32_16x16x32_bf16 v[80:83], a[128:131], a[196:199], v[80:83]
    ds_read_b64_tr_b16 a[0:1], v12 offset:32768
    v_lshrrev_b32 v3, 4, v0
    v_mfma_f32_16x16x32_bf16 v[84:87], a[128:131], a[200:203], v[84:87]
    ds_read_b64_tr_b16 a[4:5], v13 offset:32768
    v_lshl_add_u32 v4, v1, 4, v3
    v_mfma_f32_16x16x32_bf16 v[84:87], a[160:163], a[216:219], v[84:87]
    ds_read_b64_tr_b16 a[8:9], v14 offset:32768
    v_lshlrev_b32 v4, 8, v4
    v_mfma_f32_16x16x32_bf16 v[88:91], a[160:163], a[220:223], v[88:91]
    buffer_load_dwordx4 v249, s[40:43], s31 offen offset:1024  lds
    v_mfma_f32_16x16x32_bf16 v[88:91], a[128:131], a[204:207], v[88:91]
    ds_read_b64_tr_b16 a[12:13], v15 offset:32768
    v_xor_b32 v5, v2, v3
    v_mfma_f32_16x16x32_bf16 v[104:107], a[132:135], a[204:207], v[104:107]
    ds_read_b64_tr_b16 a[16:17], v16 offset:32768
    v_lshl_add_u32 v216, v5, 4, v4
    s_waitcnt lgkmcnt(13)
    v_mfma_f32_16x16x32_bf16 v[104:107], a[164:167], a[220:223], v[104:107]
    ds_read_b64_tr_b16 a[20:21], v17 offset:32768
    v_xor_b32 v217, 64, v216
    v_mfma_f32_16x16x32_bf16 v[100:103], a[164:167], a[216:219], v[100:103]
    buffer_load_dwordx4 v250, s[40:43], s31 offen offset:2048  lds
    v_mfma_f32_16x16x32_bf16 v[100:103], a[132:135], a[200:203], v[100:103]
    ds_read_b64_tr_b16 a[24:25], v18 offset:32768
    v_xor_b32 v218, 128, v216
    v_mfma_f32_16x16x32_bf16 v[96:99], a[132:135], a[196:199], v[96:99]
    ds_read_b64_tr_b16 a[28:29], v19 offset:32768
    v_xor_b32 v219, 192, v216
    v_mfma_f32_16x16x32_bf16 v[96:99], a[164:167], a[212:215], v[96:99]
    s_lshl_b32 s28, s28, 15
    v_lshlrev_b32 v5, 1, v3
    v_xor_b32 v5, v2, v5
    v_mfma_f32_16x16x32_bf16 v[92:95], a[164:167], a[208:211], v[92:95]
    buffer_load_dwordx4 v251, s[40:43], s31 offen offset:3072  lds
    v_mfma_f32_16x16x32_bf16 v[92:95], a[132:135], a[192:195], v[92:95]
    s_add_u32 s31, s31, 32768
    s_add_u32 m0, s17, 81920
    v_lshl_add_u32 v220, v5, 4, v4
    v_mfma_f32_16x16x32_bf16 v[108:111], a[136:139], a[192:195], v[108:111]
    ds_read_b128 a[232:235], v253 offset:26624
    v_xor_b32 v221, 128, v220
    s_waitcnt lgkmcnt(15)
    v_mfma_f32_16x16x32_bf16 v[108:111], a[168:171], a[208:211], v[108:111]
    s_waitcnt lgkmcnt(11)
    ds_read_b128 a[236:239], v253 offset:27648
    v_mfma_f32_16x16x32_bf16 v[112:115], a[168:171], a[212:215], v[112:115]
    buffer_load_dwordx4 v248, s[40:43], s31 offen offset:0  lds
    v_mfma_f32_16x16x32_bf16 v[112:115], a[136:139], a[196:199], v[112:115]
    ds_read_b64_tr_b16 a[2:3], v28 offset:32768
    v_mov_b32 v222, v220
    v_mfma_f32_16x16x32_bf16 v[116:119], a[136:139], a[200:203], v[116:119]
    ds_read_b64_tr_b16 a[6:7], v29 offset:32768
    v_mov_b32 v223, v221
    v_mfma_f32_16x16x32_bf16 v[116:119], a[168:171], a[216:219], v[116:119]
    ds_read_b64_tr_b16 a[10:11], v30 offset:32768
    v_and_b32 v2, 15, v0
    v_mfma_f32_16x16x32_bf16 v[120:123], a[168:171], a[220:223], v[120:123]
    buffer_load_dwordx4 v249, s[40:43], s31 offen offset:1024  lds
    v_mfma_f32_16x16x32_bf16 v[120:123], a[136:139], a[204:207], v[120:123]
    ds_read_b64_tr_b16 a[14:15], v31 offset:32768
    v_lshrrev_b32 v3, 4, v0
    v_mfma_f32_16x16x32_bf16 v[136:139], a[140:143], a[204:207], v[136:139]
    ds_read_b64_tr_b16 a[18:19], v32 offset:32768
    v_xor_b32 v4, v3, v2
    v_mfma_f32_16x16x32_bf16 v[136:139], a[172:175], a[220:223], v[136:139]
    ds_read_b64_tr_b16 a[22:23], v33 offset:32768
    v_lshlrev_b32 v4, 4, v4
    v_mfma_f32_16x16x32_bf16 v[132:135], a[172:175], a[216:219], v[132:135]
    buffer_load_dwordx4 v250, s[40:43], s31 offen offset:2048  lds
    v_mfma_f32_16x16x32_bf16 v[132:135], a[140:143], a[200:203], v[132:135]
    ds_read_b64_tr_b16 a[26:27], v34 offset:32768
    v_lshl_add_u32 v204, v2, 8, v4
    v_mfma_f32_16x16x32_bf16 v[128:131], a[140:143], a[196:199], v[128:131]
    ds_read_b64_tr_b16 a[30:31], v35 offset:32768
    v_xor_b32 v205, 64, v204
    v_mfma_f32_16x16x32_bf16 v[128:131], a[172:175], a[212:215], v[128:131]
    s_and_b32 s29, s82, 7
    v_xor_b32 v206, 128, v204
    v_xor_b32 v207, 192, v204
    v_mfma_f32_16x16x32_bf16 v[124:127], a[172:175], a[208:211], v[124:127]
    buffer_load_dwordx4 v251, s[40:43], s31 offen offset:3072  lds
    v_mfma_f32_16x16x32_bf16 v[124:127], a[140:143], a[192:195], v[124:127]
    s_add_u32 s31, s31, s96
    s_and_b32 s31, s31, 0x3fffff
    s_add_u32 m0, s17, 32768
    v_mfma_f32_16x16x32_bf16 v[140:143], a[144:147], a[192:195], v[140:143]
    ds_read_b128 a[240:243], v253 offset:28672
    v_lshrrev_b32 v4, 2, v0
    v_mfma_f32_16x16x32_bf16 v[140:143], a[176:179], a[208:211], v[140:143]
    s_waitcnt lgkmcnt(11)
    ds_read_b128 a[244:247], v253 offset:29696
    v_mfma_f32_16x16x32_bf16 v[144:147], a[176:179], a[212:215], v[144:147]
    buffer_load_dwordx4 v248, s[40:43], s31 offen offset:0  lds
    v_mfma_f32_16x16x32_bf16 v[144:147], a[144:147], a[196:199], v[144:147]
    s_waitcnt vmcnt(13)
    ds_read_b64_tr_b16 a[32:33], v12 offset:0
    v_mfma_f32_16x16x32_bf16 v[148:151], a[144:147], a[200:203], v[148:151]
    ds_read_b64_tr_b16 a[36:37], v13 offset:0
    v_and_b32 v5, 7, v4
    v_mfma_f32_16x16x32_bf16 v[148:151], a[176:179], a[216:219], v[148:151]
    ds_read_b64_tr_b16 a[40:41], v14 offset:0
    v_lshlrev_b32 v5, 5, v5
    v_mfma_f32_16x16x32_bf16 v[152:155], a[176:179], a[220:223], v[152:155]
    buffer_load_dwordx4 v249, s[40:43], s31 offen offset:1024  lds
    v_mfma_f32_16x16x32_bf16 v[152:155], a[144:147], a[204:207], v[152:155]
    ds_read_b64_tr_b16 a[44:45], v15 offset:0
    v_lshl_add_u32 v5, v4, 8, v5
    v_mfma_f32_16x16x32_bf16 v[168:171], a[148:151], a[204:207], v[168:171]
    ds_read_b64_tr_b16 a[48:49], v16 offset:0
    v_and_b32 v6, 3, v0
    v_mfma_f32_16x16x32_bf16 v[168:171], a[180:183], a[220:223], v[168:171]
    ds_read_b64_tr_b16 a[52:53], v17 offset:0
    v_lshl_add_u32 v5, v6, 3, v5
    v_mfma_f32_16x16x32_bf16 v[164:167], a[180:183], a[216:219], v[164:167]
    buffer_load_dwordx4 v250, s[40:43], s31 offen offset:2048  lds
    v_mfma_f32_16x16x32_bf16 v[164:167], a[148:151], a[200:203], v[164:167]
    ds_read_b64_tr_b16 a[56:57], v18 offset:0
    v_add_u32 v208, 65536, v5
    v_mfma_f32_16x16x32_bf16 v[160:163], a[148:151], a[196:199], v[160:163]
    ds_read_b64_tr_b16 a[60:61], v19 offset:0
    v_xor_b32 v209, 32, v208
    v_mfma_f32_16x16x32_bf16 v[160:163], a[180:183], a[212:215], v[160:163]
    s_lshl_b32 s29, s29, 7
    v_xor_b32 v210, 64, v208
    v_xor_b32 v211, 96, v208
    v_mfma_f32_16x16x32_bf16 v[156:159], a[180:183], a[208:211], v[156:159]
    buffer_load_dwordx4 v251, s[40:43], s31 offen offset:3072  lds
    v_mfma_f32_16x16x32_bf16 v[156:159], a[148:151], a[192:195], v[156:159]
    s_add_u32 s31, s31, 32768
    s_add_u32 m0, s17, 98304
    v_xor_b32 v212, 128, v208
    v_mfma_f32_16x16x32_bf16 v[172:175], a[152:155], a[192:195], v[172:175]
    ds_read_b128 a[248:251], v253 offset:30720
    v_xor_b32 v213, 160, v208
    v_mfma_f32_16x16x32_bf16 v[172:175], a[184:187], a[208:211], v[172:175]
    s_waitcnt lgkmcnt(11)
    ds_read_b128 a[252:255], v253 offset:31744
    v_mfma_f32_16x16x32_bf16 v[176:179], a[184:187], a[212:215], v[176:179]
    buffer_load_dwordx4 v248, s[40:43], s31 offen offset:0  lds
    v_mfma_f32_16x16x32_bf16 v[176:179], a[152:155], a[196:199], v[176:179]
    s_waitcnt vmcnt(13)
    ds_read_b64_tr_b16 a[34:35], v28 offset:0
    v_mfma_f32_16x16x32_bf16 v[180:183], a[152:155], a[200:203], v[180:183]
    ds_read_b64_tr_b16 a[38:39], v29 offset:0
    v_xor_b32 v214, 192, v208
    v_mfma_f32_16x16x32_bf16 v[180:183], a[184:187], a[216:219], v[180:183]
    ds_read_b64_tr_b16 a[42:43], v30 offset:0
    v_xor_b32 v215, 224, v208
    v_mfma_f32_16x16x32_bf16 v[184:187], a[184:187], a[220:223], v[184:187]
    buffer_load_dwordx4 v249, s[40:43], s31 offen offset:1024  lds
    v_mfma_f32_16x16x32_bf16 v[184:187], a[152:155], a[204:207], v[184:187]
    ds_read_b64_tr_b16 a[46:47], v31 offset:0
    v_lshl_add_u32 v4, v1, 6, v0
    v_mfma_f32_16x16x32_bf16 v[200:203], a[156:159], a[204:207], v[200:203]
    ds_read_b64_tr_b16 a[50:51], v32 offset:0
    v_lshrrev_b32 v4, 2, v4
    v_mfma_f32_16x16x32_bf16 v[200:203], a[188:191], a[220:223], v[200:203]
    ds_read_b64_tr_b16 a[54:55], v33 offset:0
    v_lshlrev_b32 v3, 2, v4
    v_mfma_f32_16x16x32_bf16 v[196:199], a[188:191], a[216:219], v[196:199]
    buffer_load_dwordx4 v250, s[40:43], s31 offen offset:2048  lds
    v_mfma_f32_16x16x32_bf16 v[196:199], a[156:159], a[200:203], v[196:199]
    ds_read_b64_tr_b16 a[58:59], v34 offset:0
    v_mul_u32_u24 v2, 12288, v4
    v_mfma_f32_16x16x32_bf16 v[192:195], a[156:159], a[196:199], v[192:195]
    ds_read_b64_tr_b16 a[62:63], v35 offset:0
    v_and_b32 v4, 3, v0
    v_mfma_f32_16x16x32_bf16 v[192:195], a[188:191], a[212:215], v[192:195]
    s_add_u32 s28, s28, s29
    v_lshl_add_u32 v2, v4, 4, v2
    v_and_b32 v255, 3, v0
    v_mfma_f32_16x16x32_bf16 v[188:191], a[188:191], a[208:211], v[188:191]
    buffer_load_dwordx4 v251, s[40:43], s31 offen offset:3072  lds
    v_mfma_f32_16x16x32_bf16 v[188:191], a[156:159], a[192:195], v[188:191]
    s_add_u32 s31, s31, s97
    s_and_b32 s31, s31, 0x3fffff
    s_add_u32 m0, s17, 0
    v_mfma_f32_16x16x32_bf16 v[76:79], a[0:3], a[224:227], v[76:79]
    ds_read_b128 a[192:195], v252 offset:57344
    v_bfe_u32 v63, v0, 2, 2
    s_waitcnt lgkmcnt(8)
    v_mfma_f32_16x16x32_bf16 v[76:79], a[32:35], a[240:243], v[76:79]
    ds_read_b128 a[196:199], v252 offset:58368
    v_lshl_add_u32 v255, v63, 3, v255
    v_mfma_f32_16x16x32_bf16 v[80:83], a[32:35], a[244:247], v[80:83]
    buffer_load_dwordx4 v248, s[40:43], s31 offen offset:0  lds
    v_mfma_f32_16x16x32_bf16 v[80:83], a[0:3], a[228:231], v[80:83]
    s_waitcnt vmcnt(13)
    ds_read_b64_tr_b16 a[64:65], v12 offset:16384
    v_mfma_f32_16x16x32_bf16 v[84:87], a[0:3], a[232:235], v[84:87]
    ds_read_b64_tr_b16 a[68:69], v13 offset:16384
    v_bfe_u32 v63, v0, 4, 1
    v_mfma_f32_16x16x32_bf16 v[84:87], a[32:35], a[248:251], v[84:87]
    ds_read_b64_tr_b16 a[72:73], v14 offset:16384
    v_lshl_add_u32 v255, v63, 2, v255
    v_mfma_f32_16x16x32_bf16 v[88:91], a[32:35], a[252:255], v[88:91]
    buffer_load_dwordx4 v249, s[40:43], s31 offen offset:1024  lds
    v_mfma_f32_16x16x32_bf16 v[88:91], a[0:3], a[236:239], v[88:91]
    ds_read_b64_tr_b16 a[76:77], v15 offset:16384
    v_lshlrev_b32 v255, 2, v255
    v_mfma_f32_16x16x32_bf16 v[104:107], a[4:7], a[236:239], v[104:107]
    ds_read_b64_tr_b16 a[80:81], v16 offset:16384
    v_lshrrev_b32 v63, 5, v0
    s_waitcnt lgkmcnt(13)
    v_mfma_f32_16x16x32_bf16 v[104:107], a[36:39], a[252:255], v[104:107]
    ds_read_b64_tr_b16 a[84:85], v17 offset:16384
    v_lshl_add_u32 v255, v63, 30, v255
    v_mfma_f32_16x16x32_bf16 v[100:103], a[36:39], a[248:251], v[100:103]
    buffer_load_dwordx4 v250, s[40:43], s31 offen offset:2048  lds
    v_mfma_f32_16x16x32_bf16 v[100:103], a[4:7], a[232:235], v[100:103]
    ds_read_b64_tr_b16 a[88:89], v18 offset:16384
    v_lshlrev_b32 v5, 2, v0
    v_mfma_f32_16x16x32_bf16 v[96:99], a[4:7], a[228:231], v[96:99]
    ds_read_b64_tr_b16 a[92:93], v19 offset:16384
    v_add_u32 v5, 135168, v5
    v_mfma_f32_16x16x32_bf16 v[96:99], a[36:39], a[244:247], v[96:99]
    s_add_u32 s50, s50, s28
    s_addc_u32 s51, s51, 0
    v_lshrrev_b32 v234, 2, v0
    v_mfma_f32_16x16x32_bf16 v[92:95], a[36:39], a[240:243], v[92:95]
    buffer_load_dwordx4 v251, s[40:43], s31 offen offset:3072  lds
    v_mfma_f32_16x16x32_bf16 v[92:95], a[4:7], a[224:227], v[92:95]
    s_add_u32 s31, s31, 32768
    s_add_u32 m0, s17, 65536
    v_and_b32 v235, 3, v0
    v_mfma_f32_16x16x32_bf16 v[108:111], a[8:11], a[224:227], v[108:111]
    ds_read_b128 a[200:203], v252 offset:59392
    v_lshrrev_b32 v233, 1, v235
    s_waitcnt lgkmcnt(15)
    v_mfma_f32_16x16x32_bf16 v[108:111], a[40:43], a[240:243], v[108:111]
    s_waitcnt lgkmcnt(11)
    ds_read_b128 a[204:207], v252 offset:60416
    v_mfma_f32_16x16x32_bf16 v[112:115], a[40:43], a[244:247], v[112:115]
    buffer_load_dwordx4 v248, s[40:43], s31 offen offset:0  lds
    v_mfma_f32_16x16x32_bf16 v[112:115], a[8:11], a[228:231], v[112:115]
    s_waitcnt vmcnt(13)
    ds_read_b64_tr_b16 a[66:67], v28 offset:16384
    v_mfma_f32_16x16x32_bf16 v[116:119], a[8:11], a[232:235], v[116:119]
    ds_read_b64_tr_b16 a[70:71], v29 offset:16384
    v_lshlrev_b32 v235, 4, v235
    v_mfma_f32_16x16x32_bf16 v[116:119], a[40:43], a[248:251], v[116:119]
    ds_read_b64_tr_b16 a[74:75], v30 offset:16384
    v_and_b32 v232, 1, v0
    v_mfma_f32_16x16x32_bf16 v[120:123], a[40:43], a[252:255], v[120:123]
    buffer_load_dwordx4 v249, s[40:43], s31 offen offset:1024  lds
    v_mfma_f32_16x16x32_bf16 v[120:123], a[8:11], a[236:239], v[120:123]
    ds_read_b64_tr_b16 a[78:79], v31 offset:16384
    v_lshlrev_b32 v232, 3, v232
    v_mfma_f32_16x16x32_bf16 v[136:139], a[12:15], a[236:239], v[136:139]
    ds_read_b64_tr_b16 a[82:83], v32 offset:16384
    v_lshl_add_u32 v232, v234, 6, v232
    v_mfma_f32_16x16x32_bf16 v[136:139], a[44:47], a[252:255], v[136:139]
    ds_read_b64_tr_b16 a[86:87], v33 offset:16384
    v_add_u32 v232, s80, v232
    v_mfma_f32_16x16x32_bf16 v[132:135], a[44:47], a[248:251], v[132:135]
    buffer_load_dwordx4 v250, s[40:43], s31 offen offset:2048  lds
    v_mfma_f32_16x16x32_bf16 v[132:135], a[12:15], a[232:235], v[132:135]
    ds_read_b64_tr_b16 a[90:91], v34 offset:16384
    v_xor_b32 v232, 4096, v232
    v_mfma_f32_16x16x32_bf16 v[128:131], a[12:15], a[228:231], v[128:131]
    ds_read_b64_tr_b16 a[94:95], v35 offset:16384
    v_mov_b32 v236, v232
    v_mfma_f32_16x16x32_bf16 v[128:131], a[44:47], a[244:247], v[128:131]
    s_mul_i32 s29, s22, 229376
    v_lshl_add_u32 v237, v234, 10, v235
    v_mov_b32 v238, s45
    v_mfma_f32_16x16x32_bf16 v[124:127], a[44:47], a[240:243], v[124:127]
    buffer_load_dwordx4 v251, s[40:43], s31 offen offset:3072  lds
    v_mfma_f32_16x16x32_bf16 v[124:127], a[12:15], a[224:227], v[124:127]
    s_add_u32 s31, s31, s96
    s_and_b32 s31, s31, 0x3fffff
    s_add_u32 m0, s17, 16384
    v_mfma_f32_16x16x32_bf16 v[140:143], a[16:19], a[224:227], v[140:143]
    ds_read_b128 a[208:211], v253 offset:8192
    v_min_u32 v239, 1, v0
    v_mfma_f32_16x16x32_bf16 v[140:143], a[48:51], a[240:243], v[140:143]
    s_waitcnt lgkmcnt(11)
    ds_read_b128 a[212:215], v253 offset:9216
    v_mfma_f32_16x16x32_bf16 v[144:147], a[48:51], a[244:247], v[144:147]
    buffer_load_dwordx4 v248, s[40:43], s31 offen offset:0  lds
    v_mfma_f32_16x16x32_bf16 v[144:147], a[16:19], a[228:231], v[144:147]
    s_waitcnt vmcnt(13)
    ds_read_b64_tr_b16 a[96:97], v12 offset:32768
    v_mfma_f32_16x16x32_bf16 v[148:151], a[16:19], a[232:235], v[148:151]
    ds_read_b64_tr_b16 a[100:101], v13 offset:32768
    v_lshlrev_b32 v239, 30, v239
    v_mfma_f32_16x16x32_bf16 v[148:151], a[48:51], a[248:251], v[148:151]
    ds_read_b64_tr_b16 a[104:105], v14 offset:32768
    s_add_u32 s28, s28, s29
    v_mfma_f32_16x16x32_bf16 v[152:155], a[48:51], a[252:255], v[152:155]
    buffer_load_dwordx4 v249, s[40:43], s31 offen offset:1024  lds
    v_mfma_f32_16x16x32_bf16 v[152:155], a[16:19], a[236:239], v[152:155]
    ds_read_b64_tr_b16 a[108:109], v15 offset:32768
    v_mfma_f32_16x16x32_bf16 v[168:171], a[20:23], a[236:239], v[168:171]
    ds_read_b64_tr_b16 a[112:113], v16 offset:32768
L_pg1:
    s_cbranch_execz L_pg5
    v_mfma_f32_16x16x32_bf16 v[168:171], a[52:55], a[252:255], v[168:171]
    ds_read_b64_tr_b16 a[116:117], v17 offset:32768
    v_mfma_f32_16x16x32_bf16 v[164:167], a[52:55], a[248:251], v[164:167]
    buffer_load_dwordx4 v250, s[40:43], s31 offen offset:2048  lds
    v_mfma_f32_16x16x32_bf16 v[164:167], a[20:23], a[232:235], v[164:167]
    ds_read_b64_tr_b16 a[120:121], v18 offset:32768
    v_mfma_f32_16x16x32_bf16 v[160:163], a[20:23], a[228:231], v[160:163]
    ds_read_b64_tr_b16 a[124:125], v19 offset:32768
    v_mfma_f32_16x16x32_bf16 v[160:163], a[52:55], a[244:247], v[160:163]
    s_cmp_lt_u32 s82, 56
    s_cselect_b32 s28, s28, 0
    s_cselect_b32 s68, 31872, 0
    v_mfma_f32_16x16x32_bf16 v[156:159], a[52:55], a[240:243], v[156:159]
    buffer_load_dwordx4 v251, s[40:43], s31 offen offset:3072  lds
    v_mfma_f32_16x16x32_bf16 v[156:159], a[20:23], a[224:227], v[156:159]
    s_add_u32 s31, s31, 32768
    s_add_u32 m0, s17, 81920
    v_mfma_f32_16x16x32_bf16 v[172:175], a[24:27], a[224:227], v[172:175]
    ds_read_b128 a[216:219], v253 offset:10240
    v_mfma_f32_16x16x32_bf16 v[172:175], a[56:59], a[240:243], v[172:175]
    s_waitcnt lgkmcnt(11)
    ds_read_b128 a[220:223], v253 offset:11264
    v_mfma_f32_16x16x32_bf16 v[176:179], a[56:59], a[244:247], v[176:179]
    buffer_load_dwordx4 v248, s[40:43], s31 offen offset:0  lds
    v_mfma_f32_16x16x32_bf16 v[176:179], a[24:27], a[228:231], v[176:179]
    s_waitcnt vmcnt(13)
    ds_read_b64_tr_b16 a[98:99], v28 offset:32768
    v_mfma_f32_16x16x32_bf16 v[180:183], a[24:27], a[232:235], v[180:183]
    ds_read_b64_tr_b16 a[102:103], v29 offset:32768
    v_mfma_f32_16x16x32_bf16 v[180:183], a[56:59], a[248:251], v[180:183]
    ds_read_b64_tr_b16 a[106:107], v30 offset:32768
    v_mfma_f32_16x16x32_bf16 v[184:187], a[56:59], a[252:255], v[184:187]
    buffer_load_dwordx4 v249, s[40:43], s31 offen offset:1024  lds
    v_mfma_f32_16x16x32_bf16 v[184:187], a[24:27], a[236:239], v[184:187]
    ds_read_b64_tr_b16 a[110:111], v31 offset:32768
    v_mfma_f32_16x16x32_bf16 v[200:203], a[28:31], a[236:239], v[200:203]
    ds_read_b64_tr_b16 a[114:115], v32 offset:32768
    v_mfma_f32_16x16x32_bf16 v[200:203], a[60:63], a[252:255], v[200:203]
    ds_read_b64_tr_b16 a[118:119], v33 offset:32768
    v_mfma_f32_16x16x32_bf16 v[196:199], a[60:63], a[248:251], v[196:199]
    buffer_load_dwordx4 v250, s[40:43], s31 offen offset:2048  lds
    v_mfma_f32_16x16x32_bf16 v[196:199], a[28:31], a[232:235], v[196:199]
    ds_read_b64_tr_b16 a[122:123], v34 offset:32768
    v_mfma_f32_16x16x32_bf16 v[192:195], a[28:31], a[228:231], v[192:195]
    ds_read_b64_tr_b16 a[126:127], v35 offset:32768
    v_mfma_f32_16x16x32_bf16 v[192:195], a[60:63], a[244:247], v[192:195]
    s_add_u32 s64, s64, s28
    s_addc_u32 s65, s65, 0
    v_mfma_f32_16x16x32_bf16 v[188:191], a[60:63], a[240:243], v[188:191]
    buffer_load_dwordx4 v251, s[40:43], s31 offen offset:3072  lds
    v_mfma_f32_16x16x32_bf16 v[188:191], a[28:31], a[224:227], v[188:191]
    s_add_u32 s31, s31, s97
    s_and_b32 s31, s31, 0x3fffff
    s_add_u32 m0, s17, 32768
    v_mfma_f32_16x16x32_bf16 v[76:79], a[64:67], a[192:195], v[76:79]
    s_barrier
    ds_read_b128 a[224:227], v253 offset:32768
    s_waitcnt lgkmcnt(8)
    v_mfma_f32_16x16x32_bf16 v[76:79], a[96:99], a[208:211], v[76:79]
    ds_read_b128 a[228:231], v253 offset:33792
    v_mfma_f32_16x16x32_bf16 v[80:83], a[96:99], a[212:215], v[80:83]
    buffer_load_dwordx4 v248, s[40:43], s31 offen offset:0  lds
    v_mfma_f32_16x16x32_bf16 v[80:83], a[64:67], a[196:199], v[80:83]
    s_waitcnt vmcnt(13)
    ds_read_b64_tr_b16 a[128:129], v12 offset:0
    v_mfma_f32_16x16x32_bf16 v[84:87], a[64:67], a[200:203], v[84:87]
    ds_read_b64_tr_b16 a[132:133], v13 offset:0
    v_mfma_f32_16x16x32_bf16 v[84:87], a[96:99], a[216:219], v[84:87]
    ds_read_b64_tr_b16 a[136:137], v14 offset:0
    v_mfma_f32_16x16x32_bf16 v[88:91], a[96:99], a[220:223], v[88:91]
    buffer_load_dwordx4 v249, s[40:43], s31 offen offset:1024  lds
    v_mfma_f32_16x16x32_bf16 v[88:91], a[64:67], a[204:207], v[88:91]
    ds_read_b64_tr_b16 a[140:141], v15 offset:0
    v_mfma_f32_16x16x32_bf16 v[104:107], a[68:71], a[204:207], v[104:107]
    ds_read_b64_tr_b16 a[144:145], v16 offset:0
    s_waitcnt lgkmcnt(13)
    v_mfma_f32_16x16x32_bf16 v[104:107], a[100:103], a[220:223], v[104:107]
    ds_read_b64_tr_b16 a[148:149], v17 offset:0
    v_mfma_f32_16x16x32_bf16 v[100:103], a[100:103], a[216:219], v[100:103]
    buffer_load_dwordx4 v250, s[40:43], s31 offen offset:2048  lds
    v_mfma_f32_16x16x32_bf16 v[100:103], a[68:71], a[200:203], v[100:103]
    ds_read_b64_tr_b16 a[152:153], v18 offset:0
    v_mfma_f32_16x16x32_bf16 v[96:99], a[68:71], a[196:199], v[96:99]
    ds_read_b64_tr_b16 a[156:157], v19 offset:0
    v_mfma_f32_16x16x32_bf16 v[96:99], a[100:103], a[212:215], v[96:99]
    s_add_u32 s66, s64, 64
    s_addc_u32 s67, s65, 0
    s_and_b32 s28, s82, 15
    v_mfma_f32_16x16x32_bf16 v[92:95], a[100:103], a[208:211], v[92:95]
    buffer_load_dwordx4 v251, s[40:43], s31 offen offset:3072  lds
    v_mfma_f32_16x16x32_bf16 v[92:95], a[68:71], a[192:195], v[92:95]
    s_add_u32 s31, s31, 32768
    s_add_u32 m0, s17, 98304
    s_mul_i32 s28, s28, 114688
    v_mfma_f32_16x16x32_bf16 v[108:111], a[72:75], a[192:195], v[108:111]
    ds_read_b128 a[232:235], v253 offset:34816
    s_lshr_b32 s29, s82, 4
    s_waitcnt lgkmcnt(15)
    v_mfma_f32_16x16x32_bf16 v[108:111], a[104:107], a[208:211], v[108:111]
    s_waitcnt lgkmcnt(11)
    ds_read_b128 a[236:239], v253 offset:35840
    v_mfma_f32_16x16x32_bf16 v[112:115], a[104:107], a[212:215], v[112:115]
    buffer_load_dwordx4 v248, s[40:43], s31 offen offset:0  lds
    v_mfma_f32_16x16x32_bf16 v[112:115], a[72:75], a[196:199], v[112:115]
    s_waitcnt vmcnt(13)
    ds_read_b64_tr_b16 a[130:131], v28 offset:0
    v_mfma_f32_16x16x32_bf16 v[116:119], a[72:75], a[200:203], v[116:119]
    ds_read_b64_tr_b16 a[134:135], v29 offset:0
    s_lshl_b32 s29, s29, 6
    v_mfma_f32_16x16x32_bf16 v[116:119], a[104:107], a[216:219], v[116:119]
    ds_read_b64_tr_b16 a[138:139], v30 offset:0
    s_add_u32 s28, s28, s29
    v_mfma_f32_16x16x32_bf16 v[120:123], a[104:107], a[220:223], v[120:123]
    buffer_load_dwordx4 v249, s[40:43], s31 offen offset:1024  lds
    v_mfma_f32_16x16x32_bf16 v[120:123], a[72:75], a[204:207], v[120:123]
    ds_read_b64_tr_b16 a[142:143], v31 offset:0
    s_mul_i32 s29, s22, 448
    v_mfma_f32_16x16x32_bf16 v[136:139], a[76:79], a[204:207], v[136:139]
    ds_read_b64_tr_b16 a[146:147], v32 offset:0
    s_add_u32 s28, s28, s29
    v_mfma_f32_16x16x32_bf16 v[136:139], a[108:111], a[220:223], v[136:139]
    ds_read_b64_tr_b16 a[150:151], v33 offset:0
    v_mfma_f32_16x16x32_bf16 v[132:135], a[108:111], a[216:219], v[132:135]
    buffer_load_dwordx4 v250, s[40:43], s31 offen offset:2048  lds
    v_mfma_f32_16x16x32_bf16 v[132:135], a[76:79], a[200:203], v[132:135]
    ds_read_b64_tr_b16 a[154:155], v34 offset:0
    v_mfma_f32_16x16x32_bf16 v[128:131], a[76:79], a[196:199], v[128:131]
    ds_read_b64_tr_b16 a[158:159], v35 offset:0
    v_mfma_f32_16x16x32_bf16 v[128:131], a[108:111], a[212:215], v[128:131]
    s_cmp_lt_u32 s82, 112
    s_cselect_b32 s28, s28, 0
    s_cselect_b32 s69, 111168, 0
    v_mfma_f32_16x16x32_bf16 v[124:127], a[108:111], a[208:211], v[124:127]
    buffer_load_dwordx4 v251, s[40:43], s31 offen offset:3072  lds
    v_mfma_f32_16x16x32_bf16 v[124:127], a[76:79], a[192:195], v[124:127]
    s_add_u32 s31, s31, s96
    s_and_b32 s31, s31, 0x3fffff
    s_add_u32 m0, s17, 0
    v_mfma_f32_16x16x32_bf16 v[140:143], a[80:83], a[192:195], v[140:143]
    ds_read_b128 a[240:243], v253 offset:36864
    v_mfma_f32_16x16x32_bf16 v[140:143], a[112:115], a[208:211], v[140:143]
    s_waitcnt lgkmcnt(11)
    ds_read_b128 a[244:247], v253 offset:37888
    v_mfma_f32_16x16x32_bf16 v[144:147], a[112:115], a[212:215], v[144:147]
    buffer_load_dwordx4 v248, s[40:43], s31 offen offset:0  lds
    v_mfma_f32_16x16x32_bf16 v[144:147], a[80:83], a[196:199], v[144:147]
    s_waitcnt vmcnt(13)
    ds_read_b64_tr_b16 a[160:161], v12 offset:16384
    v_mfma_f32_16x16x32_bf16 v[148:151], a[80:83], a[200:203], v[148:151]
    ds_read_b64_tr_b16 a[164:165], v13 offset:16384
    v_mfma_f32_16x16x32_bf16 v[148:151], a[112:115], a[216:219], v[148:151]
    ds_read_b64_tr_b16 a[168:169], v14 offset:16384
    v_mfma_f32_16x16x32_bf16 v[152:155], a[112:115], a[220:223], v[152:155]
    buffer_load_dwordx4 v249, s[40:43], s31 offen offset:1024  lds
    v_mfma_f32_16x16x32_bf16 v[152:155], a[80:83], a[204:207], v[152:155]
    ds_read_b64_tr_b16 a[172:173], v15 offset:16384
    v_mfma_f32_16x16x32_bf16 v[168:171], a[84:87], a[204:207], v[168:171]
    ds_read_b64_tr_b16 a[176:177], v16 offset:16384
    v_mfma_f32_16x16x32_bf16 v[168:171], a[116:119], a[220:223], v[168:171]
    ds_read_b64_tr_b16 a[180:181], v17 offset:16384
    v_mfma_f32_16x16x32_bf16 v[164:167], a[116:119], a[216:219], v[164:167]
    buffer_load_dwordx4 v250, s[40:43], s31 offen offset:2048  lds
    v_mfma_f32_16x16x32_bf16 v[164:167], a[84:87], a[200:203], v[164:167]
    ds_read_b64_tr_b16 a[184:185], v18 offset:16384
    v_mfma_f32_16x16x32_bf16 v[160:163], a[84:87], a[196:199], v[160:163]
    ds_read_b64_tr_b16 a[188:189], v19 offset:16384
    v_mfma_f32_16x16x32_bf16 v[160:163], a[116:119], a[212:215], v[160:163]
    s_add_u32 s70, s92, s28
    s_addc_u32 s71, s93, 0
    v_mfma_f32_16x16x32_bf16 v[156:159], a[116:119], a[208:211], v[156:159]
    buffer_load_dwordx4 v251, s[40:43], s31 offen offset:3072  lds
    v_mfma_f32_16x16x32_bf16 v[156:159], a[84:87], a[192:195], v[156:159]
    s_add_u32 s31, s31, 32768
    s_add_u32 m0, s17, 65536
    v_mfma_f32_16x16x32_bf16 v[172:175], a[88:91], a[192:195], v[172:175]
    ds_read_b128 a[248:251], v253 offset:38912
    v_mfma_f32_16x16x32_bf16 v[172:175], a[120:123], a[208:211], v[172:175]
    s_waitcnt lgkmcnt(11)
    ds_read_b128 a[252:255], v253 offset:39936
    v_mfma_f32_16x16x32_bf16 v[176:179], a[120:123], a[212:215], v[176:179]
    buffer_load_dwordx4 v248, s[40:43], s31 offen offset:0  lds
    v_mfma_f32_16x16x32_bf16 v[176:179], a[88:91], a[196:199], v[176:179]
    s_waitcnt vmcnt(13)
    ds_read_b64_tr_b16 a[162:163], v28 offset:16384
    v_mfma_f32_16x16x32_bf16 v[180:183], a[88:91], a[200:203], v[180:183]
    ds_read_b64_tr_b16 a[166:167], v29 offset:16384
    v_mfma_f32_16x16x32_bf16 v[180:183], a[120:123], a[216:219], v[180:183]
    ds_read_b64_tr_b16 a[170:171], v30 offset:16384
    v_mfma_f32_16x16x32_bf16 v[184:187], a[120:123], a[220:223], v[184:187]
    buffer_load_dwordx4 v249, s[40:43], s31 offen offset:1024  lds
    v_mfma_f32_16x16x32_bf16 v[184:187], a[88:91], a[204:207], v[184:187]
    ds_read_b64_tr_b16 a[174:175], v31 offset:16384
    v_mfma_f32_16x16x32_bf16 v[200:203], a[92:95], a[204:207], v[200:203]
    ds_read_b64_tr_b16 a[178:179], v32 offset:16384
    v_mfma_f32_16x16x32_bf16 v[200:203], a[124:127], a[220:223], v[200:203]
    ds_read_b64_tr_b16 a[182:183], v33 offset:16384
    v_mfma_f32_16x16x32_bf16 v[196:199], a[124:127], a[216:219], v[196:199]
    buffer_load_dwordx4 v250, s[40:43], s31 offen offset:2048  lds
    v_mfma_f32_16x16x32_bf16 v[196:199], a[92:95], a[200:203], v[196:199]
    ds_read_b64_tr_b16 a[186:187], v34 offset:16384
    v_mfma_f32_16x16x32_bf16 v[192:195], a[92:95], a[196:199], v[192:195]
    ds_read_b64_tr_b16 a[190:191], v35 offset:16384
    v_mfma_f32_16x16x32_bf16 v[192:195], a[124:127], a[212:215], v[192:195]
    s_add_u32 s72, s94, s28
    s_addc_u32 s73, s95, 0
    s_mul_i32 s23, s22, 1212416
    v_mfma_f32_16x16x32_bf16 v[188:191], a[124:127], a[208:211], v[188:191]
    buffer_load_dwordx4 v251, s[40:43], s31 offen offset:3072  lds
    v_mfma_f32_16x16x32_bf16 v[188:191], a[92:95], a[192:195], v[188:191]
    s_add_u32 s31, s31, s97
    s_and_b32 s31, s31, 0x3fffff
    s_add_u32 m0, s17, 16384
    v_mfma_f32_16x16x32_bf16 v[76:79], a[128:131], a[224:227], v[76:79]
    ds_read_b128 a[192:195], v252 offset:61440
    s_add_u32 s23, s23, 52428800
    s_waitcnt lgkmcnt(8)
    v_mfma_f32_16x16x32_bf16 v[76:79], a[160:163], a[240:243], v[76:79]
    ds_read_b128 a[196:199], v252 offset:62464
    s_mov_b32 s74, 2147483648
    v_mfma_f32_16x16x32_bf16 v[80:83], a[160:163], a[244:247], v[80:83]
    buffer_load_dwordx4 v248, s[40:43], s31 offen offset:0  lds
    v_mfma_f32_16x16x32_bf16 v[80:83], a[128:131], a[228:231], v[80:83]
    s_waitcnt vmcnt(13)
    ds_read_b64_tr_b16 a[0:1], v12 offset:32768
    v_mfma_f32_16x16x32_bf16 v[84:87], a[128:131], a[232:235], v[84:87]
    ds_read_b64_tr_b16 a[4:5], v13 offset:32768
    s_mov_b32 s75, 2147483648
    v_mfma_f32_16x16x32_bf16 v[84:87], a[160:163], a[248:251], v[84:87]
    ds_read_b64_tr_b16 a[8:9], v14 offset:32768
    s_mov_b32 s78, 0
    v_mfma_f32_16x16x32_bf16 v[88:91], a[160:163], a[252:255], v[88:91]
    buffer_load_dwordx4 v249, s[40:43], s31 offen offset:1024  lds
    v_mfma_f32_16x16x32_bf16 v[88:91], a[128:131], a[236:239], v[88:91]
    ds_read_b64_tr_b16 a[12:13], v15 offset:32768
    s_and_b32 s28, s82, 7
    v_mfma_f32_16x16x32_bf16 v[104:107], a[132:135], a[236:239], v[104:107]
    ds_read_b64_tr_b16 a[16:17], v16 offset:32768
    s_lshr_b32 s29, s82, 3
    s_waitcnt lgkmcnt(13)
    v_mfma_f32_16x16x32_bf16 v[104:107], a[164:167], a[252:255], v[104:107]
    ds_read_b64_tr_b16 a[20:21], v17 offset:32768
    s_lshl_b32 s29, s29, 10
    v_mfma_f32_16x16x32_bf16 v[100:103], a[164:167], a[248:251], v[100:103]
    buffer_load_dwordx4 v250, s[40:43], s31 offen offset:2048  lds
    v_mfma_f32_16x16x32_bf16 v[100:103], a[132:135], a[232:235], v[100:103]
    ds_read_b64_tr_b16 a[24:25], v18 offset:32768
    s_add_u32 s29, s29, s23
    v_mfma_f32_16x16x32_bf16 v[96:99], a[132:135], a[228:231], v[96:99]
    ds_read_b64_tr_b16 a[28:29], v19 offset:32768
    s_lshl_b32 s76, s28, 16
    v_mfma_f32_16x16x32_bf16 v[96:99], a[164:167], a[244:247], v[96:99]
    s_add_u32 s76, s76, s29
    s_mul_i32 s77, s28, 28672
    s_add_u32 s77, s77, s29
    v_mfma_f32_16x16x32_bf16 v[92:95], a[164:167], a[240:243], v[92:95]
    buffer_load_dwordx4 v251, s[40:43], s31 offen offset:3072  lds
    v_mfma_f32_16x16x32_bf16 v[92:95], a[132:135], a[224:227], v[92:95]
    s_add_u32 s31, s31, 32768
    s_add_u32 m0, s17, 81920
    s_add_u32 s77, s77, 983040
    v_mfma_f32_16x16x32_bf16 v[108:111], a[136:139], a[224:227], v[108:111]
    ds_read_b128 a[200:203], v252 offset:63488
    s_waitcnt lgkmcnt(15)
    v_mfma_f32_16x16x32_bf16 v[108:111], a[168:171], a[240:243], v[108:111]
    s_waitcnt lgkmcnt(11)
    ds_read_b128 a[204:207], v252 offset:64512
    v_mfma_f32_16x16x32_bf16 v[112:115], a[168:171], a[244:247], v[112:115]
    buffer_load_dwordx4 v248, s[40:43], s31 offen offset:0  lds
    v_mfma_f32_16x16x32_bf16 v[112:115], a[136:139], a[228:231], v[112:115]
    s_waitcnt vmcnt(13)
    ds_read_b64_tr_b16 a[2:3], v28 offset:32768
    v_mfma_f32_16x16x32_bf16 v[116:119], a[136:139], a[232:235], v[116:119]
    ds_read_b64_tr_b16 a[6:7], v29 offset:32768
    v_mfma_f32_16x16x32_bf16 v[116:119], a[168:171], a[248:251], v[116:119]
    ds_read_b64_tr_b16 a[10:11], v30 offset:32768
    v_mfma_f32_16x16x32_bf16 v[120:123], a[168:171], a[252:255], v[120:123]
    buffer_load_dwordx4 v249, s[40:43], s31 offen offset:1024  lds
    v_mfma_f32_16x16x32_bf16 v[120:123], a[136:139], a[236:239], v[120:123]
    ds_read_b64_tr_b16 a[14:15], v31 offset:32768
    v_mfma_f32_16x16x32_bf16 v[136:139], a[140:143], a[236:239], v[136:139]
    ds_read_b64_tr_b16 a[18:19], v32 offset:32768
    v_mfma_f32_16x16x32_bf16 v[136:139], a[172:175], a[252:255], v[136:139]
    ds_read_b64_tr_b16 a[22:23], v33 offset:32768
    v_mfma_f32_16x16x32_bf16 v[132:135], a[172:175], a[248:251], v[132:135]
    buffer_load_dwordx4 v250, s[40:43], s31 offen offset:2048  lds
    v_mfma_f32_16x16x32_bf16 v[132:135], a[140:143], a[232:235], v[132:135]
    ds_read_b64_tr_b16 a[26:27], v34 offset:32768
    v_mfma_f32_16x16x32_bf16 v[128:131], a[140:143], a[228:231], v[128:131]
    ds_read_b64_tr_b16 a[30:31], v35 offset:32768
    v_mfma_f32_16x16x32_bf16 v[128:131], a[172:175], a[244:247], v[128:131]
    s_cmp_lt_u32 s82, 56
    s_cselect_b32 s77, s77, 2147483648
    s_lshr_b32 s28, s82, 4
    v_mfma_f32_16x16x32_bf16 v[124:127], a[172:175], a[240:243], v[124:127]
    buffer_load_dwordx4 v251, s[40:43], s31 offen offset:3072  lds
    v_mfma_f32_16x16x32_bf16 v[124:127], a[140:143], a[224:227], v[124:127]
    s_add_u32 s31, s31, s96
    s_and_b32 s31, s31, 0x3fffff
    s_add_u32 m0, s17, 32768
    v_mfma_f32_16x16x32_bf16 v[140:143], a[144:147], a[224:227], v[140:143]
    ds_read_b128 a[208:211], v253 offset:12288
    s_lshl_b32 s28, s28, 16
    v_mfma_f32_16x16x32_bf16 v[140:143], a[176:179], a[240:243], v[140:143]
    s_waitcnt lgkmcnt(11)
    ds_read_b128 a[212:215], v253 offset:13312
    v_mfma_f32_16x16x32_bf16 v[144:147], a[176:179], a[244:247], v[144:147]
    buffer_load_dwordx4 v248, s[40:43], s31 offen offset:0  lds
    v_mfma_f32_16x16x32_bf16 v[144:147], a[144:147], a[228:231], v[144:147]
    s_waitcnt vmcnt(13)
    ds_read_b64_tr_b16 a[32:33], v12 offset:0
    v_mfma_f32_16x16x32_bf16 v[148:151], a[144:147], a[232:235], v[148:151]
    ds_read_b64_tr_b16 a[36:37], v13 offset:0
    s_and_b32 s29, s82, 15
    v_mfma_f32_16x16x32_bf16 v[148:151], a[176:179], a[248:251], v[148:151]
    ds_read_b64_tr_b16 a[40:41], v14 offset:0
    s_lshl_b32 s29, s29, 10
    v_mfma_f32_16x16x32_bf16 v[152:155], a[176:179], a[252:255], v[152:155]
    buffer_load_dwordx4 v249, s[40:43], s31 offen offset:1024  lds
    v_mfma_f32_16x16x32_bf16 v[152:155], a[144:147], a[236:239], v[152:155]
    ds_read_b64_tr_b16 a[44:45], v15 offset:0
    s_add_u32 s83, s28, s29
    v_mfma_f32_16x16x32_bf16 v[168:171], a[148:151], a[236:239], v[168:171]
    ds_read_b64_tr_b16 a[48:49], v16 offset:0
    s_add_u32 s83, s83, s23
    v_mfma_f32_16x16x32_bf16 v[168:171], a[180:183], a[252:255], v[168:171]
    ds_read_b64_tr_b16 a[52:53], v17 offset:0
    s_add_u32 s83, s83, 524288
    v_mfma_f32_16x16x32_bf16 v[164:167], a[180:183], a[248:251], v[164:167]
    buffer_load_dwordx4 v250, s[40:43], s31 offen offset:2048  lds
    v_mfma_f32_16x16x32_bf16 v[164:167], a[148:151], a[232:235], v[164:167]
    ds_read_b64_tr_b16 a[56:57], v18 offset:0
    v_mfma_f32_16x16x32_bf16 v[160:163], a[148:151], a[228:231], v[160:163]
    ds_read_b64_tr_b16 a[60:61], v19 offset:0
    v_mfma_f32_16x16x32_bf16 v[160:163], a[180:183], a[244:247], v[160:163]
    s_cmp_lt_u32 s82, 112
    s_cselect_b32 s83, s83, 2147483648
    s_mov_b32 s79, 16384
    v_mfma_f32_16x16x32_bf16 v[156:159], a[180:183], a[240:243], v[156:159]
    buffer_load_dwordx4 v251, s[40:43], s31 offen offset:3072  lds
    v_mfma_f32_16x16x32_bf16 v[156:159], a[148:151], a[224:227], v[156:159]
    s_add_u32 s31, s31, 32768
    s_add_u32 m0, s17, 98304
    s_mov_b32 s85, 32
    v_mfma_f32_16x16x32_bf16 v[172:175], a[152:155], a[224:227], v[172:175]
    ds_read_b128 a[216:219], v253 offset:14336
    s_mov_b32 s86, 2016
    v_mfma_f32_16x16x32_bf16 v[172:175], a[184:187], a[240:243], v[172:175]
    s_waitcnt lgkmcnt(11)
    ds_read_b128 a[220:223], v253 offset:15360
    v_mfma_f32_16x16x32_bf16 v[176:179], a[184:187], a[244:247], v[176:179]
    buffer_load_dwordx4 v248, s[40:43], s31 offen offset:0  lds
    v_mfma_f32_16x16x32_bf16 v[176:179], a[152:155], a[228:231], v[176:179]
    s_waitcnt vmcnt(13)
    ds_read_b64_tr_b16 a[34:35], v28 offset:0
    v_mfma_f32_16x16x32_bf16 v[180:183], a[152:155], a[232:235], v[180:183]
    ds_read_b64_tr_b16 a[38:39], v29 offset:0
    s_lshl_b32 s84, s2, 2
    v_mfma_f32_16x16x32_bf16 v[180:183], a[184:187], a[248:251], v[180:183]
    ds_read_b64_tr_b16 a[42:43], v30 offset:0
    s_add_u32 s84, s84, 327680
    v_mfma_f32_16x16x32_bf16 v[184:187], a[184:187], a[252:255], v[184:187]
    buffer_load_dwordx4 v249, s[40:43], s31 offen offset:1024  lds
    v_mfma_f32_16x16x32_bf16 v[184:187], a[152:155], a[236:239], v[184:187]
    ds_read_b64_tr_b16 a[46:47], v31 offset:0
    v_mfma_f32_16x16x32_bf16 v[200:203], a[156:159], a[236:239], v[200:203]
    ds_read_b64_tr_b16 a[50:51], v32 offset:0
    v_mfma_f32_16x16x32_bf16 v[200:203], a[188:191], a[252:255], v[200:203]
    ds_read_b64_tr_b16 a[54:55], v33 offset:0
    v_mfma_f32_16x16x32_bf16 v[196:199], a[188:191], a[248:251], v[196:199]
    buffer_load_dwordx4 v250, s[40:43], s31 offen offset:2048  lds
    v_mfma_f32_16x16x32_bf16 v[196:199], a[156:159], a[232:235], v[196:199]
    ds_read_b64_tr_b16 a[58:59], v34 offset:0
    v_mfma_f32_16x16x32_bf16 v[192:195], a[156:159], a[228:231], v[192:195]
    ds_read_b64_tr_b16 a[62:63], v35 offset:0
    v_mfma_f32_16x16x32_bf16 v[192:195], a[188:191], a[244:247], v[192:195]
    s_cmp_eq_u32 s19, 0
    s_cselect_b32 s84, s84, 2147483648
    s_mov_b32 s21, 327680
    v_mfma_f32_16x16x32_bf16 v[188:191], a[188:191], a[240:243], v[188:191]
    buffer_load_dwordx4 v251, s[40:43], s31 offen offset:3072  lds
    v_mfma_f32_16x16x32_bf16 v[188:191], a[156:159], a[224:227], v[188:191]
    s_add_u32 m0, s17, 0
    s_lshr_b32 s28, s82, 4
    v_mfma_f32_16x16x32_bf16 v[76:79], a[0:3], a[192:195], v[76:79]
    s_barrier
    ds_read_b128 a[224:227], v253 offset:40960
    s_waitcnt lgkmcnt(8)
    v_mfma_f32_16x16x32_bf16 v[76:79], a[32:35], a[208:211], v[76:79]
    ds_read_b128 a[228:231], v253 offset:41984
    v_mfma_f32_16x16x32_bf16 v[80:83], a[32:35], a[212:215], v[80:83]
    buffer_load_dwordx4 v216, s[8:11], s16 offen offset:0 nt lds
    v_mfma_f32_16x16x32_bf16 v[80:83], a[0:3], a[196:199], v[80:83]
    s_waitcnt vmcnt(13)
    ds_read_b64_tr_b16 a[64:65], v12 offset:16384
    v_mfma_f32_16x16x32_bf16 v[84:87], a[0:3], a[200:203], v[84:87]
    ds_read_b64_tr_b16 a[68:69], v13 offset:16384
    v_mfma_f32_16x16x32_bf16 v[84:87], a[32:35], a[216:219], v[84:87]
    ds_read_b64_tr_b16 a[72:73], v14 offset:16384
    v_mfma_f32_16x16x32_bf16 v[88:91], a[32:35], a[220:223], v[88:91]
    buffer_load_dwordx4 v217, s[8:11], s16 offen offset:1024 nt lds
    v_mfma_f32_16x16x32_bf16 v[88:91], a[0:3], a[204:207], v[88:91]
    ds_read_b64_tr_b16 a[76:77], v15 offset:16384
    v_mfma_f32_16x16x32_bf16 v[104:107], a[4:7], a[204:207], v[104:107]
    ds_read_b64_tr_b16 a[80:81], v16 offset:16384
    s_waitcnt lgkmcnt(13)
    v_mfma_f32_16x16x32_bf16 v[104:107], a[36:39], a[220:223], v[104:107]
    ds_read_b64_tr_b16 a[84:85], v17 offset:16384
    v_mfma_f32_16x16x32_bf16 v[100:103], a[36:39], a[216:219], v[100:103]
    buffer_load_dwordx4 v218, s[8:11], s16 offen offset:2048 nt lds
    v_mfma_f32_16x16x32_bf16 v[100:103], a[4:7], a[200:203], v[100:103]
    ds_read_b64_tr_b16 a[88:89], v18 offset:16384
    v_mfma_f32_16x16x32_bf16 v[96:99], a[4:7], a[196:199], v[96:99]
    ds_read_b64_tr_b16 a[92:93], v19 offset:16384
    v_mfma_f32_16x16x32_bf16 v[96:99], a[36:39], a[212:215], v[96:99]
    s_cmp_eq_u32 s28, 6
    s_cselect_b32 s100, 6, 63
    s_and_b32 s28, s82, 63
    v_mfma_f32_16x16x32_bf16 v[92:95], a[36:39], a[208:211], v[92:95]
    buffer_load_dwordx4 v219, s[8:11], s16 offen offset:3072 nt lds
    v_mfma_f32_16x16x32_bf16 v[92:95], a[4:7], a[192:195], v[92:95]
    s_add_u32 m0, s17, 65536
    s_mul_i32 s93, s28, 8192
    s_add_u32 s93, s93, s23
    v_mfma_f32_16x16x32_bf16 v[108:111], a[8:11], a[192:195], v[108:111]
    ds_read_b128 a[232:235], v253 offset:43008
    s_mov_b32 s92, s93
    s_waitcnt lgkmcnt(15)
    v_mfma_f32_16x16x32_bf16 v[108:111], a[40:43], a[208:211], v[108:111]
    s_waitcnt lgkmcnt(11)
    ds_read_b128 a[236:239], v253 offset:44032
    v_mfma_f32_16x16x32_bf16 v[112:115], a[40:43], a[212:215], v[112:115]
    buffer_load_dwordx4 v220, s[12:15], s16 offen offset:0 nt lds
    v_mfma_f32_16x16x32_bf16 v[112:115], a[8:11], a[196:199], v[112:115]
    s_waitcnt vmcnt(13)
    ds_read_b64_tr_b16 a[66:67], v28 offset:16384
    v_mfma_f32_16x16x32_bf16 v[116:119], a[8:11], a[200:203], v[116:119]
    ds_read_b64_tr_b16 a[70:71], v29 offset:16384
    s_mul_i32 s94, s28, 3584
    v_mfma_f32_16x16x32_bf16 v[116:119], a[40:43], a[216:219], v[116:119]
    ds_read_b64_tr_b16 a[74:75], v30 offset:16384
    s_add_u32 s94, s94, s23
    v_mfma_f32_16x16x32_bf16 v[120:123], a[40:43], a[220:223], v[120:123]
    buffer_load_dwordx4 v221, s[12:15], s16 offen offset:1024 nt lds
    v_mfma_f32_16x16x32_bf16 v[120:123], a[8:11], a[204:207], v[120:123]
    ds_read_b64_tr_b16 a[78:79], v31 offset:16384
    s_add_u32 s94, s94, 983040
    v_mfma_f32_16x16x32_bf16 v[136:139], a[12:15], a[204:207], v[136:139]
    ds_read_b64_tr_b16 a[82:83], v32 offset:16384
    s_mul_i32 s95, s28, 7168
    v_mfma_f32_16x16x32_bf16 v[136:139], a[44:47], a[220:223], v[136:139]
    ds_read_b64_tr_b16 a[86:87], v33 offset:16384
    s_add_u32 s95, s95, s23
    v_mfma_f32_16x16x32_bf16 v[132:135], a[44:47], a[216:219], v[132:135]
    buffer_load_dwordx4 v222, s[12:15], s16 offen offset:2048 nt lds
    v_mfma_f32_16x16x32_bf16 v[132:135], a[12:15], a[200:203], v[132:135]
    ds_read_b64_tr_b16 a[90:91], v34 offset:16384
    s_add_u32 s95, s95, 524288
    v_mfma_f32_16x16x32_bf16 v[128:131], a[12:15], a[196:199], v[128:131]
    ds_read_b64_tr_b16 a[94:95], v35 offset:16384
    v_mfma_f32_16x16x32_bf16 v[128:131], a[44:47], a[212:215], v[128:131]
    v_mfma_f32_16x16x32_bf16 v[124:127], a[44:47], a[208:211], v[124:127]
    buffer_load_dwordx4 v223, s[12:15], s16 offen offset:3072 nt lds
    v_mfma_f32_16x16x32_bf16 v[124:127], a[12:15], a[192:195], v[124:127]
    s_add_u32 s16, s16, s30
    s_add_u32 m0, s17, 16384
    v_mfma_f32_16x16x32_bf16 v[140:143], a[16:19], a[192:195], v[140:143]
    ds_read_b128 a[240:243], v253 offset:45056
    v_mfma_f32_16x16x32_bf16 v[140:143], a[48:51], a[208:211], v[140:143]
    s_waitcnt lgkmcnt(11)
    ds_read_b128 a[244:247], v253 offset:46080
    v_mfma_f32_16x16x32_bf16 v[144:147], a[48:51], a[212:215], v[144:147]
    buffer_load_dwordx4 v216, s[8:11], s16 offen offset:0 nt lds
    v_mfma_f32_16x16x32_bf16 v[144:147], a[16:19], a[196:199], v[144:147]
    s_waitcnt vmcnt(13)
    ds_read_b64_tr_b16 a[96:97], v12 offset:32768
    v_mfma_f32_16x16x32_bf16 v[148:151], a[16:19], a[200:203], v[148:151]
    ds_read_b64_tr_b16 a[100:101], v13 offset:32768
    v_mfma_f32_16x16x32_bf16 v[148:151], a[48:51], a[216:219], v[148:151]
    ds_read_b64_tr_b16 a[104:105], v14 offset:32768
    v_mfma_f32_16x16x32_bf16 v[152:155], a[48:51], a[220:223], v[152:155]
    buffer_load_dwordx4 v217, s[8:11], s16 offen offset:1024 nt lds
    v_mfma_f32_16x16x32_bf16 v[152:155], a[16:19], a[204:207], v[152:155]
    ds_read_b64_tr_b16 a[108:109], v15 offset:32768
    v_mfma_f32_16x16x32_bf16 v[168:171], a[20:23], a[204:207], v[168:171]
    ds_read_b64_tr_b16 a[112:113], v16 offset:32768
    v_mfma_f32_16x16x32_bf16 v[168:171], a[52:55], a[220:223], v[168:171]
    ds_read_b64_tr_b16 a[116:117], v17 offset:32768
    v_mfma_f32_16x16x32_bf16 v[164:167], a[52:55], a[216:219], v[164:167]
    buffer_load_dwordx4 v218, s[8:11], s16 offen offset:2048 nt lds
    v_mfma_f32_16x16x32_bf16 v[164:167], a[20:23], a[200:203], v[164:167]
    ds_read_b64_tr_b16 a[120:121], v18 offset:32768
    v_mfma_f32_16x16x32_bf16 v[160:163], a[20:23], a[196:199], v[160:163]
    ds_read_b64_tr_b16 a[124:125], v19 offset:32768
    v_mfma_f32_16x16x32_bf16 v[160:163], a[52:55], a[212:215], v[160:163]
    v_mfma_f32_16x16x32_bf16 v[156:159], a[52:55], a[208:211], v[156:159]
    buffer_load_dwordx4 v219, s[8:11], s16 offen offset:3072 nt lds
    v_mfma_f32_16x16x32_bf16 v[156:159], a[20:23], a[192:195], v[156:159]
    s_add_u32 m0, s17, 81920
    v_mfma_f32_16x16x32_bf16 v[172:175], a[24:27], a[192:195], v[172:175]
    ds_read_b128 a[248:251], v253 offset:47104
    v_mfma_f32_16x16x32_bf16 v[172:175], a[56:59], a[208:211], v[172:175]
    s_waitcnt lgkmcnt(11)
    ds_read_b128 a[252:255], v253 offset:48128
    v_mfma_f32_16x16x32_bf16 v[176:179], a[56:59], a[212:215], v[176:179]
    buffer_load_dwordx4 v220, s[12:15], s16 offen offset:0 nt lds
    v_mfma_f32_16x16x32_bf16 v[176:179], a[24:27], a[196:199], v[176:179]
    s_waitcnt vmcnt(13)
    ds_read_b64_tr_b16 a[98:99], v28 offset:32768
    v_mfma_f32_16x16x32_bf16 v[180:183], a[24:27], a[200:203], v[180:183]
    ds_read_b64_tr_b16 a[102:103], v29 offset:32768
    v_mfma_f32_16x16x32_bf16 v[180:183], a[56:59], a[216:219], v[180:183]
    ds_read_b64_tr_b16 a[106:107], v30 offset:32768
    v_mfma_f32_16x16x32_bf16 v[184:187], a[56:59], a[220:223], v[184:187]
    buffer_load_dwordx4 v221, s[12:15], s16 offen offset:1024 nt lds
    v_mfma_f32_16x16x32_bf16 v[184:187], a[24:27], a[204:207], v[184:187]
    ds_read_b64_tr_b16 a[110:111], v31 offset:32768
    v_mfma_f32_16x16x32_bf16 v[200:203], a[28:31], a[204:207], v[200:203]
    ds_read_b64_tr_b16 a[114:115], v32 offset:32768
    v_mfma_f32_16x16x32_bf16 v[200:203], a[60:63], a[220:223], v[200:203]
    ds_read_b64_tr_b16 a[118:119], v33 offset:32768
    v_mfma_f32_16x16x32_bf16 v[196:199], a[60:63], a[216:219], v[196:199]
    buffer_load_dwordx4 v222, s[12:15], s16 offen offset:2048 nt lds
    v_mfma_f32_16x16x32_bf16 v[196:199], a[28:31], a[200:203], v[196:199]
    ds_read_b64_tr_b16 a[122:123], v34 offset:32768
    v_mfma_f32_16x16x32_bf16 v[192:195], a[28:31], a[196:199], v[192:195]
    ds_read_b64_tr_b16 a[126:127], v35 offset:32768
    v_mfma_f32_16x16x32_bf16 v[192:195], a[60:63], a[212:215], v[192:195]
    v_mfma_f32_16x16x32_bf16 v[188:191], a[60:63], a[208:211], v[188:191]
    buffer_load_dwordx4 v223, s[12:15], s16 offen offset:3072 nt lds
    v_mfma_f32_16x16x32_bf16 v[188:191], a[28:31], a[192:195], v[188:191]
    v_mfma_f32_16x16x32_bf16 v[76:79], a[64:67], a[224:227], v[76:79]
    s_waitcnt lgkmcnt(7)
    v_mfma_f32_16x16x32_bf16 v[76:79], a[96:99], a[240:243], v[76:79]
    v_mfma_f32_16x16x32_bf16 v[80:83], a[96:99], a[244:247], v[80:83]
    buffer_load_dwordx4 v[224:227], v2, s[4:7], s32 offen
    v_mfma_f32_16x16x32_bf16 v[80:83], a[64:67], a[228:231], v[80:83]
    v_mfma_f32_16x16x32_bf16 v[84:87], a[64:67], a[232:235], v[84:87]
    v_mfma_f32_16x16x32_bf16 v[84:87], a[96:99], a[248:251], v[84:87]
    v_mfma_f32_16x16x32_bf16 v[88:91], a[96:99], a[252:255], v[88:91]
    buffer_load_dwordx4 v[228:231], v2, s[4:7], s18 offen
    v_mfma_f32_16x16x32_bf16 v[88:91], a[64:67], a[236:239], v[88:91]
    v_mfma_f32_16x16x32_bf16 v[104:107], a[68:71], a[236:239], v[104:107]
    s_waitcnt lgkmcnt(6)
    v_mfma_f32_16x16x32_bf16 v[104:107], a[100:103], a[252:255], v[104:107]
    v_mfma_f32_16x16x32_bf16 v[100:103], a[100:103], a[248:251], v[100:103]
    buffer_load_dword v6, v3, s[60:63], s33 offen
    v_mfma_f32_16x16x32_bf16 v[100:103], a[68:71], a[232:235], v[100:103]
    v_mfma_f32_16x16x32_bf16 v[96:99], a[68:71], a[228:231], v[96:99]
    v_mfma_f32_16x16x32_bf16 v[96:99], a[100:103], a[244:247], v[96:99]
    v_mfma_f32_16x16x32_bf16 v[92:95], a[100:103], a[240:243], v[92:95]
    v_mfma_f32_16x16x32_bf16 v[92:95], a[68:71], a[224:227], v[92:95]
    v_mfma_f32_16x16x32_bf16 v[108:111], a[72:75], a[224:227], v[108:111]
    s_waitcnt lgkmcnt(5)
    v_mfma_f32_16x16x32_bf16 v[108:111], a[104:107], a[240:243], v[108:111]
L_pg2:
    s_cbranch_execz L_pg6
    v_mfma_f32_16x16x32_bf16 v[112:115], a[104:107], a[244:247], v[112:115]
    v_mfma_f32_16x16x32_bf16 v[112:115], a[72:75], a[228:231], v[112:115]
    v_mfma_f32_16x16x32_bf16 v[116:119], a[72:75], a[232:235], v[116:119]
    v_cvt_pk_bf16_f32 v12, v76, v77
    v_cvt_pk_bf16_f32 v13, v78, v79
    v_mfma_f32_16x16x32_bf16 v[116:119], a[104:107], a[248:251], v[116:119]
    v_cvt_pk_bf16_f32 v14, v92, v93
    v_cvt_pk_bf16_f32 v15, v94, v95
    v_mfma_f32_16x16x32_bf16 v[120:123], a[104:107], a[252:255], v[120:123]
    v_cvt_pk_bf16_f32 v28, v80, v81
    v_cvt_pk_bf16_f32 v29, v82, v83
    v_mfma_f32_16x16x32_bf16 v[120:123], a[72:75], a[236:239], v[120:123]
    v_cvt_pk_bf16_f32 v30, v96, v97
    v_cvt_pk_bf16_f32 v31, v98, v99
    v_mfma_f32_16x16x32_bf16 v[136:139], a[76:79], a[236:239], v[136:139]
    v_cvt_pk_bf16_f32 v44, v84, v85
    v_cvt_pk_bf16_f32 v45, v86, v87
    s_waitcnt lgkmcnt(4)
    v_mfma_f32_16x16x32_bf16 v[136:139], a[108:111], a[252:255], v[136:139]
    v_cvt_pk_bf16_f32 v46, v100, v101
    v_cvt_pk_bf16_f32 v47, v102, v103
    v_mfma_f32_16x16x32_bf16 v[132:135], a[108:111], a[248:251], v[132:135]
    v_cvt_pk_bf16_f32 v60, v88, v89
    v_cvt_pk_bf16_f32 v61, v90, v91
    v_mfma_f32_16x16x32_bf16 v[132:135], a[76:79], a[232:235], v[132:135]
    v_cvt_pk_bf16_f32 v62, v104, v105
    v_cvt_pk_bf16_f32 v63, v106, v107
    v_mfma_f32_16x16x32_bf16 v[128:131], a[76:79], a[228:231], v[128:131]
    v_mfma_f32_16x16x32_bf16 v[128:131], a[108:111], a[244:247], v[128:131]
    v_mfma_f32_16x16x32_bf16 v[124:127], a[108:111], a[240:243], v[124:127]
    v_mfma_f32_16x16x32_bf16 v[124:127], a[76:79], a[224:227], v[124:127]
    v_mfma_f32_16x16x32_bf16 v[140:143], a[80:83], a[224:227], v[140:143]
    s_waitcnt lgkmcnt(3)
    v_mfma_f32_16x16x32_bf16 v[140:143], a[112:115], a[240:243], v[140:143]
    v_mfma_f32_16x16x32_bf16 v[144:147], a[112:115], a[244:247], v[144:147]
    v_mfma_f32_16x16x32_bf16 v[144:147], a[80:83], a[228:231], v[144:147]
    v_mfma_f32_16x16x32_bf16 v[148:151], a[80:83], a[232:235], v[148:151]
    v_cvt_pk_bf16_f32 v16, v108, v109
    v_cvt_pk_bf16_f32 v17, v110, v111
    v_mfma_f32_16x16x32_bf16 v[148:151], a[112:115], a[248:251], v[148:151]
    v_cvt_pk_bf16_f32 v18, v124, v125
    v_cvt_pk_bf16_f32 v19, v126, v127
    v_mfma_f32_16x16x32_bf16 v[152:155], a[112:115], a[252:255], v[152:155]
    v_cvt_pk_bf16_f32 v32, v112, v113
    v_cvt_pk_bf16_f32 v33, v114, v115
    v_mfma_f32_16x16x32_bf16 v[152:155], a[80:83], a[236:239], v[152:155]
    v_cvt_pk_bf16_f32 v34, v128, v129
    v_cvt_pk_bf16_f32 v35, v130, v131
    v_mfma_f32_16x16x32_bf16 v[168:171], a[84:87], a[236:239], v[168:171]
    v_cvt_pk_bf16_f32 v48, v116, v117
    v_cvt_pk_bf16_f32 v49, v118, v119
    s_waitcnt lgkmcnt(2)
    v_mfma_f32_16x16x32_bf16 v[168:171], a[116:119], a[252:255], v[168:171]
    v_cvt_pk_bf16_f32 v50, v132, v133
    v_cvt_pk_bf16_f32 v51, v134, v135
    v_mfma_f32_16x16x32_bf16 v[164:167], a[116:119], a[248:251], v[164:167]
    v_cvt_pk_bf16_f32 v64, v120, v121
    v_cvt_pk_bf16_f32 v65, v122, v123
    v_mfma_f32_16x16x32_bf16 v[164:167], a[84:87], a[232:235], v[164:167]
    v_cvt_pk_bf16_f32 v66, v136, v137
    v_cvt_pk_bf16_f32 v67, v138, v139
    v_mfma_f32_16x16x32_bf16 v[160:163], a[84:87], a[228:231], v[160:163]
    v_mfma_f32_16x16x32_bf16 v[160:163], a[116:119], a[244:247], v[160:163]
    v_mfma_f32_16x16x32_bf16 v[156:159], a[116:119], a[240:243], v[156:159]
    v_mfma_f32_16x16x32_bf16 v[156:159], a[84:87], a[224:227], v[156:159]
    v_mfma_f32_16x16x32_bf16 v[172:175], a[88:91], a[224:227], v[172:175]
    s_waitcnt lgkmcnt(1)
    v_mfma_f32_16x16x32_bf16 v[172:175], a[120:123], a[240:243], v[172:175]
    v_mfma_f32_16x16x32_bf16 v[176:179], a[120:123], a[244:247], v[176:179]
    v_mfma_f32_16x16x32_bf16 v[176:179], a[88:91], a[228:231], v[176:179]
    v_mfma_f32_16x16x32_bf16 v[180:183], a[88:91], a[232:235], v[180:183]
    v_cvt_pk_bf16_f32 v20, v140, v141
    v_cvt_pk_bf16_f32 v21, v142, v143
    v_mfma_f32_16x16x32_bf16 v[180:183], a[120:123], a[248:251], v[180:183]
    v_cvt_pk_bf16_f32 v22, v156, v157
    v_cvt_pk_bf16_f32 v23, v158, v159
    v_mfma_f32_16x16x32_bf16 v[184:187], a[120:123], a[252:255], v[184:187]
    v_cvt_pk_bf16_f32 v36, v144, v145
    v_cvt_pk_bf16_f32 v37, v146, v147
    v_mfma_f32_16x16x32_bf16 v[184:187], a[88:91], a[236:239], v[184:187]
    v_cvt_pk_bf16_f32 v38, v160, v161
    v_cvt_pk_bf16_f32 v39, v162, v163
    v_mfma_f32_16x16x32_bf16 v[200:203], a[92:95], a[236:239], v[200:203]
    v_cvt_pk_bf16_f32 v52, v148, v149
    v_cvt_pk_bf16_f32 v53, v150, v151
    s_waitcnt lgkmcnt(0)
    v_mfma_f32_16x16x32_bf16 v[200:203], a[124:127], a[252:255], v[200:203]
    v_cvt_pk_bf16_f32 v54, v164, v165
    v_cvt_pk_bf16_f32 v55, v166, v167
    v_mfma_f32_16x16x32_bf16 v[196:199], a[124:127], a[248:251], v[196:199]
    v_cvt_pk_bf16_f32 v68, v152, v153
    v_cvt_pk_bf16_f32 v69, v154, v155
    v_mfma_f32_16x16x32_bf16 v[196:199], a[92:95], a[232:235], v[196:199]
    v_cvt_pk_bf16_f32 v70, v168, v169
    v_cvt_pk_bf16_f32 v71, v170, v171
    v_mfma_f32_16x16x32_bf16 v[192:195], a[92:95], a[228:231], v[192:195]
    v_mfma_f32_16x16x32_bf16 v[192:195], a[124:127], a[244:247], v[192:195]
    v_mfma_f32_16x16x32_bf16 v[188:191], a[124:127], a[240:243], v[188:191]
    v_mfma_f32_16x16x32_bf16 v[188:191], a[92:95], a[224:227], v[188:191]
    s_nop 7
    v_cvt_pk_bf16_f32 v24, v172, v173
    v_cvt_pk_bf16_f32 v25, v174, v175
    v_cvt_pk_bf16_f32 v26, v188, v189
    v_cvt_pk_bf16_f32 v27, v190, v191
    v_cvt_pk_bf16_f32 v40, v176, v177
    v_cvt_pk_bf16_f32 v41, v178, v179
    v_cvt_pk_bf16_f32 v42, v192, v193
    v_cvt_pk_bf16_f32 v43, v194, v195
    v_cvt_pk_bf16_f32 v56, v180, v181
    v_cvt_pk_bf16_f32 v57, v182, v183
    v_cvt_pk_bf16_f32 v58, v196, v197
    v_cvt_pk_bf16_f32 v59, v198, v199
    v_cvt_pk_bf16_f32 v72, v184, v185
    v_cvt_pk_bf16_f32 v73, v186, v187
    v_cvt_pk_bf16_f32 v74, v200, v201
    v_cvt_pk_bf16_f32 v75, v202, v203
    s_add_u32 s16, s16, s30
    s_mov_b64 s[40:41], s[50:51]
    s_mov_b32 s42, 31872
    s_add_u32 s60, s40, 64
    s_addc_u32 s61, s41, 0
    s_mov_b32 s62, 31872
    s_waitcnt vmcnt(11)
    s_barrier
    ds_read_b128 a[128:131], v204 offset:0
    ds_read_b128 a[132:135], v205 offset:0
    ds_read_b128 a[136:139], v206 offset:0
    ds_read_b128 a[140:143], v207 offset:0
    v_add_u32 v160, 65536, v252
    ds_read_b128 v[156:159], v160
    v_mov_b32 v192, 0
    v_mov_b32 v193, 0
    v_mov_b32 v194, 0
    v_mov_b32 v195, 0
    v_mov_b32 v196, 0
    v_mov_b32 v197, 0
    v_mov_b32 v198, 0
    v_mov_b32 v199, 0
    v_mov_b32 v200, 0
    v_mov_b32 v201, 0
    v_mov_b32 v202, 0
    v_mov_b32 v203, 0
    v_mov_b32 v248, 0
    v_mov_b32 v249, 0
    v_mov_b32 v250, 0
    v_mov_b32 v251, 0
    v_bfe_i32 v11, v0, 0, 1
    v_and_b32 v11, 0xaaaaaaaa, v11
    v_or_b32 v11, 0x44444444, v11
    v_mov_b32 v188, 0x3f803f80
    v_mov_b32 v189, 0x3f803f80
    v_mov_b32 v190, 0x3f803f80
    v_mov_b32 v191, 0x3f803f80
    s_waitcnt lgkmcnt(0)
    v_mfma_f32_16x16x32_bf16 v[76:79], a[128:131], v[12:15], 0
    ds_read_b128 a[144:147], v204 offset:4096
    v_lshlrev_b32 v160, 16, v156
    v_mfma_f32_16x16x32_bf16 v[76:79], a[132:135], v[16:19], v[76:79]
    ds_read_b128 a[148:151], v205 offset:4096
    v_lshlrev_b32 v161, 16, v157
    v_mfma_f32_16x16x32_bf16 v[76:79], a[136:139], v[20:23], v[76:79]
    ds_read_b128 a[152:155], v206 offset:4096
    v_lshlrev_b32 v162, 16, v158
    v_mfma_f32_16x16x32_bf16 v[76:79], a[140:143], v[24:27], v[76:79]
    ds_read_b128 a[156:159], v207 offset:4096
    v_lshlrev_b32 v163, 16, v159
    v_mfma_f32_16x16x32_bf16 v[80:83], a[128:131], v[28:31], 0
    ds_read_b128 a[160:163], v204 offset:8192
    v_max3_f32 v156, |v156|, |v157|, |v158|
    v_mfma_f32_16x16x32_bf16 v[80:83], a[132:135], v[32:35], v[80:83]
    ds_read_b128 a[164:167], v205 offset:8192
    v_max3_f32 v160, |v160|, |v161|, |v162|
    v_mfma_f32_16x16x32_bf16 v[80:83], a[136:139], v[36:39], v[80:83]
    ds_read_b128 a[168:171], v206 offset:8192
    v_max3_f32 v156, v156, |v159|, |v163|
    v_mfma_f32_16x16x32_bf16 v[80:83], a[140:143], v[40:43], v[80:83]
    ds_read_b128 a[172:175], v207 offset:8192
    v_max_f32 v156, v156, v160
    v_mfma_f32_16x16x32_bf16 v[108:111], a[128:131], v[44:47], 0
    ds_read_b128 a[176:179], v204 offset:12288
    v_min_f32 v156, 0x5d800000, v156
    v_mfma_f32_16x16x32_bf16 v[108:111], a[132:135], v[48:51], v[108:111]
    ds_read_b128 a[180:183], v205 offset:12288
    v_min_f32_dpp v156, v156, v156 row_ror:8 row_mask:0xf bank_mask:0xf
    v_mfma_f32_16x16x32_bf16 v[108:111], a[136:139], v[52:55], v[108:111]
    ds_read_b128 a[184:187], v206 offset:12288
    v_min_f32_dpp v156, v156, v156 row_ror:4 row_mask:0xf bank_mask:0xf
    v_mfma_f32_16x16x32_bf16 v[108:111], a[140:143], v[56:59], v[108:111]
    s_nop 0
    v_min_f32_dpp v156, v156, v156 row_ror:2 row_mask:0xf bank_mask:0xf
    v_mfma_f32_16x16x32_bf16 v[112:115], a[128:131], v[60:63], 0
    s_nop 0
    v_min_f32_dpp v156, v156, v156 row_ror:1 row_mask:0xf bank_mask:0xf
    v_mfma_f32_16x16x32_bf16 v[112:115], a[132:135], v[64:67], v[112:115]
    v_readlane_b32 s4, v156, 0
    v_readlane_b32 s5, v156, 16
    v_mfma_f32_16x16x32_bf16 v[112:115], a[136:139], v[68:71], v[112:115]
    v_readlane_b32 s6, v156, 32
    v_readlane_b32 s7, v156, 48
    v_mfma_f32_16x16x32_bf16 v[112:115], a[140:143], v[72:75], v[112:115]
    v_mov_b32 v156, s4
    v_min_u32 v156, s5, v156
    v_max3_f32 v172, v76, v77, v78
    v_max_f32 v172, v172, v79
    v_max3_f32 v176, v80, v81, v82
    v_max_f32 v176, v176, v83
    v_max3_f32 v180, v108, v109, v110
    v_max_f32 v180, v180, v111
    s_nop 1
    v_max3_f32 v184, v112, v113, v114
    v_max_f32 v184, v184, v115
    v_min_u32 v156, s6, v156
    v_min_u32 v156, s7, v156
    v_mul_f32 v156, 0x3b000000, v156
    s_nop 0
    v_readfirstlane_b32 s33, v156
    v_accvgpr_write_b32 a92, v156
    v_accvgpr_write_b32 a93, v156
    v_accvgpr_write_b32 a94, v156
    v_accvgpr_write_b32 a95, v156
L_entry:
    s_mov_b32 s29, 0xc1a00000
    v_mov_b32 v173, v172
    v_mov_b32 v177, v176
    v_mov_b32 v181, v180
    v_mov_b32 v185, v184
    v_permlane32_swap_b32 v172, v173
    v_permlane32_swap_b32 v176, v177
    v_permlane32_swap_b32 v180, v181
    v_permlane32_swap_b32 v184, v185
    v_max_f32 v172, v172, v173
    v_max_f32 v176, v176, v177
    v_max_f32 v180, v180, v181
    v_max_f32 v184, v184, v185
    v_mov_b32 v173, v172
    v_mov_b32 v177, v176
    v_mov_b32 v181, v180
    v_mov_b32 v185, v184
    v_permlane16_swap_b32 v172, v173
    v_permlane16_swap_b32 v176, v177
    v_permlane16_swap_b32 v180, v181
    v_permlane16_swap_b32 v184, v185
    v_max_f32 v172, v172, v173
    v_max_f32 v176, v176, v177
    v_max_f32 v180, v180, v181
    v_max_f32 v184, v184, v185
    v_sub_f32 v173, s29, v172
    v_sub_f32 v174, s29, v172
    v_sub_f32 v175, s29, v172
    v_sub_f32 v172, s29, v172
    v_sub_f32 v177, s29, v176
    v_sub_f32 v178, s29, v176
    v_sub_f32 v179, s29, v176
    v_sub_f32 v176, s29, v176
    v_sub_f32 v181, s29, v180
    v_sub_f32 v182, s29, v180
    v_sub_f32 v183, s29, v180
    v_sub_f32 v180, s29, v180
    v_sub_f32 v185, s29, v184
    v_sub_f32 v186, s29, v184
    v_sub_f32 v187, s29, v184
    v_sub_f32 v184, s29, v184
    s_mov_b32 s18, 8
    s_waitcnt lgkmcnt(0)
    v_mfma_f32_16x16x32_bf16 v[76:79], a[128:131], v[12:15], v[172:175]
    v_mfma_f32_16x16x32_bf16 v[76:79], a[132:135], v[16:19], v[76:79]
    ds_read_b128 a[188:191], v207 offset:12288
    v_mfma_f32_16x16x32_bf16 v[76:79], a[136:139], v[20:23], v[76:79]
    s_add_u32 m0, s17, 32768
    v_mfma_f32_16x16x32_bf16 v[76:79], a[140:143], v[24:27], v[76:79]
    buffer_load_dwordx4 v216, s[8:11], s16 offen offset:0 nt lds
    v_mfma_f32_16x16x32_bf16 v[80:83], a[140:143], v[40:43], v[176:179]
    v_mfma_f32_16x16x32_bf16 v[80:83], a[136:139], v[36:39], v[80:83]
    s_nop 1
    v_mfma_f32_16x16x32_bf16 v[80:83], a[132:135], v[32:35], v[80:83]
    v_mfma_f32_16x16x32_bf16 v[80:83], a[128:131], v[28:31], v[80:83]
    buffer_load_dwordx4 v217, s[8:11], s16 offen offset:1024 nt lds
    v_mfma_f32_16x16x32_bf16 v[88:91], a[144:147], v[28:31], v[176:179]
    v_exp_f32 v76, v76
    v_mfma_f32_16x16x32_bf16 v[88:91], a[148:151], v[32:35], v[88:91]
    v_mfma_f32_16x16x32_bf16 v[88:91], a[152:155], v[36:39], v[88:91]
    v_exp_f32 v77, v77
    v_mfma_f32_16x16x32_bf16 v[88:91], a[156:159], v[40:43], v[88:91]
    buffer_load_dwordx4 v218, s[8:11], s16 offen offset:2048 nt lds
    v_mfma_f32_16x16x32_bf16 v[84:87], a[156:159], v[24:27], v[172:175]
    v_exp_f32 v78, v78
    v_mfma_f32_16x16x32_bf16 v[84:87], a[152:155], v[20:23], v[84:87]
    v_cvt_pk_bf16_f32 v140, v76, v77
    v_mfma_f32_16x16x32_bf16 v[84:87], a[148:151], v[16:19], v[84:87]
    s_waitcnt lgkmcnt(0)
    v_exp_f32 v79, v79
    v_mfma_f32_16x16x32_bf16 v[84:87], a[144:147], v[12:15], v[84:87]
    buffer_load_dwordx4 v219, s[8:11], s16 offen offset:3072 nt lds
    v_mfma_f32_16x16x32_bf16 v[92:95], a[160:163], v[12:15], v[172:175]
    v_exp_f32 v80, v80
    v_mfma_f32_16x16x32_bf16 v[92:95], a[164:167], v[16:19], v[92:95]
    v_cvt_pk_bf16_f32 v141, v78, v79
    v_mfma_f32_16x16x32_bf16 v[92:95], a[168:171], v[20:23], v[92:95]
    s_add_u32 m0, s17, 98304
    v_exp_f32 v81, v81
    v_mfma_f32_16x16x32_bf16 v[92:95], a[172:175], v[24:27], v[92:95]
    buffer_load_dwordx4 v220, s[12:15], s16 offen offset:0 nt lds
    v_mfma_f32_16x16x32_bf16 v[96:99], a[172:175], v[40:43], v[176:179]
    v_exp_f32 v82, v82
    v_mfma_f32_16x16x32_bf16 v[96:99], a[168:171], v[36:39], v[96:99]
    v_cvt_pk_bf16_f32 v148, v80, v81
    v_mfma_f32_16x16x32_bf16 v[96:99], a[164:167], v[32:35], v[96:99]
    v_exp_f32 v83, v83
    v_mfma_f32_16x16x32_bf16 v[96:99], a[160:163], v[28:31], v[96:99]
    buffer_load_dwordx4 v221, s[12:15], s16 offen offset:1024 nt lds
    v_mfma_f32_16x16x32_bf16 v[104:107], a[176:179], v[28:31], v[176:179]
    v_exp_f32 v88, v88
    v_mfma_f32_16x16x32_bf16 v[104:107], a[180:183], v[32:35], v[104:107]
    v_cvt_pk_bf16_f32 v149, v82, v83
    v_mfma_f32_16x16x32_bf16 v[104:107], a[184:187], v[36:39], v[104:107]
    v_exp_f32 v89, v89
    v_mfma_f32_16x16x32_bf16 v[104:107], a[188:191], v[40:43], v[104:107]
    buffer_load_dwordx4 v222, s[12:15], s16 offen offset:2048 nt lds
    v_mfma_f32_16x16x32_bf16 v[100:103], a[188:191], v[24:27], v[172:175]
    v_exp_f32 v90, v90
    v_mfma_f32_16x16x32_bf16 v[100:103], a[184:187], v[20:23], v[100:103]
    v_cvt_pk_bf16_f32 v150, v88, v89
    v_mfma_f32_16x16x32_bf16 v[100:103], a[180:183], v[16:19], v[100:103]
    v_exp_f32 v91, v91
    v_mfma_f32_16x16x32_bf16 v[100:103], a[176:179], v[12:15], v[100:103]
    buffer_load_dwordx4 v223, s[12:15], s16 offen offset:3072 nt lds
    s_waitcnt vmcnt(8)
    v_and_b32 v7, 0xffff0000, v6
    v_lshlrev_b32 v6, 16, v6
    s_add_u32 m0, s80, 0
    v_exp_f32 v84, v84
    v_mul_f32 v156, 0xbfb8aa3b, v6
    v_mul_f32 v157, 0xbfb8aa3b, v7
    v_exp_f32 v156, v156
    s_bitcmp1_b32 s74, 31
    v_cvt_pk_bf16_f32 v151, v90, v91
    buffer_load_dwordx4 v237, s[40:43], 0 offen sc1 lds
    v_exp_f32 v157, v157
    v_and_b32 v254, 3, v0
    v_add_f32 v156, 1.0, v156
    s_add_u32 s16, s16, s30
    v_exp_f32 v85, v85
    v_add_f32 v157, 1.0, v157
    v_rcp_f32 v156, v156
    v_rcp_f32 v157, v157
    ds_read_b64_tr_b16 a[192:193], v208 offset:0
    v_cvt_pk_bf16_f32 v142, v84, v85
    v_lshlrev_b32 v254, 5, v254
    v_mul_f32 v6, v6, v156
    v_mul_f32 v7, v7, v157
    s_mov_b32 s74, s75
    v_exp_f32 v86, v86
    v_lshlrev_b32 v156, 16, v224
    v_and_b32 v157, 0xffff0000, v224
    ds_read_b64_tr_b16 a[194:195], v208 offset:4096
    v_lshlrev_b32 v158, 16, v225
    v_and_b32 v159, 0xffff0000, v225
    s_mov_b32 s75, s76
    v_exp_f32 v87, v87
    v_lshlrev_b32 v160, 16, v226
    v_and_b32 v161, 0xffff0000, v226
    ds_read_b64_tr_b16 a[224:225], v208 offset:8192
    v_cvt_pk_bf16_f32 v143, v86, v87
    v_lshlrev_b32 v162, 16, v227
    v_and_b32 v163, 0xffff0000, v227
    s_mov_b32 s76, s77
    v_exp_f32 v92, v92
    v_mul_f32 v164, v156, v6
    v_mul_f32 v165, v157, v6
    ds_read_b64_tr_b16 a[226:227], v208 offset:12288
    v_mul_f32 v166, v158, v6
    v_mul_f32 v167, v159, v6
    s_mov_b32 s77, s83
    v_exp_f32 v93, v93
    v_mul_f32 v168, v160, v6
    v_mul_f32 v169, v161, v6
    ds_read_b64_tr_b16 a[196:197], v209 offset:0
    v_cvt_pk_bf16_f32 v144, v92, v93
    v_mul_f32 v170, v162, v6
    v_mul_f32 v171, v163, v6
    s_mov_b32 s83, 2147483648
    v_exp_f32 v94, v94
    v_lshlrev_b32 v156, 16, v228
    v_and_b32 v157, 0xffff0000, v228
    ds_read_b64_tr_b16 a[198:199], v209 offset:4096
    v_lshlrev_b32 v158, 16, v229
    v_and_b32 v159, 0xffff0000, v229
    s_cmp_eq_u32 s18, 6
    v_exp_f32 v95, v95
    v_lshlrev_b32 v160, 16, v230
    v_and_b32 v161, 0xffff0000, v230
    ds_read_b64_tr_b16 a[228:229], v209 offset:8192
    v_cvt_pk_bf16_f32 v145, v94, v95
    v_lshlrev_b32 v162, 16, v231
    v_and_b32 v163, 0xffff0000, v231
    s_cselect_b32 s78, 7, 16
    v_exp_f32 v96, v96
    v_fmac_f32 v164, v156, v7
    v_fmac_f32 v165, v157, v7
    ds_read_b64_tr_b16 a[230:231], v209 offset:12288
    v_fmac_f32 v166, v158, v7
    v_fmac_f32 v167, v159, v7
    s_lshl_b32 s78, s78, 10
    v_exp_f32 v97, v97
    v_fmac_f32 v168, v160, v7
    v_fmac_f32 v169, v161, v7
    ds_read_b64_tr_b16 a[200:201], v210 offset:0
    v_cvt_pk_bf16_f32 v152, v96, v97
    v_fmac_f32 v170, v162, v7
    v_fmac_f32 v171, v163, v7
    s_cmp_eq_u32 s18, 3
    v_exp_f32 v98, v98
    v_permlane32_swap_b32 v164, v168
    v_permlane32_swap_b32 v165, v169
    ds_read_b64_tr_b16 a[202:203], v210 offset:4096
    v_permlane32_swap_b32 v166, v170
    v_permlane32_swap_b32 v167, v171
    s_cselect_b32 s81, s84, 2147483648
    v_exp_f32 v99, v99
    v_add_f32 v164, v164, v168
    v_add_f32 v165, v165, v169
    ds_read_b64_tr_b16 a[232:233], v210 offset:8192
    v_cvt_pk_bf16_f32 v153, v98, v99
    v_add_f32 v166, v166, v170
    v_add_f32 v167, v167, v171
    s_cmp_eq_u32 s18, 2
    v_exp_f32 v104, v104
    v_lshrrev_b32 v156, 4, v0
    v_permlane16_swap_b32 v164, v166
    ds_read_b64_tr_b16 a[234:235], v210 offset:12288
    v_permlane16_swap_b32 v165, v167
    v_add_f32 v164, v164, v166
    s_cselect_b32 s50, s21, 2147483648
    v_exp_f32 v105, v105
    v_add_f32 v165, v165, v167
    v_lshl_add_u32 v254, v156, 3, v254
    ds_read_b64_tr_b16 a[204:205], v211 offset:0
    v_cvt_pk_bf16_f32 v154, v104, v105
    v_add_f32_dpp v164, v164, v164 row_ror:8 row_mask:0xf bank_mask:0xf
    v_add_f32_dpp v165, v165, v165 row_ror:8 row_mask:0xf bank_mask:0xf
    v_exp_f32 v106, v106
    s_nop 0
    v_add_f32_dpp v164, v164, v164 row_ror:4 row_mask:0xf bank_mask:0xf
    ds_read_b64_tr_b16 a[206:207], v211 offset:4096
    v_add_f32_dpp v165, v165, v165 row_ror:4 row_mask:0xf bank_mask:0xf
    v_lshl_add_u32 v254, v1, 8, v254
    v_exp_f32 v107, v107
    v_add_u32 v254, 135168, v254
    ds_write_b64 v254, v[164:165] offset:0
    ds_read_b64_tr_b16 a[236:237], v211 offset:8192
    v_cvt_pk_bf16_f32 v155, v106, v107
    v_mfma_f32_16x16x32_bf16 v[76:79], a[128:131], v[44:47], v[180:183]
    v_exp_f32 v100, v100
    v_mfma_f32_16x16x32_bf16 v[76:79], a[132:135], v[48:51], v[76:79]
    ds_read_b64_tr_b16 a[238:239], v211 offset:12288
    v_mfma_f32_16x16x32_bf16 v[76:79], a[136:139], v[52:55], v[76:79]
    v_exp_f32 v101, v101
    v_mfma_f32_16x16x32_bf16 v[76:79], a[140:143], v[56:59], v[76:79]
    ds_read_b64_tr_b16 a[208:209], v212 offset:0
    v_cvt_pk_bf16_f32 v146, v100, v101
    v_mfma_f32_16x16x32_bf16 v[80:83], a[140:143], v[72:75], v[184:187]
    v_exp_f32 v102, v102
    v_mfma_f32_16x16x32_bf16 v[80:83], a[136:139], v[68:71], v[80:83]
    ds_read_b64_tr_b16 a[210:211], v212 offset:4096
    v_mfma_f32_16x16x32_bf16 v[80:83], a[132:135], v[64:67], v[80:83]
    v_exp_f32 v103, v103
    v_mfma_f32_16x16x32_bf16 v[80:83], a[128:131], v[60:63], v[80:83]
    ds_read_b64_tr_b16 a[240:241], v212 offset:8192
    v_cvt_pk_bf16_f32 v147, v102, v103
    v_mfma_f32_16x16x32_bf16 v[88:91], a[144:147], v[60:63], v[184:187]
    v_exp_f32 v76, v76
    v_mfma_f32_16x16x32_bf16 v[88:91], a[148:151], v[64:67], v[88:91]
    ds_read_b64_tr_b16 a[242:243], v212 offset:12288
    v_mfma_f32_16x16x32_bf16 v[88:91], a[152:155], v[68:71], v[88:91]
    v_exp_f32 v77, v77
    v_mfma_f32_16x16x32_bf16 v[88:91], a[156:159], v[72:75], v[88:91]
    ds_read_b64_tr_b16 a[212:213], v213 offset:0
    v_cvt_pk_bf16_f32 v156, v76, v77
    v_mfma_f32_16x16x32_bf16 v[84:87], a[156:159], v[56:59], v[180:183]
    v_exp_f32 v78, v78
    v_mfma_f32_16x16x32_bf16 v[84:87], a[152:155], v[52:55], v[84:87]
    ds_read_b64_tr_b16 a[214:215], v213 offset:4096
    v_mfma_f32_16x16x32_bf16 v[84:87], a[148:151], v[48:51], v[84:87]
    v_exp_f32 v79, v79
    v_mfma_f32_16x16x32_bf16 v[84:87], a[144:147], v[44:47], v[84:87]
    ds_read_b64_tr_b16 a[244:245], v213 offset:8192
    v_cvt_pk_bf16_f32 v157, v78, v79
    v_mfma_f32_16x16x32_bf16 v[92:95], a[160:163], v[44:47], v[180:183]
    v_exp_f32 v80, v80
    v_mfma_f32_16x16x32_bf16 v[92:95], a[164:167], v[48:51], v[92:95]
    ds_read_b64_tr_b16 a[246:247], v213 offset:12288
    v_mfma_f32_16x16x32_bf16 v[92:95], a[168:171], v[52:55], v[92:95]
    v_exp_f32 v81, v81
    v_mfma_f32_16x16x32_bf16 v[92:95], a[172:175], v[56:59], v[92:95]
    ds_read_b64_tr_b16 a[216:217], v214 offset:0
    v_cvt_pk_bf16_f32 v164, v80, v81
    v_mfma_f32_16x16x32_bf16 v[96:99], a[172:175], v[72:75], v[184:187]
    v_exp_f32 v82, v82
    v_mfma_f32_16x16x32_bf16 v[96:99], a[168:171], v[68:71], v[96:99]
    ds_read_b64_tr_b16 a[218:219], v214 offset:4096
    v_mfma_f32_16x16x32_bf16 v[96:99], a[164:167], v[64:67], v[96:99]
    v_exp_f32 v83, v83
    v_mfma_f32_16x16x32_bf16 v[96:99], a[160:163], v[60:63], v[96:99]
    ds_read_b64_tr_b16 a[248:249], v214 offset:8192
    v_cvt_pk_bf16_f32 v165, v82, v83
    v_mfma_f32_16x16x32_bf16 v[104:107], a[176:179], v[60:63], v[184:187]
    v_exp_f32 v88, v88
    v_mfma_f32_16x16x32_bf16 v[104:107], a[180:183], v[64:67], v[104:107]
    ds_read_b64_tr_b16 a[250:251], v214 offset:12288
    v_mfma_f32_16x16x32_bf16 v[104:107], a[184:187], v[68:71], v[104:107]
    v_exp_f32 v89, v89
    v_mfma_f32_16x16x32_bf16 v[104:107], a[188:191], v[72:75], v[104:107]
    ds_read_b64_tr_b16 a[220:221], v215 offset:0
    v_cvt_pk_bf16_f32 v166, v88, v89
    v_mfma_f32_16x16x32_bf16 v[100:103], a[188:191], v[56:59], v[180:183]
    v_exp_f32 v90, v90
    v_mfma_f32_16x16x32_bf16 v[100:103], a[184:187], v[52:55], v[100:103]
    ds_read_b64_tr_b16 a[222:223], v215 offset:4096
    v_mfma_f32_16x16x32_bf16 v[100:103], a[180:183], v[48:51], v[100:103]
    s_waitcnt lgkmcnt(6)
    v_exp_f32 v91, v91
    v_mfma_f32_16x16x32_bf16 v[100:103], a[176:179], v[44:47], v[100:103]
    ds_read_b64_tr_b16 a[252:253], v215 offset:8192
    v_cvt_pk_bf16_f32 v167, v90, v91
    v_mfma_f32_16x16x32_bf16 a[0:3], a[192:195], v[140:143], a[92:95]
    v_exp_f32 v84, v84
    v_mfma_f32_16x16x32_bf16 a[0:3], a[224:227], v[144:147], a[0:3]
    ds_read_b64_tr_b16 a[254:255], v215 offset:12288
    v_smfmac_f32_16x16x64_bf16 v[192:195], v[188:191], v[140:147], v11
    s_waitcnt vmcnt(9)
    v_xor_b32 v232, 4096, v232
    v_smfmac_f32_16x16x64_bf16 v[196:199], v[188:191], v[148:155], v11
    s_barrier
    v_add_u32 v236, s85, v236
    v_mfma_f32_16x16x32_bf16 a[32:35], a[224:227], v[152:155], a[92:95]
    v_exp_f32 v85, v85
    v_mfma_f32_16x16x32_bf16 a[32:35], a[192:195], v[148:151], a[32:35]
    ds_read_b128 a[128:131], v204 offset:16384
    v_cvt_pk_bf16_f32 v158, v84, v85
    v_mfma_f32_16x16x32_bf16 a[36:39], a[196:199], v[148:151], a[92:95]
    v_exp_f32 v86, v86
    v_mfma_f32_16x16x32_bf16 a[36:39], a[228:231], v[152:155], a[36:39]
    ds_read_b128 a[132:135], v205 offset:16384
    v_mfma_f32_16x16x32_bf16 a[4:7], a[228:231], v[144:147], a[92:95]
    v_exp_f32 v87, v87
    v_mfma_f32_16x16x32_bf16 a[4:7], a[196:199], v[140:143], a[4:7]
    ds_read_b128 a[136:139], v206 offset:16384
    v_cvt_pk_bf16_f32 v159, v86, v87
    v_mfma_f32_16x16x32_bf16 a[8:11], a[200:203], v[140:143], a[92:95]
    v_exp_f32 v92, v92
    v_mfma_f32_16x16x32_bf16 a[8:11], a[232:235], v[144:147], a[8:11]
    ds_read_b128 a[140:143], v207 offset:16384
    v_mfma_f32_16x16x32_bf16 a[40:43], a[232:235], v[152:155], a[92:95]
    v_exp_f32 v93, v93
    v_mfma_f32_16x16x32_bf16 a[40:43], a[200:203], v[148:151], a[40:43]
    ds_read_b128 a[144:147], v204 offset:20480
    v_cvt_pk_bf16_f32 v160, v92, v93
    v_mfma_f32_16x16x32_bf16 a[44:47], a[204:207], v[148:151], a[92:95]
    v_exp_f32 v94, v94
    v_mfma_f32_16x16x32_bf16 a[44:47], a[236:239], v[152:155], a[44:47]
    ds_read_b128 a[148:151], v205 offset:20480
    v_mfma_f32_16x16x32_bf16 a[12:15], a[236:239], v[144:147], a[92:95]
    v_exp_f32 v95, v95
    v_mfma_f32_16x16x32_bf16 a[12:15], a[204:207], v[140:143], a[12:15]
    ds_read_b128 a[152:155], v206 offset:20480
    v_cvt_pk_bf16_f32 v161, v94, v95
    v_mfma_f32_16x16x32_bf16 a[16:19], a[208:211], v[140:143], a[92:95]
    v_exp_f32 v96, v96
    v_mfma_f32_16x16x32_bf16 a[16:19], a[240:243], v[144:147], a[16:19]
    ds_read_b128 a[156:159], v207 offset:20480
    v_mfma_f32_16x16x32_bf16 a[48:51], a[240:243], v[152:155], a[92:95]
    v_exp_f32 v97, v97
    v_mfma_f32_16x16x32_bf16 a[48:51], a[208:211], v[148:151], a[48:51]
    ds_read_b128 a[160:163], v204 offset:24576
    v_cvt_pk_bf16_f32 v168, v96, v97
    v_mfma_f32_16x16x32_bf16 a[52:55], a[212:215], v[148:151], a[92:95]
    v_exp_f32 v98, v98
    v_mfma_f32_16x16x32_bf16 a[52:55], a[244:247], v[152:155], a[52:55]
    ds_read_b128 a[164:167], v205 offset:24576
    v_mfma_f32_16x16x32_bf16 a[20:23], a[244:247], v[144:147], a[92:95]
    s_waitcnt lgkmcnt(10)
    v_exp_f32 v99, v99
    v_mfma_f32_16x16x32_bf16 a[20:23], a[212:215], v[140:143], a[20:23]
    ds_read_b128 a[168:171], v206 offset:24576
    v_cvt_pk_bf16_f32 v169, v98, v99
    v_mfma_f32_16x16x32_bf16 a[24:27], a[216:219], v[140:143], a[92:95]
    v_exp_f32 v104, v104
    v_mfma_f32_16x16x32_bf16 a[24:27], a[248:251], v[144:147], a[24:27]
    ds_read_b128 a[172:175], v207 offset:24576
    v_mfma_f32_16x16x32_bf16 a[56:59], a[248:251], v[152:155], a[92:95]
    v_exp_f32 v105, v105
    v_mfma_f32_16x16x32_bf16 a[56:59], a[216:219], v[148:151], a[56:59]
    ds_read_b128 a[176:179], v204 offset:28672
    v_cvt_pk_bf16_f32 v170, v104, v105
    v_mfma_f32_16x16x32_bf16 a[60:63], a[220:223], v[148:151], a[92:95]
    v_exp_f32 v106, v106
    v_mfma_f32_16x16x32_bf16 a[60:63], a[252:255], v[152:155], a[60:63]
    ds_read_b128 a[180:183], v205 offset:28672
    v_mfma_f32_16x16x32_bf16 a[28:31], a[252:255], v[144:147], a[92:95]
    s_waitcnt lgkmcnt(6)
    v_exp_f32 v107, v107
    v_mfma_f32_16x16x32_bf16 a[28:31], a[220:223], v[140:143], a[28:31]
    ds_read_b128 a[184:187], v206 offset:28672
    v_cvt_pk_bf16_f32 v171, v106, v107
    v_mfma_f32_16x16x32_bf16 v[76:79], a[128:131], v[12:15], v[172:175]
    v_exp_f32 v100, v100
    v_mfma_f32_16x16x32_bf16 v[76:79], a[132:135], v[16:19], v[76:79]
    ds_read_b128 a[188:191], v207 offset:28672
    v_mfma_f32_16x16x32_bf16 v[76:79], a[136:139], v[20:23], v[76:79]
    s_add_u32 m0, s17, 49152
    v_exp_f32 v101, v101
    v_mfma_f32_16x16x32_bf16 v[76:79], a[140:143], v[24:27], v[76:79]
    buffer_load_dwordx4 v216, s[8:11], s16 offen offset:0 nt lds
    v_mfma_f32_16x16x32_bf16 v[80:83], a[140:143], v[40:43], v[176:179]
    v_exp_f32 v102, v102
    v_mfma_f32_16x16x32_bf16 v[80:83], a[136:139], v[36:39], v[80:83]
    ds_read_b32 v2, v5 offset:0
    ds_read_b32 v3, v5 offset:256
    ds_read_b32 v4, v5 offset:512
    ds_read_b32 v6, v5 offset:768
    v_cvt_pk_bf16_f32 v162, v100, v101
    v_mfma_f32_16x16x32_bf16 v[80:83], a[132:135], v[32:35], v[80:83]
    v_exp_f32 v103, v103
    v_mfma_f32_16x16x32_bf16 v[80:83], a[128:131], v[28:31], v[80:83]
L_pg3:
    s_cbranch_execz L_pg7
    buffer_load_dwordx4 v217, s[8:11], s16 offen offset:1024 nt lds
    v_mfma_f32_16x16x32_bf16 v[88:91], a[144:147], v[28:31], v[176:179]
    v_exp_f32 v76, v76
    v_mfma_f32_16x16x32_bf16 v[88:91], a[148:151], v[32:35], v[88:91]
    v_cvt_pk_bf16_f32 v163, v102, v103
    v_mfma_f32_16x16x32_bf16 v[88:91], a[152:155], v[36:39], v[88:91]
    v_exp_f32 v77, v77
    v_mfma_f32_16x16x32_bf16 v[88:91], a[156:159], v[40:43], v[88:91]
    buffer_load_dwordx4 v218, s[8:11], s16 offen offset:2048 nt lds
    v_mfma_f32_16x16x32_bf16 v[84:87], a[156:159], v[24:27], v[172:175]
    v_exp_f32 v78, v78
    v_mfma_f32_16x16x32_bf16 v[84:87], a[152:155], v[20:23], v[84:87]
    v_cvt_pk_bf16_f32 v140, v76, v77
    v_mfma_f32_16x16x32_bf16 v[84:87], a[148:151], v[16:19], v[84:87]
    s_waitcnt lgkmcnt(0)
    v_exp_f32 v79, v79
    v_mfma_f32_16x16x32_bf16 v[84:87], a[144:147], v[12:15], v[84:87]
    buffer_load_dwordx4 v219, s[8:11], s16 offen offset:3072 nt lds
    v_mfma_f32_16x16x32_bf16 v[92:95], a[160:163], v[12:15], v[172:175]
    v_exp_f32 v80, v80
    v_mfma_f32_16x16x32_bf16 v[92:95], a[164:167], v[16:19], v[92:95]
    v_cvt_pk_bf16_f32 v141, v78, v79
    v_mfma_f32_16x16x32_bf16 v[92:95], a[168:171], v[20:23], v[92:95]
    s_add_u32 m0, s17, 114688
    v_exp_f32 v81, v81
    v_mfma_f32_16x16x32_bf16 v[92:95], a[172:175], v[24:27], v[92:95]
    buffer_load_dwordx4 v220, s[12:15], s16 offen offset:0 nt lds
    v_mfma_f32_16x16x32_bf16 v[96:99], a[172:175], v[40:43], v[176:179]
    v_exp_f32 v82, v82
    v_mfma_f32_16x16x32_bf16 v[96:99], a[168:171], v[36:39], v[96:99]
    v_cvt_pk_bf16_f32 v148, v80, v81
    v_mfma_f32_16x16x32_bf16 v[96:99], a[164:167], v[32:35], v[96:99]
    v_exp_f32 v83, v83
    v_mfma_f32_16x16x32_bf16 v[96:99], a[160:163], v[28:31], v[96:99]
    buffer_load_dwordx4 v221, s[12:15], s16 offen offset:1024 nt lds
    v_mfma_f32_16x16x32_bf16 v[104:107], a[176:179], v[28:31], v[176:179]
    v_exp_f32 v88, v88
    v_mfma_f32_16x16x32_bf16 v[104:107], a[180:183], v[32:35], v[104:107]
    v_cvt_pk_bf16_f32 v149, v82, v83
    v_mfma_f32_16x16x32_bf16 v[104:107], a[184:187], v[36:39], v[104:107]
    v_exp_f32 v89, v89
    v_mfma_f32_16x16x32_bf16 v[104:107], a[188:191], v[40:43], v[104:107]
    buffer_load_dwordx4 v222, s[12:15], s16 offen offset:2048 nt lds
    v_mfma_f32_16x16x32_bf16 v[100:103], a[188:191], v[24:27], v[172:175]
    v_exp_f32 v90, v90
    v_mfma_f32_16x16x32_bf16 v[100:103], a[184:187], v[20:23], v[100:103]
    v_cvt_pk_bf16_f32 v150, v88, v89
    v_mfma_f32_16x16x32_bf16 v[100:103], a[180:183], v[16:19], v[100:103]
    v_exp_f32 v91, v91
    v_mfma_f32_16x16x32_bf16 v[100:103], a[176:179], v[12:15], v[100:103]
    buffer_load_dwordx4 v223, s[12:15], s16 offen offset:3072 nt lds
    v_mfma_f32_16x16x32_bf16 a[64:67], a[192:195], v[156:159], a[92:95]
    s_add_u32 m0, s80, 1024
    v_exp_f32 v84, v84
    v_mfma_f32_16x16x32_bf16 a[64:67], a[224:227], v[160:163], a[64:67]
    s_bitcmp1_b32 s74, 31
    v_cvt_pk_bf16_f32 v151, v90, v91
    v_smfmac_f32_16x16x64_bf16 v[200:203], v[188:191], v[156:163], v11
    v_add_f32 v2, v2, v3
    v_add_f32 v4, v4, v6
    v_add_f32 v2, v2, v4
    v_add_f32 v2, s35, v2
    buffer_store_dword v2, v255, s[24:27], s34 offen sc1
    s_mov_b32 s34, 2147483648
    v_smfmac_f32_16x16x64_bf16 v[248:251], v[188:191], v[164:171], v11
    buffer_load_dwordx4 v237, s[40:43], s79 offen sc1 lds
    v_mfma_f32_16x16x32_bf16 a[96:99], a[224:227], v[168:171], a[92:95]
    s_add_u32 s16, s16, s30
    v_exp_f32 v85, v85
    v_mfma_f32_16x16x32_bf16 a[96:99], a[192:195], v[164:167], a[96:99]
    ds_read_b64_tr_b16 a[192:193], v208 offset:16384
    v_cvt_pk_bf16_f32 v142, v84, v85
    v_mfma_f32_16x16x32_bf16 a[100:103], a[196:199], v[164:167], a[92:95]
    s_add_u32 s74, s74, s78
    v_exp_f32 v86, v86
    v_mfma_f32_16x16x32_bf16 a[100:103], a[228:231], v[168:171], a[100:103]
    ds_read_b64_tr_b16 a[194:195], v208 offset:20480
    v_mfma_f32_16x16x32_bf16 a[68:71], a[228:231], v[160:163], a[92:95]
    v_exp_f32 v87, v87
    v_mfma_f32_16x16x32_bf16 a[68:71], a[196:199], v[156:159], a[68:71]
    ds_read_b64_tr_b16 a[224:225], v208 offset:24576
    v_cvt_pk_bf16_f32 v143, v86, v87
    v_mfma_f32_16x16x32_bf16 a[72:75], a[200:203], v[156:159], a[92:95]
    v_exp_f32 v92, v92
    v_mfma_f32_16x16x32_bf16 a[72:75], a[232:235], v[160:163], a[72:75]
    ds_read_b64_tr_b16 a[226:227], v208 offset:28672
    v_mfma_f32_16x16x32_bf16 a[104:107], a[232:235], v[168:171], a[92:95]
    v_exp_f32 v93, v93
    v_mfma_f32_16x16x32_bf16 a[104:107], a[200:203], v[164:167], a[104:107]
    ds_read_b64_tr_b16 a[196:197], v209 offset:16384
    v_cvt_pk_bf16_f32 v144, v92, v93
    v_mfma_f32_16x16x32_bf16 a[108:111], a[204:207], v[164:167], a[92:95]
    v_exp_f32 v94, v94
    v_mfma_f32_16x16x32_bf16 a[108:111], a[236:239], v[168:171], a[108:111]
    ds_read_b64_tr_b16 a[198:199], v209 offset:20480
    v_mfma_f32_16x16x32_bf16 a[76:79], a[236:239], v[160:163], a[92:95]
    v_exp_f32 v95, v95
    v_mfma_f32_16x16x32_bf16 a[76:79], a[204:207], v[156:159], a[76:79]
    ds_read_b64_tr_b16 a[228:229], v209 offset:24576
    v_cvt_pk_bf16_f32 v145, v94, v95
    v_mfma_f32_16x16x32_bf16 a[80:83], a[208:211], v[156:159], a[92:95]
    v_exp_f32 v96, v96
    v_mfma_f32_16x16x32_bf16 a[80:83], a[240:243], v[160:163], a[80:83]
    ds_read_b64_tr_b16 a[230:231], v209 offset:28672
    v_mfma_f32_16x16x32_bf16 a[112:115], a[240:243], v[168:171], a[92:95]
    v_exp_f32 v97, v97
    v_mfma_f32_16x16x32_bf16 a[112:115], a[208:211], v[164:167], a[112:115]
    ds_read_b64_tr_b16 a[200:201], v210 offset:16384
    v_cvt_pk_bf16_f32 v152, v96, v97
    v_mfma_f32_16x16x32_bf16 a[116:119], a[212:215], v[164:167], a[92:95]
    v_exp_f32 v98, v98
    v_mfma_f32_16x16x32_bf16 a[116:119], a[244:247], v[168:171], a[116:119]
    ds_read_b64_tr_b16 a[202:203], v210 offset:20480
    v_mfma_f32_16x16x32_bf16 a[84:87], a[244:247], v[160:163], a[92:95]
    v_exp_f32 v99, v99
    v_mfma_f32_16x16x32_bf16 a[84:87], a[212:215], v[156:159], a[84:87]
    ds_read_b64_tr_b16 a[232:233], v210 offset:24576
    v_cvt_pk_bf16_f32 v153, v98, v99
    v_mfma_f32_16x16x32_bf16 a[88:91], a[216:219], v[156:159], a[92:95]
    v_exp_f32 v104, v104
    v_mfma_f32_16x16x32_bf16 a[88:91], a[248:251], v[160:163], a[88:91]
    ds_read_b64_tr_b16 a[234:235], v210 offset:28672
    v_mfma_f32_16x16x32_bf16 a[120:123], a[248:251], v[168:171], a[92:95]
    v_exp_f32 v105, v105
    v_mfma_f32_16x16x32_bf16 a[120:123], a[216:219], v[164:167], a[120:123]
    ds_read_b64_tr_b16 a[204:205], v211 offset:16384
    v_cvt_pk_bf16_f32 v154, v104, v105
    v_mfma_f32_16x16x32_bf16 a[124:127], a[220:223], v[164:167], a[92:95]
    v_exp_f32 v106, v106
    v_mfma_f32_16x16x32_bf16 a[124:127], a[252:255], v[168:171], a[124:127]
    ds_read_b64_tr_b16 a[206:207], v211 offset:20480
    v_mfma_f32_16x16x32_bf16 a[92:95], a[252:255], v[160:163], a[92:95]
    v_exp_f32 v107, v107
    v_mfma_f32_16x16x32_bf16 a[92:95], a[220:223], v[156:159], a[92:95]
    ds_read_b64_tr_b16 a[236:237], v211 offset:24576
    v_cvt_pk_bf16_f32 v155, v106, v107
    v_mfma_f32_16x16x32_bf16 v[76:79], a[128:131], v[44:47], v[180:183]
    v_exp_f32 v100, v100
    v_mfma_f32_16x16x32_bf16 v[76:79], a[132:135], v[48:51], v[76:79]
    ds_read_b64_tr_b16 a[238:239], v211 offset:28672
    v_mfma_f32_16x16x32_bf16 v[76:79], a[136:139], v[52:55], v[76:79]
    v_exp_f32 v101, v101
    v_mfma_f32_16x16x32_bf16 v[76:79], a[140:143], v[56:59], v[76:79]
    ds_read_b64_tr_b16 a[208:209], v212 offset:16384
    v_cvt_pk_bf16_f32 v146, v100, v101
    v_mfma_f32_16x16x32_bf16 v[80:83], a[140:143], v[72:75], v[184:187]
    v_exp_f32 v102, v102
    v_mfma_f32_16x16x32_bf16 v[80:83], a[136:139], v[68:71], v[80:83]
    ds_read_b64_tr_b16 a[210:211], v212 offset:20480
    v_mfma_f32_16x16x32_bf16 v[80:83], a[132:135], v[64:67], v[80:83]
    v_exp_f32 v103, v103
    v_mfma_f32_16x16x32_bf16 v[80:83], a[128:131], v[60:63], v[80:83]
    ds_read_b64_tr_b16 a[240:241], v212 offset:24576
    v_cvt_pk_bf16_f32 v147, v102, v103
    v_mfma_f32_16x16x32_bf16 v[88:91], a[144:147], v[60:63], v[184:187]
    v_exp_f32 v76, v76
    v_mfma_f32_16x16x32_bf16 v[88:91], a[148:151], v[64:67], v[88:91]
    ds_read_b64_tr_b16 a[242:243], v212 offset:28672
    v_mfma_f32_16x16x32_bf16 v[88:91], a[152:155], v[68:71], v[88:91]
    v_exp_f32 v77, v77
    v_mfma_f32_16x16x32_bf16 v[88:91], a[156:159], v[72:75], v[88:91]
    ds_read_b64_tr_b16 a[212:213], v213 offset:16384
    v_cvt_pk_bf16_f32 v156, v76, v77
    v_mfma_f32_16x16x32_bf16 v[84:87], a[156:159], v[56:59], v[180:183]
    v_exp_f32 v78, v78
    v_mfma_f32_16x16x32_bf16 v[84:87], a[152:155], v[52:55], v[84:87]
    ds_read_b64_tr_b16 a[214:215], v213 offset:20480
    v_mfma_f32_16x16x32_bf16 v[84:87], a[148:151], v[48:51], v[84:87]
    v_exp_f32 v79, v79
    v_mfma_f32_16x16x32_bf16 v[84:87], a[144:147], v[44:47], v[84:87]
    ds_read_b64_tr_b16 a[244:245], v213 offset:24576
    v_cvt_pk_bf16_f32 v157, v78, v79
    v_mfma_f32_16x16x32_bf16 v[92:95], a[160:163], v[44:47], v[180:183]
    v_exp_f32 v80, v80
    v_mfma_f32_16x16x32_bf16 v[92:95], a[164:167], v[48:51], v[92:95]
    ds_read_b64_tr_b16 a[246:247], v213 offset:28672
    v_mfma_f32_16x16x32_bf16 v[92:95], a[168:171], v[52:55], v[92:95]
    v_exp_f32 v81, v81
    v_mfma_f32_16x16x32_bf16 v[92:95], a[172:175], v[56:59], v[92:95]
    ds_read_b64_tr_b16 a[216:217], v214 offset:16384
    v_cvt_pk_bf16_f32 v164, v80, v81
    v_mfma_f32_16x16x32_bf16 v[96:99], a[172:175], v[72:75], v[184:187]
    v_exp_f32 v82, v82
    v_mfma_f32_16x16x32_bf16 v[96:99], a[168:171], v[68:71], v[96:99]
    ds_read_b64_tr_b16 a[218:219], v214 offset:20480
    v_mfma_f32_16x16x32_bf16 v[96:99], a[164:167], v[64:67], v[96:99]
    v_exp_f32 v83, v83
    v_mfma_f32_16x16x32_bf16 v[96:99], a[160:163], v[60:63], v[96:99]
    ds_read_b64_tr_b16 a[248:249], v214 offset:24576
    v_cvt_pk_bf16_f32 v165, v82, v83
    v_mfma_f32_16x16x32_bf16 v[104:107], a[176:179], v[60:63], v[184:187]
    v_exp_f32 v88, v88
    v_mfma_f32_16x16x32_bf16 v[104:107], a[180:183], v[64:67], v[104:107]
    ds_read_b64_tr_b16 a[250:251], v214 offset:28672
    v_mfma_f32_16x16x32_bf16 v[104:107], a[184:187], v[68:71], v[104:107]
    v_exp_f32 v89, v89
    v_mfma_f32_16x16x32_bf16 v[104:107], a[188:191], v[72:75], v[104:107]
    ds_read_b64_tr_b16 a[220:221], v215 offset:16384
    v_cvt_pk_bf16_f32 v166, v88, v89
    v_mfma_f32_16x16x32_bf16 v[100:103], a[188:191], v[56:59], v[180:183]
    v_exp_f32 v90, v90
    v_mfma_f32_16x16x32_bf16 v[100:103], a[184:187], v[52:55], v[100:103]
    ds_read_b64_tr_b16 a[222:223], v215 offset:20480
    v_mfma_f32_16x16x32_bf16 v[100:103], a[180:183], v[48:51], v[100:103]
    s_waitcnt lgkmcnt(6)
    v_exp_f32 v91, v91
    v_mfma_f32_16x16x32_bf16 v[100:103], a[176:179], v[44:47], v[100:103]
    ds_read_b64_tr_b16 a[252:253], v215 offset:24576
    v_cvt_pk_bf16_f32 v167, v90, v91
    v_mfma_f32_16x16x32_bf16 a[0:3], a[192:195], v[140:143], a[0:3]
    v_exp_f32 v84, v84
    v_mfma_f32_16x16x32_bf16 a[0:3], a[224:227], v[144:147], a[0:3]
    ds_read_b64_tr_b16 a[254:255], v215 offset:28672
    v_smfmac_f32_16x16x64_bf16 v[192:195], v[188:191], v[140:147], v11
    s_waitcnt vmcnt(11)
    v_smfmac_f32_16x16x64_bf16 v[196:199], v[188:191], v[148:155], v11
    s_barrier
    v_add_u32 v236, s86, v236
    v_mfma_f32_16x16x32_bf16 a[32:35], a[224:227], v[152:155], a[32:35]
    v_exp_f32 v85, v85
    v_mfma_f32_16x16x32_bf16 a[32:35], a[192:195], v[148:151], a[32:35]
    ds_read_b128 a[128:131], v204 offset:32768
    v_cvt_pk_bf16_f32 v158, v84, v85
    v_mfma_f32_16x16x32_bf16 a[36:39], a[196:199], v[148:151], a[36:39]
    v_exp_f32 v86, v86
    v_mfma_f32_16x16x32_bf16 a[36:39], a[228:231], v[152:155], a[36:39]
    ds_read_b128 a[132:135], v205 offset:32768
    v_mfma_f32_16x16x32_bf16 a[4:7], a[228:231], v[144:147], a[4:7]
    v_exp_f32 v87, v87
    v_mfma_f32_16x16x32_bf16 a[4:7], a[196:199], v[140:143], a[4:7]
    ds_read_b128 a[136:139], v206 offset:32768
    v_cvt_pk_bf16_f32 v159, v86, v87
    v_mfma_f32_16x16x32_bf16 a[8:11], a[200:203], v[140:143], a[8:11]
    v_exp_f32 v92, v92
    v_mfma_f32_16x16x32_bf16 a[8:11], a[232:235], v[144:147], a[8:11]
    ds_read_b128 a[140:143], v207 offset:32768
    v_mfma_f32_16x16x32_bf16 a[40:43], a[232:235], v[152:155], a[40:43]
    v_exp_f32 v93, v93
    v_mfma_f32_16x16x32_bf16 a[40:43], a[200:203], v[148:151], a[40:43]
    ds_read_b128 a[144:147], v204 offset:36864
    v_cvt_pk_bf16_f32 v160, v92, v93
    v_mfma_f32_16x16x32_bf16 a[44:47], a[204:207], v[148:151], a[44:47]
    v_exp_f32 v94, v94
    v_mfma_f32_16x16x32_bf16 a[44:47], a[236:239], v[152:155], a[44:47]
    ds_read_b128 a[148:151], v205 offset:36864
    v_mfma_f32_16x16x32_bf16 a[12:15], a[236:239], v[144:147], a[12:15]
    v_exp_f32 v95, v95
    v_mfma_f32_16x16x32_bf16 a[12:15], a[204:207], v[140:143], a[12:15]
    ds_read_b128 a[152:155], v206 offset:36864
    v_cvt_pk_bf16_f32 v161, v94, v95
    v_mfma_f32_16x16x32_bf16 a[16:19], a[208:211], v[140:143], a[16:19]
    v_exp_f32 v96, v96
    v_mfma_f32_16x16x32_bf16 a[16:19], a[240:243], v[144:147], a[16:19]
    ds_read_b128 a[156:159], v207 offset:36864
    v_mfma_f32_16x16x32_bf16 a[48:51], a[240:243], v[152:155], a[48:51]
    v_exp_f32 v97, v97
    v_mfma_f32_16x16x32_bf16 a[48:51], a[208:211], v[148:151], a[48:51]
    ds_read_b128 a[160:163], v204 offset:40960
    v_cvt_pk_bf16_f32 v168, v96, v97
    v_mfma_f32_16x16x32_bf16 a[52:55], a[212:215], v[148:151], a[52:55]
    v_exp_f32 v98, v98
    v_mfma_f32_16x16x32_bf16 a[52:55], a[244:247], v[152:155], a[52:55]
    ds_read_b128 a[164:167], v205 offset:40960
    v_mfma_f32_16x16x32_bf16 a[20:23], a[244:247], v[144:147], a[20:23]
    s_waitcnt lgkmcnt(10)
    v_exp_f32 v99, v99
    v_mfma_f32_16x16x32_bf16 a[20:23], a[212:215], v[140:143], a[20:23]
    ds_read_b128 a[168:171], v206 offset:40960
    v_cvt_pk_bf16_f32 v169, v98, v99
    v_mfma_f32_16x16x32_bf16 a[24:27], a[216:219], v[140:143], a[24:27]
    v_exp_f32 v104, v104
    v_mfma_f32_16x16x32_bf16 a[24:27], a[248:251], v[144:147], a[24:27]
    ds_read_b128 a[172:175], v207 offset:40960
    v_mfma_f32_16x16x32_bf16 a[56:59], a[248:251], v[152:155], a[56:59]
    v_exp_f32 v105, v105
    v_mfma_f32_16x16x32_bf16 a[56:59], a[216:219], v[148:151], a[56:59]
    ds_read_b128 a[176:179], v204 offset:45056
    v_cvt_pk_bf16_f32 v170, v104, v105
    v_mfma_f32_16x16x32_bf16 a[60:63], a[220:223], v[148:151], a[60:63]
    v_exp_f32 v106, v106
    v_mfma_f32_16x16x32_bf16 a[60:63], a[252:255], v[152:155], a[60:63]
    ds_read_b128 a[180:183], v205 offset:45056
    v_mfma_f32_16x16x32_bf16 a[28:31], a[252:255], v[144:147], a[28:31]
    s_waitcnt lgkmcnt(6)
    v_exp_f32 v107, v107
    v_mfma_f32_16x16x32_bf16 a[28:31], a[220:223], v[140:143], a[28:31]
    ds_read_b128 a[184:187], v206 offset:45056
    v_cvt_pk_bf16_f32 v171, v106, v107
    s_branch L_mid
.p2align 6
L_loop:
    v_mfma_f32_16x16x32_bf16 v[76:79], a[128:131], v[12:15], v[172:175]
    v_exp_f32 v100, v100
    v_mfma_f32_16x16x32_bf16 v[76:79], a[132:135], v[16:19], v[76:79]
    ds_read_b128 a[188:191], v207 offset:12288
    v_mfma_f32_16x16x32_bf16 v[76:79], a[136:139], v[20:23], v[76:79]
    s_add_u32 m0, s17, 32768
    v_exp_f32 v101, v101
    v_mfma_f32_16x16x32_bf16 v[76:79], a[140:143], v[24:27], v[76:79]
    buffer_load_dwordx4 v216, s[8:11], s16 offen offset:0 nt lds
    v_mfma_f32_16x16x32_bf16 v[80:83], a[140:143], v[40:43], v[176:179]
    v_exp_f32 v102, v102
    v_mfma_f32_16x16x32_bf16 v[80:83], a[136:139], v[36:39], v[80:83]
    v_cvt_pk_bf16_f32 v162, v100, v101
    v_mfma_f32_16x16x32_bf16 v[80:83], a[132:135], v[32:35], v[80:83]
    v_exp_f32 v103, v103
    v_mfma_f32_16x16x32_bf16 v[80:83], a[128:131], v[28:31], v[80:83]
    buffer_load_dwordx4 v217, s[8:11], s16 offen offset:1024 nt lds
    v_mfma_f32_16x16x32_bf16 v[88:91], a[144:147], v[28:31], v[176:179]
    v_exp_f32 v76, v76
    v_mfma_f32_16x16x32_bf16 v[88:91], a[148:151], v[32:35], v[88:91]
    v_cvt_pk_bf16_f32 v163, v102, v103
    v_mfma_f32_16x16x32_bf16 v[88:91], a[152:155], v[36:39], v[88:91]
    v_exp_f32 v77, v77
    v_mfma_f32_16x16x32_bf16 v[88:91], a[156:159], v[40:43], v[88:91]
    buffer_load_dwordx4 v218, s[8:11], s16 offen offset:2048 nt lds
    v_mfma_f32_16x16x32_bf16 v[84:87], a[156:159], v[24:27], v[172:175]
    v_exp_f32 v78, v78
    v_mfma_f32_16x16x32_bf16 v[84:87], a[152:155], v[20:23], v[84:87]
    v_cvt_pk_bf16_f32 v140, v76, v77
    v_mfma_f32_16x16x32_bf16 v[84:87], a[148:151], v[16:19], v[84:87]
    s_waitcnt lgkmcnt(0)
    v_exp_f32 v79, v79
    v_mfma_f32_16x16x32_bf16 v[84:87], a[144:147], v[12:15], v[84:87]
    buffer_load_dwordx4 v219, s[8:11], s16 offen offset:3072 nt lds
    v_mfma_f32_16x16x32_bf16 v[92:95], a[160:163], v[12:15], v[172:175]
    v_exp_f32 v80, v80
    v_mfma_f32_16x16x32_bf16 v[92:95], a[164:167], v[16:19], v[92:95]
    v_cvt_pk_bf16_f32 v141, v78, v79
    v_mfma_f32_16x16x32_bf16 v[92:95], a[168:171], v[20:23], v[92:95]
    s_add_u32 m0, s17, 98304
    v_exp_f32 v81, v81
    v_mfma_f32_16x16x32_bf16 v[92:95], a[172:175], v[24:27], v[92:95]
    buffer_load_dwordx4 v220, s[12:15], s16 offen offset:0 nt lds
    v_mfma_f32_16x16x32_bf16 v[96:99], a[172:175], v[40:43], v[176:179]
    v_exp_f32 v82, v82
    v_mfma_f32_16x16x32_bf16 v[96:99], a[168:171], v[36:39], v[96:99]
    v_cvt_pk_bf16_f32 v148, v80, v81
    v_mfma_f32_16x16x32_bf16 v[96:99], a[164:167], v[32:35], v[96:99]
    v_exp_f32 v83, v83
    v_mfma_f32_16x16x32_bf16 v[96:99], a[160:163], v[28:31], v[96:99]
    buffer_load_dwordx4 v221, s[12:15], s16 offen offset:1024 nt lds
    v_mfma_f32_16x16x32_bf16 v[104:107], a[176:179], v[28:31], v[176:179]
    v_exp_f32 v88, v88
    v_mfma_f32_16x16x32_bf16 v[104:107], a[180:183], v[32:35], v[104:107]
    v_cvt_pk_bf16_f32 v149, v82, v83
    v_mfma_f32_16x16x32_bf16 v[104:107], a[184:187], v[36:39], v[104:107]
    v_exp_f32 v89, v89
    v_mfma_f32_16x16x32_bf16 v[104:107], a[188:191], v[40:43], v[104:107]
    buffer_load_dwordx4 v222, s[12:15], s16 offen offset:2048 nt lds
    v_mfma_f32_16x16x32_bf16 v[100:103], a[188:191], v[24:27], v[172:175]
    v_exp_f32 v90, v90
    v_mfma_f32_16x16x32_bf16 v[100:103], a[184:187], v[20:23], v[100:103]
    v_cvt_pk_bf16_f32 v150, v88, v89
    v_mfma_f32_16x16x32_bf16 v[100:103], a[180:183], v[16:19], v[100:103]
    v_exp_f32 v91, v91
    v_mfma_f32_16x16x32_bf16 v[100:103], a[176:179], v[12:15], v[100:103]
    buffer_load_dwordx4 v223, s[12:15], s16 offen offset:3072 nt lds
    v_mfma_f32_16x16x32_bf16 a[64:67], a[192:195], v[156:159], a[64:67]
    s_add_u32 m0, s80, 0
    v_exp_f32 v84, v84
    v_mfma_f32_16x16x32_bf16 a[64:67], a[224:227], v[160:163], a[64:67]
    s_bitcmp1_b32 s74, 31
    v_cvt_pk_bf16_f32 v151, v90, v91
    v_smfmac_f32_16x16x64_bf16 v[200:203], v[188:191], v[156:163], v11
    s_cbranch_scc1 L_ns0
    buffer_store_dwordx4 v[224:227], v252, s[24:27], s74 offen sc1
L_ns0:
    v_smfmac_f32_16x16x64_bf16 v[248:251], v[188:191], v[164:171], v11
    buffer_load_dwordx4 v237, s[40:43], 0 offen sc1 lds
    v_mfma_f32_16x16x32_bf16 a[96:99], a[224:227], v[168:171], a[96:99]
    s_add_u32 s16, s16, s30
    v_exp_f32 v85, v85
    v_mfma_f32_16x16x32_bf16 a[96:99], a[192:195], v[164:167], a[96:99]
    ds_read_b64_tr_b16 a[192:193], v208 offset:0
    v_cvt_pk_bf16_f32 v142, v84, v85
    v_mfma_f32_16x16x32_bf16 a[100:103], a[196:199], v[164:167], a[100:103]
    s_mov_b32 s74, s75
    v_exp_f32 v86, v86
    v_mfma_f32_16x16x32_bf16 a[100:103], a[228:231], v[168:171], a[100:103]
    ds_read_b64_tr_b16 a[194:195], v208 offset:4096
    v_mfma_f32_16x16x32_bf16 a[68:71], a[228:231], v[160:163], a[68:71]
    s_mov_b32 s75, s76
    v_exp_f32 v87, v87
    v_mfma_f32_16x16x32_bf16 a[68:71], a[196:199], v[156:159], a[68:71]
    ds_read_b64_tr_b16 a[224:225], v208 offset:8192
    v_cvt_pk_bf16_f32 v143, v86, v87
    v_mfma_f32_16x16x32_bf16 a[72:75], a[200:203], v[156:159], a[72:75]
    s_mov_b32 s76, s77
    v_exp_f32 v92, v92
    v_mfma_f32_16x16x32_bf16 a[72:75], a[232:235], v[160:163], a[72:75]
    ds_read_b64_tr_b16 a[226:227], v208 offset:12288
    v_mfma_f32_16x16x32_bf16 a[104:107], a[232:235], v[168:171], a[104:107]
    s_mov_b32 s77, s83
    v_exp_f32 v93, v93
    v_mfma_f32_16x16x32_bf16 a[104:107], a[200:203], v[164:167], a[104:107]
    ds_read_b64_tr_b16 a[196:197], v209 offset:0
    v_cvt_pk_bf16_f32 v144, v92, v93
    v_mfma_f32_16x16x32_bf16 a[108:111], a[204:207], v[164:167], a[108:111]
    s_mov_b32 s83, 2147483648
    v_exp_f32 v94, v94
    v_mfma_f32_16x16x32_bf16 a[108:111], a[236:239], v[168:171], a[108:111]
    ds_read_b64_tr_b16 a[198:199], v209 offset:4096
    v_mfma_f32_16x16x32_bf16 a[76:79], a[236:239], v[160:163], a[76:79]
    s_cmp_eq_u32 s18, 6
    v_exp_f32 v95, v95
    v_mfma_f32_16x16x32_bf16 a[76:79], a[204:207], v[156:159], a[76:79]
    ds_read_b64_tr_b16 a[228:229], v209 offset:8192
    v_cvt_pk_bf16_f32 v145, v94, v95
    v_mfma_f32_16x16x32_bf16 a[80:83], a[208:211], v[156:159], a[80:83]
    s_cselect_b32 s78, 7, 16
    v_exp_f32 v96, v96
    v_mfma_f32_16x16x32_bf16 a[80:83], a[240:243], v[160:163], a[80:83]
    ds_read_b64_tr_b16 a[230:231], v209 offset:12288
    v_mfma_f32_16x16x32_bf16 a[112:115], a[240:243], v[168:171], a[112:115]
    s_lshl_b32 s78, s78, 10
    v_exp_f32 v97, v97
    v_mfma_f32_16x16x32_bf16 a[112:115], a[208:211], v[164:167], a[112:115]
    ds_read_b64_tr_b16 a[200:201], v210 offset:0
    v_cvt_pk_bf16_f32 v152, v96, v97
    v_mfma_f32_16x16x32_bf16 a[116:119], a[212:215], v[164:167], a[116:119]
    s_cmp_eq_u32 s18, 3
    v_exp_f32 v98, v98
    v_mfma_f32_16x16x32_bf16 a[116:119], a[244:247], v[168:171], a[116:119]
    ds_read_b64_tr_b16 a[202:203], v210 offset:4096
    v_mfma_f32_16x16x32_bf16 a[84:87], a[244:247], v[160:163], a[84:87]
    s_cselect_b32 s81, s84, 2147483648
    v_exp_f32 v99, v99
    v_mfma_f32_16x16x32_bf16 a[84:87], a[212:215], v[156:159], a[84:87]
    ds_read_b64_tr_b16 a[232:233], v210 offset:8192
    v_cvt_pk_bf16_f32 v153, v98, v99
    v_mfma_f32_16x16x32_bf16 a[88:91], a[216:219], v[156:159], a[88:91]
    s_cmp_eq_u32 s18, 2
    v_exp_f32 v104, v104
    v_mfma_f32_16x16x32_bf16 a[88:91], a[248:251], v[160:163], a[88:91]
    ds_read_b64_tr_b16 a[234:235], v210 offset:12288
    v_mfma_f32_16x16x32_bf16 a[120:123], a[248:251], v[168:171], a[120:123]
    s_cselect_b32 s50, s21, 2147483648
    v_exp_f32 v105, v105
    v_mfma_f32_16x16x32_bf16 a[120:123], a[216:219], v[164:167], a[120:123]
    ds_read_b64_tr_b16 a[204:205], v211 offset:0
    v_cvt_pk_bf16_f32 v154, v104, v105
    v_mfma_f32_16x16x32_bf16 a[124:127], a[220:223], v[164:167], a[124:127]
    v_exp_f32 v106, v106
    v_mfma_f32_16x16x32_bf16 a[124:127], a[252:255], v[168:171], a[124:127]
    ds_read_b64_tr_b16 a[206:207], v211 offset:4096
    v_mfma_f32_16x16x32_bf16 a[92:95], a[252:255], v[160:163], a[92:95]
    v_exp_f32 v107, v107
    v_mfma_f32_16x16x32_bf16 a[92:95], a[220:223], v[156:159], a[92:95]
    ds_read_b64_tr_b16 a[236:237], v211 offset:8192
    v_cvt_pk_bf16_f32 v155, v106, v107
    v_mfma_f32_16x16x32_bf16 v[76:79], a[128:131], v[44:47], v[180:183]
    v_exp_f32 v100, v100
    v_mfma_f32_16x16x32_bf16 v[76:79], a[132:135], v[48:51], v[76:79]
    ds_read_b64_tr_b16 a[238:239], v211 offset:12288
    v_mfma_f32_16x16x32_bf16 v[76:79], a[136:139], v[52:55], v[76:79]
    v_exp_f32 v101, v101
    v_mfma_f32_16x16x32_bf16 v[76:79], a[140:143], v[56:59], v[76:79]
    ds_read_b64_tr_b16 a[208:209], v212 offset:0
    v_cvt_pk_bf16_f32 v146, v100, v101
    v_mfma_f32_16x16x32_bf16 v[80:83], a[140:143], v[72:75], v[184:187]
    v_exp_f32 v102, v102
    v_mfma_f32_16x16x32_bf16 v[80:83], a[136:139], v[68:71], v[80:83]
    ds_read_b64_tr_b16 a[210:211], v212 offset:4096
    v_mfma_f32_16x16x32_bf16 v[80:83], a[132:135], v[64:67], v[80:83]
    v_exp_f32 v103, v103
    v_mfma_f32_16x16x32_bf16 v[80:83], a[128:131], v[60:63], v[80:83]
    ds_read_b64_tr_b16 a[240:241], v212 offset:8192
    v_cvt_pk_bf16_f32 v147, v102, v103
    v_mfma_f32_16x16x32_bf16 v[88:91], a[144:147], v[60:63], v[184:187]
    v_exp_f32 v76, v76
    v_mfma_f32_16x16x32_bf16 v[88:91], a[148:151], v[64:67], v[88:91]
    ds_read_b64_tr_b16 a[242:243], v212 offset:12288
    v_mfma_f32_16x16x32_bf16 v[88:91], a[152:155], v[68:71], v[88:91]
    v_exp_f32 v77, v77
    v_mfma_f32_16x16x32_bf16 v[88:91], a[156:159], v[72:75], v[88:91]
    ds_read_b64_tr_b16 a[212:213], v213 offset:0
    v_cvt_pk_bf16_f32 v156, v76, v77
    v_mfma_f32_16x16x32_bf16 v[84:87], a[156:159], v[56:59], v[180:183]
    v_exp_f32 v78, v78
    v_mfma_f32_16x16x32_bf16 v[84:87], a[152:155], v[52:55], v[84:87]
    ds_read_b64_tr_b16 a[214:215], v213 offset:4096
    v_mfma_f32_16x16x32_bf16 v[84:87], a[148:151], v[48:51], v[84:87]
    v_exp_f32 v79, v79
    v_mfma_f32_16x16x32_bf16 v[84:87], a[144:147], v[44:47], v[84:87]
    ds_read_b64_tr_b16 a[244:245], v213 offset:8192
    v_cvt_pk_bf16_f32 v157, v78, v79
    v_mfma_f32_16x16x32_bf16 v[92:95], a[160:163], v[44:47], v[180:183]
    v_exp_f32 v80, v80
    v_mfma_f32_16x16x32_bf16 v[92:95], a[164:167], v[48:51], v[92:95]
    ds_read_b64_tr_b16 a[246:247], v213 offset:12288
    v_mfma_f32_16x16x32_bf16 v[92:95], a[168:171], v[52:55], v[92:95]
    v_exp_f32 v81, v81
    v_mfma_f32_16x16x32_bf16 v[92:95], a[172:175], v[56:59], v[92:95]
    ds_read_b64_tr_b16 a[216:217], v214 offset:0
    v_cvt_pk_bf16_f32 v164, v80, v81
    v_mfma_f32_16x16x32_bf16 v[96:99], a[172:175], v[72:75], v[184:187]
    v_exp_f32 v82, v82
    v_mfma_f32_16x16x32_bf16 v[96:99], a[168:171], v[68:71], v[96:99]
    ds_read_b64_tr_b16 a[218:219], v214 offset:4096
    v_mfma_f32_16x16x32_bf16 v[96:99], a[164:167], v[64:67], v[96:99]
    v_exp_f32 v83, v83
    v_mfma_f32_16x16x32_bf16 v[96:99], a[160:163], v[60:63], v[96:99]
    ds_read_b64_tr_b16 a[248:249], v214 offset:8192
    v_cvt_pk_bf16_f32 v165, v82, v83
    v_mfma_f32_16x16x32_bf16 v[104:107], a[176:179], v[60:63], v[184:187]
    v_exp_f32 v88, v88
    v_mfma_f32_16x16x32_bf16 v[104:107], a[180:183], v[64:67], v[104:107]
    ds_read_b64_tr_b16 a[250:251], v214 offset:12288
    v_mfma_f32_16x16x32_bf16 v[104:107], a[184:187], v[68:71], v[104:107]
    v_exp_f32 v89, v89
    v_mfma_f32_16x16x32_bf16 v[104:107], a[188:191], v[72:75], v[104:107]
    ds_read_b64_tr_b16 a[220:221], v215 offset:0
    v_cvt_pk_bf16_f32 v166, v88, v89
    v_mfma_f32_16x16x32_bf16 v[100:103], a[188:191], v[56:59], v[180:183]
    v_exp_f32 v90, v90
    v_mfma_f32_16x16x32_bf16 v[100:103], a[184:187], v[52:55], v[100:103]
    ds_read_b64_tr_b16 a[222:223], v215 offset:4096
    v_mfma_f32_16x16x32_bf16 v[100:103], a[180:183], v[48:51], v[100:103]
    s_waitcnt lgkmcnt(6)
    v_exp_f32 v91, v91
    v_mfma_f32_16x16x32_bf16 v[100:103], a[176:179], v[44:47], v[100:103]
    ds_read_b64_tr_b16 a[252:253], v215 offset:8192
    v_cvt_pk_bf16_f32 v167, v90, v91
    v_mfma_f32_16x16x32_bf16 a[0:3], a[192:195], v[140:143], a[0:3]
    v_exp_f32 v84, v84
    v_mfma_f32_16x16x32_bf16 a[0:3], a[224:227], v[144:147], a[0:3]
    ds_read_b64_tr_b16 a[254:255], v215 offset:12288
    v_smfmac_f32_16x16x64_bf16 v[192:195], v[188:191], v[140:147], v11
    s_waitcnt vmcnt(9)
    ds_read_b64_tr_b16 v[224:225], v236
    v_xor_b32 v232, 4096, v232
    v_smfmac_f32_16x16x64_bf16 v[196:199], v[188:191], v[148:155], v11
    s_barrier
    ds_read_b64_tr_b16 v[226:227], v236 offset:1024
    v_add_u32 v236, s85, v236
    v_mfma_f32_16x16x32_bf16 a[32:35], a[224:227], v[152:155], a[32:35]
    v_exp_f32 v85, v85
    v_mfma_f32_16x16x32_bf16 a[32:35], a[192:195], v[148:151], a[32:35]
    ds_read_b128 a[128:131], v204 offset:16384
    v_cvt_pk_bf16_f32 v158, v84, v85
    v_mfma_f32_16x16x32_bf16 a[36:39], a[196:199], v[148:151], a[36:39]
    v_exp_f32 v86, v86
    v_mfma_f32_16x16x32_bf16 a[36:39], a[228:231], v[152:155], a[36:39]
    ds_read_b128 a[132:135], v205 offset:16384
    v_mfma_f32_16x16x32_bf16 a[4:7], a[228:231], v[144:147], a[4:7]
    v_exp_f32 v87, v87
    v_mfma_f32_16x16x32_bf16 a[4:7], a[196:199], v[140:143], a[4:7]
    ds_read_b128 a[136:139], v206 offset:16384
    v_cvt_pk_bf16_f32 v159, v86, v87
    v_mfma_f32_16x16x32_bf16 a[8:11], a[200:203], v[140:143], a[8:11]
    v_exp_f32 v92, v92
    v_mfma_f32_16x16x32_bf16 a[8:11], a[232:235], v[144:147], a[8:11]
    ds_read_b128 a[140:143], v207 offset:16384
    v_mfma_f32_16x16x32_bf16 a[40:43], a[232:235], v[152:155], a[40:43]
    v_exp_f32 v93, v93
    v_mfma_f32_16x16x32_bf16 a[40:43], a[200:203], v[148:151], a[40:43]
    ds_read_b128 a[144:147], v204 offset:20480
    v_cvt_pk_bf16_f32 v160, v92, v93
    v_mfma_f32_16x16x32_bf16 a[44:47], a[204:207], v[148:151], a[44:47]
    v_exp_f32 v94, v94
    v_mfma_f32_16x16x32_bf16 a[44:47], a[236:239], v[152:155], a[44:47]
    ds_read_b128 a[148:151], v205 offset:20480
    v_mfma_f32_16x16x32_bf16 a[12:15], a[236:239], v[144:147], a[12:15]
    v_exp_f32 v95, v95
    v_mfma_f32_16x16x32_bf16 a[12:15], a[204:207], v[140:143], a[12:15]
    ds_read_b128 a[152:155], v206 offset:20480
    v_cvt_pk_bf16_f32 v161, v94, v95
    v_mfma_f32_16x16x32_bf16 a[16:19], a[208:211], v[140:143], a[16:19]
    v_exp_f32 v96, v96
    v_mfma_f32_16x16x32_bf16 a[16:19], a[240:243], v[144:147], a[16:19]
    ds_read_b128 a[156:159], v207 offset:20480
    v_mfma_f32_16x16x32_bf16 a[48:51], a[240:243], v[152:155], a[48:51]
    v_exp_f32 v97, v97
    v_mfma_f32_16x16x32_bf16 a[48:51], a[208:211], v[148:151], a[48:51]
    ds_read_b128 a[160:163], v204 offset:24576
    v_cvt_pk_bf16_f32 v168, v96, v97
    v_mfma_f32_16x16x32_bf16 a[52:55], a[212:215], v[148:151], a[52:55]
    v_exp_f32 v98, v98
    v_mfma_f32_16x16x32_bf16 a[52:55], a[244:247], v[152:155], a[52:55]
    ds_read_b128 a[164:167], v205 offset:24576
    v_mfma_f32_16x16x32_bf16 a[20:23], a[244:247], v[144:147], a[20:23]
    s_waitcnt lgkmcnt(10)
    v_exp_f32 v99, v99
    v_mfma_f32_16x16x32_bf16 a[20:23], a[212:215], v[140:143], a[20:23]
    ds_read_b128 a[168:171], v206 offset:24576
    v_cvt_pk_bf16_f32 v169, v98, v99
    v_mfma_f32_16x16x32_bf16 a[24:27], a[216:219], v[140:143], a[24:27]
L_pg4:
    s_cbranch_execz L_pg8
    v_exp_f32 v104, v104
    v_mfma_f32_16x16x32_bf16 a[24:27], a[248:251], v[144:147], a[24:27]
    ds_read_b128 a[172:175], v207 offset:24576
    v_mfma_f32_16x16x32_bf16 a[56:59], a[248:251], v[152:155], a[56:59]
    v_exp_f32 v105, v105
    v_mfma_f32_16x16x32_bf16 a[56:59], a[216:219], v[148:151], a[56:59]
    ds_read_b128 a[176:179], v204 offset:28672
    v_cvt_pk_bf16_f32 v170, v104, v105
    v_mfma_f32_16x16x32_bf16 a[60:63], a[220:223], v[148:151], a[60:63]
    v_exp_f32 v106, v106
    v_mfma_f32_16x16x32_bf16 a[60:63], a[252:255], v[152:155], a[60:63]
    ds_read_b128 a[180:183], v205 offset:28672
    v_mfma_f32_16x16x32_bf16 a[28:31], a[252:255], v[144:147], a[28:31]
    s_waitcnt lgkmcnt(6)
    v_exp_f32 v107, v107
    v_mfma_f32_16x16x32_bf16 a[28:31], a[220:223], v[140:143], a[28:31]
    ds_read_b128 a[184:187], v206 offset:28672
    v_cvt_pk_bf16_f32 v171, v106, v107
    v_mfma_f32_16x16x32_bf16 v[76:79], a[128:131], v[12:15], v[172:175]
    v_exp_f32 v100, v100
    v_mfma_f32_16x16x32_bf16 v[76:79], a[132:135], v[16:19], v[76:79]
    ds_read_b128 a[188:191], v207 offset:28672
    v_mfma_f32_16x16x32_bf16 v[76:79], a[136:139], v[20:23], v[76:79]
    s_add_u32 m0, s17, 49152
    v_exp_f32 v101, v101
    v_mfma_f32_16x16x32_bf16 v[76:79], a[140:143], v[24:27], v[76:79]
    buffer_load_dwordx4 v216, s[8:11], s16 offen offset:0 nt lds
    v_mfma_f32_16x16x32_bf16 v[80:83], a[140:143], v[40:43], v[176:179]
    v_exp_f32 v102, v102
    v_mfma_f32_16x16x32_bf16 v[80:83], a[136:139], v[36:39], v[80:83]
    v_cvt_pk_bf16_f32 v162, v100, v101
    v_mfma_f32_16x16x32_bf16 v[80:83], a[132:135], v[32:35], v[80:83]
    v_exp_f32 v103, v103
    v_mfma_f32_16x16x32_bf16 v[80:83], a[128:131], v[28:31], v[80:83]
    buffer_load_dwordx4 v217, s[8:11], s16 offen offset:1024 nt lds
    v_mfma_f32_16x16x32_bf16 v[88:91], a[144:147], v[28:31], v[176:179]
    v_exp_f32 v76, v76
    v_mfma_f32_16x16x32_bf16 v[88:91], a[148:151], v[32:35], v[88:91]
    buffer_store_dword v238, v239, s[24:27], s81 offen sc1
    v_cvt_pk_bf16_f32 v163, v102, v103
    v_mfma_f32_16x16x32_bf16 v[88:91], a[152:155], v[36:39], v[88:91]
    v_exp_f32 v77, v77
    v_mfma_f32_16x16x32_bf16 v[88:91], a[156:159], v[40:43], v[88:91]
    buffer_load_dwordx4 v218, s[8:11], s16 offen offset:2048 nt lds
    v_mfma_f32_16x16x32_bf16 v[84:87], a[156:159], v[24:27], v[172:175]
    v_exp_f32 v78, v78
    v_mfma_f32_16x16x32_bf16 v[84:87], a[152:155], v[20:23], v[84:87]
    v_cvt_pk_bf16_f32 v140, v76, v77
    v_mfma_f32_16x16x32_bf16 v[84:87], a[148:151], v[16:19], v[84:87]
    s_waitcnt lgkmcnt(0)
    v_exp_f32 v79, v79
    v_mfma_f32_16x16x32_bf16 v[84:87], a[144:147], v[12:15], v[84:87]
    buffer_load_dwordx4 v219, s[8:11], s16 offen offset:3072 nt lds
    v_mfma_f32_16x16x32_bf16 v[92:95], a[160:163], v[12:15], v[172:175]
    v_exp_f32 v80, v80
    v_mfma_f32_16x16x32_bf16 v[92:95], a[164:167], v[16:19], v[92:95]
    v_cvt_pk_bf16_f32 v141, v78, v79
    v_mfma_f32_16x16x32_bf16 v[92:95], a[168:171], v[20:23], v[92:95]
    s_add_u32 m0, s17, 114688
    v_exp_f32 v81, v81
    v_mfma_f32_16x16x32_bf16 v[92:95], a[172:175], v[24:27], v[92:95]
    buffer_load_dwordx4 v220, s[12:15], s16 offen offset:0 nt lds
    v_mfma_f32_16x16x32_bf16 v[96:99], a[172:175], v[40:43], v[176:179]
    v_exp_f32 v82, v82
    v_mfma_f32_16x16x32_bf16 v[96:99], a[168:171], v[36:39], v[96:99]
    v_cvt_pk_bf16_f32 v148, v80, v81
    v_mfma_f32_16x16x32_bf16 v[96:99], a[164:167], v[32:35], v[96:99]
    v_exp_f32 v83, v83
    v_mfma_f32_16x16x32_bf16 v[96:99], a[160:163], v[28:31], v[96:99]
    buffer_load_dwordx4 v221, s[12:15], s16 offen offset:1024 nt lds
    v_mfma_f32_16x16x32_bf16 v[104:107], a[176:179], v[28:31], v[176:179]
    v_exp_f32 v88, v88
    v_mfma_f32_16x16x32_bf16 v[104:107], a[180:183], v[32:35], v[104:107]
    v_cvt_pk_bf16_f32 v149, v82, v83
    v_mfma_f32_16x16x32_bf16 v[104:107], a[184:187], v[36:39], v[104:107]
    v_exp_f32 v89, v89
    v_mfma_f32_16x16x32_bf16 v[104:107], a[188:191], v[40:43], v[104:107]
    buffer_load_dwordx4 v222, s[12:15], s16 offen offset:2048 nt lds
    v_mfma_f32_16x16x32_bf16 v[100:103], a[188:191], v[24:27], v[172:175]
    v_exp_f32 v90, v90
    v_mfma_f32_16x16x32_bf16 v[100:103], a[184:187], v[20:23], v[100:103]
    v_cvt_pk_bf16_f32 v150, v88, v89
    v_mfma_f32_16x16x32_bf16 v[100:103], a[180:183], v[16:19], v[100:103]
    v_exp_f32 v91, v91
    v_mfma_f32_16x16x32_bf16 v[100:103], a[176:179], v[12:15], v[100:103]
    buffer_load_dwordx4 v223, s[12:15], s16 offen offset:3072 nt lds
    v_mfma_f32_16x16x32_bf16 a[64:67], a[192:195], v[156:159], a[64:67]
    s_add_u32 m0, s80, 1024
    v_exp_f32 v84, v84
    v_mfma_f32_16x16x32_bf16 a[64:67], a[224:227], v[160:163], a[64:67]
    s_bitcmp1_b32 s74, 31
    v_cvt_pk_bf16_f32 v151, v90, v91
    v_smfmac_f32_16x16x64_bf16 v[200:203], v[188:191], v[156:163], v11
    s_cbranch_scc1 L_ns1
    buffer_store_dwordx4 v[224:227], v252, s[24:27], s74 offen sc1
L_ns1:
    v_smfmac_f32_16x16x64_bf16 v[248:251], v[188:191], v[164:171], v11
    buffer_load_dwordx4 v237, s[40:43], s79 offen sc1 lds
    v_mfma_f32_16x16x32_bf16 a[96:99], a[224:227], v[168:171], a[96:99]
    s_add_u32 s16, s16, s30
    v_exp_f32 v85, v85
    v_mfma_f32_16x16x32_bf16 a[96:99], a[192:195], v[164:167], a[96:99]
    ds_read_b64_tr_b16 a[192:193], v208 offset:16384
    v_cvt_pk_bf16_f32 v142, v84, v85
    v_mfma_f32_16x16x32_bf16 a[100:103], a[196:199], v[164:167], a[100:103]
    s_add_u32 s74, s74, s78
    v_exp_f32 v86, v86
    v_mfma_f32_16x16x32_bf16 a[100:103], a[228:231], v[168:171], a[100:103]
    ds_read_b64_tr_b16 a[194:195], v208 offset:20480
    v_mfma_f32_16x16x32_bf16 a[68:71], a[228:231], v[160:163], a[68:71]
    v_exp_f32 v87, v87
    v_mfma_f32_16x16x32_bf16 a[68:71], a[196:199], v[156:159], a[68:71]
    ds_read_b64_tr_b16 a[224:225], v208 offset:24576
    v_cvt_pk_bf16_f32 v143, v86, v87
    v_mfma_f32_16x16x32_bf16 a[72:75], a[200:203], v[156:159], a[72:75]
    v_exp_f32 v92, v92
    v_mfma_f32_16x16x32_bf16 a[72:75], a[232:235], v[160:163], a[72:75]
    ds_read_b64_tr_b16 a[226:227], v208 offset:28672
    v_mfma_f32_16x16x32_bf16 a[104:107], a[232:235], v[168:171], a[104:107]
    v_exp_f32 v93, v93
    v_mfma_f32_16x16x32_bf16 a[104:107], a[200:203], v[164:167], a[104:107]
    ds_read_b64_tr_b16 a[196:197], v209 offset:16384
    v_cvt_pk_bf16_f32 v144, v92, v93
    v_mfma_f32_16x16x32_bf16 a[108:111], a[204:207], v[164:167], a[108:111]
    v_exp_f32 v94, v94
    v_mfma_f32_16x16x32_bf16 a[108:111], a[236:239], v[168:171], a[108:111]
    ds_read_b64_tr_b16 a[198:199], v209 offset:20480
    v_mfma_f32_16x16x32_bf16 a[76:79], a[236:239], v[160:163], a[76:79]
    v_exp_f32 v95, v95
    v_mfma_f32_16x16x32_bf16 a[76:79], a[204:207], v[156:159], a[76:79]
    ds_read_b64_tr_b16 a[228:229], v209 offset:24576
    v_cvt_pk_bf16_f32 v145, v94, v95
    v_mfma_f32_16x16x32_bf16 a[80:83], a[208:211], v[156:159], a[80:83]
    v_exp_f32 v96, v96
    v_mfma_f32_16x16x32_bf16 a[80:83], a[240:243], v[160:163], a[80:83]
    ds_read_b64_tr_b16 a[230:231], v209 offset:28672
    v_mfma_f32_16x16x32_bf16 a[112:115], a[240:243], v[168:171], a[112:115]
    v_exp_f32 v97, v97
    v_mfma_f32_16x16x32_bf16 a[112:115], a[208:211], v[164:167], a[112:115]
    ds_read_b64_tr_b16 a[200:201], v210 offset:16384
    v_cvt_pk_bf16_f32 v152, v96, v97
    v_mfma_f32_16x16x32_bf16 a[116:119], a[212:215], v[164:167], a[116:119]
    v_exp_f32 v98, v98
    v_mfma_f32_16x16x32_bf16 a[116:119], a[244:247], v[168:171], a[116:119]
    ds_read_b64_tr_b16 a[202:203], v210 offset:20480
    v_mfma_f32_16x16x32_bf16 a[84:87], a[244:247], v[160:163], a[84:87]
    v_exp_f32 v99, v99
    v_mfma_f32_16x16x32_bf16 a[84:87], a[212:215], v[156:159], a[84:87]
    ds_read_b64_tr_b16 a[232:233], v210 offset:24576
    v_cvt_pk_bf16_f32 v153, v98, v99
    v_mfma_f32_16x16x32_bf16 a[88:91], a[216:219], v[156:159], a[88:91]
    v_exp_f32 v104, v104
    v_mfma_f32_16x16x32_bf16 a[88:91], a[248:251], v[160:163], a[88:91]
    ds_read_b64_tr_b16 a[234:235], v210 offset:28672
    v_mfma_f32_16x16x32_bf16 a[120:123], a[248:251], v[168:171], a[120:123]
    v_exp_f32 v105, v105
    v_mfma_f32_16x16x32_bf16 a[120:123], a[216:219], v[164:167], a[120:123]
    ds_read_b64_tr_b16 a[204:205], v211 offset:16384
    v_cvt_pk_bf16_f32 v154, v104, v105
    v_mfma_f32_16x16x32_bf16 a[124:127], a[220:223], v[164:167], a[124:127]
    v_exp_f32 v106, v106
    v_mfma_f32_16x16x32_bf16 a[124:127], a[252:255], v[168:171], a[124:127]
    ds_read_b64_tr_b16 a[206:207], v211 offset:20480
    v_mfma_f32_16x16x32_bf16 a[92:95], a[252:255], v[160:163], a[92:95]
    v_exp_f32 v107, v107
    v_mfma_f32_16x16x32_bf16 a[92:95], a[220:223], v[156:159], a[92:95]
    ds_read_b64_tr_b16 a[236:237], v211 offset:24576
    v_cvt_pk_bf16_f32 v155, v106, v107
    v_mfma_f32_16x16x32_bf16 v[76:79], a[128:131], v[44:47], v[180:183]
    v_exp_f32 v100, v100
    v_mfma_f32_16x16x32_bf16 v[76:79], a[132:135], v[48:51], v[76:79]
    ds_read_b64_tr_b16 a[238:239], v211 offset:28672
    v_mfma_f32_16x16x32_bf16 v[76:79], a[136:139], v[52:55], v[76:79]
    v_exp_f32 v101, v101
    v_mfma_f32_16x16x32_bf16 v[76:79], a[140:143], v[56:59], v[76:79]
    ds_read_b64_tr_b16 a[208:209], v212 offset:16384
    v_cvt_pk_bf16_f32 v146, v100, v101
    v_mfma_f32_16x16x32_bf16 v[80:83], a[140:143], v[72:75], v[184:187]
    v_exp_f32 v102, v102
    v_mfma_f32_16x16x32_bf16 v[80:83], a[136:139], v[68:71], v[80:83]
    ds_read_b64_tr_b16 a[210:211], v212 offset:20480
    v_mfma_f32_16x16x32_bf16 v[80:83], a[132:135], v[64:67], v[80:83]
    v_exp_f32 v103, v103
    v_mfma_f32_16x16x32_bf16 v[80:83], a[128:131], v[60:63], v[80:83]
    ds_read_b64_tr_b16 a[240:241], v212 offset:24576
    v_cvt_pk_bf16_f32 v147, v102, v103
    v_mfma_f32_16x16x32_bf16 v[88:91], a[144:147], v[60:63], v[184:187]
    v_exp_f32 v76, v76
    v_mfma_f32_16x16x32_bf16 v[88:91], a[148:151], v[64:67], v[88:91]
    ds_read_b64_tr_b16 a[242:243], v212 offset:28672
    v_mfma_f32_16x16x32_bf16 v[88:91], a[152:155], v[68:71], v[88:91]
    v_exp_f32 v77, v77
    v_mfma_f32_16x16x32_bf16 v[88:91], a[156:159], v[72:75], v[88:91]
    ds_read_b64_tr_b16 a[212:213], v213 offset:16384
    v_cvt_pk_bf16_f32 v156, v76, v77
    v_mfma_f32_16x16x32_bf16 v[84:87], a[156:159], v[56:59], v[180:183]
    v_exp_f32 v78, v78
    v_mfma_f32_16x16x32_bf16 v[84:87], a[152:155], v[52:55], v[84:87]
    ds_read_b64_tr_b16 a[214:215], v213 offset:20480
    v_mfma_f32_16x16x32_bf16 v[84:87], a[148:151], v[48:51], v[84:87]
    v_exp_f32 v79, v79
    v_mfma_f32_16x16x32_bf16 v[84:87], a[144:147], v[44:47], v[84:87]
    ds_read_b64_tr_b16 a[244:245], v213 offset:24576
    v_cvt_pk_bf16_f32 v157, v78, v79
    v_mfma_f32_16x16x32_bf16 v[92:95], a[160:163], v[44:47], v[180:183]
    v_exp_f32 v80, v80
    v_mfma_f32_16x16x32_bf16 v[92:95], a[164:167], v[48:51], v[92:95]
    ds_read_b64_tr_b16 a[246:247], v213 offset:28672
    v_mfma_f32_16x16x32_bf16 v[92:95], a[168:171], v[52:55], v[92:95]
    v_exp_f32 v81, v81
    v_mfma_f32_16x16x32_bf16 v[92:95], a[172:175], v[56:59], v[92:95]
    ds_read_b64_tr_b16 a[216:217], v214 offset:16384
    v_cvt_pk_bf16_f32 v164, v80, v81
    v_mfma_f32_16x16x32_bf16 v[96:99], a[172:175], v[72:75], v[184:187]
    v_exp_f32 v82, v82
    v_mfma_f32_16x16x32_bf16 v[96:99], a[168:171], v[68:71], v[96:99]
    ds_read_b64_tr_b16 a[218:219], v214 offset:20480
    v_mfma_f32_16x16x32_bf16 v[96:99], a[164:167], v[64:67], v[96:99]
    v_exp_f32 v83, v83
    v_mfma_f32_16x16x32_bf16 v[96:99], a[160:163], v[60:63], v[96:99]
    ds_read_b64_tr_b16 a[248:249], v214 offset:24576
    v_cvt_pk_bf16_f32 v165, v82, v83
    v_mfma_f32_16x16x32_bf16 v[104:107], a[176:179], v[60:63], v[184:187]
    v_exp_f32 v88, v88
    v_mfma_f32_16x16x32_bf16 v[104:107], a[180:183], v[64:67], v[104:107]
    ds_read_b64_tr_b16 a[250:251], v214 offset:28672
    v_mfma_f32_16x16x32_bf16 v[104:107], a[184:187], v[68:71], v[104:107]
    v_exp_f32 v89, v89
    v_mfma_f32_16x16x32_bf16 v[104:107], a[188:191], v[72:75], v[104:107]
    ds_read_b64_tr_b16 a[220:221], v215 offset:16384
    v_cvt_pk_bf16_f32 v166, v88, v89
    v_mfma_f32_16x16x32_bf16 v[100:103], a[188:191], v[56:59], v[180:183]
    v_exp_f32 v90, v90
    v_mfma_f32_16x16x32_bf16 v[100:103], a[184:187], v[52:55], v[100:103]
    ds_read_b64_tr_b16 a[222:223], v215 offset:20480
    v_mfma_f32_16x16x32_bf16 v[100:103], a[180:183], v[48:51], v[100:103]
    s_waitcnt lgkmcnt(6)
    v_exp_f32 v91, v91
    v_mfma_f32_16x16x32_bf16 v[100:103], a[176:179], v[44:47], v[100:103]
    ds_read_b64_tr_b16 a[252:253], v215 offset:24576
    v_cvt_pk_bf16_f32 v167, v90, v91
    v_mfma_f32_16x16x32_bf16 a[0:3], a[192:195], v[140:143], a[0:3]
    v_exp_f32 v84, v84
    v_mfma_f32_16x16x32_bf16 a[0:3], a[224:227], v[144:147], a[0:3]
    ds_read_b64_tr_b16 a[254:255], v215 offset:28672
    v_smfmac_f32_16x16x64_bf16 v[192:195], v[188:191], v[140:147], v11
    s_waitcnt vmcnt(11)
    ds_read_b64_tr_b16 v[224:225], v236
    v_smfmac_f32_16x16x64_bf16 v[196:199], v[188:191], v[148:155], v11
    s_barrier
    ds_read_b64_tr_b16 v[226:227], v236 offset:1024
    v_add_u32 v236, s86, v236
    v_mfma_f32_16x16x32_bf16 a[32:35], a[224:227], v[152:155], a[32:35]
    v_exp_f32 v85, v85
    v_mfma_f32_16x16x32_bf16 a[32:35], a[192:195], v[148:151], a[32:35]
    ds_read_b128 a[128:131], v204 offset:32768
    v_cvt_pk_bf16_f32 v158, v84, v85
    v_mfma_f32_16x16x32_bf16 a[36:39], a[196:199], v[148:151], a[36:39]
    v_exp_f32 v86, v86
    v_mfma_f32_16x16x32_bf16 a[36:39], a[228:231], v[152:155], a[36:39]
    ds_read_b128 a[132:135], v205 offset:32768
    v_mfma_f32_16x16x32_bf16 a[4:7], a[228:231], v[144:147], a[4:7]
    v_exp_f32 v87, v87
    v_mfma_f32_16x16x32_bf16 a[4:7], a[196:199], v[140:143], a[4:7]
    ds_read_b128 a[136:139], v206 offset:32768
    v_cvt_pk_bf16_f32 v159, v86, v87
    v_mfma_f32_16x16x32_bf16 a[8:11], a[200:203], v[140:143], a[8:11]
    v_exp_f32 v92, v92
    v_mfma_f32_16x16x32_bf16 a[8:11], a[232:235], v[144:147], a[8:11]
    ds_read_b128 a[140:143], v207 offset:32768
    v_mfma_f32_16x16x32_bf16 a[40:43], a[232:235], v[152:155], a[40:43]
    v_exp_f32 v93, v93
    v_mfma_f32_16x16x32_bf16 a[40:43], a[200:203], v[148:151], a[40:43]
    ds_read_b128 a[144:147], v204 offset:36864
    v_cvt_pk_bf16_f32 v160, v92, v93
    v_mfma_f32_16x16x32_bf16 a[44:47], a[204:207], v[148:151], a[44:47]
    v_exp_f32 v94, v94
    v_mfma_f32_16x16x32_bf16 a[44:47], a[236:239], v[152:155], a[44:47]
    ds_read_b128 a[148:151], v205 offset:36864
    v_mfma_f32_16x16x32_bf16 a[12:15], a[236:239], v[144:147], a[12:15]
    v_exp_f32 v95, v95
    v_mfma_f32_16x16x32_bf16 a[12:15], a[204:207], v[140:143], a[12:15]
    ds_read_b128 a[152:155], v206 offset:36864
    v_cvt_pk_bf16_f32 v161, v94, v95
    v_mfma_f32_16x16x32_bf16 a[16:19], a[208:211], v[140:143], a[16:19]
    v_exp_f32 v96, v96
    v_mfma_f32_16x16x32_bf16 a[16:19], a[240:243], v[144:147], a[16:19]
    ds_read_b128 a[156:159], v207 offset:36864
    v_mfma_f32_16x16x32_bf16 a[48:51], a[240:243], v[152:155], a[48:51]
    v_exp_f32 v97, v97
    v_mfma_f32_16x16x32_bf16 a[48:51], a[208:211], v[148:151], a[48:51]
    ds_read_b128 a[160:163], v204 offset:40960
    v_cvt_pk_bf16_f32 v168, v96, v97
    v_mfma_f32_16x16x32_bf16 a[52:55], a[212:215], v[148:151], a[52:55]
    v_exp_f32 v98, v98
    v_mfma_f32_16x16x32_bf16 a[52:55], a[244:247], v[152:155], a[52:55]
    ds_read_b128 a[164:167], v205 offset:40960
    v_mfma_f32_16x16x32_bf16 a[20:23], a[244:247], v[144:147], a[20:23]
    s_waitcnt lgkmcnt(10)
    v_exp_f32 v99, v99
    v_mfma_f32_16x16x32_bf16 a[20:23], a[212:215], v[140:143], a[20:23]
    ds_read_b128 a[168:171], v206 offset:40960
    v_cvt_pk_bf16_f32 v169, v98, v99
    v_mfma_f32_16x16x32_bf16 a[24:27], a[216:219], v[140:143], a[24:27]
    v_exp_f32 v104, v104
    v_mfma_f32_16x16x32_bf16 a[24:27], a[248:251], v[144:147], a[24:27]
    ds_read_b128 a[172:175], v207 offset:40960
    v_mfma_f32_16x16x32_bf16 a[56:59], a[248:251], v[152:155], a[56:59]
    v_exp_f32 v105, v105
    v_mfma_f32_16x16x32_bf16 a[56:59], a[216:219], v[148:151], a[56:59]
    ds_read_b128 a[176:179], v204 offset:45056
    v_cvt_pk_bf16_f32 v170, v104, v105
    v_mfma_f32_16x16x32_bf16 a[60:63], a[220:223], v[148:151], a[60:63]
    v_exp_f32 v106, v106
    v_mfma_f32_16x16x32_bf16 a[60:63], a[252:255], v[152:155], a[60:63]
    ds_read_b128 a[180:183], v205 offset:45056
    v_mfma_f32_16x16x32_bf16 a[28:31], a[252:255], v[144:147], a[28:31]
    s_waitcnt lgkmcnt(6)
    v_exp_f32 v107, v107
    v_mfma_f32_16x16x32_bf16 a[28:31], a[220:223], v[140:143], a[28:31]
    ds_read_b128 a[184:187], v206 offset:45056
    v_cvt_pk_bf16_f32 v171, v106, v107
L_mid:
    v_mfma_f32_16x16x32_bf16 v[76:79], a[128:131], v[12:15], v[172:175]
L_jm:
    s_cbranch_execz L_pg3
    v_exp_f32 v100, v100
    v_mfma_f32_16x16x32_bf16 v[76:79], a[132:135], v[16:19], v[76:79]
    ds_read_b128 a[188:191], v207 offset:45056
    v_mfma_f32_16x16x32_bf16 v[76:79], a[136:139], v[20:23], v[76:79]
    s_add_u32 m0, s17, 0
    v_exp_f32 v101, v101
    v_mfma_f32_16x16x32_bf16 v[76:79], a[140:143], v[24:27], v[76:79]
    buffer_load_dwordx4 v216, s[8:11], s16 offen offset:0 nt lds
    v_mfma_f32_16x16x32_bf16 v[80:83], a[140:143], v[40:43], v[176:179]
    v_exp_f32 v102, v102
    v_mfma_f32_16x16x32_bf16 v[80:83], a[136:139], v[36:39], v[80:83]
    v_cvt_pk_bf16_f32 v162, v100, v101
    v_mfma_f32_16x16x32_bf16 v[80:83], a[132:135], v[32:35], v[80:83]
    v_exp_f32 v103, v103
    v_mfma_f32_16x16x32_bf16 v[80:83], a[128:131], v[28:31], v[80:83]
    buffer_load_dwordx4 v217, s[8:11], s16 offen offset:1024 nt lds
    v_mfma_f32_16x16x32_bf16 v[88:91], a[144:147], v[28:31], v[176:179]
    v_exp_f32 v76, v76
    v_mfma_f32_16x16x32_bf16 v[88:91], a[148:151], v[32:35], v[88:91]
    buffer_load_dwordx4 v[228:231], v252, s[24:27], s50 offen sc1
    v_cvt_pk_bf16_f32 v163, v102, v103
    v_mfma_f32_16x16x32_bf16 v[88:91], a[152:155], v[36:39], v[88:91]
    v_exp_f32 v77, v77
    v_mfma_f32_16x16x32_bf16 v[88:91], a[156:159], v[40:43], v[88:91]
    buffer_load_dwordx4 v218, s[8:11], s16 offen offset:2048 nt lds
    v_mfma_f32_16x16x32_bf16 v[84:87], a[156:159], v[24:27], v[172:175]
    v_exp_f32 v78, v78
    v_mfma_f32_16x16x32_bf16 v[84:87], a[152:155], v[20:23], v[84:87]
    v_cvt_pk_bf16_f32 v140, v76, v77
    v_mfma_f32_16x16x32_bf16 v[84:87], a[148:151], v[16:19], v[84:87]
    s_waitcnt lgkmcnt(0)
    v_exp_f32 v79, v79
    v_mfma_f32_16x16x32_bf16 v[84:87], a[144:147], v[12:15], v[84:87]
    buffer_load_dwordx4 v219, s[8:11], s16 offen offset:3072 nt lds
    v_mfma_f32_16x16x32_bf16 v[92:95], a[160:163], v[12:15], v[172:175]
    v_exp_f32 v80, v80
    v_mfma_f32_16x16x32_bf16 v[92:95], a[164:167], v[16:19], v[92:95]
    v_cvt_pk_bf16_f32 v141, v78, v79
    v_mfma_f32_16x16x32_bf16 v[92:95], a[168:171], v[20:23], v[92:95]
    s_add_u32 m0, s17, 65536
    v_exp_f32 v81, v81
    v_mfma_f32_16x16x32_bf16 v[92:95], a[172:175], v[24:27], v[92:95]
    buffer_load_dwordx4 v220, s[12:15], s16 offen offset:0 nt lds
    v_mfma_f32_16x16x32_bf16 v[96:99], a[172:175], v[40:43], v[176:179]
    v_exp_f32 v82, v82
    v_mfma_f32_16x16x32_bf16 v[96:99], a[168:171], v[36:39], v[96:99]
    v_cvt_pk_bf16_f32 v148, v80, v81
    v_mfma_f32_16x16x32_bf16 v[96:99], a[164:167], v[32:35], v[96:99]
    v_exp_f32 v83, v83
    v_mfma_f32_16x16x32_bf16 v[96:99], a[160:163], v[28:31], v[96:99]
    buffer_load_dwordx4 v221, s[12:15], s16 offen offset:1024 nt lds
    v_mfma_f32_16x16x32_bf16 v[104:107], a[176:179], v[28:31], v[176:179]
    v_exp_f32 v88, v88
    v_mfma_f32_16x16x32_bf16 v[104:107], a[180:183], v[32:35], v[104:107]
    v_cvt_pk_bf16_f32 v149, v82, v83
    v_mfma_f32_16x16x32_bf16 v[104:107], a[184:187], v[36:39], v[104:107]
    v_exp_f32 v89, v89
    v_mfma_f32_16x16x32_bf16 v[104:107], a[188:191], v[40:43], v[104:107]
    buffer_load_dwordx4 v222, s[12:15], s16 offen offset:2048 nt lds
    v_mfma_f32_16x16x32_bf16 v[100:103], a[188:191], v[24:27], v[172:175]
    v_exp_f32 v90, v90
    v_mfma_f32_16x16x32_bf16 v[100:103], a[184:187], v[20:23], v[100:103]
    v_cvt_pk_bf16_f32 v150, v88, v89
    v_mfma_f32_16x16x32_bf16 v[100:103], a[180:183], v[16:19], v[100:103]
    v_exp_f32 v91, v91
    v_mfma_f32_16x16x32_bf16 v[100:103], a[176:179], v[12:15], v[100:103]
    buffer_load_dwordx4 v223, s[12:15], s16 offen offset:3072 nt lds
    v_mfma_f32_16x16x32_bf16 a[64:67], a[192:195], v[156:159], a[64:67]
    s_add_u32 m0, s80, 2048
    v_exp_f32 v84, v84
    v_mfma_f32_16x16x32_bf16 a[64:67], a[224:227], v[160:163], a[64:67]
    s_bitcmp1_b32 s74, 31
    v_cvt_pk_bf16_f32 v151, v90, v91
    v_smfmac_f32_16x16x64_bf16 v[200:203], v[188:191], v[156:163], v11
    s_cbranch_scc1 L_ns2
    buffer_store_dwordx4 v[224:227], v252, s[24:27], s74 offen sc1
L_ns2:
    v_smfmac_f32_16x16x64_bf16 v[248:251], v[188:191], v[164:171], v11
    buffer_load_dwordx4 v237, s[60:63], 0 offen sc1 lds
    v_mfma_f32_16x16x32_bf16 a[96:99], a[224:227], v[168:171], a[96:99]
    s_add_u32 s16, s16, s30
    v_exp_f32 v85, v85
    v_mfma_f32_16x16x32_bf16 a[96:99], a[192:195], v[164:167], a[96:99]
    ds_read_b64_tr_b16 a[192:193], v208 offset:32768
    v_cvt_pk_bf16_f32 v142, v84, v85
    v_mfma_f32_16x16x32_bf16 a[100:103], a[196:199], v[164:167], a[100:103]
    s_add_u32 s74, s74, s78
    v_exp_f32 v86, v86
    v_mfma_f32_16x16x32_bf16 a[100:103], a[228:231], v[168:171], a[100:103]
    ds_read_b64_tr_b16 a[194:195], v208 offset:36864
    v_mfma_f32_16x16x32_bf16 a[68:71], a[228:231], v[160:163], a[68:71]
    v_exp_f32 v87, v87
    v_mfma_f32_16x16x32_bf16 a[68:71], a[196:199], v[156:159], a[68:71]
    ds_read_b64_tr_b16 a[224:225], v208 offset:40960
    v_cvt_pk_bf16_f32 v143, v86, v87
    v_mfma_f32_16x16x32_bf16 a[72:75], a[200:203], v[156:159], a[72:75]
    v_exp_f32 v92, v92
    v_mfma_f32_16x16x32_bf16 a[72:75], a[232:235], v[160:163], a[72:75]
    ds_read_b64_tr_b16 a[226:227], v208 offset:45056
    v_mfma_f32_16x16x32_bf16 a[104:107], a[232:235], v[168:171], a[104:107]
    v_exp_f32 v93, v93
    v_mfma_f32_16x16x32_bf16 a[104:107], a[200:203], v[164:167], a[104:107]
    ds_read_b64_tr_b16 a[196:197], v209 offset:32768
    v_cvt_pk_bf16_f32 v144, v92, v93
    v_mfma_f32_16x16x32_bf16 a[108:111], a[204:207], v[164:167], a[108:111]
    v_exp_f32 v94, v94
    v_mfma_f32_16x16x32_bf16 a[108:111], a[236:239], v[168:171], a[108:111]
    ds_read_b64_tr_b16 a[198:199], v209 offset:36864
    v_mfma_f32_16x16x32_bf16 a[76:79], a[236:239], v[160:163], a[76:79]
    v_exp_f32 v95, v95
    v_mfma_f32_16x16x32_bf16 a[76:79], a[204:207], v[156:159], a[76:79]
    ds_read_b64_tr_b16 a[228:229], v209 offset:40960
    v_cvt_pk_bf16_f32 v145, v94, v95
    v_mfma_f32_16x16x32_bf16 a[80:83], a[208:211], v[156:159], a[80:83]
    v_exp_f32 v96, v96
    v_mfma_f32_16x16x32_bf16 a[80:83], a[240:243], v[160:163], a[80:83]
    ds_read_b64_tr_b16 a[230:231], v209 offset:45056
    v_mfma_f32_16x16x32_bf16 a[112:115], a[240:243], v[168:171], a[112:115]
    v_exp_f32 v97, v97
    v_mfma_f32_16x16x32_bf16 a[112:115], a[208:211], v[164:167], a[112:115]
    ds_read_b64_tr_b16 a[200:201], v210 offset:32768
    v_cvt_pk_bf16_f32 v152, v96, v97
    v_mfma_f32_16x16x32_bf16 a[116:119], a[212:215], v[164:167], a[116:119]
    v_exp_f32 v98, v98
    v_mfma_f32_16x16x32_bf16 a[116:119], a[244:247], v[168:171], a[116:119]
    ds_read_b64_tr_b16 a[202:203], v210 offset:36864
    v_mfma_f32_16x16x32_bf16 a[84:87], a[244:247], v[160:163], a[84:87]
    v_exp_f32 v99, v99
    v_mfma_f32_16x16x32_bf16 a[84:87], a[212:215], v[156:159], a[84:87]
    ds_read_b64_tr_b16 a[232:233], v210 offset:40960
    v_cvt_pk_bf16_f32 v153, v98, v99
    v_mfma_f32_16x16x32_bf16 a[88:91], a[216:219], v[156:159], a[88:91]
    v_exp_f32 v104, v104
    v_mfma_f32_16x16x32_bf16 a[88:91], a[248:251], v[160:163], a[88:91]
    ds_read_b64_tr_b16 a[234:235], v210 offset:45056
    v_mfma_f32_16x16x32_bf16 a[120:123], a[248:251], v[168:171], a[120:123]
    v_exp_f32 v105, v105
    v_mfma_f32_16x16x32_bf16 a[120:123], a[216:219], v[164:167], a[120:123]
    ds_read_b64_tr_b16 a[204:205], v211 offset:32768
    v_cvt_pk_bf16_f32 v154, v104, v105
    v_mfma_f32_16x16x32_bf16 a[124:127], a[220:223], v[164:167], a[124:127]
    v_exp_f32 v106, v106
    v_mfma_f32_16x16x32_bf16 a[124:127], a[252:255], v[168:171], a[124:127]
    ds_read_b64_tr_b16 a[206:207], v211 offset:36864
    v_mfma_f32_16x16x32_bf16 a[92:95], a[252:255], v[160:163], a[92:95]
    v_exp_f32 v107, v107
    v_mfma_f32_16x16x32_bf16 a[92:95], a[220:223], v[156:159], a[92:95]
    ds_read_b64_tr_b16 a[236:237], v211 offset:40960
    v_cvt_pk_bf16_f32 v155, v106, v107
    v_mfma_f32_16x16x32_bf16 v[76:79], a[128:131], v[44:47], v[180:183]
    v_exp_f32 v100, v100
    v_mfma_f32_16x16x32_bf16 v[76:79], a[132:135], v[48:51], v[76:79]
    ds_read_b64_tr_b16 a[238:239], v211 offset:45056
    v_mfma_f32_16x16x32_bf16 v[76:79], a[136:139], v[52:55], v[76:79]
    v_exp_f32 v101, v101
    v_mfma_f32_16x16x32_bf16 v[76:79], a[140:143], v[56:59], v[76:79]
    ds_read_b64_tr_b16 a[208:209], v212 offset:32768
    v_cvt_pk_bf16_f32 v146, v100, v101
    v_mfma_f32_16x16x32_bf16 v[80:83], a[140:143], v[72:75], v[184:187]
    v_exp_f32 v102, v102
    v_mfma_f32_16x16x32_bf16 v[80:83], a[136:139], v[68:71], v[80:83]
    ds_read_b64_tr_b16 a[210:211], v212 offset:36864
    v_mfma_f32_16x16x32_bf16 v[80:83], a[132:135], v[64:67], v[80:83]
    v_exp_f32 v103, v103
    v_mfma_f32_16x16x32_bf16 v[80:83], a[128:131], v[60:63], v[80:83]
    ds_read_b64_tr_b16 a[240:241], v212 offset:40960
    v_cvt_pk_bf16_f32 v147, v102, v103
    v_mfma_f32_16x16x32_bf16 v[88:91], a[144:147], v[60:63], v[184:187]
    v_exp_f32 v76, v76
    v_mfma_f32_16x16x32_bf16 v[88:91], a[148:151], v[64:67], v[88:91]
    ds_read_b64_tr_b16 a[242:243], v212 offset:45056
    v_mfma_f32_16x16x32_bf16 v[88:91], a[152:155], v[68:71], v[88:91]
    v_exp_f32 v77, v77
    v_mfma_f32_16x16x32_bf16 v[88:91], a[156:159], v[72:75], v[88:91]
    ds_read_b64_tr_b16 a[212:213], v213 offset:32768
    v_cvt_pk_bf16_f32 v156, v76, v77
    v_mfma_f32_16x16x32_bf16 v[84:87], a[156:159], v[56:59], v[180:183]
    v_exp_f32 v78, v78
    v_mfma_f32_16x16x32_bf16 v[84:87], a[152:155], v[52:55], v[84:87]
    ds_read_b64_tr_b16 a[214:215], v213 offset:36864
    v_mfma_f32_16x16x32_bf16 v[84:87], a[148:151], v[48:51], v[84:87]
    v_exp_f32 v79, v79
    v_mfma_f32_16x16x32_bf16 v[84:87], a[144:147], v[44:47], v[84:87]
    ds_read_b64_tr_b16 a[244:245], v213 offset:40960
    v_cvt_pk_bf16_f32 v157, v78, v79
    v_mfma_f32_16x16x32_bf16 v[92:95], a[160:163], v[44:47], v[180:183]
    v_exp_f32 v80, v80
    v_mfma_f32_16x16x32_bf16 v[92:95], a[164:167], v[48:51], v[92:95]
    ds_read_b64_tr_b16 a[246:247], v213 offset:45056
    v_mfma_f32_16x16x32_bf16 v[92:95], a[168:171], v[52:55], v[92:95]
    v_exp_f32 v81, v81
    v_mfma_f32_16x16x32_bf16 v[92:95], a[172:175], v[56:59], v[92:95]
    ds_read_b64_tr_b16 a[216:217], v214 offset:32768
    v_cvt_pk_bf16_f32 v164, v80, v81
    v_mfma_f32_16x16x32_bf16 v[96:99], a[172:175], v[72:75], v[184:187]
    v_exp_f32 v82, v82
    v_mfma_f32_16x16x32_bf16 v[96:99], a[168:171], v[68:71], v[96:99]
    ds_read_b64_tr_b16 a[218:219], v214 offset:36864
    v_mfma_f32_16x16x32_bf16 v[96:99], a[164:167], v[64:67], v[96:99]
    v_exp_f32 v83, v83
    v_mfma_f32_16x16x32_bf16 v[96:99], a[160:163], v[60:63], v[96:99]
    ds_read_b64_tr_b16 a[248:249], v214 offset:40960
    v_cvt_pk_bf16_f32 v165, v82, v83
    v_mfma_f32_16x16x32_bf16 v[104:107], a[176:179], v[60:63], v[184:187]
    v_exp_f32 v88, v88
    v_mfma_f32_16x16x32_bf16 v[104:107], a[180:183], v[64:67], v[104:107]
    ds_read_b64_tr_b16 a[250:251], v214 offset:45056
    v_mfma_f32_16x16x32_bf16 v[104:107], a[184:187], v[68:71], v[104:107]
    v_exp_f32 v89, v89
    v_mfma_f32_16x16x32_bf16 v[104:107], a[188:191], v[72:75], v[104:107]
    ds_read_b64_tr_b16 a[220:221], v215 offset:32768
    v_cvt_pk_bf16_f32 v166, v88, v89
    v_mfma_f32_16x16x32_bf16 v[100:103], a[188:191], v[56:59], v[180:183]
    v_exp_f32 v90, v90
    v_mfma_f32_16x16x32_bf16 v[100:103], a[184:187], v[52:55], v[100:103]
    ds_read_b64_tr_b16 a[222:223], v215 offset:36864
    v_mfma_f32_16x16x32_bf16 v[100:103], a[180:183], v[48:51], v[100:103]
    s_waitcnt lgkmcnt(6)
    v_exp_f32 v91, v91
    v_mfma_f32_16x16x32_bf16 v[100:103], a[176:179], v[44:47], v[100:103]
    ds_read_b64_tr_b16 a[252:253], v215 offset:40960
    v_cvt_pk_bf16_f32 v167, v90, v91
    v_mfma_f32_16x16x32_bf16 a[0:3], a[192:195], v[140:143], a[0:3]
    v_exp_f32 v84, v84
    v_mfma_f32_16x16x32_bf16 a[0:3], a[224:227], v[144:147], a[0:3]
    ds_read_b64_tr_b16 a[254:255], v215 offset:45056
    v_smfmac_f32_16x16x64_bf16 v[192:195], v[188:191], v[140:147], v11
    s_waitcnt vmcnt(11)
    ds_read_b64_tr_b16 v[224:225], v236
    v_smfmac_f32_16x16x64_bf16 v[196:199], v[188:191], v[148:155], v11
    s_barrier
    ds_read_b64_tr_b16 v[226:227], v236 offset:1024
    v_add_u32 v236, s85, v236
    v_mfma_f32_16x16x32_bf16 a[32:35], a[224:227], v[152:155], a[32:35]
    v_exp_f32 v85, v85
    v_mfma_f32_16x16x32_bf16 a[32:35], a[192:195], v[148:151], a[32:35]
    ds_read_b128 a[128:131], v204 offset:49152
    v_cvt_pk_bf16_f32 v158, v84, v85
    v_mfma_f32_16x16x32_bf16 a[36:39], a[196:199], v[148:151], a[36:39]
    v_exp_f32 v86, v86
    v_mfma_f32_16x16x32_bf16 a[36:39], a[228:231], v[152:155], a[36:39]
    ds_read_b128 a[132:135], v205 offset:49152
    v_mfma_f32_16x16x32_bf16 a[4:7], a[228:231], v[144:147], a[4:7]
    v_exp_f32 v87, v87
    v_mfma_f32_16x16x32_bf16 a[4:7], a[196:199], v[140:143], a[4:7]
    ds_read_b128 a[136:139], v206 offset:49152
    v_cvt_pk_bf16_f32 v159, v86, v87
    v_mfma_f32_16x16x32_bf16 a[8:11], a[200:203], v[140:143], a[8:11]
    v_exp_f32 v92, v92
    v_mfma_f32_16x16x32_bf16 a[8:11], a[232:235], v[144:147], a[8:11]
    ds_read_b128 a[140:143], v207 offset:49152
    v_mfma_f32_16x16x32_bf16 a[40:43], a[232:235], v[152:155], a[40:43]
    v_exp_f32 v93, v93
    v_mfma_f32_16x16x32_bf16 a[40:43], a[200:203], v[148:151], a[40:43]
    ds_read_b128 a[144:147], v204 offset:53248
    v_cvt_pk_bf16_f32 v160, v92, v93
    v_mfma_f32_16x16x32_bf16 a[44:47], a[204:207], v[148:151], a[44:47]
    v_exp_f32 v94, v94
    v_mfma_f32_16x16x32_bf16 a[44:47], a[236:239], v[152:155], a[44:47]
    ds_read_b128 a[148:151], v205 offset:53248
    v_mfma_f32_16x16x32_bf16 a[12:15], a[236:239], v[144:147], a[12:15]
    v_exp_f32 v95, v95
    v_mfma_f32_16x16x32_bf16 a[12:15], a[204:207], v[140:143], a[12:15]
L_pg5:
    s_cbranch_execz L_pg9
    ds_read_b128 a[152:155], v206 offset:53248
    v_cvt_pk_bf16_f32 v161, v94, v95
    v_mfma_f32_16x16x32_bf16 a[16:19], a[208:211], v[140:143], a[16:19]
    v_exp_f32 v96, v96
    v_mfma_f32_16x16x32_bf16 a[16:19], a[240:243], v[144:147], a[16:19]
    ds_read_b128 a[156:159], v207 offset:53248
    v_mfma_f32_16x16x32_bf16 a[48:51], a[240:243], v[152:155], a[48:51]
    v_exp_f32 v97, v97
    v_mfma_f32_16x16x32_bf16 a[48:51], a[208:211], v[148:151], a[48:51]
    ds_read_b128 a[160:163], v204 offset:57344
    v_cvt_pk_bf16_f32 v168, v96, v97
    v_mfma_f32_16x16x32_bf16 a[52:55], a[212:215], v[148:151], a[52:55]
    v_exp_f32 v98, v98
    v_mfma_f32_16x16x32_bf16 a[52:55], a[244:247], v[152:155], a[52:55]
    ds_read_b128 a[164:167], v205 offset:57344
    v_mfma_f32_16x16x32_bf16 a[20:23], a[244:247], v[144:147], a[20:23]
    s_waitcnt lgkmcnt(10)
    v_exp_f32 v99, v99
    v_mfma_f32_16x16x32_bf16 a[20:23], a[212:215], v[140:143], a[20:23]
    ds_read_b128 a[168:171], v206 offset:57344
    v_cvt_pk_bf16_f32 v169, v98, v99
    v_mfma_f32_16x16x32_bf16 a[24:27], a[216:219], v[140:143], a[24:27]
    v_exp_f32 v104, v104
    v_mfma_f32_16x16x32_bf16 a[24:27], a[248:251], v[144:147], a[24:27]
    ds_read_b128 a[172:175], v207 offset:57344
    v_mfma_f32_16x16x32_bf16 a[56:59], a[248:251], v[152:155], a[56:59]
    v_exp_f32 v105, v105
    v_mfma_f32_16x16x32_bf16 a[56:59], a[216:219], v[148:151], a[56:59]
    ds_read_b128 a[176:179], v204 offset:61440
    v_cvt_pk_bf16_f32 v170, v104, v105
    v_mfma_f32_16x16x32_bf16 a[60:63], a[220:223], v[148:151], a[60:63]
    v_exp_f32 v106, v106
    v_mfma_f32_16x16x32_bf16 a[60:63], a[252:255], v[152:155], a[60:63]
    ds_read_b128 a[180:183], v205 offset:61440
    v_mfma_f32_16x16x32_bf16 a[28:31], a[252:255], v[144:147], a[28:31]
    s_waitcnt lgkmcnt(6)
    v_exp_f32 v107, v107
    v_mfma_f32_16x16x32_bf16 a[28:31], a[220:223], v[140:143], a[28:31]
    ds_read_b128 a[184:187], v206 offset:61440
    v_cvt_pk_bf16_f32 v171, v106, v107
    v_mfma_f32_16x16x32_bf16 v[76:79], a[128:131], v[12:15], v[172:175]
    v_exp_f32 v100, v100
    v_mfma_f32_16x16x32_bf16 v[76:79], a[132:135], v[16:19], v[76:79]
    ds_read_b128 a[188:191], v207 offset:61440
    v_mfma_f32_16x16x32_bf16 v[76:79], a[136:139], v[20:23], v[76:79]
    s_add_u32 m0, s17, 16384
    v_exp_f32 v101, v101
    v_mfma_f32_16x16x32_bf16 v[76:79], a[140:143], v[24:27], v[76:79]
    buffer_load_dwordx4 v216, s[8:11], s16 offen offset:0 nt lds
    v_mfma_f32_16x16x32_bf16 v[80:83], a[140:143], v[40:43], v[176:179]
    v_exp_f32 v102, v102
    v_mfma_f32_16x16x32_bf16 v[80:83], a[136:139], v[36:39], v[80:83]
    v_cvt_pk_bf16_f32 v162, v100, v101
    v_mfma_f32_16x16x32_bf16 v[80:83], a[132:135], v[32:35], v[80:83]
    v_exp_f32 v103, v103
    v_mfma_f32_16x16x32_bf16 v[80:83], a[128:131], v[28:31], v[80:83]
    buffer_load_dwordx4 v217, s[8:11], s16 offen offset:1024 nt lds
    v_mfma_f32_16x16x32_bf16 v[88:91], a[144:147], v[28:31], v[176:179]
    v_exp_f32 v76, v76
    v_mfma_f32_16x16x32_bf16 v[88:91], a[148:151], v[32:35], v[88:91]
    v_cvt_pk_bf16_f32 v163, v102, v103
    v_mfma_f32_16x16x32_bf16 v[88:91], a[152:155], v[36:39], v[88:91]
    v_exp_f32 v77, v77
    v_mfma_f32_16x16x32_bf16 v[88:91], a[156:159], v[40:43], v[88:91]
    buffer_load_dwordx4 v218, s[8:11], s16 offen offset:2048 nt lds
    v_mfma_f32_16x16x32_bf16 v[84:87], a[156:159], v[24:27], v[172:175]
    v_exp_f32 v78, v78
    v_mfma_f32_16x16x32_bf16 v[84:87], a[152:155], v[20:23], v[84:87]
    v_cvt_pk_bf16_f32 v140, v76, v77
    v_mfma_f32_16x16x32_bf16 v[84:87], a[148:151], v[16:19], v[84:87]
    s_waitcnt lgkmcnt(0)
    v_exp_f32 v79, v79
    v_mfma_f32_16x16x32_bf16 v[84:87], a[144:147], v[12:15], v[84:87]
    buffer_load_dwordx4 v219, s[8:11], s16 offen offset:3072 nt lds
    v_mfma_f32_16x16x32_bf16 v[92:95], a[160:163], v[12:15], v[172:175]
    v_exp_f32 v80, v80
    v_mfma_f32_16x16x32_bf16 v[92:95], a[164:167], v[16:19], v[92:95]
    v_cvt_pk_bf16_f32 v141, v78, v79
    v_mfma_f32_16x16x32_bf16 v[92:95], a[168:171], v[20:23], v[92:95]
    s_add_u32 m0, s17, 81920
    v_exp_f32 v81, v81
    v_mfma_f32_16x16x32_bf16 v[92:95], a[172:175], v[24:27], v[92:95]
    buffer_load_dwordx4 v220, s[12:15], s16 offen offset:0 nt lds
    v_mfma_f32_16x16x32_bf16 v[96:99], a[172:175], v[40:43], v[176:179]
    v_exp_f32 v82, v82
    v_mfma_f32_16x16x32_bf16 v[96:99], a[168:171], v[36:39], v[96:99]
    v_cvt_pk_bf16_f32 v148, v80, v81
    v_mfma_f32_16x16x32_bf16 v[96:99], a[164:167], v[32:35], v[96:99]
    v_exp_f32 v83, v83
    v_mfma_f32_16x16x32_bf16 v[96:99], a[160:163], v[28:31], v[96:99]
    buffer_load_dwordx4 v221, s[12:15], s16 offen offset:1024 nt lds
    v_mfma_f32_16x16x32_bf16 v[104:107], a[176:179], v[28:31], v[176:179]
    v_exp_f32 v88, v88
    v_mfma_f32_16x16x32_bf16 v[104:107], a[180:183], v[32:35], v[104:107]
    v_cvt_pk_bf16_f32 v149, v82, v83
    v_mfma_f32_16x16x32_bf16 v[104:107], a[184:187], v[36:39], v[104:107]
    v_exp_f32 v89, v89
    v_mfma_f32_16x16x32_bf16 v[104:107], a[188:191], v[40:43], v[104:107]
    buffer_load_dwordx4 v222, s[12:15], s16 offen offset:2048 nt lds
    v_mfma_f32_16x16x32_bf16 v[100:103], a[188:191], v[24:27], v[172:175]
    v_exp_f32 v90, v90
    v_mfma_f32_16x16x32_bf16 v[100:103], a[184:187], v[20:23], v[100:103]
    v_cvt_pk_bf16_f32 v150, v88, v89
    v_mfma_f32_16x16x32_bf16 v[100:103], a[180:183], v[16:19], v[100:103]
    v_exp_f32 v91, v91
    v_mfma_f32_16x16x32_bf16 v[100:103], a[176:179], v[12:15], v[100:103]
    buffer_load_dwordx4 v223, s[12:15], s16 offen offset:3072 nt lds
    v_mfma_f32_16x16x32_bf16 a[64:67], a[192:195], v[156:159], a[64:67]
    s_add_u32 m0, s80, 3072
    v_exp_f32 v84, v84
    v_mfma_f32_16x16x32_bf16 a[64:67], a[224:227], v[160:163], a[64:67]
    s_bitcmp1_b32 s74, 31
    v_cvt_pk_bf16_f32 v151, v90, v91
    v_smfmac_f32_16x16x64_bf16 v[200:203], v[188:191], v[156:163], v11
    s_cbranch_scc1 L_ns3
    buffer_store_dwordx4 v[224:227], v252, s[24:27], s74 offen sc1
L_ns3:
    v_smfmac_f32_16x16x64_bf16 v[248:251], v[188:191], v[164:171], v11
    buffer_load_dwordx4 v237, s[60:63], s79 offen sc1 lds
    v_mfma_f32_16x16x32_bf16 a[96:99], a[224:227], v[168:171], a[96:99]
    s_add_u32 s16, s16, s30
    v_exp_f32 v85, v85
    v_mfma_f32_16x16x32_bf16 a[96:99], a[192:195], v[164:167], a[96:99]
    ds_read_b64_tr_b16 a[192:193], v208 offset:49152
    v_cvt_pk_bf16_f32 v142, v84, v85
    v_mfma_f32_16x16x32_bf16 a[100:103], a[196:199], v[164:167], a[100:103]
    s_add_u32 s74, s74, s78
    v_exp_f32 v86, v86
    v_mfma_f32_16x16x32_bf16 a[100:103], a[228:231], v[168:171], a[100:103]
    ds_read_b64_tr_b16 a[194:195], v208 offset:53248
    v_mfma_f32_16x16x32_bf16 a[68:71], a[228:231], v[160:163], a[68:71]
    s_mov_b64 s[40:41], s[64:65]
    v_exp_f32 v87, v87
    v_mfma_f32_16x16x32_bf16 a[68:71], a[196:199], v[156:159], a[68:71]
    ds_read_b64_tr_b16 a[224:225], v208 offset:57344
    v_cvt_pk_bf16_f32 v143, v86, v87
    v_mfma_f32_16x16x32_bf16 a[72:75], a[200:203], v[156:159], a[72:75]
    s_mov_b64 s[60:61], s[66:67]
    v_exp_f32 v92, v92
    v_mfma_f32_16x16x32_bf16 a[72:75], a[232:235], v[160:163], a[72:75]
    ds_read_b64_tr_b16 a[226:227], v208 offset:61440
    v_mfma_f32_16x16x32_bf16 a[104:107], a[232:235], v[168:171], a[104:107]
    s_mov_b32 s42, s68
    v_exp_f32 v93, v93
    v_mfma_f32_16x16x32_bf16 a[104:107], a[200:203], v[164:167], a[104:107]
    ds_read_b64_tr_b16 a[196:197], v209 offset:49152
    v_cvt_pk_bf16_f32 v144, v92, v93
    v_mfma_f32_16x16x32_bf16 a[108:111], a[204:207], v[164:167], a[108:111]
    s_mov_b32 s62, s68
    v_exp_f32 v94, v94
    v_mfma_f32_16x16x32_bf16 a[108:111], a[236:239], v[168:171], a[108:111]
    ds_read_b64_tr_b16 a[198:199], v209 offset:53248
    v_mfma_f32_16x16x32_bf16 a[76:79], a[236:239], v[160:163], a[76:79]
    s_mov_b64 s[64:65], s[70:71]
    v_exp_f32 v95, v95
    v_mfma_f32_16x16x32_bf16 a[76:79], a[204:207], v[156:159], a[76:79]
    ds_read_b64_tr_b16 a[228:229], v209 offset:57344
    v_cvt_pk_bf16_f32 v145, v94, v95
    v_mfma_f32_16x16x32_bf16 a[80:83], a[208:211], v[156:159], a[80:83]
    s_mov_b64 s[66:67], s[72:73]
    v_exp_f32 v96, v96
    v_mfma_f32_16x16x32_bf16 a[80:83], a[240:243], v[160:163], a[80:83]
    ds_read_b64_tr_b16 a[230:231], v209 offset:61440
    v_mfma_f32_16x16x32_bf16 a[112:115], a[240:243], v[168:171], a[112:115]
    s_mov_b32 s68, s69
    v_exp_f32 v97, v97
    v_mfma_f32_16x16x32_bf16 a[112:115], a[208:211], v[164:167], a[112:115]
    ds_read_b64_tr_b16 a[200:201], v210 offset:49152
    v_cvt_pk_bf16_f32 v152, v96, v97
    v_mfma_f32_16x16x32_bf16 a[116:119], a[212:215], v[164:167], a[116:119]
    s_add_u32 s70, s24, s92
    s_addc_u32 s71, s25, 0
    v_exp_f32 v98, v98
    v_mfma_f32_16x16x32_bf16 a[116:119], a[244:247], v[168:171], a[116:119]
    ds_read_b64_tr_b16 a[202:203], v210 offset:53248
    v_mfma_f32_16x16x32_bf16 a[84:87], a[244:247], v[160:163], a[84:87]
    s_add_u32 s72, s70, 4096
    s_addc_u32 s73, s71, 0
    v_exp_f32 v99, v99
    v_mfma_f32_16x16x32_bf16 a[84:87], a[212:215], v[156:159], a[84:87]
    ds_read_b64_tr_b16 a[232:233], v210 offset:57344
    v_cvt_pk_bf16_f32 v153, v98, v99
    v_mfma_f32_16x16x32_bf16 a[88:91], a[216:219], v[156:159], a[88:91]
    s_mov_b32 s92, s93
    v_exp_f32 v104, v104
    v_mfma_f32_16x16x32_bf16 a[88:91], a[248:251], v[160:163], a[88:91]
    ds_read_b64_tr_b16 a[234:235], v210 offset:61440
    v_mfma_f32_16x16x32_bf16 a[120:123], a[248:251], v[168:171], a[120:123]
    s_mov_b32 s93, s94
    v_exp_f32 v105, v105
    v_mfma_f32_16x16x32_bf16 a[120:123], a[216:219], v[164:167], a[120:123]
    ds_read_b64_tr_b16 a[204:205], v211 offset:49152
    v_cvt_pk_bf16_f32 v154, v104, v105
    v_mfma_f32_16x16x32_bf16 a[124:127], a[220:223], v[164:167], a[124:127]
    s_mov_b32 s94, s95
    v_exp_f32 v106, v106
    v_mfma_f32_16x16x32_bf16 a[124:127], a[252:255], v[168:171], a[124:127]
    ds_read_b64_tr_b16 a[206:207], v211 offset:53248
    v_mfma_f32_16x16x32_bf16 a[92:95], a[252:255], v[160:163], a[92:95]
    s_cmp_eq_u32 s18, 8
    v_exp_f32 v107, v107
    v_mfma_f32_16x16x32_bf16 a[92:95], a[220:223], v[156:159], a[92:95]
    ds_read_b64_tr_b16 a[236:237], v211 offset:57344
    v_cvt_pk_bf16_f32 v155, v106, v107
    v_mfma_f32_16x16x32_bf16 v[76:79], a[128:131], v[44:47], v[180:183]
    s_cselect_b32 s69, 0, 4096
    v_exp_f32 v100, v100
    v_mfma_f32_16x16x32_bf16 v[76:79], a[132:135], v[48:51], v[76:79]
    ds_read_b64_tr_b16 a[238:239], v211 offset:61440
    v_mfma_f32_16x16x32_bf16 v[76:79], a[136:139], v[52:55], v[76:79]
    s_cselect_b32 s51, 8, 1
    v_exp_f32 v101, v101
    v_mfma_f32_16x16x32_bf16 v[76:79], a[140:143], v[56:59], v[76:79]
    ds_read_b64_tr_b16 a[208:209], v212 offset:49152
    v_cvt_pk_bf16_f32 v146, v100, v101
    v_mfma_f32_16x16x32_bf16 v[80:83], a[140:143], v[72:75], v[184:187]
    s_xor_b32 s80, s80, 4096
    v_exp_f32 v102, v102
    v_mfma_f32_16x16x32_bf16 v[80:83], a[136:139], v[68:71], v[80:83]
    ds_read_b64_tr_b16 a[210:211], v212 offset:53248
    v_mfma_f32_16x16x32_bf16 v[80:83], a[132:135], v[64:67], v[80:83]
    s_cmp_eq_u32 s18, 7
    v_exp_f32 v103, v103
    v_mfma_f32_16x16x32_bf16 v[80:83], a[128:131], v[60:63], v[80:83]
    ds_read_b64_tr_b16 a[240:241], v212 offset:57344
    v_cvt_pk_bf16_f32 v147, v102, v103
    v_mfma_f32_16x16x32_bf16 v[88:91], a[144:147], v[60:63], v[184:187]
    s_cselect_b32 s51, 28, s51
    v_exp_f32 v76, v76
    v_mfma_f32_16x16x32_bf16 v[88:91], a[148:151], v[64:67], v[88:91]
    ds_read_b64_tr_b16 a[242:243], v212 offset:61440
    v_mfma_f32_16x16x32_bf16 v[88:91], a[152:155], v[68:71], v[88:91]
    s_lshl_b32 s51, s51, 7
    v_exp_f32 v77, v77
    v_mfma_f32_16x16x32_bf16 v[88:91], a[156:159], v[72:75], v[88:91]
    ds_read_b64_tr_b16 a[212:213], v213 offset:49152
    v_cvt_pk_bf16_f32 v156, v76, v77
    v_mfma_f32_16x16x32_bf16 v[84:87], a[156:159], v[56:59], v[180:183]
    s_lshl_b32 s79, s51, 4
    v_exp_f32 v78, v78
    v_mfma_f32_16x16x32_bf16 v[84:87], a[152:155], v[52:55], v[84:87]
    ds_read_b64_tr_b16 a[214:215], v213 offset:53248
    v_mfma_f32_16x16x32_bf16 v[84:87], a[148:151], v[48:51], v[84:87]
    s_cmp_eq_u32 s18, s100
    v_exp_f32 v79, v79
    v_mfma_f32_16x16x32_bf16 v[84:87], a[144:147], v[44:47], v[84:87]
    ds_read_b64_tr_b16 a[244:245], v213 offset:57344
    v_cvt_pk_bf16_f32 v157, v78, v79
    v_mfma_f32_16x16x32_bf16 v[92:95], a[160:163], v[44:47], v[180:183]
    s_cselect_b32 s87, 2048, 16
    v_exp_f32 v80, v80
    v_mfma_f32_16x16x32_bf16 v[92:95], a[164:167], v[48:51], v[92:95]
    ds_read_b64_tr_b16 a[246:247], v213 offset:61440
    v_mfma_f32_16x16x32_bf16 v[92:95], a[168:171], v[52:55], v[92:95]
    s_cselect_b32 s85, 16, 32
    v_exp_f32 v81, v81
    v_mfma_f32_16x16x32_bf16 v[92:95], a[172:175], v[56:59], v[92:95]
    ds_read_b64_tr_b16 a[216:217], v214 offset:49152
    v_cvt_pk_bf16_f32 v164, v80, v81
    v_mfma_f32_16x16x32_bf16 v[96:99], a[172:175], v[72:75], v[184:187]
    s_cselect_b32 s86, 16, 2016
    v_exp_f32 v82, v82
    v_mfma_f32_16x16x32_bf16 v[96:99], a[168:171], v[68:71], v[96:99]
    ds_read_b64_tr_b16 a[218:219], v214 offset:53248
    v_mfma_f32_16x16x32_bf16 v[96:99], a[164:167], v[64:67], v[96:99]
    v_exp_f32 v83, v83
    v_mfma_f32_16x16x32_bf16 v[96:99], a[160:163], v[60:63], v[96:99]
    ds_read_b64_tr_b16 a[248:249], v214 offset:57344
    v_cvt_pk_bf16_f32 v165, v82, v83
    v_mfma_f32_16x16x32_bf16 v[104:107], a[176:179], v[60:63], v[184:187]
    v_exp_f32 v88, v88
    v_mfma_f32_16x16x32_bf16 v[104:107], a[180:183], v[64:67], v[104:107]
    ds_read_b64_tr_b16 a[250:251], v214 offset:61440
    v_mfma_f32_16x16x32_bf16 v[104:107], a[184:187], v[68:71], v[104:107]
    v_exp_f32 v89, v89
    v_mfma_f32_16x16x32_bf16 v[104:107], a[188:191], v[72:75], v[104:107]
    ds_read_b64_tr_b16 a[220:221], v215 offset:49152
    v_cvt_pk_bf16_f32 v166, v88, v89
    v_mfma_f32_16x16x32_bf16 v[100:103], a[188:191], v[56:59], v[180:183]
    v_exp_f32 v90, v90
    v_mfma_f32_16x16x32_bf16 v[100:103], a[184:187], v[52:55], v[100:103]
    ds_read_b64_tr_b16 a[222:223], v215 offset:53248
    v_mfma_f32_16x16x32_bf16 v[100:103], a[180:183], v[48:51], v[100:103]
    s_waitcnt lgkmcnt(6)
    v_exp_f32 v91, v91
    v_mfma_f32_16x16x32_bf16 v[100:103], a[176:179], v[44:47], v[100:103]
    ds_read_b64_tr_b16 a[252:253], v215 offset:57344
    v_cvt_pk_bf16_f32 v167, v90, v91
    v_mfma_f32_16x16x32_bf16 a[0:3], a[192:195], v[140:143], a[0:3]
    v_exp_f32 v84, v84
    v_mfma_f32_16x16x32_bf16 a[0:3], a[224:227], v[144:147], a[0:3]
    ds_read_b64_tr_b16 a[254:255], v215 offset:61440
    v_smfmac_f32_16x16x64_bf16 v[192:195], v[188:191], v[140:147], v11
    s_waitcnt vmcnt(10)
    ds_read_b64_tr_b16 v[224:225], v236
    v_mad_u32_u24 v237, v234, s51, v235
    v_smfmac_f32_16x16x64_bf16 v[196:199], v[188:191], v[148:155], v11
    s_barrier
    ds_read_b64_tr_b16 v[226:227], v236 offset:1024
    v_mad_u32_u24 v236, v233, s87, v232
    v_mfma_f32_16x16x32_bf16 a[32:35], a[224:227], v[152:155], a[32:35]
    v_exp_f32 v85, v85
    v_mfma_f32_16x16x32_bf16 a[32:35], a[192:195], v[148:151], a[32:35]
    ds_read_b128 a[128:131], v204 offset:0
    v_cvt_pk_bf16_f32 v158, v84, v85
    v_mfma_f32_16x16x32_bf16 a[36:39], a[196:199], v[148:151], a[36:39]
    v_exp_f32 v86, v86
    v_mfma_f32_16x16x32_bf16 a[36:39], a[228:231], v[152:155], a[36:39]
    ds_read_b128 a[132:135], v205 offset:0
    v_mfma_f32_16x16x32_bf16 a[4:7], a[228:231], v[144:147], a[4:7]
    v_exp_f32 v87, v87
    v_mfma_f32_16x16x32_bf16 a[4:7], a[196:199], v[140:143], a[4:7]
    ds_read_b128 a[136:139], v206 offset:0
    v_cvt_pk_bf16_f32 v159, v86, v87
    v_mfma_f32_16x16x32_bf16 a[8:11], a[200:203], v[140:143], a[8:11]
    v_exp_f32 v92, v92
    v_mfma_f32_16x16x32_bf16 a[8:11], a[232:235], v[144:147], a[8:11]
    ds_read_b128 a[140:143], v207 offset:0
    v_mfma_f32_16x16x32_bf16 a[40:43], a[232:235], v[152:155], a[40:43]
    v_exp_f32 v93, v93
    v_mfma_f32_16x16x32_bf16 a[40:43], a[200:203], v[148:151], a[40:43]
    ds_read_b128 a[144:147], v204 offset:4096
    v_cvt_pk_bf16_f32 v160, v92, v93
    v_mfma_f32_16x16x32_bf16 a[44:47], a[204:207], v[148:151], a[44:47]
    v_exp_f32 v94, v94
    v_mfma_f32_16x16x32_bf16 a[44:47], a[236:239], v[152:155], a[44:47]
    ds_read_b128 a[148:151], v205 offset:4096
    v_mfma_f32_16x16x32_bf16 a[12:15], a[236:239], v[144:147], a[12:15]
    v_exp_f32 v95, v95
    v_mfma_f32_16x16x32_bf16 a[12:15], a[204:207], v[140:143], a[12:15]
    ds_read_b128 a[152:155], v206 offset:4096
    v_cvt_pk_bf16_f32 v161, v94, v95
    v_mfma_f32_16x16x32_bf16 a[16:19], a[208:211], v[140:143], a[16:19]
    v_exp_f32 v96, v96
    v_mfma_f32_16x16x32_bf16 a[16:19], a[240:243], v[144:147], a[16:19]
    ds_read_b128 a[156:159], v207 offset:4096
    v_mfma_f32_16x16x32_bf16 a[48:51], a[240:243], v[152:155], a[48:51]
    v_exp_f32 v97, v97
    v_mfma_f32_16x16x32_bf16 a[48:51], a[208:211], v[148:151], a[48:51]
    ds_read_b128 a[160:163], v204 offset:8192
    v_cvt_pk_bf16_f32 v168, v96, v97
    v_mfma_f32_16x16x32_bf16 a[52:55], a[212:215], v[148:151], a[52:55]
    v_exp_f32 v98, v98
    v_mfma_f32_16x16x32_bf16 a[52:55], a[244:247], v[152:155], a[52:55]
    ds_read_b128 a[164:167], v205 offset:8192
    v_mfma_f32_16x16x32_bf16 a[20:23], a[244:247], v[144:147], a[20:23]
    s_waitcnt lgkmcnt(10)
    v_exp_f32 v99, v99
    v_mfma_f32_16x16x32_bf16 a[20:23], a[212:215], v[140:143], a[20:23]
    ds_read_b128 a[168:171], v206 offset:8192
    v_cvt_pk_bf16_f32 v169, v98, v99
    v_mfma_f32_16x16x32_bf16 a[24:27], a[216:219], v[140:143], a[24:27]
    s_sub_u32 s18, s18, 1
    v_exp_f32 v104, v104
    v_mfma_f32_16x16x32_bf16 a[24:27], a[248:251], v[144:147], a[24:27]
    ds_read_b128 a[172:175], v207 offset:8192
    v_mfma_f32_16x16x32_bf16 a[56:59], a[248:251], v[152:155], a[56:59]
    s_cmp_lg_u32 s18, 1
    v_exp_f32 v105, v105
    v_mfma_f32_16x16x32_bf16 a[56:59], a[216:219], v[148:151], a[56:59]
    ds_read_b128 a[176:179], v204 offset:12288
    v_cvt_pk_bf16_f32 v170, v104, v105
    v_mfma_f32_16x16x32_bf16 a[60:63], a[220:223], v[148:151], a[60:63]
    v_exp_f32 v106, v106
    v_mfma_f32_16x16x32_bf16 a[60:63], a[252:255], v[152:155], a[60:63]
    ds_read_b128 a[180:183], v205 offset:12288
    v_mfma_f32_16x16x32_bf16 a[28:31], a[252:255], v[144:147], a[28:31]
    s_waitcnt lgkmcnt(6)
    v_exp_f32 v107, v107
    v_mfma_f32_16x16x32_bf16 a[28:31], a[220:223], v[140:143], a[28:31]
    ds_read_b128 a[184:187], v206 offset:12288
    v_cvt_pk_bf16_f32 v171, v106, v107
    s_cbranch_scc1 L_loop
    v_mfma_f32_16x16x32_bf16 v[76:79], a[128:131], v[12:15], v[172:175]
    v_exp_f32 v100, v100
    v_mfma_f32_16x16x32_bf16 v[76:79], a[132:135], v[16:19], v[76:79]
    ds_read_b128 a[188:191], v207 offset:12288
    v_mfma_f32_16x16x32_bf16 v[76:79], a[136:139], v[20:23], v[76:79]
    s_add_u32 m0, s17, 32768
    v_exp_f32 v101, v101
    v_mfma_f32_16x16x32_bf16 v[76:79], a[140:143], v[24:27], v[76:79]
    buffer_load_dwordx4 v216, s[8:11], s16 offen offset:0 nt lds
    v_mfma_f32_16x16x32_bf16 v[80:83], a[140:143], v[40:43], v[176:179]
    s_mul_i32 s23, s22, 1212416
    v_exp_f32 v102, v102
    v_mfma_f32_16x16x32_bf16 v[80:83], a[136:139], v[36:39], v[80:83]
    v_xor_b32 v2, v238, v228
    v_bitop3_b32 v2, v2, v229, v238 bitop3:0xf6
    v_bitop3_b32 v2, v2, v230, v238 bitop3:0xf6
    v_bitop3_b32 v2, v2, v231, v238 bitop3:0xf6
    v_cmp_ne_u32 vcc, 0, v2
    v_cvt_pk_bf16_f32 v162, v100, v101
    v_mfma_f32_16x16x32_bf16 v[80:83], a[132:135], v[32:35], v[80:83]
    s_add_u32 s23, s23, 52428800
    v_exp_f32 v103, v103
    v_mfma_f32_16x16x32_bf16 v[80:83], a[128:131], v[28:31], v[80:83]
    buffer_load_dwordx4 v217, s[8:11], s16 offen offset:1024 nt lds
    v_mfma_f32_16x16x32_bf16 v[88:91], a[144:147], v[28:31], v[176:179]
    s_cbranch_vccnz L_hook
L_back:
    v_exp_f32 v76, v76
    v_mfma_f32_16x16x32_bf16 v[88:91], a[148:151], v[32:35], v[88:91]
    v_and_b32 v236, 15, v0
    v_lshlrev_b32 v236, 6, v236
    v_lshl_add_u32 v236, v1, 10, v236
    v_cvt_pk_bf16_f32 v163, v102, v103
    v_mfma_f32_16x16x32_bf16 v[88:91], a[152:155], v[36:39], v[88:91]
    s_and_b32 s29, s82, 63
    v_exp_f32 v77, v77
    v_mfma_f32_16x16x32_bf16 v[88:91], a[156:159], v[40:43], v[88:91]
    buffer_load_dwordx4 v218, s[8:11], s16 offen offset:2048 nt lds
    v_mfma_f32_16x16x32_bf16 v[84:87], a[156:159], v[24:27], v[172:175]
    s_mul_i32 s29, s29, 18944
    v_exp_f32 v78, v78
    v_mfma_f32_16x16x32_bf16 v[84:87], a[152:155], v[20:23], v[84:87]
    v_cvt_pk_bf16_f32 v140, v76, v77
    v_mfma_f32_16x16x32_bf16 v[84:87], a[148:151], v[16:19], v[84:87]
    s_waitcnt lgkmcnt(0)
    v_exp_f32 v79, v79
    v_mfma_f32_16x16x32_bf16 v[84:87], a[144:147], v[12:15], v[84:87]
    buffer_load_dwordx4 v219, s[8:11], s16 offen offset:3072 nt lds
    v_mfma_f32_16x16x32_bf16 v[92:95], a[160:163], v[12:15], v[172:175]
    s_add_u32 s74, s23, s29
    v_exp_f32 v80, v80
    v_mfma_f32_16x16x32_bf16 v[92:95], a[164:167], v[16:19], v[92:95]
    v_cvt_pk_bf16_f32 v141, v78, v79
    v_mfma_f32_16x16x32_bf16 v[92:95], a[168:171], v[20:23], v[92:95]
    s_add_u32 m0, s17, 98304
    v_exp_f32 v81, v81
    v_mfma_f32_16x16x32_bf16 v[92:95], a[172:175], v[24:27], v[92:95]
    buffer_load_dwordx4 v220, s[12:15], s16 offen offset:0 nt lds
    v_mfma_f32_16x16x32_bf16 v[96:99], a[172:175], v[40:43], v[176:179]
    s_mov_b32 s75, 589824
    v_exp_f32 v82, v82
    v_mfma_f32_16x16x32_bf16 v[96:99], a[168:171], v[36:39], v[96:99]
    v_cvt_pk_bf16_f32 v148, v80, v81
    v_mfma_f32_16x16x32_bf16 v[96:99], a[164:167], v[32:35], v[96:99]
    s_cmp_eq_u32 s2, 0
    v_exp_f32 v83, v83
    v_mfma_f32_16x16x32_bf16 v[96:99], a[160:163], v[28:31], v[96:99]
    buffer_load_dwordx4 v221, s[12:15], s16 offen offset:1024 nt lds
    v_mfma_f32_16x16x32_bf16 v[104:107], a[176:179], v[28:31], v[176:179]
    s_cselect_b32 s75, s75, 2147483648
    v_exp_f32 v88, v88
    v_mfma_f32_16x16x32_bf16 v[104:107], a[180:183], v[32:35], v[104:107]
    v_cvt_pk_bf16_f32 v149, v82, v83
    v_mfma_f32_16x16x32_bf16 v[104:107], a[184:187], v[36:39], v[104:107]
    s_lshl_b32 s76, s19, 17
    v_exp_f32 v89, v89
    v_mfma_f32_16x16x32_bf16 v[104:107], a[188:191], v[40:43], v[104:107]
    buffer_load_dwordx4 v222, s[12:15], s16 offen offset:2048 nt lds
    v_mfma_f32_16x16x32_bf16 v[100:103], a[188:191], v[24:27], v[172:175]
    s_add_u32 s76, s76, s23
    v_exp_f32 v90, v90
    v_mfma_f32_16x16x32_bf16 v[100:103], a[184:187], v[20:23], v[100:103]
    v_cvt_pk_bf16_f32 v150, v88, v89
    v_mfma_f32_16x16x32_bf16 v[100:103], a[180:183], v[16:19], v[100:103]
    v_exp_f32 v91, v91
    v_mfma_f32_16x16x32_bf16 v[100:103], a[176:179], v[12:15], v[100:103]
    buffer_load_dwordx4 v223, s[12:15], s16 offen offset:3072 nt lds
    v_mfma_f32_16x16x32_bf16 a[64:67], a[192:195], v[156:159], a[64:67]
    v_exp_f32 v84, v84
    v_mfma_f32_16x16x32_bf16 a[64:67], a[224:227], v[160:163], a[64:67]
    v_cvt_pk_bf16_f32 v151, v90, v91
    v_smfmac_f32_16x16x64_bf16 v[200:203], v[188:191], v[156:163], v11
    v_smfmac_f32_16x16x64_bf16 v[248:251], v[188:191], v[164:171], v11
    v_mfma_f32_16x16x32_bf16 a[96:99], a[224:227], v[168:171], a[96:99]
    s_add_u32 s16, s16, s30
    v_exp_f32 v85, v85
    v_mfma_f32_16x16x32_bf16 a[96:99], a[192:195], v[164:167], a[96:99]
    ds_read_b64_tr_b16 a[192:193], v208 offset:0
    v_cvt_pk_bf16_f32 v142, v84, v85
    v_mfma_f32_16x16x32_bf16 a[100:103], a[196:199], v[164:167], a[100:103]
    s_mov_b32 s60, s88
    v_exp_f32 v86, v86
    v_mfma_f32_16x16x32_bf16 a[100:103], a[228:231], v[168:171], a[100:103]
    ds_read_b64_tr_b16 a[194:195], v208 offset:4096
    v_mfma_f32_16x16x32_bf16 a[68:71], a[228:231], v[160:163], a[68:71]
    s_mov_b32 s61, s89
    v_exp_f32 v87, v87
    v_mfma_f32_16x16x32_bf16 a[68:71], a[196:199], v[156:159], a[68:71]
    ds_read_b64_tr_b16 a[224:225], v208 offset:8192
    v_cvt_pk_bf16_f32 v143, v86, v87
    v_mfma_f32_16x16x32_bf16 a[72:75], a[200:203], v[156:159], a[72:75]
    s_mov_b32 s62, L_fallback-L_pc
    v_exp_f32 v92, v92
    v_mfma_f32_16x16x32_bf16 a[72:75], a[232:235], v[160:163], a[72:75]
    ds_read_b64_tr_b16 a[226:227], v208 offset:12288
    v_mfma_f32_16x16x32_bf16 a[104:107], a[232:235], v[168:171], a[104:107]
    s_lshr_b32 s77, s20, 3
    v_exp_f32 v93, v93
    v_mfma_f32_16x16x32_bf16 a[104:107], a[200:203], v[164:167], a[104:107]
    ds_read_b64_tr_b16 a[196:197], v209 offset:0
    v_cvt_pk_bf16_f32 v144, v92, v93
    v_mfma_f32_16x16x32_bf16 a[108:111], a[204:207], v[164:167], a[108:111]
    s_lshl_b32 s77, s77, 12
    v_exp_f32 v94, v94
    v_mfma_f32_16x16x32_bf16 a[108:111], a[236:239], v[168:171], a[108:111]
    ds_read_b64_tr_b16 a[198:199], v209 offset:4096
    v_mfma_f32_16x16x32_bf16 a[76:79], a[236:239], v[160:163], a[76:79]
    s_lshl_b32 s78, s19, 11
    v_exp_f32 v95, v95
    v_mfma_f32_16x16x32_bf16 a[76:79], a[204:207], v[156:159], a[76:79]
    ds_read_b64_tr_b16 a[228:229], v209 offset:8192
    v_cvt_pk_bf16_f32 v145, v94, v95
    v_mfma_f32_16x16x32_bf16 a[80:83], a[208:211], v[156:159], a[80:83]
    s_add_u32 s78, s78, 557056
    v_exp_f32 v96, v96
    v_mfma_f32_16x16x32_bf16 a[80:83], a[240:243], v[160:163], a[80:83]
    ds_read_b64_tr_b16 a[230:231], v209 offset:12288
    v_mfma_f32_16x16x32_bf16 a[112:115], a[240:243], v[168:171], a[112:115]
    s_lshl_b32 s79, s19, 13
    v_exp_f32 v97, v97
    v_mfma_f32_16x16x32_bf16 a[112:115], a[208:211], v[164:167], a[112:115]
    ds_read_b64_tr_b16 a[200:201], v210 offset:0
    v_cvt_pk_bf16_f32 v152, v96, v97
    v_mfma_f32_16x16x32_bf16 a[116:119], a[212:215], v[164:167], a[116:119]
    s_add_u32 s79, s79, 131072
    v_exp_f32 v98, v98
    v_mfma_f32_16x16x32_bf16 a[116:119], a[244:247], v[168:171], a[116:119]
    ds_read_b64_tr_b16 a[202:203], v210 offset:4096
    v_mfma_f32_16x16x32_bf16 a[84:87], a[244:247], v[160:163], a[84:87]
    v_exp_f32 v99, v99
    v_mfma_f32_16x16x32_bf16 a[84:87], a[212:215], v[156:159], a[84:87]
    ds_read_b64_tr_b16 a[232:233], v210 offset:8192
    v_cvt_pk_bf16_f32 v153, v98, v99
    v_mfma_f32_16x16x32_bf16 a[88:91], a[216:219], v[156:159], a[88:91]
    v_exp_f32 v104, v104
    v_mfma_f32_16x16x32_bf16 a[88:91], a[248:251], v[160:163], a[88:91]
    ds_read_b64_tr_b16 a[234:235], v210 offset:12288
    v_mfma_f32_16x16x32_bf16 a[120:123], a[248:251], v[168:171], a[120:123]
    v_exp_f32 v105, v105
    v_mfma_f32_16x16x32_bf16 a[120:123], a[216:219], v[164:167], a[120:123]
    ds_read_b64_tr_b16 a[204:205], v211 offset:0
    v_cvt_pk_bf16_f32 v154, v104, v105
    v_mfma_f32_16x16x32_bf16 a[124:127], a[220:223], v[164:167], a[124:127]
    v_exp_f32 v106, v106
    v_mfma_f32_16x16x32_bf16 a[124:127], a[252:255], v[168:171], a[124:127]
    ds_read_b64_tr_b16 a[206:207], v211 offset:4096
    v_mfma_f32_16x16x32_bf16 a[92:95], a[252:255], v[160:163], a[92:95]
    v_exp_f32 v107, v107
    v_mfma_f32_16x16x32_bf16 a[92:95], a[220:223], v[156:159], a[92:95]
    ds_read_b64_tr_b16 a[236:237], v211 offset:8192
    v_cvt_pk_bf16_f32 v155, v106, v107
    v_mfma_f32_16x16x32_bf16 v[76:79], a[128:131], v[44:47], v[180:183]
    v_exp_f32 v100, v100
    v_mfma_f32_16x16x32_bf16 v[76:79], a[132:135], v[48:51], v[76:79]
    ds_read_b64_tr_b16 a[238:239], v211 offset:12288
    v_mfma_f32_16x16x32_bf16 v[76:79], a[136:139], v[52:55], v[76:79]
    v_exp_f32 v101, v101
    v_mfma_f32_16x16x32_bf16 v[76:79], a[140:143], v[56:59], v[76:79]
    ds_read_b64_tr_b16 a[208:209], v212 offset:0
    v_cvt_pk_bf16_f32 v146, v100, v101
    v_mfma_f32_16x16x32_bf16 v[80:83], a[140:143], v[72:75], v[184:187]
    v_exp_f32 v102, v102
    v_mfma_f32_16x16x32_bf16 v[80:83], a[136:139], v[68:71], v[80:83]
    ds_read_b64_tr_b16 a[210:211], v212 offset:4096
    v_mfma_f32_16x16x32_bf16 v[80:83], a[132:135], v[64:67], v[80:83]
    v_exp_f32 v103, v103
    v_mfma_f32_16x16x32_bf16 v[80:83], a[128:131], v[60:63], v[80:83]
    ds_read_b64_tr_b16 a[240:241], v212 offset:8192
    v_cvt_pk_bf16_f32 v147, v102, v103
    v_mfma_f32_16x16x32_bf16 v[88:91], a[144:147], v[60:63], v[184:187]
    v_exp_f32 v76, v76
    v_mfma_f32_16x16x32_bf16 v[88:91], a[148:151], v[64:67], v[88:91]
    ds_read_b64_tr_b16 a[242:243], v212 offset:12288
    v_mfma_f32_16x16x32_bf16 v[88:91], a[152:155], v[68:71], v[88:91]
    v_exp_f32 v77, v77
    v_mfma_f32_16x16x32_bf16 v[88:91], a[156:159], v[72:75], v[88:91]
    ds_read_b64_tr_b16 a[212:213], v213 offset:0
    v_cvt_pk_bf16_f32 v156, v76, v77
    v_mfma_f32_16x16x32_bf16 v[84:87], a[156:159], v[56:59], v[180:183]
    v_exp_f32 v78, v78
    v_mfma_f32_16x16x32_bf16 v[84:87], a[152:155], v[52:55], v[84:87]
    ds_read_b64_tr_b16 a[214:215], v213 offset:4096
    v_mfma_f32_16x16x32_bf16 v[84:87], a[148:151], v[48:51], v[84:87]
    v_exp_f32 v79, v79
    v_mfma_f32_16x16x32_bf16 v[84:87], a[144:147], v[44:47], v[84:87]
    ds_read_b64_tr_b16 a[244:245], v213 offset:8192
    v_cvt_pk_bf16_f32 v157, v78, v79
    v_mfma_f32_16x16x32_bf16 v[92:95], a[160:163], v[44:47], v[180:183]
    v_exp_f32 v80, v80
    v_mfma_f32_16x16x32_bf16 v[92:95], a[164:167], v[48:51], v[92:95]
    ds_read_b64_tr_b16 a[246:247], v213 offset:12288
    v_mfma_f32_16x16x32_bf16 v[92:95], a[168:171], v[52:55], v[92:95]
    v_exp_f32 v81, v81
    v_mfma_f32_16x16x32_bf16 v[92:95], a[172:175], v[56:59], v[92:95]
    ds_read_b64_tr_b16 a[216:217], v214 offset:0
    v_cvt_pk_bf16_f32 v164, v80, v81
    v_mfma_f32_16x16x32_bf16 v[96:99], a[172:175], v[72:75], v[184:187]
    v_exp_f32 v82, v82
    v_mfma_f32_16x16x32_bf16 v[96:99], a[168:171], v[68:71], v[96:99]
    ds_read_b64_tr_b16 a[218:219], v214 offset:4096
    v_mfma_f32_16x16x32_bf16 v[96:99], a[164:167], v[64:67], v[96:99]
    v_exp_f32 v83, v83
    v_mfma_f32_16x16x32_bf16 v[96:99], a[160:163], v[60:63], v[96:99]
    ds_read_b64_tr_b16 a[248:249], v214 offset:8192
    v_cvt_pk_bf16_f32 v165, v82, v83
L_pg6:
    s_cbranch_execz L_pg10
    v_mfma_f32_16x16x32_bf16 v[104:107], a[176:179], v[60:63], v[184:187]
    v_exp_f32 v88, v88
    v_mfma_f32_16x16x32_bf16 v[104:107], a[180:183], v[64:67], v[104:107]
    ds_read_b64_tr_b16 a[250:251], v214 offset:12288
    v_mfma_f32_16x16x32_bf16 v[104:107], a[184:187], v[68:71], v[104:107]
    v_exp_f32 v89, v89
    v_mfma_f32_16x16x32_bf16 v[104:107], a[188:191], v[72:75], v[104:107]
    ds_read_b64_tr_b16 a[220:221], v215 offset:0
    v_cvt_pk_bf16_f32 v166, v88, v89
    v_mfma_f32_16x16x32_bf16 v[100:103], a[188:191], v[56:59], v[180:183]
    v_exp_f32 v90, v90
    v_mfma_f32_16x16x32_bf16 v[100:103], a[184:187], v[52:55], v[100:103]
    ds_read_b64_tr_b16 a[222:223], v215 offset:4096
    v_mfma_f32_16x16x32_bf16 v[100:103], a[180:183], v[48:51], v[100:103]
    s_waitcnt lgkmcnt(6)
    v_exp_f32 v91, v91
    v_mfma_f32_16x16x32_bf16 v[100:103], a[176:179], v[44:47], v[100:103]
    ds_read_b64_tr_b16 a[252:253], v215 offset:8192
    v_cvt_pk_bf16_f32 v167, v90, v91
    v_mfma_f32_16x16x32_bf16 a[0:3], a[192:195], v[140:143], a[0:3]
    v_exp_f32 v84, v84
    v_mfma_f32_16x16x32_bf16 a[0:3], a[224:227], v[144:147], a[0:3]
    ds_read_b64_tr_b16 a[254:255], v215 offset:12288
    v_smfmac_f32_16x16x64_bf16 v[192:195], v[188:191], v[140:147], v11
    s_waitcnt vmcnt(9)
    buffer_load_dword v233, v236, s[60:63], s77 offen
    v_smfmac_f32_16x16x64_bf16 v[196:199], v[188:191], v[148:155], v11
    s_barrier
    buffer_store_dword v238, v239, s[24:27], s75 offen sc1
    v_mfma_f32_16x16x32_bf16 a[32:35], a[224:227], v[152:155], a[32:35]
    v_exp_f32 v85, v85
    v_mfma_f32_16x16x32_bf16 a[32:35], a[192:195], v[148:151], a[32:35]
    ds_read_b128 a[128:131], v204 offset:16384
    v_cvt_pk_bf16_f32 v158, v84, v85
    v_mfma_f32_16x16x32_bf16 a[36:39], a[196:199], v[148:151], a[36:39]
    v_exp_f32 v86, v86
    v_mfma_f32_16x16x32_bf16 a[36:39], a[228:231], v[152:155], a[36:39]
    ds_read_b128 a[132:135], v205 offset:16384
    v_mfma_f32_16x16x32_bf16 a[4:7], a[228:231], v[144:147], a[4:7]
    v_exp_f32 v87, v87
    v_mfma_f32_16x16x32_bf16 a[4:7], a[196:199], v[140:143], a[4:7]
    ds_read_b128 a[136:139], v206 offset:16384
    v_cvt_pk_bf16_f32 v159, v86, v87
    v_mfma_f32_16x16x32_bf16 a[8:11], a[200:203], v[140:143], a[8:11]
    v_exp_f32 v92, v92
    v_mfma_f32_16x16x32_bf16 a[8:11], a[232:235], v[144:147], a[8:11]
    ds_read_b128 a[140:143], v207 offset:16384
    v_mfma_f32_16x16x32_bf16 a[40:43], a[232:235], v[152:155], a[40:43]
    v_exp_f32 v93, v93
    v_mfma_f32_16x16x32_bf16 a[40:43], a[200:203], v[148:151], a[40:43]
    ds_read_b128 a[144:147], v204 offset:20480
    v_cvt_pk_bf16_f32 v160, v92, v93
    v_mfma_f32_16x16x32_bf16 a[44:47], a[204:207], v[148:151], a[44:47]
    v_exp_f32 v94, v94
    v_mfma_f32_16x16x32_bf16 a[44:47], a[236:239], v[152:155], a[44:47]
    ds_read_b128 a[148:151], v205 offset:20480
    v_mfma_f32_16x16x32_bf16 a[12:15], a[236:239], v[144:147], a[12:15]
    v_exp_f32 v95, v95
    v_mfma_f32_16x16x32_bf16 a[12:15], a[204:207], v[140:143], a[12:15]
    ds_read_b128 a[152:155], v206 offset:20480
    v_cvt_pk_bf16_f32 v161, v94, v95
    v_mfma_f32_16x16x32_bf16 a[16:19], a[208:211], v[140:143], a[16:19]
    v_exp_f32 v96, v96
    v_mfma_f32_16x16x32_bf16 a[16:19], a[240:243], v[144:147], a[16:19]
    ds_read_b128 a[156:159], v207 offset:20480
    v_mfma_f32_16x16x32_bf16 a[48:51], a[240:243], v[152:155], a[48:51]
    v_exp_f32 v97, v97
    v_mfma_f32_16x16x32_bf16 a[48:51], a[208:211], v[148:151], a[48:51]
    ds_read_b128 a[160:163], v204 offset:24576
    v_cvt_pk_bf16_f32 v168, v96, v97
    v_mfma_f32_16x16x32_bf16 a[52:55], a[212:215], v[148:151], a[52:55]
    v_exp_f32 v98, v98
    v_mfma_f32_16x16x32_bf16 a[52:55], a[244:247], v[152:155], a[52:55]
    ds_read_b128 a[164:167], v205 offset:24576
    v_mfma_f32_16x16x32_bf16 a[20:23], a[244:247], v[144:147], a[20:23]
    s_waitcnt lgkmcnt(10)
    v_exp_f32 v99, v99
    v_mfma_f32_16x16x32_bf16 a[20:23], a[212:215], v[140:143], a[20:23]
    ds_read_b128 a[168:171], v206 offset:24576
    v_cvt_pk_bf16_f32 v169, v98, v99
    v_mfma_f32_16x16x32_bf16 a[24:27], a[216:219], v[140:143], a[24:27]
    v_exp_f32 v104, v104
    v_mfma_f32_16x16x32_bf16 a[24:27], a[248:251], v[144:147], a[24:27]
    ds_read_b128 a[172:175], v207 offset:24576
    v_mfma_f32_16x16x32_bf16 a[56:59], a[248:251], v[152:155], a[56:59]
    v_exp_f32 v105, v105
    v_mfma_f32_16x16x32_bf16 a[56:59], a[216:219], v[148:151], a[56:59]
    ds_read_b128 a[176:179], v204 offset:28672
    v_cvt_pk_bf16_f32 v170, v104, v105
    v_mfma_f32_16x16x32_bf16 a[60:63], a[220:223], v[148:151], a[60:63]
    v_exp_f32 v106, v106
    v_mfma_f32_16x16x32_bf16 a[60:63], a[252:255], v[152:155], a[60:63]
    ds_read_b128 a[180:183], v205 offset:28672
    v_mfma_f32_16x16x32_bf16 a[28:31], a[252:255], v[144:147], a[28:31]
    s_waitcnt lgkmcnt(6)
    v_exp_f32 v107, v107
    v_mfma_f32_16x16x32_bf16 a[28:31], a[220:223], v[140:143], a[28:31]
    ds_read_b128 a[184:187], v206 offset:28672
    v_cvt_pk_bf16_f32 v171, v106, v107
    v_mfma_f32_16x16x32_bf16 v[76:79], a[128:131], v[12:15], v[172:175]
    v_exp_f32 v100, v100
    v_mfma_f32_16x16x32_bf16 v[76:79], a[132:135], v[16:19], v[76:79]
    ds_read_b128 a[188:191], v207 offset:28672
    v_mfma_f32_16x16x32_bf16 v[76:79], a[136:139], v[20:23], v[76:79]
    s_add_u32 m0, s17, 49152
    v_exp_f32 v101, v101
    v_mfma_f32_16x16x32_bf16 v[76:79], a[140:143], v[24:27], v[76:79]
    buffer_load_dwordx4 v216, s[8:11], s16 offen offset:0 nt lds
    v_mfma_f32_16x16x32_bf16 v[80:83], a[140:143], v[40:43], v[176:179]
    v_exp_f32 v102, v102
    v_mfma_f32_16x16x32_bf16 v[80:83], a[136:139], v[36:39], v[80:83]
    v_cvt_pk_bf16_f32 v162, v100, v101
    v_mfma_f32_16x16x32_bf16 v[80:83], a[132:135], v[32:35], v[80:83]
    v_exp_f32 v103, v103
    v_mfma_f32_16x16x32_bf16 v[80:83], a[128:131], v[28:31], v[80:83]
    buffer_load_dwordx4 v217, s[8:11], s16 offen offset:1024 nt lds
    v_mfma_f32_16x16x32_bf16 v[88:91], a[144:147], v[28:31], v[176:179]
    v_exp_f32 v76, v76
    v_mfma_f32_16x16x32_bf16 v[88:91], a[148:151], v[32:35], v[88:91]
    v_cvt_pk_bf16_f32 v163, v102, v103
    v_mfma_f32_16x16x32_bf16 v[88:91], a[152:155], v[36:39], v[88:91]
    v_exp_f32 v77, v77
    v_mfma_f32_16x16x32_bf16 v[88:91], a[156:159], v[40:43], v[88:91]
    buffer_load_dwordx4 v218, s[8:11], s16 offen offset:2048 nt lds
    v_mfma_f32_16x16x32_bf16 v[84:87], a[156:159], v[24:27], v[172:175]
    v_exp_f32 v78, v78
    v_mfma_f32_16x16x32_bf16 v[84:87], a[152:155], v[20:23], v[84:87]
    v_cvt_pk_bf16_f32 v140, v76, v77
    v_mfma_f32_16x16x32_bf16 v[84:87], a[148:151], v[16:19], v[84:87]
    s_waitcnt lgkmcnt(0)
    v_exp_f32 v79, v79
    v_mfma_f32_16x16x32_bf16 v[84:87], a[144:147], v[12:15], v[84:87]
    buffer_load_dwordx4 v219, s[8:11], s16 offen offset:3072 nt lds
    v_mfma_f32_16x16x32_bf16 v[92:95], a[160:163], v[12:15], v[172:175]
    v_exp_f32 v80, v80
    v_mfma_f32_16x16x32_bf16 v[92:95], a[164:167], v[16:19], v[92:95]
    v_cvt_pk_bf16_f32 v141, v78, v79
    v_mfma_f32_16x16x32_bf16 v[92:95], a[168:171], v[20:23], v[92:95]
    s_add_u32 m0, s17, 114688
    v_exp_f32 v81, v81
    v_mfma_f32_16x16x32_bf16 v[92:95], a[172:175], v[24:27], v[92:95]
    buffer_load_dwordx4 v220, s[12:15], s16 offen offset:0 nt lds
    v_mfma_f32_16x16x32_bf16 v[96:99], a[172:175], v[40:43], v[176:179]
    v_exp_f32 v82, v82
    v_mfma_f32_16x16x32_bf16 v[96:99], a[168:171], v[36:39], v[96:99]
    v_cvt_pk_bf16_f32 v148, v80, v81
    v_mfma_f32_16x16x32_bf16 v[96:99], a[164:167], v[32:35], v[96:99]
    v_exp_f32 v83, v83
    v_mfma_f32_16x16x32_bf16 v[96:99], a[160:163], v[28:31], v[96:99]
    buffer_load_dwordx4 v221, s[12:15], s16 offen offset:1024 nt lds
    v_mfma_f32_16x16x32_bf16 v[104:107], a[176:179], v[28:31], v[176:179]
    v_exp_f32 v88, v88
    v_mfma_f32_16x16x32_bf16 v[104:107], a[180:183], v[32:35], v[104:107]
    v_cvt_pk_bf16_f32 v149, v82, v83
    v_mfma_f32_16x16x32_bf16 v[104:107], a[184:187], v[36:39], v[104:107]
    v_exp_f32 v89, v89
    v_mfma_f32_16x16x32_bf16 v[104:107], a[188:191], v[40:43], v[104:107]
    buffer_load_dwordx4 v222, s[12:15], s16 offen offset:2048 nt lds
    v_mfma_f32_16x16x32_bf16 v[100:103], a[188:191], v[24:27], v[172:175]
    v_exp_f32 v90, v90
    v_mfma_f32_16x16x32_bf16 v[100:103], a[184:187], v[20:23], v[100:103]
    v_cvt_pk_bf16_f32 v150, v88, v89
    v_mfma_f32_16x16x32_bf16 v[100:103], a[180:183], v[16:19], v[100:103]
    v_exp_f32 v91, v91
    v_mfma_f32_16x16x32_bf16 v[100:103], a[176:179], v[12:15], v[100:103]
    buffer_load_dwordx4 v223, s[12:15], s16 offen offset:3072 nt lds
    v_mfma_f32_16x16x32_bf16 a[64:67], a[192:195], v[156:159], a[64:67]
    v_exp_f32 v84, v84
    v_mfma_f32_16x16x32_bf16 a[64:67], a[224:227], v[160:163], a[64:67]
    v_cvt_pk_bf16_f32 v151, v90, v91
    v_smfmac_f32_16x16x64_bf16 v[200:203], v[188:191], v[156:163], v11
    v_smfmac_f32_16x16x64_bf16 v[248:251], v[188:191], v[164:171], v11
    s_add_u32 m0, s79, 0
    s_nop 0
    buffer_load_dwordx4 v252, s[24:27], s78 offen offset:0 sc1 lds
    v_mfma_f32_16x16x32_bf16 a[96:99], a[224:227], v[168:171], a[96:99]
    s_add_u32 s16, s16, s30
    v_exp_f32 v85, v85
    v_mfma_f32_16x16x32_bf16 a[96:99], a[192:195], v[164:167], a[96:99]
    ds_read_b64_tr_b16 a[192:193], v208 offset:16384
    v_cvt_pk_bf16_f32 v142, v84, v85
    v_mfma_f32_16x16x32_bf16 a[100:103], a[196:199], v[164:167], a[100:103]
    v_exp_f32 v86, v86
    v_mfma_f32_16x16x32_bf16 a[100:103], a[228:231], v[168:171], a[100:103]
    ds_read_b64_tr_b16 a[194:195], v208 offset:20480
    v_mfma_f32_16x16x32_bf16 a[68:71], a[228:231], v[160:163], a[68:71]
    v_exp_f32 v87, v87
    v_mfma_f32_16x16x32_bf16 a[68:71], a[196:199], v[156:159], a[68:71]
    ds_read_b64_tr_b16 a[224:225], v208 offset:24576
    v_cvt_pk_bf16_f32 v143, v86, v87
    v_mfma_f32_16x16x32_bf16 a[72:75], a[200:203], v[156:159], a[72:75]
    v_exp_f32 v92, v92
    v_mfma_f32_16x16x32_bf16 a[72:75], a[232:235], v[160:163], a[72:75]
    ds_read_b64_tr_b16 a[226:227], v208 offset:28672
    v_mfma_f32_16x16x32_bf16 a[104:107], a[232:235], v[168:171], a[104:107]
    v_exp_f32 v93, v93
    v_mfma_f32_16x16x32_bf16 a[104:107], a[200:203], v[164:167], a[104:107]
    ds_read_b64_tr_b16 a[196:197], v209 offset:16384
    v_cvt_pk_bf16_f32 v144, v92, v93
    v_mfma_f32_16x16x32_bf16 a[108:111], a[204:207], v[164:167], a[108:111]
    s_add_u32 s28, s76, 12288
    buffer_load_dwordx4 v[108:111], v252, s[24:27], s28 offen offset:0 sc1
    v_exp_f32 v94, v94
    v_mfma_f32_16x16x32_bf16 a[108:111], a[236:239], v[168:171], a[108:111]
    ds_read_b64_tr_b16 a[198:199], v209 offset:20480
    v_mfma_f32_16x16x32_bf16 a[76:79], a[236:239], v[160:163], a[76:79]
    v_exp_f32 v95, v95
    v_mfma_f32_16x16x32_bf16 a[76:79], a[204:207], v[156:159], a[76:79]
    ds_read_b64_tr_b16 a[228:229], v209 offset:24576
    v_cvt_pk_bf16_f32 v145, v94, v95
    v_mfma_f32_16x16x32_bf16 a[80:83], a[208:211], v[156:159], a[80:83]
    v_exp_f32 v96, v96
    v_mfma_f32_16x16x32_bf16 a[80:83], a[240:243], v[160:163], a[80:83]
    ds_read_b64_tr_b16 a[230:231], v209 offset:28672
    v_mfma_f32_16x16x32_bf16 a[112:115], a[240:243], v[168:171], a[112:115]
    v_exp_f32 v97, v97
    v_mfma_f32_16x16x32_bf16 a[112:115], a[208:211], v[164:167], a[112:115]
    ds_read_b64_tr_b16 a[200:201], v210 offset:16384
    v_cvt_pk_bf16_f32 v152, v96, v97
    v_mfma_f32_16x16x32_bf16 a[116:119], a[212:215], v[164:167], a[116:119]
    v_exp_f32 v98, v98
    v_mfma_f32_16x16x32_bf16 a[116:119], a[244:247], v[168:171], a[116:119]
    ds_read_b64_tr_b16 a[202:203], v210 offset:20480
    v_mfma_f32_16x16x32_bf16 a[84:87], a[244:247], v[160:163], a[84:87]
    v_exp_f32 v99, v99
    v_mfma_f32_16x16x32_bf16 a[84:87], a[212:215], v[156:159], a[84:87]
    ds_read_b64_tr_b16 a[232:233], v210 offset:24576
    v_cvt_pk_bf16_f32 v153, v98, v99
    v_mfma_f32_16x16x32_bf16 a[88:91], a[216:219], v[156:159], a[88:91]
    buffer_load_dwordx4 v[112:115], v252, s[24:27], s28 offen offset:1024 sc1
    v_exp_f32 v104, v104
    v_mfma_f32_16x16x32_bf16 a[88:91], a[248:251], v[160:163], a[88:91]
    ds_read_b64_tr_b16 a[234:235], v210 offset:28672
    v_mfma_f32_16x16x32_bf16 a[120:123], a[248:251], v[168:171], a[120:123]
    v_exp_f32 v105, v105
    v_mfma_f32_16x16x32_bf16 a[120:123], a[216:219], v[164:167], a[120:123]
    ds_read_b64_tr_b16 a[204:205], v211 offset:16384
    v_cvt_pk_bf16_f32 v154, v104, v105
    v_mfma_f32_16x16x32_bf16 a[124:127], a[220:223], v[164:167], a[124:127]
    v_exp_f32 v106, v106
    v_mfma_f32_16x16x32_bf16 a[124:127], a[252:255], v[168:171], a[124:127]
    ds_read_b64_tr_b16 a[206:207], v211 offset:20480
    v_mfma_f32_16x16x32_bf16 a[92:95], a[252:255], v[160:163], a[92:95]
    v_exp_f32 v107, v107
    v_mfma_f32_16x16x32_bf16 a[92:95], a[220:223], v[156:159], a[92:95]
    ds_read_b64_tr_b16 a[236:237], v211 offset:24576
    v_cvt_pk_bf16_f32 v155, v106, v107
    v_mfma_f32_16x16x32_bf16 v[76:79], a[128:131], v[44:47], v[180:183]
    v_exp_f32 v100, v100
    v_mfma_f32_16x16x32_bf16 v[76:79], a[132:135], v[48:51], v[76:79]
    ds_read_b64_tr_b16 a[238:239], v211 offset:28672
    v_mfma_f32_16x16x32_bf16 v[76:79], a[136:139], v[52:55], v[76:79]
    v_exp_f32 v101, v101
    v_mfma_f32_16x16x32_bf16 v[76:79], a[140:143], v[56:59], v[76:79]
    ds_read_b64_tr_b16 a[208:209], v212 offset:16384
    v_cvt_pk_bf16_f32 v146, v100, v101
    v_mfma_f32_16x16x32_bf16 v[80:83], a[140:143], v[72:75], v[184:187]
    buffer_load_dwordx4 v[116:119], v252, s[24:27], s28 offen offset:2048 sc1
    v_exp_f32 v102, v102
    v_mfma_f32_16x16x32_bf16 v[80:83], a[136:139], v[68:71], v[80:83]
    ds_read_b64_tr_b16 a[210:211], v212 offset:20480
    v_mfma_f32_16x16x32_bf16 v[80:83], a[132:135], v[64:67], v[80:83]
    v_exp_f32 v103, v103
    v_mfma_f32_16x16x32_bf16 v[80:83], a[128:131], v[60:63], v[80:83]
    ds_read_b64_tr_b16 a[240:241], v212 offset:24576
    v_cvt_pk_bf16_f32 v147, v102, v103
    v_mfma_f32_16x16x32_bf16 v[88:91], a[144:147], v[60:63], v[184:187]
    v_exp_f32 v76, v76
    v_mfma_f32_16x16x32_bf16 v[88:91], a[148:151], v[64:67], v[88:91]
    ds_read_b64_tr_b16 a[242:243], v212 offset:28672
    v_mfma_f32_16x16x32_bf16 v[88:91], a[152:155], v[68:71], v[88:91]
    v_exp_f32 v77, v77
    v_mfma_f32_16x16x32_bf16 v[88:91], a[156:159], v[72:75], v[88:91]
    ds_read_b64_tr_b16 a[212:213], v213 offset:16384
    v_cvt_pk_bf16_f32 v156, v76, v77
    v_mfma_f32_16x16x32_bf16 v[84:87], a[156:159], v[56:59], v[180:183]
    v_exp_f32 v78, v78
    v_mfma_f32_16x16x32_bf16 v[84:87], a[152:155], v[52:55], v[84:87]
    ds_read_b64_tr_b16 a[214:215], v213 offset:20480
    v_mfma_f32_16x16x32_bf16 v[84:87], a[148:151], v[48:51], v[84:87]
    v_exp_f32 v79, v79
    v_mfma_f32_16x16x32_bf16 v[84:87], a[144:147], v[44:47], v[84:87]
    ds_read_b64_tr_b16 a[244:245], v213 offset:24576
    v_cvt_pk_bf16_f32 v157, v78, v79
    v_mfma_f32_16x16x32_bf16 v[92:95], a[160:163], v[44:47], v[180:183]
    buffer_load_dwordx4 v[120:123], v252, s[24:27], s28 offen offset:3072 sc1
    v_exp_f32 v80, v80
    v_mfma_f32_16x16x32_bf16 v[92:95], a[164:167], v[48:51], v[92:95]
    ds_read_b64_tr_b16 a[246:247], v213 offset:28672
    v_mfma_f32_16x16x32_bf16 v[92:95], a[168:171], v[52:55], v[92:95]
    v_exp_f32 v81, v81
    v_mfma_f32_16x16x32_bf16 v[92:95], a[172:175], v[56:59], v[92:95]
    ds_read_b64_tr_b16 a[216:217], v214 offset:16384
    v_cvt_pk_bf16_f32 v164, v80, v81
    v_mfma_f32_16x16x32_bf16 v[96:99], a[172:175], v[72:75], v[184:187]
    v_exp_f32 v82, v82
    v_mfma_f32_16x16x32_bf16 v[96:99], a[168:171], v[68:71], v[96:99]
    ds_read_b64_tr_b16 a[218:219], v214 offset:20480
    v_mfma_f32_16x16x32_bf16 v[96:99], a[164:167], v[64:67], v[96:99]
    v_exp_f32 v83, v83
    v_mfma_f32_16x16x32_bf16 v[96:99], a[160:163], v[60:63], v[96:99]
    ds_read_b64_tr_b16 a[248:249], v214 offset:24576
    v_cvt_pk_bf16_f32 v165, v82, v83
    v_mfma_f32_16x16x32_bf16 v[104:107], a[176:179], v[60:63], v[184:187]
    v_exp_f32 v88, v88
    v_mfma_f32_16x16x32_bf16 v[104:107], a[180:183], v[64:67], v[104:107]
    ds_read_b64_tr_b16 a[250:251], v214 offset:28672
    v_mfma_f32_16x16x32_bf16 v[104:107], a[184:187], v[68:71], v[104:107]
    v_exp_f32 v89, v89
    v_mfma_f32_16x16x32_bf16 v[104:107], a[188:191], v[72:75], v[104:107]
    ds_read_b64_tr_b16 a[220:221], v215 offset:16384
    v_cvt_pk_bf16_f32 v166, v88, v89
    v_mfma_f32_16x16x32_bf16 v[100:103], a[188:191], v[56:59], v[180:183]
    v_exp_f32 v90, v90
    v_mfma_f32_16x16x32_bf16 v[100:103], a[184:187], v[52:55], v[100:103]
    ds_read_b64_tr_b16 a[222:223], v215 offset:20480
    v_mfma_f32_16x16x32_bf16 v[100:103], a[180:183], v[48:51], v[100:103]
    s_waitcnt lgkmcnt(6)
    v_exp_f32 v91, v91
    v_mfma_f32_16x16x32_bf16 v[100:103], a[176:179], v[44:47], v[100:103]
    ds_read_b64_tr_b16 a[252:253], v215 offset:24576
    v_cvt_pk_bf16_f32 v167, v90, v91
    v_mfma_f32_16x16x32_bf16 a[0:3], a[192:195], v[140:143], a[0:3]
    v_exp_f32 v84, v84
    v_mfma_f32_16x16x32_bf16 a[0:3], a[224:227], v[144:147], a[0:3]
    ds_read_b64_tr_b16 a[254:255], v215 offset:28672
    v_smfmac_f32_16x16x64_bf16 v[192:195], v[188:191], v[140:147], v11
    s_waitcnt vmcnt(15)
    s_add_u32 m0, s79, 0
    s_nop 0
    buffer_load_dwordx4 v252, s[24:27], s78 offen offset:1024 sc1 lds
    s_add_u32 s78, s78, 8192
    v_smfmac_f32_16x16x64_bf16 v[196:199], v[188:191], v[148:155], v11
    s_barrier
    s_add_u32 m0, s79, 2048
    s_nop 0
    buffer_load_dwordx4 v252, s[24:27], s78 offen offset:0 sc1 lds
    v_mfma_f32_16x16x32_bf16 a[32:35], a[224:227], v[152:155], a[32:35]
    v_exp_f32 v85, v85
    v_mfma_f32_16x16x32_bf16 a[32:35], a[192:195], v[148:151], a[32:35]
    ds_read_b128 a[128:131], v204 offset:32768
    v_cvt_pk_bf16_f32 v158, v84, v85
    v_mfma_f32_16x16x32_bf16 a[36:39], a[196:199], v[148:151], a[36:39]
    v_exp_f32 v86, v86
    v_mfma_f32_16x16x32_bf16 a[36:39], a[228:231], v[152:155], a[36:39]
    ds_read_b128 a[132:135], v205 offset:32768
    v_mfma_f32_16x16x32_bf16 a[4:7], a[228:231], v[144:147], a[4:7]
    v_exp_f32 v87, v87
    v_mfma_f32_16x16x32_bf16 a[4:7], a[196:199], v[140:143], a[4:7]
    ds_read_b128 a[136:139], v206 offset:32768
    v_cvt_pk_bf16_f32 v159, v86, v87
    v_mfma_f32_16x16x32_bf16 a[8:11], a[200:203], v[140:143], a[8:11]
    v_exp_f32 v92, v92
    v_mfma_f32_16x16x32_bf16 a[8:11], a[232:235], v[144:147], a[8:11]
    ds_read_b128 a[140:143], v207 offset:32768
    v_mfma_f32_16x16x32_bf16 a[40:43], a[232:235], v[152:155], a[40:43]
    v_exp_f32 v93, v93
    v_mfma_f32_16x16x32_bf16 a[40:43], a[200:203], v[148:151], a[40:43]
    ds_read_b128 a[144:147], v204 offset:36864
    v_cvt_pk_bf16_f32 v160, v92, v93
    v_mfma_f32_16x16x32_bf16 a[44:47], a[204:207], v[148:151], a[44:47]
    v_exp_f32 v94, v94
    v_mfma_f32_16x16x32_bf16 a[44:47], a[236:239], v[152:155], a[44:47]
    ds_read_b128 a[148:151], v205 offset:36864
    v_mfma_f32_16x16x32_bf16 a[12:15], a[236:239], v[144:147], a[12:15]
    v_exp_f32 v95, v95
    v_mfma_f32_16x16x32_bf16 a[12:15], a[204:207], v[140:143], a[12:15]
    ds_read_b128 a[152:155], v206 offset:36864
    v_cvt_pk_bf16_f32 v161, v94, v95
    v_mfma_f32_16x16x32_bf16 a[16:19], a[208:211], v[140:143], a[16:19]
    v_exp_f32 v96, v96
    v_mfma_f32_16x16x32_bf16 a[16:19], a[240:243], v[144:147], a[16:19]
    ds_read_b128 a[156:159], v207 offset:36864
    v_mfma_f32_16x16x32_bf16 a[48:51], a[240:243], v[152:155], a[48:51]
    v_exp_f32 v97, v97
    v_mfma_f32_16x16x32_bf16 a[48:51], a[208:211], v[148:151], a[48:51]
    ds_read_b128 a[160:163], v204 offset:40960
    v_cvt_pk_bf16_f32 v168, v96, v97
    v_mfma_f32_16x16x32_bf16 a[52:55], a[212:215], v[148:151], a[52:55]
    v_exp_f32 v98, v98
    v_mfma_f32_16x16x32_bf16 a[52:55], a[244:247], v[152:155], a[52:55]
    ds_read_b128 a[164:167], v205 offset:40960
    v_mfma_f32_16x16x32_bf16 a[20:23], a[244:247], v[144:147], a[20:23]
    s_waitcnt lgkmcnt(10)
    v_exp_f32 v99, v99
    v_mfma_f32_16x16x32_bf16 a[20:23], a[212:215], v[140:143], a[20:23]
    ds_read_b128 a[168:171], v206 offset:40960
    v_cvt_pk_bf16_f32 v169, v98, v99
    v_mfma_f32_16x16x32_bf16 a[24:27], a[216:219], v[140:143], a[24:27]
    v_exp_f32 v104, v104
    v_mfma_f32_16x16x32_bf16 a[24:27], a[248:251], v[144:147], a[24:27]
    ds_read_b128 a[172:175], v207 offset:40960
    v_mfma_f32_16x16x32_bf16 a[56:59], a[248:251], v[152:155], a[56:59]
    v_exp_f32 v105, v105
    v_mfma_f32_16x16x32_bf16 a[56:59], a[216:219], v[148:151], a[56:59]
    ds_read_b128 a[176:179], v204 offset:45056
    v_cvt_pk_bf16_f32 v170, v104, v105
    v_mfma_f32_16x16x32_bf16 a[60:63], a[220:223], v[148:151], a[60:63]
    v_exp_f32 v106, v106
    v_mfma_f32_16x16x32_bf16 a[60:63], a[252:255], v[152:155], a[60:63]
    ds_read_b128 a[180:183], v205 offset:45056
    v_mfma_f32_16x16x32_bf16 a[28:31], a[252:255], v[144:147], a[28:31]
    s_waitcnt lgkmcnt(6)
    v_exp_f32 v107, v107
    v_mfma_f32_16x16x32_bf16 a[28:31], a[220:223], v[140:143], a[28:31]
    ds_read_b128 a[184:187], v206 offset:45056
    v_cvt_pk_bf16_f32 v171, v106, v107
    v_mfma_f32_16x16x32_bf16 v[76:79], a[128:131], v[12:15], v[172:175]
    v_exp_f32 v100, v100
    v_mfma_f32_16x16x32_bf16 v[76:79], a[132:135], v[16:19], v[76:79]
    ds_read_b128 a[188:191], v207 offset:45056
    v_mfma_f32_16x16x32_bf16 v[76:79], a[136:139], v[20:23], v[76:79]
    s_add_u32 s29, s76, 8192
    s_add_u32 m0, s17, 0
    v_exp_f32 v101, v101
    v_mfma_f32_16x16x32_bf16 v[76:79], a[140:143], v[24:27], v[76:79]
    buffer_load_dwordx4 v252, s[24:27], s29 offen offset:0 sc1 lds
    v_mfma_f32_16x16x32_bf16 v[80:83], a[140:143], v[40:43], v[176:179]
    v_exp_f32 v102, v102
    v_mfma_f32_16x16x32_bf16 v[80:83], a[136:139], v[36:39], v[80:83]
    v_cvt_pk_bf16_f32 v162, v100, v101
    v_mfma_f32_16x16x32_bf16 v[80:83], a[132:135], v[32:35], v[80:83]
    v_exp_f32 v103, v103
    v_mfma_f32_16x16x32_bf16 v[80:83], a[128:131], v[28:31], v[80:83]
    buffer_load_dwordx4 v252, s[24:27], s29 offen offset:1024 sc1 lds
    v_mfma_f32_16x16x32_bf16 v[88:91], a[144:147], v[28:31], v[176:179]
    v_exp_f32 v76, v76
    v_mfma_f32_16x16x32_bf16 v[88:91], a[148:151], v[32:35], v[88:91]
    v_cvt_pk_bf16_f32 v163, v102, v103
    v_mfma_f32_16x16x32_bf16 v[88:91], a[152:155], v[36:39], v[88:91]
    v_exp_f32 v77, v77
    v_mfma_f32_16x16x32_bf16 v[88:91], a[156:159], v[40:43], v[88:91]
    buffer_load_dwordx4 v252, s[24:27], s29 offen offset:2048 sc1 lds
    v_mfma_f32_16x16x32_bf16 v[84:87], a[156:159], v[24:27], v[172:175]
    v_exp_f32 v78, v78
    v_mfma_f32_16x16x32_bf16 v[84:87], a[152:155], v[20:23], v[84:87]
    v_cvt_pk_bf16_f32 v140, v76, v77
    v_mfma_f32_16x16x32_bf16 v[84:87], a[148:151], v[16:19], v[84:87]
    s_waitcnt lgkmcnt(0)
    v_exp_f32 v79, v79
    v_mfma_f32_16x16x32_bf16 v[84:87], a[144:147], v[12:15], v[84:87]
    buffer_load_dwordx4 v252, s[24:27], s29 offen offset:3072 sc1 lds
    v_mfma_f32_16x16x32_bf16 v[92:95], a[160:163], v[12:15], v[172:175]
    v_exp_f32 v80, v80
    v_mfma_f32_16x16x32_bf16 v[92:95], a[164:167], v[16:19], v[92:95]
    v_cvt_pk_bf16_f32 v141, v78, v79
    v_mfma_f32_16x16x32_bf16 v[92:95], a[168:171], v[20:23], v[92:95]
    s_add_u32 s29, s76, 24576
    s_add_u32 m0, s17, 65536
    v_exp_f32 v81, v81
    v_mfma_f32_16x16x32_bf16 v[92:95], a[172:175], v[24:27], v[92:95]
    buffer_load_dwordx4 v252, s[24:27], s29 offen offset:0 sc1 lds
    v_mfma_f32_16x16x32_bf16 v[96:99], a[172:175], v[40:43], v[176:179]
    v_exp_f32 v82, v82
    v_mfma_f32_16x16x32_bf16 v[96:99], a[168:171], v[36:39], v[96:99]
    v_cvt_pk_bf16_f32 v148, v80, v81
    v_mfma_f32_16x16x32_bf16 v[96:99], a[164:167], v[32:35], v[96:99]
    v_exp_f32 v83, v83
    v_mfma_f32_16x16x32_bf16 v[96:99], a[160:163], v[28:31], v[96:99]
    buffer_load_dwordx4 v252, s[24:27], s29 offen offset:1024 sc1 lds
    v_mfma_f32_16x16x32_bf16 v[104:107], a[176:179], v[28:31], v[176:179]
    v_exp_f32 v88, v88
    v_mfma_f32_16x16x32_bf16 v[104:107], a[180:183], v[32:35], v[104:107]
    v_cvt_pk_bf16_f32 v149, v82, v83
    v_mfma_f32_16x16x32_bf16 v[104:107], a[184:187], v[36:39], v[104:107]
    v_exp_f32 v89, v89
    v_mfma_f32_16x16x32_bf16 v[104:107], a[188:191], v[40:43], v[104:107]
    buffer_load_dwordx4 v252, s[24:27], s29 offen offset:2048 sc1 lds
    v_mfma_f32_16x16x32_bf16 v[100:103], a[188:191], v[24:27], v[172:175]
    v_exp_f32 v90, v90
    v_mfma_f32_16x16x32_bf16 v[100:103], a[184:187], v[20:23], v[100:103]
    v_cvt_pk_bf16_f32 v150, v88, v89
    v_mfma_f32_16x16x32_bf16 v[100:103], a[180:183], v[16:19], v[100:103]
    v_exp_f32 v91, v91
    v_mfma_f32_16x16x32_bf16 v[100:103], a[176:179], v[12:15], v[100:103]
    buffer_load_dwordx4 v252, s[24:27], s29 offen offset:3072 sc1 lds
    v_mfma_f32_16x16x32_bf16 a[64:67], a[192:195], v[156:159], a[64:67]
    v_exp_f32 v84, v84
    v_mfma_f32_16x16x32_bf16 a[64:67], a[224:227], v[160:163], a[64:67]
    v_cvt_pk_bf16_f32 v151, v90, v91
    v_smfmac_f32_16x16x64_bf16 v[200:203], v[188:191], v[156:163], v11
    v_smfmac_f32_16x16x64_bf16 v[248:251], v[188:191], v[164:171], v11
    s_add_u32 m0, s79, 2048
    s_nop 0
    buffer_load_dwordx4 v252, s[24:27], s78 offen offset:1024 sc1 lds
    s_add_u32 s78, s78, 8192
    v_mfma_f32_16x16x32_bf16 a[96:99], a[224:227], v[168:171], a[96:99]
    s_add_u32 s16, s16, s30
    v_exp_f32 v85, v85
    v_mfma_f32_16x16x32_bf16 a[96:99], a[192:195], v[164:167], a[96:99]
    ds_read_b64_tr_b16 a[192:193], v208 offset:32768
    v_cvt_pk_bf16_f32 v142, v84, v85
    v_mfma_f32_16x16x32_bf16 a[100:103], a[196:199], v[164:167], a[100:103]
    v_exp_f32 v86, v86
    v_mfma_f32_16x16x32_bf16 a[100:103], a[228:231], v[168:171], a[100:103]
    ds_read_b64_tr_b16 a[194:195], v208 offset:36864
    v_mfma_f32_16x16x32_bf16 a[68:71], a[228:231], v[160:163], a[68:71]
    v_exp_f32 v87, v87
    v_mfma_f32_16x16x32_bf16 a[68:71], a[196:199], v[156:159], a[68:71]
    ds_read_b64_tr_b16 a[224:225], v208 offset:40960
    v_cvt_pk_bf16_f32 v143, v86, v87
    v_mfma_f32_16x16x32_bf16 a[72:75], a[200:203], v[156:159], a[72:75]
    v_exp_f32 v92, v92
    v_mfma_f32_16x16x32_bf16 a[72:75], a[232:235], v[160:163], a[72:75]
    ds_read_b64_tr_b16 a[226:227], v208 offset:45056
    v_mfma_f32_16x16x32_bf16 a[104:107], a[232:235], v[168:171], a[104:107]
    v_exp_f32 v93, v93
    v_mfma_f32_16x16x32_bf16 a[104:107], a[200:203], v[164:167], a[104:107]
    ds_read_b64_tr_b16 a[196:197], v209 offset:32768
    v_cvt_pk_bf16_f32 v144, v92, v93
    v_mfma_f32_16x16x32_bf16 a[108:111], a[204:207], v[164:167], a[108:111]
    s_add_u32 s28, s76, 28672
    buffer_load_dwordx4 v[124:127], v252, s[24:27], s28 offen offset:0 sc1
    v_exp_f32 v94, v94
    v_mfma_f32_16x16x32_bf16 a[108:111], a[236:239], v[168:171], a[108:111]
    ds_read_b64_tr_b16 a[198:199], v209 offset:36864
    v_mfma_f32_16x16x32_bf16 a[76:79], a[236:239], v[160:163], a[76:79]
    v_exp_f32 v95, v95
    v_mfma_f32_16x16x32_bf16 a[76:79], a[204:207], v[156:159], a[76:79]
    ds_read_b64_tr_b16 a[228:229], v209 offset:40960
    v_cvt_pk_bf16_f32 v145, v94, v95
    v_mfma_f32_16x16x32_bf16 a[80:83], a[208:211], v[156:159], a[80:83]
    v_exp_f32 v96, v96
    v_mfma_f32_16x16x32_bf16 a[80:83], a[240:243], v[160:163], a[80:83]
    ds_read_b64_tr_b16 a[230:231], v209 offset:45056
    v_mfma_f32_16x16x32_bf16 a[112:115], a[240:243], v[168:171], a[112:115]
    v_exp_f32 v97, v97
    v_mfma_f32_16x16x32_bf16 a[112:115], a[208:211], v[164:167], a[112:115]
    ds_read_b64_tr_b16 a[200:201], v210 offset:32768
    v_cvt_pk_bf16_f32 v152, v96, v97
    v_mfma_f32_16x16x32_bf16 a[116:119], a[212:215], v[164:167], a[116:119]
    v_exp_f32 v98, v98
    v_mfma_f32_16x16x32_bf16 a[116:119], a[244:247], v[168:171], a[116:119]
    ds_read_b64_tr_b16 a[202:203], v210 offset:36864
    v_mfma_f32_16x16x32_bf16 a[84:87], a[244:247], v[160:163], a[84:87]
    v_exp_f32 v99, v99
    v_mfma_f32_16x16x32_bf16 a[84:87], a[212:215], v[156:159], a[84:87]
    ds_read_b64_tr_b16 a[232:233], v210 offset:40960
    v_cvt_pk_bf16_f32 v153, v98, v99
    v_mfma_f32_16x16x32_bf16 a[88:91], a[216:219], v[156:159], a[88:91]
    buffer_load_dwordx4 v[128:131], v252, s[24:27], s28 offen offset:1024 sc1
    v_exp_f32 v104, v104
    v_mfma_f32_16x16x32_bf16 a[88:91], a[248:251], v[160:163], a[88:91]
    ds_read_b64_tr_b16 a[234:235], v210 offset:45056
    v_mfma_f32_16x16x32_bf16 a[120:123], a[248:251], v[168:171], a[120:123]
    v_exp_f32 v105, v105
    v_mfma_f32_16x16x32_bf16 a[120:123], a[216:219], v[164:167], a[120:123]
    ds_read_b64_tr_b16 a[204:205], v211 offset:32768
    v_cvt_pk_bf16_f32 v154, v104, v105
    v_mfma_f32_16x16x32_bf16 a[124:127], a[220:223], v[164:167], a[124:127]
    v_exp_f32 v106, v106
    v_mfma_f32_16x16x32_bf16 a[124:127], a[252:255], v[168:171], a[124:127]
    ds_read_b64_tr_b16 a[206:207], v211 offset:36864
    v_mfma_f32_16x16x32_bf16 a[92:95], a[252:255], v[160:163], a[92:95]
    v_exp_f32 v107, v107
    v_mfma_f32_16x16x32_bf16 a[92:95], a[220:223], v[156:159], a[92:95]
    ds_read_b64_tr_b16 a[236:237], v211 offset:40960
    v_cvt_pk_bf16_f32 v155, v106, v107
    v_mfma_f32_16x16x32_bf16 v[76:79], a[128:131], v[44:47], v[180:183]
    v_exp_f32 v100, v100
    v_mfma_f32_16x16x32_bf16 v[76:79], a[132:135], v[48:51], v[76:79]
    ds_read_b64_tr_b16 a[238:239], v211 offset:45056
    v_mfma_f32_16x16x32_bf16 v[76:79], a[136:139], v[52:55], v[76:79]
    v_exp_f32 v101, v101
    v_mfma_f32_16x16x32_bf16 v[76:79], a[140:143], v[56:59], v[76:79]
    ds_read_b64_tr_b16 a[208:209], v212 offset:32768
    v_cvt_pk_bf16_f32 v146, v100, v101
    v_mfma_f32_16x16x32_bf16 v[80:83], a[140:143], v[72:75], v[184:187]
    buffer_load_dwordx4 v[132:135], v252, s[24:27], s28 offen offset:2048 sc1
    v_exp_f32 v102, v102
    v_mfma_f32_16x16x32_bf16 v[80:83], a[136:139], v[68:71], v[80:83]
    ds_read_b64_tr_b16 a[210:211], v212 offset:36864
    v_mfma_f32_16x16x32_bf16 v[80:83], a[132:135], v[64:67], v[80:83]
    v_exp_f32 v103, v103
    v_mfma_f32_16x16x32_bf16 v[80:83], a[128:131], v[60:63], v[80:83]
    ds_read_b64_tr_b16 a[240:241], v212 offset:40960
    v_cvt_pk_bf16_f32 v147, v102, v103
    v_mfma_f32_16x16x32_bf16 v[88:91], a[144:147], v[60:63], v[184:187]
    v_exp_f32 v76, v76
    v_mfma_f32_16x16x32_bf16 v[88:91], a[148:151], v[64:67], v[88:91]
    ds_read_b64_tr_b16 a[242:243], v212 offset:45056
    v_mfma_f32_16x16x32_bf16 v[88:91], a[152:155], v[68:71], v[88:91]
    v_exp_f32 v77, v77
L_pg7:
    s_cbranch_execz L_pg11
    v_mfma_f32_16x16x32_bf16 v[88:91], a[156:159], v[72:75], v[88:91]
    ds_read_b64_tr_b16 a[212:213], v213 offset:32768
    v_cvt_pk_bf16_f32 v156, v76, v77
    v_mfma_f32_16x16x32_bf16 v[84:87], a[156:159], v[56:59], v[180:183]
    v_exp_f32 v78, v78
    v_mfma_f32_16x16x32_bf16 v[84:87], a[152:155], v[52:55], v[84:87]
    ds_read_b64_tr_b16 a[214:215], v213 offset:36864
    v_mfma_f32_16x16x32_bf16 v[84:87], a[148:151], v[48:51], v[84:87]
    v_exp_f32 v79, v79
    v_mfma_f32_16x16x32_bf16 v[84:87], a[144:147], v[44:47], v[84:87]
    ds_read_b64_tr_b16 a[244:245], v213 offset:40960
    v_cvt_pk_bf16_f32 v157, v78, v79
    v_mfma_f32_16x16x32_bf16 v[92:95], a[160:163], v[44:47], v[180:183]
    buffer_load_dwordx4 v[136:139], v252, s[24:27], s28 offen offset:3072 sc1
    v_exp_f32 v80, v80
    v_mfma_f32_16x16x32_bf16 v[92:95], a[164:167], v[48:51], v[92:95]
    ds_read_b64_tr_b16 a[246:247], v213 offset:45056
    v_mfma_f32_16x16x32_bf16 v[92:95], a[168:171], v[52:55], v[92:95]
    v_exp_f32 v81, v81
    v_mfma_f32_16x16x32_bf16 v[92:95], a[172:175], v[56:59], v[92:95]
    ds_read_b64_tr_b16 a[216:217], v214 offset:32768
    v_cvt_pk_bf16_f32 v164, v80, v81
    v_mfma_f32_16x16x32_bf16 v[96:99], a[172:175], v[72:75], v[184:187]
    v_exp_f32 v82, v82
    v_mfma_f32_16x16x32_bf16 v[96:99], a[168:171], v[68:71], v[96:99]
    ds_read_b64_tr_b16 a[218:219], v214 offset:36864
    v_mfma_f32_16x16x32_bf16 v[96:99], a[164:167], v[64:67], v[96:99]
    v_exp_f32 v83, v83
    v_mfma_f32_16x16x32_bf16 v[96:99], a[160:163], v[60:63], v[96:99]
    ds_read_b64_tr_b16 a[248:249], v214 offset:40960
    v_cvt_pk_bf16_f32 v165, v82, v83
    v_mfma_f32_16x16x32_bf16 v[104:107], a[176:179], v[60:63], v[184:187]
    v_exp_f32 v88, v88
    v_mfma_f32_16x16x32_bf16 v[104:107], a[180:183], v[64:67], v[104:107]
    ds_read_b64_tr_b16 a[250:251], v214 offset:45056
    v_mfma_f32_16x16x32_bf16 v[104:107], a[184:187], v[68:71], v[104:107]
    v_exp_f32 v89, v89
    v_mfma_f32_16x16x32_bf16 v[104:107], a[188:191], v[72:75], v[104:107]
    ds_read_b64_tr_b16 a[220:221], v215 offset:32768
    v_cvt_pk_bf16_f32 v166, v88, v89
    v_mfma_f32_16x16x32_bf16 v[100:103], a[188:191], v[56:59], v[180:183]
    v_exp_f32 v90, v90
    v_mfma_f32_16x16x32_bf16 v[100:103], a[184:187], v[52:55], v[100:103]
    ds_read_b64_tr_b16 a[222:223], v215 offset:36864
    v_mfma_f32_16x16x32_bf16 v[100:103], a[180:183], v[48:51], v[100:103]
    s_waitcnt lgkmcnt(6)
    v_exp_f32 v91, v91
    v_mfma_f32_16x16x32_bf16 v[100:103], a[176:179], v[44:47], v[100:103]
    ds_read_b64_tr_b16 a[252:253], v215 offset:40960
    v_cvt_pk_bf16_f32 v167, v90, v91
    v_mfma_f32_16x16x32_bf16 a[0:3], a[192:195], v[140:143], a[0:3]
    v_exp_f32 v84, v84
    v_mfma_f32_16x16x32_bf16 a[0:3], a[224:227], v[144:147], a[0:3]
    ds_read_b64_tr_b16 a[254:255], v215 offset:45056
    v_smfmac_f32_16x16x64_bf16 v[192:195], v[188:191], v[140:147], v11
    s_waitcnt vmcnt(20)
    s_add_u32 m0, s79, 4096
    s_nop 0
    buffer_load_dwordx4 v252, s[24:27], s78 offen offset:0 sc1 lds
    v_smfmac_f32_16x16x64_bf16 v[196:199], v[188:191], v[148:155], v11
    s_barrier
    s_add_u32 m0, s79, 4096
    s_nop 0
    buffer_load_dwordx4 v252, s[24:27], s78 offen offset:1024 sc1 lds
    s_add_u32 s78, s78, 8192
    v_mfma_f32_16x16x32_bf16 a[32:35], a[224:227], v[152:155], a[32:35]
    v_exp_f32 v85, v85
    v_mfma_f32_16x16x32_bf16 a[32:35], a[192:195], v[148:151], a[32:35]
    ds_read_b128 a[128:131], v204 offset:49152
    v_cvt_pk_bf16_f32 v158, v84, v85
    v_mfma_f32_16x16x32_bf16 a[36:39], a[196:199], v[148:151], a[36:39]
    v_exp_f32 v86, v86
    v_mfma_f32_16x16x32_bf16 a[36:39], a[228:231], v[152:155], a[36:39]
    ds_read_b128 a[132:135], v205 offset:49152
    v_mfma_f32_16x16x32_bf16 a[4:7], a[228:231], v[144:147], a[4:7]
    v_exp_f32 v87, v87
    v_mfma_f32_16x16x32_bf16 a[4:7], a[196:199], v[140:143], a[4:7]
    ds_read_b128 a[136:139], v206 offset:49152
    v_cvt_pk_bf16_f32 v159, v86, v87
    v_mfma_f32_16x16x32_bf16 a[8:11], a[200:203], v[140:143], a[8:11]
    v_exp_f32 v92, v92
    v_mfma_f32_16x16x32_bf16 a[8:11], a[232:235], v[144:147], a[8:11]
    ds_read_b128 a[140:143], v207 offset:49152
    v_mfma_f32_16x16x32_bf16 a[40:43], a[232:235], v[152:155], a[40:43]
    v_exp_f32 v93, v93
    v_mfma_f32_16x16x32_bf16 a[40:43], a[200:203], v[148:151], a[40:43]
    ds_read_b128 a[144:147], v204 offset:53248
    v_cvt_pk_bf16_f32 v160, v92, v93
    v_mfma_f32_16x16x32_bf16 a[44:47], a[204:207], v[148:151], a[44:47]
    v_exp_f32 v94, v94
    v_mfma_f32_16x16x32_bf16 a[44:47], a[236:239], v[152:155], a[44:47]
    ds_read_b128 a[148:151], v205 offset:53248
    v_mfma_f32_16x16x32_bf16 a[12:15], a[236:239], v[144:147], a[12:15]
    v_exp_f32 v95, v95
    v_mfma_f32_16x16x32_bf16 a[12:15], a[204:207], v[140:143], a[12:15]
    ds_read_b128 a[152:155], v206 offset:53248
    v_cvt_pk_bf16_f32 v161, v94, v95
    v_mfma_f32_16x16x32_bf16 a[16:19], a[208:211], v[140:143], a[16:19]
    v_exp_f32 v96, v96
    v_mfma_f32_16x16x32_bf16 a[16:19], a[240:243], v[144:147], a[16:19]
    ds_read_b128 a[156:159], v207 offset:53248
    v_mfma_f32_16x16x32_bf16 a[48:51], a[240:243], v[152:155], a[48:51]
    v_exp_f32 v97, v97
    v_mfma_f32_16x16x32_bf16 a[48:51], a[208:211], v[148:151], a[48:51]
    ds_read_b128 a[160:163], v204 offset:57344
    v_cvt_pk_bf16_f32 v168, v96, v97
    v_mfma_f32_16x16x32_bf16 a[52:55], a[212:215], v[148:151], a[52:55]
    v_exp_f32 v98, v98
    v_mfma_f32_16x16x32_bf16 a[52:55], a[244:247], v[152:155], a[52:55]
    ds_read_b128 a[164:167], v205 offset:57344
    v_mfma_f32_16x16x32_bf16 a[20:23], a[244:247], v[144:147], a[20:23]
    s_waitcnt lgkmcnt(10)
    v_exp_f32 v99, v99
    v_mfma_f32_16x16x32_bf16 a[20:23], a[212:215], v[140:143], a[20:23]
    ds_read_b128 a[168:171], v206 offset:57344
    v_cvt_pk_bf16_f32 v169, v98, v99
    v_mfma_f32_16x16x32_bf16 a[24:27], a[216:219], v[140:143], a[24:27]
    v_exp_f32 v104, v104
    v_mfma_f32_16x16x32_bf16 a[24:27], a[248:251], v[144:147], a[24:27]
    ds_read_b128 a[172:175], v207 offset:57344
    v_mfma_f32_16x16x32_bf16 a[56:59], a[248:251], v[152:155], a[56:59]
    v_exp_f32 v105, v105
    v_mfma_f32_16x16x32_bf16 a[56:59], a[216:219], v[148:151], a[56:59]
    ds_read_b128 a[176:179], v204 offset:61440
    v_cvt_pk_bf16_f32 v170, v104, v105
    v_mfma_f32_16x16x32_bf16 a[60:63], a[220:223], v[148:151], a[60:63]
    v_exp_f32 v106, v106
    v_mfma_f32_16x16x32_bf16 a[60:63], a[252:255], v[152:155], a[60:63]
    ds_read_b128 a[180:183], v205 offset:61440
    v_mfma_f32_16x16x32_bf16 a[28:31], a[252:255], v[144:147], a[28:31]
    s_waitcnt lgkmcnt(6)
    v_exp_f32 v107, v107
    v_mfma_f32_16x16x32_bf16 a[28:31], a[220:223], v[140:143], a[28:31]
    ds_read_b128 a[184:187], v206 offset:61440
    v_cvt_pk_bf16_f32 v171, v106, v107
    v_mfma_f32_16x16x32_bf16 v[76:79], a[128:131], v[12:15], v[172:175]
    v_exp_f32 v100, v100
    v_mfma_f32_16x16x32_bf16 v[76:79], a[132:135], v[16:19], v[76:79]
    ds_read_b128 a[188:191], v207 offset:61440
    v_mfma_f32_16x16x32_bf16 v[76:79], a[136:139], v[20:23], v[76:79]
    s_add_u32 s29, s76, 32768
    s_add_u32 m0, s17, 16384
    v_exp_f32 v101, v101
    v_mfma_f32_16x16x32_bf16 v[76:79], a[140:143], v[24:27], v[76:79]
    buffer_load_dwordx4 v252, s[24:27], s29 offen offset:0 sc1 lds
    v_mfma_f32_16x16x32_bf16 v[80:83], a[140:143], v[40:43], v[176:179]
    v_exp_f32 v102, v102
    v_mfma_f32_16x16x32_bf16 v[80:83], a[136:139], v[36:39], v[80:83]
    v_cvt_pk_bf16_f32 v162, v100, v101
    v_mfma_f32_16x16x32_bf16 v[80:83], a[132:135], v[32:35], v[80:83]
    v_exp_f32 v103, v103
    v_mfma_f32_16x16x32_bf16 v[80:83], a[128:131], v[28:31], v[80:83]
    buffer_load_dwordx4 v252, s[24:27], s29 offen offset:1024 sc1 lds
    v_mfma_f32_16x16x32_bf16 v[88:91], a[144:147], v[28:31], v[176:179]
    v_exp_f32 v76, v76
    v_mfma_f32_16x16x32_bf16 v[88:91], a[148:151], v[32:35], v[88:91]
    v_cvt_pk_bf16_f32 v163, v102, v103
    v_mfma_f32_16x16x32_bf16 v[88:91], a[152:155], v[36:39], v[88:91]
    v_exp_f32 v77, v77
    v_mfma_f32_16x16x32_bf16 v[88:91], a[156:159], v[40:43], v[88:91]
    buffer_load_dwordx4 v252, s[24:27], s29 offen offset:2048 sc1 lds
    v_mfma_f32_16x16x32_bf16 v[84:87], a[156:159], v[24:27], v[172:175]
    v_exp_f32 v78, v78
    v_mfma_f32_16x16x32_bf16 v[84:87], a[152:155], v[20:23], v[84:87]
    v_cvt_pk_bf16_f32 v140, v76, v77
    v_mfma_f32_16x16x32_bf16 v[84:87], a[148:151], v[16:19], v[84:87]
    s_waitcnt lgkmcnt(0)
    v_exp_f32 v79, v79
    v_mfma_f32_16x16x32_bf16 v[84:87], a[144:147], v[12:15], v[84:87]
    buffer_load_dwordx4 v252, s[24:27], s29 offen offset:3072 sc1 lds
    v_mfma_f32_16x16x32_bf16 v[92:95], a[160:163], v[12:15], v[172:175]
    v_exp_f32 v80, v80
    v_mfma_f32_16x16x32_bf16 v[92:95], a[164:167], v[16:19], v[92:95]
    v_cvt_pk_bf16_f32 v141, v78, v79
    v_mfma_f32_16x16x32_bf16 v[92:95], a[168:171], v[20:23], v[92:95]
    s_add_u32 s29, s76, 49152
    s_add_u32 m0, s17, 81920
    v_exp_f32 v81, v81
    v_mfma_f32_16x16x32_bf16 v[92:95], a[172:175], v[24:27], v[92:95]
    buffer_load_dwordx4 v252, s[24:27], s29 offen offset:0 sc1 lds
    v_mfma_f32_16x16x32_bf16 v[96:99], a[172:175], v[40:43], v[176:179]
    v_exp_f32 v82, v82
    v_mfma_f32_16x16x32_bf16 v[96:99], a[168:171], v[36:39], v[96:99]
    v_cvt_pk_bf16_f32 v148, v80, v81
    v_mfma_f32_16x16x32_bf16 v[96:99], a[164:167], v[32:35], v[96:99]
    v_exp_f32 v83, v83
    v_mfma_f32_16x16x32_bf16 v[96:99], a[160:163], v[28:31], v[96:99]
    buffer_load_dwordx4 v252, s[24:27], s29 offen offset:1024 sc1 lds
    v_mfma_f32_16x16x32_bf16 v[104:107], a[176:179], v[28:31], v[176:179]
    v_exp_f32 v88, v88
    v_mfma_f32_16x16x32_bf16 v[104:107], a[180:183], v[32:35], v[104:107]
    v_cvt_pk_bf16_f32 v149, v82, v83
    v_mfma_f32_16x16x32_bf16 v[104:107], a[184:187], v[36:39], v[104:107]
    v_exp_f32 v89, v89
    v_mfma_f32_16x16x32_bf16 v[104:107], a[188:191], v[40:43], v[104:107]
    buffer_load_dwordx4 v252, s[24:27], s29 offen offset:2048 sc1 lds
    v_mfma_f32_16x16x32_bf16 v[100:103], a[188:191], v[24:27], v[172:175]
    v_exp_f32 v90, v90
    v_mfma_f32_16x16x32_bf16 v[100:103], a[184:187], v[20:23], v[100:103]
    v_cvt_pk_bf16_f32 v150, v88, v89
    v_mfma_f32_16x16x32_bf16 v[100:103], a[180:183], v[16:19], v[100:103]
    v_exp_f32 v91, v91
    v_mfma_f32_16x16x32_bf16 v[100:103], a[176:179], v[12:15], v[100:103]
    buffer_load_dwordx4 v252, s[24:27], s29 offen offset:3072 sc1 lds
    v_mfma_f32_16x16x32_bf16 a[64:67], a[192:195], v[156:159], a[64:67]
    v_exp_f32 v84, v84
    v_mfma_f32_16x16x32_bf16 a[64:67], a[224:227], v[160:163], a[64:67]
    v_cvt_pk_bf16_f32 v151, v90, v91
    v_smfmac_f32_16x16x64_bf16 v[200:203], v[188:191], v[156:163], v11
    v_smfmac_f32_16x16x64_bf16 v[248:251], v[188:191], v[164:171], v11
    s_add_u32 m0, s79, 6144
    s_nop 0
    buffer_load_dwordx4 v252, s[24:27], s78 offen offset:0 sc1 lds
    v_mfma_f32_16x16x32_bf16 a[96:99], a[224:227], v[168:171], a[96:99]
    s_add_u32 s16, s16, s30
    v_exp_f32 v85, v85
    v_mfma_f32_16x16x32_bf16 a[96:99], a[192:195], v[164:167], a[96:99]
    ds_read_b64_tr_b16 a[192:193], v208 offset:49152
    v_cvt_pk_bf16_f32 v142, v84, v85
    v_mfma_f32_16x16x32_bf16 a[100:103], a[196:199], v[164:167], a[100:103]
    v_exp_f32 v86, v86
    v_mfma_f32_16x16x32_bf16 a[100:103], a[228:231], v[168:171], a[100:103]
    ds_read_b64_tr_b16 a[194:195], v208 offset:53248
    v_mfma_f32_16x16x32_bf16 a[68:71], a[228:231], v[160:163], a[68:71]
    v_exp_f32 v87, v87
    v_mfma_f32_16x16x32_bf16 a[68:71], a[196:199], v[156:159], a[68:71]
    ds_read_b64_tr_b16 a[224:225], v208 offset:57344
    v_cvt_pk_bf16_f32 v143, v86, v87
    v_mfma_f32_16x16x32_bf16 a[72:75], a[200:203], v[156:159], a[72:75]
    v_exp_f32 v92, v92
    v_mfma_f32_16x16x32_bf16 a[72:75], a[232:235], v[160:163], a[72:75]
    ds_read_b64_tr_b16 a[226:227], v208 offset:61440
    v_mfma_f32_16x16x32_bf16 a[104:107], a[232:235], v[168:171], a[104:107]
    v_exp_f32 v93, v93
    v_mfma_f32_16x16x32_bf16 a[104:107], a[200:203], v[164:167], a[104:107]
    ds_read_b64_tr_b16 a[196:197], v209 offset:49152
    v_cvt_pk_bf16_f32 v144, v92, v93
    v_mfma_f32_16x16x32_bf16 a[108:111], a[204:207], v[164:167], a[108:111]
    buffer_load_dwordx2 v[216:217], v240, s[52:55], s39 offen offset:0
    v_exp_f32 v94, v94
    v_mfma_f32_16x16x32_bf16 a[108:111], a[236:239], v[168:171], a[108:111]
    ds_read_b64_tr_b16 a[198:199], v209 offset:53248
    v_mfma_f32_16x16x32_bf16 a[76:79], a[236:239], v[160:163], a[76:79]
    v_exp_f32 v95, v95
    v_mfma_f32_16x16x32_bf16 a[76:79], a[204:207], v[156:159], a[76:79]
    ds_read_b64_tr_b16 a[228:229], v209 offset:57344
    v_cvt_pk_bf16_f32 v145, v94, v95
    v_mfma_f32_16x16x32_bf16 a[80:83], a[208:211], v[156:159], a[80:83]
    v_exp_f32 v96, v96
    v_mfma_f32_16x16x32_bf16 a[80:83], a[240:243], v[160:163], a[80:83]
    ds_read_b64_tr_b16 a[230:231], v209 offset:61440
    v_mfma_f32_16x16x32_bf16 a[112:115], a[240:243], v[168:171], a[112:115]
    v_exp_f32 v97, v97
    v_mfma_f32_16x16x32_bf16 a[112:115], a[208:211], v[164:167], a[112:115]
    ds_read_b64_tr_b16 a[200:201], v210 offset:49152
    v_cvt_pk_bf16_f32 v152, v96, v97
    v_mfma_f32_16x16x32_bf16 a[116:119], a[212:215], v[164:167], a[116:119]
    v_exp_f32 v98, v98
    v_mfma_f32_16x16x32_bf16 a[116:119], a[244:247], v[168:171], a[116:119]
    ds_read_b64_tr_b16 a[202:203], v210 offset:53248
    v_mfma_f32_16x16x32_bf16 a[84:87], a[244:247], v[160:163], a[84:87]
    v_exp_f32 v99, v99
    v_mfma_f32_16x16x32_bf16 a[84:87], a[212:215], v[156:159], a[84:87]
    ds_read_b64_tr_b16 a[232:233], v210 offset:57344
    v_cvt_pk_bf16_f32 v153, v98, v99
    v_mfma_f32_16x16x32_bf16 a[88:91], a[216:219], v[156:159], a[88:91]
    buffer_load_dwordx2 v[218:219], v240, s[52:55], s39 offen offset:32
    v_exp_f32 v104, v104
    v_mfma_f32_16x16x32_bf16 a[88:91], a[248:251], v[160:163], a[88:91]
    ds_read_b64_tr_b16 a[234:235], v210 offset:61440
    v_mfma_f32_16x16x32_bf16 a[120:123], a[248:251], v[168:171], a[120:123]
    v_exp_f32 v105, v105
    v_mfma_f32_16x16x32_bf16 a[120:123], a[216:219], v[164:167], a[120:123]
    ds_read_b64_tr_b16 a[204:205], v211 offset:49152
    v_cvt_pk_bf16_f32 v154, v104, v105
    v_mfma_f32_16x16x32_bf16 a[124:127], a[220:223], v[164:167], a[124:127]
    v_exp_f32 v106, v106
    v_mfma_f32_16x16x32_bf16 a[124:127], a[252:255], v[168:171], a[124:127]
    ds_read_b64_tr_b16 a[206:207], v211 offset:53248
    v_mfma_f32_16x16x32_bf16 a[92:95], a[252:255], v[160:163], a[92:95]
    v_exp_f32 v107, v107
    v_mfma_f32_16x16x32_bf16 a[92:95], a[220:223], v[156:159], a[92:95]
    ds_read_b64_tr_b16 a[236:237], v211 offset:57344
    v_cvt_pk_bf16_f32 v155, v106, v107
    v_mfma_f32_16x16x32_bf16 v[76:79], a[128:131], v[44:47], v[180:183]
    v_exp_f32 v100, v100
    v_mfma_f32_16x16x32_bf16 v[76:79], a[132:135], v[48:51], v[76:79]
    ds_read_b64_tr_b16 a[238:239], v211 offset:61440
    v_mfma_f32_16x16x32_bf16 v[76:79], a[136:139], v[52:55], v[76:79]
    v_exp_f32 v101, v101
    v_mfma_f32_16x16x32_bf16 v[76:79], a[140:143], v[56:59], v[76:79]
    ds_read_b64_tr_b16 a[208:209], v212 offset:49152
    v_cvt_pk_bf16_f32 v146, v100, v101
    v_mfma_f32_16x16x32_bf16 v[80:83], a[140:143], v[72:75], v[184:187]
    buffer_load_dwordx2 v[220:221], v240, s[52:55], s39 offen offset:128
    v_exp_f32 v102, v102
    v_mfma_f32_16x16x32_bf16 v[80:83], a[136:139], v[68:71], v[80:83]
    ds_read_b64_tr_b16 a[210:211], v212 offset:53248
    v_mfma_f32_16x16x32_bf16 v[80:83], a[132:135], v[64:67], v[80:83]
    v_exp_f32 v103, v103
    v_mfma_f32_16x16x32_bf16 v[80:83], a[128:131], v[60:63], v[80:83]
    ds_read_b64_tr_b16 a[240:241], v212 offset:57344
    v_cvt_pk_bf16_f32 v147, v102, v103
    v_mfma_f32_16x16x32_bf16 v[88:91], a[144:147], v[60:63], v[184:187]
    v_exp_f32 v76, v76
    v_mfma_f32_16x16x32_bf16 v[88:91], a[148:151], v[64:67], v[88:91]
    ds_read_b64_tr_b16 a[242:243], v212 offset:61440
    v_mfma_f32_16x16x32_bf16 v[88:91], a[152:155], v[68:71], v[88:91]
    v_exp_f32 v77, v77
    v_mfma_f32_16x16x32_bf16 v[88:91], a[156:159], v[72:75], v[88:91]
    ds_read_b64_tr_b16 a[212:213], v213 offset:49152
    v_cvt_pk_bf16_f32 v156, v76, v77
    v_mfma_f32_16x16x32_bf16 v[84:87], a[156:159], v[56:59], v[180:183]
    v_exp_f32 v78, v78
    v_mfma_f32_16x16x32_bf16 v[84:87], a[152:155], v[52:55], v[84:87]
    ds_read_b64_tr_b16 a[214:215], v213 offset:53248
    v_mfma_f32_16x16x32_bf16 v[84:87], a[148:151], v[48:51], v[84:87]
    v_exp_f32 v79, v79
    v_mfma_f32_16x16x32_bf16 v[84:87], a[144:147], v[44:47], v[84:87]
    ds_read_b64_tr_b16 a[244:245], v213 offset:57344
    v_cvt_pk_bf16_f32 v157, v78, v79
    v_mfma_f32_16x16x32_bf16 v[92:95], a[160:163], v[44:47], v[180:183]
    buffer_load_dwordx2 v[222:223], v240, s[52:55], s39 offen offset:160
    v_exp_f32 v80, v80
    v_mfma_f32_16x16x32_bf16 v[92:95], a[164:167], v[48:51], v[92:95]
    ds_read_b64_tr_b16 a[246:247], v213 offset:61440
    v_mfma_f32_16x16x32_bf16 v[92:95], a[168:171], v[52:55], v[92:95]
    v_exp_f32 v81, v81
    v_mfma_f32_16x16x32_bf16 v[92:95], a[172:175], v[56:59], v[92:95]
    ds_read_b64_tr_b16 a[216:217], v214 offset:49152
    v_cvt_pk_bf16_f32 v164, v80, v81
    v_mfma_f32_16x16x32_bf16 v[96:99], a[172:175], v[72:75], v[184:187]
    v_exp_f32 v82, v82
    v_mfma_f32_16x16x32_bf16 v[96:99], a[168:171], v[68:71], v[96:99]
    ds_read_b64_tr_b16 a[218:219], v214 offset:53248
    v_mfma_f32_16x16x32_bf16 v[96:99], a[164:167], v[64:67], v[96:99]
    v_exp_f32 v83, v83
    v_mfma_f32_16x16x32_bf16 v[96:99], a[160:163], v[60:63], v[96:99]
    ds_read_b64_tr_b16 a[248:249], v214 offset:57344
    v_cvt_pk_bf16_f32 v165, v82, v83
    v_mfma_f32_16x16x32_bf16 v[104:107], a[176:179], v[60:63], v[184:187]
    v_exp_f32 v88, v88
    v_mfma_f32_16x16x32_bf16 v[104:107], a[180:183], v[64:67], v[104:107]
    ds_read_b64_tr_b16 a[250:251], v214 offset:61440
    v_mfma_f32_16x16x32_bf16 v[104:107], a[184:187], v[68:71], v[104:107]
    v_exp_f32 v89, v89
    v_mfma_f32_16x16x32_bf16 v[104:107], a[188:191], v[72:75], v[104:107]
    ds_read_b64_tr_b16 a[220:221], v215 offset:49152
    v_cvt_pk_bf16_f32 v166, v88, v89
    v_mfma_f32_16x16x32_bf16 v[100:103], a[188:191], v[56:59], v[180:183]
    v_exp_f32 v90, v90
    v_mfma_f32_16x16x32_bf16 v[100:103], a[184:187], v[52:55], v[100:103]
    ds_read_b64_tr_b16 a[222:223], v215 offset:53248
    v_mfma_f32_16x16x32_bf16 v[100:103], a[180:183], v[48:51], v[100:103]
    s_waitcnt lgkmcnt(6)
    v_exp_f32 v91, v91
    v_mfma_f32_16x16x32_bf16 v[100:103], a[176:179], v[44:47], v[100:103]
    ds_read_b64_tr_b16 a[252:253], v215 offset:57344
    v_cvt_pk_bf16_f32 v167, v90, v91
    v_mfma_f32_16x16x32_bf16 a[0:3], a[192:195], v[140:143], a[0:3]
    v_exp_f32 v84, v84
    v_mfma_f32_16x16x32_bf16 a[0:3], a[224:227], v[144:147], a[0:3]
    ds_read_b64_tr_b16 a[254:255], v215 offset:61440
    v_smfmac_f32_16x16x64_bf16 v[192:195], v[188:191], v[140:147], v11
    s_add_u32 m0, s79, 6144
    s_nop 0
    buffer_load_dwordx4 v252, s[24:27], s78 offen offset:1024 sc1 lds
    s_add_u32 s78, s78, 8192
    v_smfmac_f32_16x16x64_bf16 v[196:199], v[188:191], v[148:155], v11
    s_barrier
    v_mfma_f32_16x16x32_bf16 a[32:35], a[224:227], v[152:155], a[32:35]
    v_exp_f32 v85, v85
    v_mfma_f32_16x16x32_bf16 a[32:35], a[192:195], v[148:151], a[32:35]
    s_add_u32 s28, s76, 0
    buffer_load_dwordx4 a[128:131], v252, s[24:27], s28 offen offset:0 sc1
    v_cvt_pk_bf16_f32 v158, v84, v85
    v_mfma_f32_16x16x32_bf16 a[36:39], a[196:199], v[148:151], a[36:39]
    v_exp_f32 v86, v86
    v_mfma_f32_16x16x32_bf16 a[36:39], a[228:231], v[152:155], a[36:39]
    v_mfma_f32_16x16x32_bf16 a[4:7], a[228:231], v[144:147], a[4:7]
    v_exp_f32 v87, v87
    v_mfma_f32_16x16x32_bf16 a[4:7], a[196:199], v[140:143], a[4:7]
    buffer_load_dwordx4 a[132:135], v252, s[24:27], s28 offen offset:1024 sc1
    v_cvt_pk_bf16_f32 v159, v86, v87
    v_mfma_f32_16x16x32_bf16 a[8:11], a[200:203], v[140:143], a[8:11]
    v_exp_f32 v92, v92
    v_mfma_f32_16x16x32_bf16 a[8:11], a[232:235], v[144:147], a[8:11]
    v_mfma_f32_16x16x32_bf16 a[40:43], a[232:235], v[152:155], a[40:43]
    v_exp_f32 v93, v93
    v_mfma_f32_16x16x32_bf16 a[40:43], a[200:203], v[148:151], a[40:43]
    buffer_load_dwordx4 a[136:139], v252, s[24:27], s28 offen offset:2048 sc1
    v_cvt_pk_bf16_f32 v160, v92, v93
    v_mfma_f32_16x16x32_bf16 a[44:47], a[204:207], v[148:151], a[44:47]
    v_exp_f32 v94, v94
    v_mfma_f32_16x16x32_bf16 a[44:47], a[236:239], v[152:155], a[44:47]
    v_mfma_f32_16x16x32_bf16 a[12:15], a[236:239], v[144:147], a[12:15]
    v_exp_f32 v95, v95
    v_mfma_f32_16x16x32_bf16 a[12:15], a[204:207], v[140:143], a[12:15]
    buffer_load_dwordx4 a[140:143], v252, s[24:27], s28 offen offset:3072 sc1
    v_cvt_pk_bf16_f32 v161, v94, v95
    v_mfma_f32_16x16x32_bf16 a[16:19], a[208:211], v[140:143], a[16:19]
    v_exp_f32 v96, v96
    v_mfma_f32_16x16x32_bf16 a[16:19], a[240:243], v[144:147], a[16:19]
    v_mfma_f32_16x16x32_bf16 a[48:51], a[240:243], v[152:155], a[48:51]
    v_exp_f32 v97, v97
    v_mfma_f32_16x16x32_bf16 a[48:51], a[208:211], v[148:151], a[48:51]
    v_cvt_pk_bf16_f32 v168, v96, v97
    v_mfma_f32_16x16x32_bf16 a[52:55], a[212:215], v[148:151], a[52:55]
    v_exp_f32 v98, v98
    v_mfma_f32_16x16x32_bf16 a[52:55], a[244:247], v[152:155], a[52:55]
    s_add_u32 s28, s76, 16384
    buffer_load_dwordx4 a[144:147], v252, s[24:27], s28 offen offset:0 sc1
    v_mfma_f32_16x16x32_bf16 a[20:23], a[244:247], v[144:147], a[20:23]
    s_waitcnt lgkmcnt(0)
    v_exp_f32 v99, v99
    v_mfma_f32_16x16x32_bf16 a[20:23], a[212:215], v[140:143], a[20:23]
    v_cvt_pk_bf16_f32 v169, v98, v99
    v_mfma_f32_16x16x32_bf16 a[24:27], a[216:219], v[140:143], a[24:27]
    v_exp_f32 v104, v104
    v_mfma_f32_16x16x32_bf16 a[24:27], a[248:251], v[144:147], a[24:27]
    buffer_load_dwordx4 a[148:151], v252, s[24:27], s28 offen offset:1024 sc1
    v_mfma_f32_16x16x32_bf16 a[56:59], a[248:251], v[152:155], a[56:59]
    v_exp_f32 v105, v105
    v_mfma_f32_16x16x32_bf16 a[56:59], a[216:219], v[148:151], a[56:59]
    v_cvt_pk_bf16_f32 v170, v104, v105
    v_mfma_f32_16x16x32_bf16 a[60:63], a[220:223], v[148:151], a[60:63]
    v_exp_f32 v106, v106
    v_mfma_f32_16x16x32_bf16 a[60:63], a[252:255], v[152:155], a[60:63]
    buffer_load_dwordx4 a[152:155], v252, s[24:27], s28 offen offset:2048 sc1
    v_mfma_f32_16x16x32_bf16 a[28:31], a[252:255], v[144:147], a[28:31]
    v_exp_f32 v107, v107
    v_mfma_f32_16x16x32_bf16 a[28:31], a[220:223], v[140:143], a[28:31]
    v_cvt_pk_bf16_f32 v171, v106, v107
L_epi:
    v_exp_f32 v100, v100
    s_nop 0
    v_exp_f32 v101, v101
    s_nop 0
    v_exp_f32 v102, v102
    s_nop 0
    v_cvt_pk_bf16_f32 v162, v100, v101
    v_exp_f32 v103, v103
    s_nop 0
    v_cvt_pk_bf16_f32 v163, v102, v103
    s_nop 0
    v_smfmac_f32_16x16x64_bf16 v[248:251], v[188:191], v[164:171], v11
    buffer_load_dwordx4 a[156:159], v252, s[24:27], s28 offen offset:3072 sc1
    v_smfmac_f32_16x16x64_bf16 v[200:203], v[188:191], v[156:163], v11
    v_add_f32 v2, v192, v193
    v_add_f32 v3, v196, v197
    v_mfma_f32_16x16x32_bf16 a[64:67], a[192:195], v[156:159], a[64:67]
    v_add_f32 v6, v2, v3
    v_rcp_f32 v2, v2
    v_mfma_f32_16x16x32_bf16 a[64:67], a[224:227], v[160:163], a[64:67]
    v_rcp_f32 v3, v3
    v_mfma_f32_16x16x32_bf16 a[96:99], a[224:227], v[168:171], a[96:99]
    s_add_u32 s28, s76, 4096
    buffer_load_dwordx4 a[160:163], v252, s[24:27], s28 offen offset:0 sc1
    v_mfma_f32_16x16x32_bf16 a[96:99], a[192:195], v[164:167], a[96:99]
    v_accvgpr_read_b32 v76, a0
    v_accvgpr_read_b32 v77, a1
    v_mfma_f32_16x16x32_bf16 a[100:103], a[196:199], v[164:167], a[100:103]
    v_accvgpr_read_b32 v78, a2
    v_accvgpr_read_b32 v79, a3
    v_mfma_f32_16x16x32_bf16 a[100:103], a[228:231], v[168:171], a[100:103]
    v_add_f32 v4, v200, v201
    v_add_f32 v5, v248, v249
    v_mfma_f32_16x16x32_bf16 a[68:71], a[228:231], v[160:163], a[68:71]
    buffer_load_dwordx4 a[164:167], v252, s[24:27], s28 offen offset:1024 sc1
    v_mfma_f32_16x16x32_bf16 a[68:71], a[196:199], v[156:159], a[68:71]
    v_add_f32 v7, v4, v5
    v_add_f32 v6, v6, v7
    v_mfma_f32_16x16x32_bf16 a[72:75], a[200:203], v[156:159], a[72:75]
    v_cmp_ngt_f32 vcc, 0x4e800000, v6
    v_rcp_f32 v4, v4
    v_mfma_f32_16x16x32_bf16 a[72:75], a[232:235], v[160:163], a[72:75]
    s_cmp_lg_u64 vcc, 0
    s_cselect_b32 s29, 1, 0
    v_and_b32 v6, 3, v0
    v_lshlrev_b32 v6, 13, v6
    v_mfma_f32_16x16x32_bf16 a[104:107], a[232:235], v[168:171], a[104:107]
    buffer_load_dwordx4 a[168:171], v252, s[24:27], s28 offen offset:2048 sc1
    v_mfma_f32_16x16x32_bf16 a[104:107], a[200:203], v[164:167], a[104:107]
    v_lshl_add_u32 v6, v1, 2, v6
    v_mov_b32 v7, s29
    v_mfma_f32_16x16x32_bf16 a[108:111], a[204:207], v[164:167], a[108:111]
    ds_write_b32 v6, v7 offset:32768
    v_mfma_f32_16x16x32_bf16 a[108:111], a[236:239], v[168:171], a[108:111]
    v_rcp_f32 v5, v5
    v_mfma_f32_16x16x32_bf16 a[76:79], a[236:239], v[160:163], a[76:79]
    buffer_load_dwordx4 a[172:175], v252, s[24:27], s28 offen offset:3072 sc1
    v_mfma_f32_16x16x32_bf16 a[76:79], a[204:207], v[156:159], a[76:79]
    v_lshlrev_b32 v6, 13, v1
    v_add_u32 v10, s17, v9
    v_mfma_f32_16x16x32_bf16 a[80:83], a[208:211], v[156:159], a[80:83]
    v_add_u32 v11, 98304, v10
    s_waitcnt lgkmcnt(0)
    s_barrier
    v_mul_f32 v228, -v2, s33
    v_mfma_f32_16x16x32_bf16 a[80:83], a[240:243], v[160:163], a[80:83]
    v_mul_f32 v229, -v3, s33
    v_mul_f32 v230, -v4, s33
    v_mfma_f32_16x16x32_bf16 a[112:115], a[240:243], v[168:171], a[112:115]
    s_add_u32 s28, s76, 20480
    buffer_load_dwordx4 a[176:179], v252, s[24:27], s28 offen offset:0 sc1
    v_mfma_f32_16x16x32_bf16 a[112:115], a[208:211], v[164:167], a[112:115]
    v_mul_f32 v231, -v5, s33
    ds_read_b128 v[224:227], v6 offset:32768
    v_mfma_f32_16x16x32_bf16 a[116:119], a[212:215], v[164:167], a[116:119]
    v_accvgpr_read_b32 v80, a4
    v_accvgpr_read_b32 v81, a5
    v_mfma_f32_16x16x32_bf16 a[116:119], a[244:247], v[168:171], a[116:119]
    v_accvgpr_read_b32 v82, a6
    v_accvgpr_read_b32 v83, a7
    v_mfma_f32_16x16x32_bf16 a[84:87], a[244:247], v[160:163], a[84:87]
    buffer_load_dwordx4 a[180:183], v252, s[24:27], s28 offen offset:1024 sc1
    v_mfma_f32_16x16x32_bf16 a[84:87], a[212:215], v[156:159], a[84:87]
    v_fma_f32 v76, v76, v2, v228
    v_fma_f32 v77, v77, v2, v228
    v_mfma_f32_16x16x32_bf16 a[88:91], a[216:219], v[156:159], a[88:91]
    v_fma_f32 v78, v78, v2, v228
    v_fma_f32 v79, v79, v2, v228
    v_mfma_f32_16x16x32_bf16 a[88:91], a[248:251], v[160:163], a[88:91]
    v_fma_f32 v80, v80, v2, v228
    v_fma_f32 v81, v81, v2, v228
    v_mfma_f32_16x16x32_bf16 a[120:123], a[248:251], v[168:171], a[120:123]
    buffer_load_dwordx4 a[184:187], v252, s[24:27], s28 offen offset:2048 sc1
    v_mfma_f32_16x16x32_bf16 a[120:123], a[216:219], v[164:167], a[120:123]
    v_fma_f32 v82, v82, v2, v228
    v_fma_f32 v83, v83, v2, v228
    v_mfma_f32_16x16x32_bf16 a[124:127], a[220:223], v[164:167], a[124:127]
    v_cvt_pk_bf16_f32 v76, v76, v77
    v_cvt_pk_bf16_f32 v77, v78, v79
    v_mfma_f32_16x16x32_bf16 a[124:127], a[252:255], v[168:171], a[124:127]
    v_cvt_pk_bf16_f32 v78, v80, v81
    v_cvt_pk_bf16_f32 v79, v82, v83
    v_mfma_f32_16x16x32_bf16 a[92:95], a[252:255], v[160:163], a[92:95]
    buffer_load_dwordx4 a[188:191], v252, s[24:27], s28 offen offset:3072 sc1
    v_mfma_f32_16x16x32_bf16 a[92:95], a[220:223], v[156:159], a[92:95]
    ds_write_b128 v10, v[76:79] offset:32768
    s_waitcnt lgkmcnt(1)
    v_or3_b32 v224, v224, v225, v226
    v_or_b32 v224, v224, v227
    s_nop 0
    v_readfirstlane_b32 s29, v224
    s_nop 1
    s_andn2_b32 s29, s29, s44
    s_cbranch_scc1 L_fallback
    s_mov_b32 s64, s76
    v_add_u32 v204, 65536, v9
    v_add_u32 v253, 98304, v252
    s_waitcnt vmcnt(22)
    s_add_u32 s31, s64, 36864
    buffer_load_dwordx4 v[140:143], v252, s[24:27], s31 offen offset:0 sc1
    buffer_load_dwordx4 v[144:147], v252, s[24:27], s31 offen offset:1024 sc1
    v_accvgpr_read_b32 v84, a8
    v_accvgpr_read_b32 v85, a9
    v_accvgpr_read_b32 v86, a10
    v_accvgpr_read_b32 v87, a11
    v_accvgpr_read_b32 v88, a12
    v_accvgpr_read_b32 v89, a13
    v_accvgpr_read_b32 v90, a14
    v_accvgpr_read_b32 v91, a15
    v_pk_fma_f32 v[84:85], v[84:85], v[2:3], v[228:229] op_sel:[0,0,0] op_sel_hi:[1,0,0]
    v_pk_fma_f32 v[86:87], v[86:87], v[2:3], v[228:229] op_sel:[0,0,0] op_sel_hi:[1,0,0]
    v_pk_fma_f32 v[88:89], v[88:89], v[2:3], v[228:229] op_sel:[0,0,0] op_sel_hi:[1,0,0]
    v_pk_fma_f32 v[90:91], v[90:91], v[2:3], v[228:229] op_sel:[0,0,0] op_sel_hi:[1,0,0]
    v_cvt_pk_bf16_f32 v84, v84, v85
    v_cvt_pk_bf16_f32 v85, v86, v87
    v_cvt_pk_bf16_f32 v86, v88, v89
    v_cvt_pk_bf16_f32 v87, v90, v91
    ds_write_b128 v10, v[84:87] offset:36864
    buffer_load_dwordx4 v[148:151], v252, s[24:27], s31 offen offset:2048 sc1
    v_accvgpr_read_b32 v92, a16
    v_accvgpr_read_b32 v93, a17
    v_accvgpr_read_b32 v94, a18
    v_accvgpr_read_b32 v95, a19
    v_accvgpr_read_b32 v96, a20
    v_accvgpr_read_b32 v97, a21
    v_accvgpr_read_b32 v98, a22
    v_accvgpr_read_b32 v99, a23
    v_pk_fma_f32 v[92:93], v[92:93], v[2:3], v[228:229] op_sel:[0,0,0] op_sel_hi:[1,0,0]
    v_pk_fma_f32 v[94:95], v[94:95], v[2:3], v[228:229] op_sel:[0,0,0] op_sel_hi:[1,0,0]
    v_pk_fma_f32 v[96:97], v[96:97], v[2:3], v[228:229] op_sel:[0,0,0] op_sel_hi:[1,0,0]
L_pg8:
    s_cbranch_execz L_pg12
    v_pk_fma_f32 v[98:99], v[98:99], v[2:3], v[228:229] op_sel:[0,0,0] op_sel_hi:[1,0,0]
    v_cvt_pk_bf16_f32 v92, v92, v93
    v_cvt_pk_bf16_f32 v93, v94, v95
    v_cvt_pk_bf16_f32 v94, v96, v97
    v_cvt_pk_bf16_f32 v95, v98, v99
    ds_write_b128 v11, v[92:95] offset:0
    buffer_load_dwordx4 v[152:155], v252, s[24:27], s31 offen offset:3072 sc1
    v_accvgpr_read_b32 v100, a24
    v_accvgpr_read_b32 v101, a25
    v_accvgpr_read_b32 v102, a26
    v_accvgpr_read_b32 v103, a27
    v_accvgpr_read_b32 v104, a28
    v_accvgpr_read_b32 v105, a29
    v_accvgpr_read_b32 v106, a30
    v_accvgpr_read_b32 v107, a31
    v_pk_fma_f32 v[100:101], v[100:101], v[2:3], v[228:229] op_sel:[0,0,0] op_sel_hi:[1,0,0]
    v_pk_fma_f32 v[102:103], v[102:103], v[2:3], v[228:229] op_sel:[0,0,0] op_sel_hi:[1,0,0]
    v_pk_fma_f32 v[104:105], v[104:105], v[2:3], v[228:229] op_sel:[0,0,0] op_sel_hi:[1,0,0]
    v_pk_fma_f32 v[106:107], v[106:107], v[2:3], v[228:229] op_sel:[0,0,0] op_sel_hi:[1,0,0]
    v_cvt_pk_bf16_f32 v100, v100, v101
    v_cvt_pk_bf16_f32 v101, v102, v103
    v_cvt_pk_bf16_f32 v102, v104, v105
    v_cvt_pk_bf16_f32 v103, v106, v107
    ds_write_b128 v11, v[100:103] offset:4096
    s_add_u32 s31, s64, 53248
    buffer_load_dwordx4 v[156:159], v252, s[24:27], s31 offen offset:0 sc1
    v_accvgpr_read_b32 v76, a32
    v_accvgpr_read_b32 v77, a33
    v_accvgpr_read_b32 v78, a34
    v_accvgpr_read_b32 v79, a35
    v_accvgpr_read_b32 v80, a36
    v_accvgpr_read_b32 v81, a37
    v_accvgpr_read_b32 v82, a38
    v_accvgpr_read_b32 v83, a39
    v_pk_fma_f32 v[76:77], v[76:77], v[2:3], v[228:229] op_sel:[0,1,1] op_sel_hi:[1,1,1]
    v_pk_fma_f32 v[78:79], v[78:79], v[2:3], v[228:229] op_sel:[0,1,1] op_sel_hi:[1,1,1]
    v_pk_fma_f32 v[80:81], v[80:81], v[2:3], v[228:229] op_sel:[0,1,1] op_sel_hi:[1,1,1]
    v_pk_fma_f32 v[82:83], v[82:83], v[2:3], v[228:229] op_sel:[0,1,1] op_sel_hi:[1,1,1]
    v_cvt_pk_bf16_f32 v76, v76, v77
    v_cvt_pk_bf16_f32 v77, v78, v79
    v_cvt_pk_bf16_f32 v78, v80, v81
    v_cvt_pk_bf16_f32 v79, v82, v83
    ds_write_b128 v10, v[76:79] offset:33792
    buffer_load_dwordx4 v[160:163], v252, s[24:27], s31 offen offset:1024 sc1
    v_accvgpr_read_b32 v84, a40
    v_accvgpr_read_b32 v85, a41
    v_accvgpr_read_b32 v86, a42
    v_accvgpr_read_b32 v87, a43
    v_accvgpr_read_b32 v88, a44
    v_accvgpr_read_b32 v89, a45
    v_accvgpr_read_b32 v90, a46
    v_accvgpr_read_b32 v91, a47
    v_pk_fma_f32 v[84:85], v[84:85], v[2:3], v[228:229] op_sel:[0,1,1] op_sel_hi:[1,1,1]
    v_pk_fma_f32 v[86:87], v[86:87], v[2:3], v[228:229] op_sel:[0,1,1] op_sel_hi:[1,1,1]
    v_pk_fma_f32 v[88:89], v[88:89], v[2:3], v[228:229] op_sel:[0,1,1] op_sel_hi:[1,1,1]
    v_pk_fma_f32 v[90:91], v[90:91], v[2:3], v[228:229] op_sel:[0,1,1] op_sel_hi:[1,1,1]
    v_cvt_pk_bf16_f32 v84, v84, v85
    v_cvt_pk_bf16_f32 v85, v86, v87
    v_cvt_pk_bf16_f32 v86, v88, v89
    v_cvt_pk_bf16_f32 v87, v90, v91
    ds_write_b128 v10, v[84:87] offset:37888
    buffer_load_dwordx4 v[164:167], v252, s[24:27], s31 offen offset:2048 sc1
    v_accvgpr_read_b32 v92, a48
    v_accvgpr_read_b32 v93, a49
    v_accvgpr_read_b32 v94, a50
    v_accvgpr_read_b32 v95, a51
    v_accvgpr_read_b32 v96, a52
    v_accvgpr_read_b32 v97, a53
    v_accvgpr_read_b32 v98, a54
    v_accvgpr_read_b32 v99, a55
    v_pk_fma_f32 v[92:93], v[92:93], v[2:3], v[228:229] op_sel:[0,1,1] op_sel_hi:[1,1,1]
    v_pk_fma_f32 v[94:95], v[94:95], v[2:3], v[228:229] op_sel:[0,1,1] op_sel_hi:[1,1,1]
    v_pk_fma_f32 v[96:97], v[96:97], v[2:3], v[228:229] op_sel:[0,1,1] op_sel_hi:[1,1,1]
    v_pk_fma_f32 v[98:99], v[98:99], v[2:3], v[228:229] op_sel:[0,1,1] op_sel_hi:[1,1,1]
    v_cvt_pk_bf16_f32 v92, v92, v93
    v_cvt_pk_bf16_f32 v93, v94, v95
    v_cvt_pk_bf16_f32 v94, v96, v97
    v_cvt_pk_bf16_f32 v95, v98, v99
    ds_write_b128 v11, v[92:95] offset:1024
    buffer_load_dwordx4 v[168:171], v252, s[24:27], s31 offen offset:3072 sc1
    v_accvgpr_read_b32 v100, a56
    v_accvgpr_read_b32 v101, a57
    v_accvgpr_read_b32 v102, a58
    v_accvgpr_read_b32 v103, a59
    v_accvgpr_read_b32 v104, a60
    v_accvgpr_read_b32 v105, a61
    v_accvgpr_read_b32 v106, a62
    v_accvgpr_read_b32 v107, a63
    v_pk_fma_f32 v[100:101], v[100:101], v[2:3], v[228:229] op_sel:[0,1,1] op_sel_hi:[1,1,1]
    v_pk_fma_f32 v[102:103], v[102:103], v[2:3], v[228:229] op_sel:[0,1,1] op_sel_hi:[1,1,1]
    v_pk_fma_f32 v[104:105], v[104:105], v[2:3], v[228:229] op_sel:[0,1,1] op_sel_hi:[1,1,1]
    v_pk_fma_f32 v[106:107], v[106:107], v[2:3], v[228:229] op_sel:[0,1,1] op_sel_hi:[1,1,1]
    v_cvt_pk_bf16_f32 v100, v100, v101
    v_cvt_pk_bf16_f32 v101, v102, v103
    v_cvt_pk_bf16_f32 v102, v104, v105
    v_cvt_pk_bf16_f32 v103, v106, v107
    ds_write_b128 v11, v[100:103] offset:5120
    s_add_u32 s31, s64, 40960
    buffer_load_dwordx4 v[172:175], v252, s[24:27], s31 offen offset:0 sc1
    v_accvgpr_read_b32 v76, a64
    v_accvgpr_read_b32 v77, a65
    v_accvgpr_read_b32 v78, a66
    v_accvgpr_read_b32 v79, a67
    v_accvgpr_read_b32 v80, a68
    v_accvgpr_read_b32 v81, a69
    v_accvgpr_read_b32 v82, a70
    v_accvgpr_read_b32 v83, a71
    v_pk_fma_f32 v[76:77], v[76:77], v[4:5], v[230:231] op_sel:[0,0,0] op_sel_hi:[1,0,0]
    v_pk_fma_f32 v[78:79], v[78:79], v[4:5], v[230:231] op_sel:[0,0,0] op_sel_hi:[1,0,0]
    v_pk_fma_f32 v[80:81], v[80:81], v[4:5], v[230:231] op_sel:[0,0,0] op_sel_hi:[1,0,0]
    v_pk_fma_f32 v[82:83], v[82:83], v[4:5], v[230:231] op_sel:[0,0,0] op_sel_hi:[1,0,0]
    v_cvt_pk_bf16_f32 v76, v76, v77
    v_cvt_pk_bf16_f32 v77, v78, v79
    v_cvt_pk_bf16_f32 v78, v80, v81
    v_cvt_pk_bf16_f32 v79, v82, v83
    ds_write_b128 v10, v[76:79] offset:34816
    buffer_load_dwordx4 v[176:179], v252, s[24:27], s31 offen offset:1024 sc1
    v_accvgpr_read_b32 v84, a72
    v_accvgpr_read_b32 v85, a73
    v_accvgpr_read_b32 v86, a74
    v_accvgpr_read_b32 v87, a75
    v_accvgpr_read_b32 v88, a76
    v_accvgpr_read_b32 v89, a77
    v_accvgpr_read_b32 v90, a78
    v_accvgpr_read_b32 v91, a79
    v_pk_fma_f32 v[84:85], v[84:85], v[4:5], v[230:231] op_sel:[0,0,0] op_sel_hi:[1,0,0]
    v_pk_fma_f32 v[86:87], v[86:87], v[4:5], v[230:231] op_sel:[0,0,0] op_sel_hi:[1,0,0]
    v_pk_fma_f32 v[88:89], v[88:89], v[4:5], v[230:231] op_sel:[0,0,0] op_sel_hi:[1,0,0]
    v_pk_fma_f32 v[90:91], v[90:91], v[4:5], v[230:231] op_sel:[0,0,0] op_sel_hi:[1,0,0]
    v_cvt_pk_bf16_f32 v84, v84, v85
    v_cvt_pk_bf16_f32 v85, v86, v87
    v_cvt_pk_bf16_f32 v86, v88, v89
    v_cvt_pk_bf16_f32 v87, v90, v91
    ds_write_b128 v10, v[84:87] offset:38912
    buffer_load_dwordx4 v[180:183], v252, s[24:27], s31 offen offset:2048 sc1
    v_accvgpr_read_b32 v92, a80
    v_accvgpr_read_b32 v93, a81
    v_accvgpr_read_b32 v94, a82
    v_accvgpr_read_b32 v95, a83
    v_accvgpr_read_b32 v96, a84
    v_accvgpr_read_b32 v97, a85
    v_accvgpr_read_b32 v98, a86
    v_accvgpr_read_b32 v99, a87
    v_pk_fma_f32 v[92:93], v[92:93], v[4:5], v[230:231] op_sel:[0,0,0] op_sel_hi:[1,0,0]
    v_pk_fma_f32 v[94:95], v[94:95], v[4:5], v[230:231] op_sel:[0,0,0] op_sel_hi:[1,0,0]
    v_pk_fma_f32 v[96:97], v[96:97], v[4:5], v[230:231] op_sel:[0,0,0] op_sel_hi:[1,0,0]
    v_pk_fma_f32 v[98:99], v[98:99], v[4:5], v[230:231] op_sel:[0,0,0] op_sel_hi:[1,0,0]
    v_cvt_pk_bf16_f32 v92, v92, v93
    v_cvt_pk_bf16_f32 v93, v94, v95
    v_cvt_pk_bf16_f32 v94, v96, v97
    v_cvt_pk_bf16_f32 v95, v98, v99
    ds_write_b128 v11, v[92:95] offset:2048
    buffer_load_dwordx4 v[184:187], v252, s[24:27], s31 offen offset:3072 sc1
    v_accvgpr_read_b32 v100, a88
    v_accvgpr_read_b32 v101, a89
    v_accvgpr_read_b32 v102, a90
    v_accvgpr_read_b32 v103, a91
    v_accvgpr_read_b32 v104, a92
    v_accvgpr_read_b32 v105, a93
    v_accvgpr_read_b32 v106, a94
    v_accvgpr_read_b32 v107, a95
    v_pk_fma_f32 v[100:101], v[100:101], v[4:5], v[230:231] op_sel:[0,0,0] op_sel_hi:[1,0,0]
    v_pk_fma_f32 v[102:103], v[102:103], v[4:5], v[230:231] op_sel:[0,0,0] op_sel_hi:[1,0,0]
    v_pk_fma_f32 v[104:105], v[104:105], v[4:5], v[230:231] op_sel:[0,0,0] op_sel_hi:[1,0,0]
    v_pk_fma_f32 v[106:107], v[106:107], v[4:5], v[230:231] op_sel:[0,0,0] op_sel_hi:[1,0,0]
    v_cvt_pk_bf16_f32 v100, v100, v101
    v_cvt_pk_bf16_f32 v101, v102, v103
    v_cvt_pk_bf16_f32 v102, v104, v105
    v_cvt_pk_bf16_f32 v103, v106, v107
    ds_write_b128 v11, v[100:103] offset:6144
    s_add_u32 s31, s64, 57344
    buffer_load_dwordx4 v[188:191], v252, s[24:27], s31 offen offset:0 sc1
    v_accvgpr_read_b32 v76, a96
    v_accvgpr_read_b32 v77, a97
    v_accvgpr_read_b32 v78, a98
    v_accvgpr_read_b32 v79, a99
    v_accvgpr_read_b32 v80, a100
    v_accvgpr_read_b32 v81, a101
    v_accvgpr_read_b32 v82, a102
    v_accvgpr_read_b32 v83, a103
    v_pk_fma_f32 v[76:77], v[76:77], v[4:5], v[230:231] op_sel:[0,1,1] op_sel_hi:[1,1,1]
    v_pk_fma_f32 v[78:79], v[78:79], v[4:5], v[230:231] op_sel:[0,1,1] op_sel_hi:[1,1,1]
    v_pk_fma_f32 v[80:81], v[80:81], v[4:5], v[230:231] op_sel:[0,1,1] op_sel_hi:[1,1,1]
    v_pk_fma_f32 v[82:83], v[82:83], v[4:5], v[230:231] op_sel:[0,1,1] op_sel_hi:[1,1,1]
    v_cvt_pk_bf16_f32 v76, v76, v77
    v_cvt_pk_bf16_f32 v77, v78, v79
    v_cvt_pk_bf16_f32 v78, v80, v81
    v_cvt_pk_bf16_f32 v79, v82, v83
    ds_write_b128 v10, v[76:79] offset:35840
    buffer_load_dwordx4 v[192:195], v252, s[24:27], s31 offen offset:1024 sc1
    v_accvgpr_read_b32 v84, a104
    v_accvgpr_read_b32 v85, a105
    v_accvgpr_read_b32 v86, a106
    v_accvgpr_read_b32 v87, a107
    v_accvgpr_read_b32 v88, a108
    v_accvgpr_read_b32 v89, a109
    v_accvgpr_read_b32 v90, a110
    v_accvgpr_read_b32 v91, a111
    v_pk_fma_f32 v[84:85], v[84:85], v[4:5], v[230:231] op_sel:[0,1,1] op_sel_hi:[1,1,1]
    v_pk_fma_f32 v[86:87], v[86:87], v[4:5], v[230:231] op_sel:[0,1,1] op_sel_hi:[1,1,1]
    v_pk_fma_f32 v[88:89], v[88:89], v[4:5], v[230:231] op_sel:[0,1,1] op_sel_hi:[1,1,1]
    v_pk_fma_f32 v[90:91], v[90:91], v[4:5], v[230:231] op_sel:[0,1,1] op_sel_hi:[1,1,1]
    v_cvt_pk_bf16_f32 v84, v84, v85
    v_cvt_pk_bf16_f32 v85, v86, v87
    v_cvt_pk_bf16_f32 v86, v88, v89
    v_cvt_pk_bf16_f32 v87, v90, v91
    ds_write_b128 v10, v[84:87] offset:39936
    buffer_load_dwordx4 v[196:199], v252, s[24:27], s31 offen offset:2048 sc1
    v_accvgpr_read_b32 v92, a112
    v_accvgpr_read_b32 v93, a113
    v_accvgpr_read_b32 v94, a114
    v_accvgpr_read_b32 v95, a115
    v_accvgpr_read_b32 v96, a116
    v_accvgpr_read_b32 v97, a117
    v_accvgpr_read_b32 v98, a118
    v_accvgpr_read_b32 v99, a119
    v_pk_fma_f32 v[92:93], v[92:93], v[4:5], v[230:231] op_sel:[0,1,1] op_sel_hi:[1,1,1]
    v_pk_fma_f32 v[94:95], v[94:95], v[4:5], v[230:231] op_sel:[0,1,1] op_sel_hi:[1,1,1]
    v_pk_fma_f32 v[96:97], v[96:97], v[4:5], v[230:231] op_sel:[0,1,1] op_sel_hi:[1,1,1]
    v_pk_fma_f32 v[98:99], v[98:99], v[4:5], v[230:231] op_sel:[0,1,1] op_sel_hi:[1,1,1]
    v_cvt_pk_bf16_f32 v92, v92, v93
    v_cvt_pk_bf16_f32 v93, v94, v95
    v_cvt_pk_bf16_f32 v94, v96, v97
    v_cvt_pk_bf16_f32 v95, v98, v99
    ds_write_b128 v11, v[92:95] offset:3072
    buffer_load_dwordx4 v[200:203], v252, s[24:27], s31 offen offset:3072 sc1
    v_accvgpr_read_b32 v100, a120
    v_accvgpr_read_b32 v101, a121
    v_accvgpr_read_b32 v102, a122
    v_accvgpr_read_b32 v103, a123
    v_accvgpr_read_b32 v104, a124
    v_accvgpr_read_b32 v105, a125
    v_accvgpr_read_b32 v106, a126
    v_accvgpr_read_b32 v107, a127
    v_pk_fma_f32 v[100:101], v[100:101], v[4:5], v[230:231] op_sel:[0,1,1] op_sel_hi:[1,1,1]
    v_pk_fma_f32 v[102:103], v[102:103], v[4:5], v[230:231] op_sel:[0,1,1] op_sel_hi:[1,1,1]
    v_pk_fma_f32 v[104:105], v[104:105], v[4:5], v[230:231] op_sel:[0,1,1] op_sel_hi:[1,1,1]
    v_pk_fma_f32 v[106:107], v[106:107], v[4:5], v[230:231] op_sel:[0,1,1] op_sel_hi:[1,1,1]
    v_cvt_pk_bf16_f32 v100, v100, v101
    v_cvt_pk_bf16_f32 v101, v102, v103
    v_cvt_pk_bf16_f32 v102, v104, v105
    v_cvt_pk_bf16_f32 v103, v106, v107
    ds_write_b128 v11, v[100:103] offset:7168
    s_waitcnt lgkmcnt(0)
    s_barrier
    ds_read_b128 a[0:3], v252 offset:32768
    ds_read_b128 a[4:7], v252 offset:36864
    ds_read_b128 a[8:11], v253 offset:0
    ds_read_b128 a[12:15], v253 offset:4096
    ds_read_b128 a[28:31], v253 offset:5120
    ds_read_b128 a[24:27], v253 offset:1024
    ds_read_b128 a[20:23], v252 offset:37888
    v_mov_b32 v2, s45
    s_waitcnt vmcnt(28)
    s_waitcnt lgkmcnt(6)
    v_mfma_f32_16x16x32_bf16 v[76:79], a[128:131], a[0:3], 0
    ds_read_b128 a[16:19], v252 offset:33792
    s_waitcnt lgkmcnt(6)
    v_mfma_f32_16x16x32_bf16 v[76:79], a[132:135], a[4:7], v[76:79]
    ds_read_b128 a[32:35], v252 offset:34816
    s_waitcnt lgkmcnt(6)
    v_mfma_f32_16x16x32_bf16 v[76:79], a[136:139], a[8:11], v[76:79]
    ds_read_b128 a[36:39], v252 offset:38912
    s_waitcnt lgkmcnt(6)
    v_mfma_f32_16x16x32_bf16 v[76:79], a[140:143], a[12:15], v[76:79]
    ds_read_b128 a[40:43], v253 offset:2048
    s_waitcnt lgkmcnt(6)
    v_mfma_f32_16x16x32_bf16 v[80:83], a[140:143], a[28:31], 0
    ds_read_b128 a[44:47], v253 offset:6144
    s_waitcnt lgkmcnt(6)
    v_mfma_f32_16x16x32_bf16 v[80:83], a[136:139], a[24:27], v[80:83]
    ds_read_b128 a[60:63], v253 offset:7168
    s_waitcnt lgkmcnt(6)
    v_mfma_f32_16x16x32_bf16 v[80:83], a[132:135], a[20:23], v[80:83]
    ds_read_b128 a[56:59], v253 offset:3072
    s_waitcnt lgkmcnt(6)
    v_mfma_f32_16x16x32_bf16 v[80:83], a[128:131], a[16:19], v[80:83]
    ds_read_b128 a[52:55], v252 offset:39936
    s_waitcnt lgkmcnt(6)
    v_mfma_f32_16x16x32_bf16 v[84:87], a[128:131], a[32:35], 0
    ds_read_b128 a[48:51], v252 offset:35840
    s_waitcnt lgkmcnt(6)
    v_mfma_f32_16x16x32_bf16 v[84:87], a[132:135], a[36:39], v[84:87]
    ds_read_b128 v[12:15], v9 offset:0
    s_waitcnt lgkmcnt(6)
    v_mfma_f32_16x16x32_bf16 v[84:87], a[136:139], a[40:43], v[84:87]
    ds_read_b128 v[16:19], v9 offset:1024
    s_waitcnt lgkmcnt(6)
    v_mfma_f32_16x16x32_bf16 v[84:87], a[140:143], a[44:47], v[84:87]
    ds_read_b128 v[20:23], v9 offset:2048
    s_waitcnt lgkmcnt(6)
    v_mfma_f32_16x16x32_bf16 v[88:91], a[140:143], a[60:63], 0
    ds_read_b128 v[24:27], v9 offset:3072
    s_waitcnt lgkmcnt(6)
    v_mfma_f32_16x16x32_bf16 v[88:91], a[136:139], a[56:59], v[88:91]
    ds_read_b128 a[64:67], v252 offset:40960
    s_waitcnt lgkmcnt(6)
    v_mfma_f32_16x16x32_bf16 v[88:91], a[132:135], a[52:55], v[88:91]
    ds_read_b128 a[68:71], v252 offset:45056
    s_waitcnt lgkmcnt(6)
    v_mfma_f32_16x16x32_bf16 v[88:91], a[128:131], a[48:51], v[88:91]
    ds_read_b128 a[72:75], v253 offset:8192
    s_waitcnt vmcnt(24)
    v_mfma_f32_16x16x32_bf16 v[104:107], a[144:147], a[48:51], 0
    ds_read_b128 a[76:79], v253 offset:12288
    v_mfma_f32_16x16x32_bf16 v[104:107], a[148:151], a[52:55], v[104:107]
    s_waitcnt lgkmcnt(4)
    s_add_u32 s29, s64, 61440
    s_add_u32 m0, s17, 0
    s_nop 0
    buffer_load_dwordx4 v252, s[24:27], s29 offen offset:0 sc1 lds
    v_mfma_f32_16x16x32_bf16 v[104:107], a[152:155], a[56:59], v[104:107]
    ds_read_b128 a[92:95], v253 offset:13312
    v_mfma_f32_16x16x32_bf16 v[104:107], a[156:159], a[60:63], v[104:107]
    ds_read_b128 a[88:91], v253 offset:9216
    v_mfma_f32_16x16x32_bf16 v[100:103], a[156:159], a[44:47], 0
    ds_read_b128 a[84:87], v252 offset:46080
    v_mfma_f32_16x16x32_bf16 v[100:103], a[152:155], a[40:43], v[100:103]
    buffer_load_dwordx4 v252, s[24:27], s29 offen offset:1024 sc1 lds
    v_mfma_f32_16x16x32_bf16 v[100:103], a[148:151], a[36:39], v[100:103]
    ds_read_b128 a[80:83], v252 offset:41984
    v_mfma_f32_16x16x32_bf16 v[100:103], a[144:147], a[32:35], v[100:103]
    ds_read_b128 a[96:99], v252 offset:43008
    v_mfma_f32_16x16x32_bf16 v[96:99], a[144:147], a[16:19], 0
    ds_read_b128 a[100:103], v252 offset:47104
    v_mfma_f32_16x16x32_bf16 v[96:99], a[148:151], a[20:23], v[96:99]
    ds_read_b128 a[104:107], v253 offset:10240
    v_mfma_f32_16x16x32_bf16 v[96:99], a[152:155], a[24:27], v[96:99]
    buffer_load_dwordx4 v252, s[24:27], s29 offen offset:2048 sc1 lds
    v_mfma_f32_16x16x32_bf16 v[96:99], a[156:159], a[28:31], v[96:99]
    ds_read_b128 a[108:111], v253 offset:14336
    v_mfma_f32_16x16x32_bf16 v[92:95], a[156:159], a[12:15], 0
    ds_read_b128 a[124:127], v253 offset:15360
    v_mfma_f32_16x16x32_bf16 v[92:95], a[152:155], a[8:11], v[92:95]
    ds_read_b128 a[120:123], v253 offset:11264
    v_mfma_f32_16x16x32_bf16 v[92:95], a[148:151], a[4:7], v[92:95]
    buffer_load_dwordx4 v252, s[24:27], s29 offen offset:3072 sc1 lds
    v_mfma_f32_16x16x32_bf16 v[92:95], a[144:147], a[0:3], v[92:95]
    ds_read_b128 a[116:119], v252 offset:48128
    s_waitcnt vmcnt(24)
    s_waitcnt lgkmcnt(14)
    v_mfma_f32_16x16x32_bf16 v[76:79], a[160:163], a[64:67], v[76:79]
    ds_read_b128 a[112:115], v252 offset:44032
    s_waitcnt lgkmcnt(14)
    v_mfma_f32_16x16x32_bf16 v[76:79], a[164:167], a[68:71], v[76:79]
    ds_read_b128 v[28:31], v204 offset:0
    s_waitcnt lgkmcnt(14)
    v_mfma_f32_16x16x32_bf16 v[76:79], a[168:171], a[72:75], v[76:79]
    ds_read_b128 v[32:35], v204 offset:1024
    s_waitcnt lgkmcnt(14)
    v_mfma_f32_16x16x32_bf16 v[76:79], a[172:175], a[76:79], v[76:79]
    ds_read_b128 v[36:39], v204 offset:2048
    s_waitcnt lgkmcnt(14)
    v_mfma_f32_16x16x32_bf16 v[80:83], a[172:175], a[92:95], v[80:83]
    ds_read_b128 v[40:43], v204 offset:3072
    s_waitcnt lgkmcnt(14)
    v_mfma_f32_16x16x32_bf16 v[80:83], a[168:171], a[88:91], v[80:83]
    ds_read_b128 v[44:47], v9 offset:16384
    s_waitcnt lgkmcnt(14)
    v_mfma_f32_16x16x32_bf16 v[80:83], a[164:167], a[84:87], v[80:83]
    ds_read_b128 v[48:51], v9 offset:17408
    s_waitcnt lgkmcnt(14)
    v_mfma_f32_16x16x32_bf16 v[80:83], a[160:163], a[80:83], v[80:83]
    ds_read_b128 v[52:55], v9 offset:18432
    s_waitcnt lgkmcnt(14)
    v_mfma_f32_16x16x32_bf16 v[84:87], a[160:163], a[96:99], v[84:87]
    ds_read_b128 v[56:59], v9 offset:19456
    s_waitcnt lgkmcnt(14)
    v_mfma_f32_16x16x32_bf16 v[84:87], a[164:167], a[100:103], v[84:87]
    s_waitcnt lgkmcnt(4)
    s_add_u32 s29, s64, 69632
    s_add_u32 m0, s17, 65536
    s_nop 0
    buffer_load_dwordx4 v252, s[24:27], s29 offen offset:0 sc1 lds
    v_mfma_f32_16x16x32_bf16 v[84:87], a[168:171], a[104:107], v[84:87]
    ds_read_b128 a[192:195], v252 offset:49152
    v_mfma_f32_16x16x32_bf16 v[84:87], a[172:175], a[108:111], v[84:87]
    ds_read_b128 a[196:199], v252 offset:53248
    v_mfma_f32_16x16x32_bf16 v[88:91], a[172:175], a[124:127], v[88:91]
    ds_read_b128 a[200:203], v253 offset:16384
    v_mfma_f32_16x16x32_bf16 v[88:91], a[168:171], a[120:123], v[88:91]
    buffer_load_dwordx4 v252, s[24:27], s29 offen offset:1024 sc1 lds
    v_mfma_f32_16x16x32_bf16 v[88:91], a[164:167], a[116:119], v[88:91]
    ds_read_b128 a[204:207], v253 offset:20480
    v_mfma_f32_16x16x32_bf16 v[88:91], a[160:163], a[112:115], v[88:91]
    ds_read_b128 a[220:223], v253 offset:21504
    s_waitcnt vmcnt(22)
    v_mfma_f32_16x16x32_bf16 v[104:107], a[176:179], a[112:115], v[104:107]
    ds_read_b128 a[216:219], v253 offset:17408
    v_mfma_f32_16x16x32_bf16 v[104:107], a[180:183], a[116:119], v[104:107]
    ds_read_b128 a[212:215], v252 offset:54272
    v_mfma_f32_16x16x32_bf16 v[104:107], a[184:187], a[120:123], v[104:107]
    buffer_load_dwordx4 v252, s[24:27], s29 offen offset:2048 sc1 lds
    v_mfma_f32_16x16x32_bf16 v[104:107], a[188:191], a[124:127], v[104:107]
    ds_read_b128 a[208:211], v252 offset:50176
    v_mfma_f32_16x16x32_bf16 v[100:103], a[188:191], a[108:111], v[100:103]
    ds_read_b128 a[224:227], v252 offset:51200
    v_mfma_f32_16x16x32_bf16 v[100:103], a[184:187], a[104:107], v[100:103]
    ds_read_b128 a[228:231], v252 offset:55296
    v_mfma_f32_16x16x32_bf16 v[100:103], a[180:183], a[100:103], v[100:103]
    buffer_load_dwordx4 v252, s[24:27], s29 offen offset:3072 sc1 lds
    v_mfma_f32_16x16x32_bf16 v[100:103], a[176:179], a[96:99], v[100:103]
    ds_read_b128 a[232:235], v253 offset:18432
    v_mfma_f32_16x16x32_bf16 v[96:99], a[176:179], a[80:83], v[96:99]
    ds_read_b128 a[236:239], v253 offset:22528
    v_mfma_f32_16x16x32_bf16 v[96:99], a[180:183], a[84:87], v[96:99]
    ds_read_b128 a[252:255], v253 offset:23552
    v_mfma_f32_16x16x32_bf16 v[96:99], a[184:187], a[88:91], v[96:99]
    ds_read_b128 a[248:251], v253 offset:19456
    v_mfma_f32_16x16x32_bf16 v[96:99], a[188:191], a[92:95], v[96:99]
    s_waitcnt lgkmcnt(14)
    s_add_u32 s29, s64, 77824
    s_add_u32 m0, s17, 16384
    s_nop 0
    buffer_load_dwordx4 v252, s[24:27], s29 offen offset:0 sc1 lds
    v_mfma_f32_16x16x32_bf16 v[92:95], a[188:191], a[76:79], v[92:95]
    ds_read_b128 a[244:247], v252 offset:56320
    v_mfma_f32_16x16x32_bf16 v[92:95], a[184:187], a[72:75], v[92:95]
    ds_read_b128 a[240:243], v252 offset:52224
    v_mfma_f32_16x16x32_bf16 v[92:95], a[180:183], a[68:71], v[92:95]
    ds_read_b128 v[60:63], v204 offset:16384
    v_mfma_f32_16x16x32_bf16 v[92:95], a[176:179], a[64:67], v[92:95]
    ds_read_b128 v[64:67], v204 offset:17408
    s_waitcnt lgkmcnt(15)
    v_mfma_f32_16x16x32_bf16 v[76:79], v[12:15], a[192:195], v[76:79]
    buffer_load_dwordx4 v252, s[24:27], s29 offen offset:1024 sc1 lds
    v_mfma_f32_16x16x32_bf16 v[76:79], v[16:19], a[196:199], v[76:79]
    ds_read_b128 v[68:71], v204 offset:18432
    v_mfma_f32_16x16x32_bf16 v[76:79], v[20:23], a[200:203], v[76:79]
    ds_read_b128 v[72:75], v204 offset:19456
    s_waitcnt lgkmcnt(15)
    v_mfma_f32_16x16x32_bf16 v[76:79], v[24:27], a[204:207], v[76:79]
    ds_read_b128 a[128:131], v252 offset:57344
    v_mfma_f32_16x16x32_bf16 v[80:83], v[24:27], a[220:223], v[80:83]
    buffer_load_dwordx4 v252, s[24:27], s29 offen offset:2048 sc1 lds
    s_waitcnt lgkmcnt(15)
    v_mfma_f32_16x16x32_bf16 v[80:83], v[20:23], a[216:219], v[80:83]
    ds_read_b128 a[132:135], v252 offset:61440
    s_waitcnt lgkmcnt(15)
    v_mfma_f32_16x16x32_bf16 v[80:83], v[16:19], a[212:215], v[80:83]
    ds_read_b128 a[136:139], v253 offset:24576
    s_waitcnt lgkmcnt(15)
    v_mfma_f32_16x16x32_bf16 v[80:83], v[12:15], a[208:211], v[80:83]
    ds_read_b128 a[140:143], v253 offset:28672
    s_waitcnt lgkmcnt(15)
    v_mfma_f32_16x16x32_bf16 v[84:87], v[12:15], a[224:227], v[84:87]
    ds_read_b128 a[156:159], v253 offset:29696
    s_waitcnt lgkmcnt(15)
    v_mfma_f32_16x16x32_bf16 v[84:87], v[16:19], a[228:231], v[84:87]
    buffer_load_dwordx4 v252, s[24:27], s29 offen offset:3072 sc1 lds
    s_waitcnt lgkmcnt(14)
    v_mfma_f32_16x16x32_bf16 v[84:87], v[20:23], a[232:235], v[84:87]
    ds_read_b128 a[152:155], v253 offset:25600
    s_waitcnt lgkmcnt(14)
    v_mfma_f32_16x16x32_bf16 v[84:87], v[24:27], a[236:239], v[84:87]
    ds_read_b128 a[148:151], v252 offset:62464
    s_waitcnt lgkmcnt(14)
    v_mfma_f32_16x16x32_bf16 v[88:91], v[24:27], a[252:255], v[88:91]
    ds_read_b128 a[144:147], v252 offset:58368
    s_waitcnt lgkmcnt(14)
    v_mfma_f32_16x16x32_bf16 v[88:91], v[20:23], a[248:251], v[88:91]
    s_waitcnt lgkmcnt(8)
    s_add_u32 s29, s64, 102400
    s_add_u32 m0, s17, 81920
    s_nop 0
    buffer_load_dwordx4 v252, s[24:27], s29 offen offset:0 sc1 lds
    v_mfma_f32_16x16x32_bf16 v[88:91], v[16:19], a[244:247], v[88:91]
    ds_read_b128 a[160:163], v252 offset:59392
    v_mfma_f32_16x16x32_bf16 v[88:91], v[12:15], a[240:243], v[88:91]
    ds_read_b128 a[164:167], v252 offset:63488
    v_mfma_f32_16x16x32_bf16 v[104:107], v[28:31], a[240:243], v[104:107]
    ds_read_b128 a[168:171], v253 offset:26624
    v_mfma_f32_16x16x32_bf16 v[104:107], v[32:35], a[244:247], v[104:107]
    ds_read_b128 a[172:175], v253 offset:30720
    v_mfma_f32_16x16x32_bf16 v[104:107], v[36:39], a[248:251], v[104:107]
    buffer_load_dwordx4 v252, s[24:27], s29 offen offset:1024 sc1 lds
    v_mfma_f32_16x16x32_bf16 v[104:107], v[40:43], a[252:255], v[104:107]
    ds_read_b128 a[188:191], v253 offset:31744
    v_mfma_f32_16x16x32_bf16 v[100:103], v[40:43], a[236:239], v[100:103]
    s_lshl_b32 s28, s22, 21
    ds_read_b128 a[184:187], v253 offset:27648
    v_mfma_f32_16x16x32_bf16 v[100:103], v[36:39], a[232:235], v[100:103]
    s_lshl_b32 s30, s3, 16
    ds_read_b128 a[180:183], v252 offset:64512
    v_mfma_f32_16x16x32_bf16 v[100:103], v[32:35], a[228:231], v[100:103]
    s_add_u32 s28, s28, s30
    ds_read_b128 a[176:179], v252 offset:60416
    v_mfma_f32_16x16x32_bf16 v[100:103], v[28:31], a[224:227], v[100:103]
    s_add_u32 s28, s28, s17
    buffer_load_dwordx4 v252, s[24:27], s29 offen offset:2048 sc1 lds
    v_mfma_f32_16x16x32_bf16 v[96:99], v[28:31], a[208:211], v[96:99]
    s_add_u32 s28, s28, 4194304
    s_add_u32 s31, s64, 45056
    v_mfma_f32_16x16x32_bf16 v[96:99], v[32:35], a[212:215], v[96:99]
    s_lshr_b32 s30, s22, 1
    v_mfma_f32_16x16x32_bf16 v[96:99], v[36:39], a[216:219], v[96:99]
    s_lshl_b32 s30, s30, 14
    v_mfma_f32_16x16x32_bf16 v[96:99], v[40:43], a[220:223], v[96:99]
    s_add_u32 s32, s28, s30
    buffer_load_dwordx4 v252, s[24:27], s29 offen offset:3072 sc1 lds
    v_mfma_f32_16x16x32_bf16 v[92:95], v[40:43], a[204:207], v[92:95]
    s_xor_b32 s33, s32, 16384
    v_mfma_f32_16x16x32_bf16 v[92:95], v[36:39], a[200:203], v[92:95]
    s_xor_b32 s34, s32, 32768
    v_mfma_f32_16x16x32_bf16 v[92:95], v[32:35], a[196:199], v[92:95]
    s_xor_b32 s35, s32, 49152
    v_mfma_f32_16x16x32_bf16 v[92:95], v[28:31], a[192:195], v[92:95]
    s_lshl_b32 s65, s19, 16
    s_waitcnt lgkmcnt(15)
    v_mfma_f32_16x16x32_bf16 v[76:79], v[108:111], a[128:131], v[76:79]
    s_add_u32 s65, s65, s23
    buffer_load_dwordx4 v[12:15], v252, s[24:27], s31 offen offset:0 sc1
    s_waitcnt lgkmcnt(14)
    v_mfma_f32_16x16x32_bf16 v[76:79], v[112:115], a[132:135], v[76:79]
    s_add_u32 s65, s65, 524288
    s_waitcnt lgkmcnt(13)
    v_mfma_f32_16x16x32_bf16 v[76:79], v[116:119], a[136:139], v[76:79]
    s_lshl_b32 s93, s19, 14
    s_waitcnt lgkmcnt(12)
    v_mfma_f32_16x16x32_bf16 v[76:79], v[120:123], a[140:143], v[76:79]
    s_add_u32 s93, s93, s23
    s_waitcnt lgkmcnt(11)
    v_mfma_f32_16x16x32_bf16 v[80:83], v[120:123], a[156:159], v[80:83]
    s_add_u32 s93, s93, 917504
    buffer_load_dwordx4 v[16:19], v252, s[24:27], s31 offen offset:1024 sc1
    s_waitcnt lgkmcnt(10)
    v_mfma_f32_16x16x32_bf16 v[80:83], v[116:119], a[152:155], v[80:83]
    s_and_b32 s28, s19, 2
    s_waitcnt lgkmcnt(9)
    v_mfma_f32_16x16x32_bf16 v[80:83], v[112:115], a[148:151], v[80:83]
    s_lshl_b32 s28, s28, 14
    s_waitcnt lgkmcnt(8)
    v_mfma_f32_16x16x32_bf16 v[80:83], v[108:111], a[144:147], v[80:83]
    s_add_u32 s92, s93, s28
    s_waitcnt lgkmcnt(7)
    v_mfma_f32_16x16x32_bf16 v[84:87], v[108:111], a[160:163], v[84:87]
    s_sub_u32 s92, s92, 131072
    s_waitcnt lgkmcnt(6)
    v_mfma_f32_16x16x32_bf16 v[84:87], v[112:115], a[164:167], v[84:87]
    s_mul_i32 s66, s19, 57344
    buffer_load_dwordx4 v[20:23], v252, s[24:27], s31 offen offset:2048 sc1
    s_waitcnt lgkmcnt(5)
    v_mfma_f32_16x16x32_bf16 v[84:87], v[116:119], a[168:171], v[84:87]
    s_add_u32 s66, s66, s23
    s_waitcnt lgkmcnt(4)
    v_mfma_f32_16x16x32_bf16 v[84:87], v[120:123], a[172:175], v[84:87]
    s_add_u32 s66, s66, 983040
    s_waitcnt lgkmcnt(3)
    v_mfma_f32_16x16x32_bf16 v[88:91], v[120:123], a[188:191], v[88:91]
    s_waitcnt lgkmcnt(2)
    v_mfma_f32_16x16x32_bf16 v[88:91], v[116:119], a[184:187], v[88:91]
    s_waitcnt lgkmcnt(1)
    v_mfma_f32_16x16x32_bf16 v[88:91], v[112:115], a[180:183], v[88:91]
L_pg9:
    s_cbranch_execz L_pg13
    buffer_load_dwordx4 v[24:27], v252, s[24:27], s31 offen offset:3072 sc1
    s_waitcnt lgkmcnt(0)
    v_mfma_f32_16x16x32_bf16 v[88:91], v[108:111], a[176:179], v[88:91]
    s_waitcnt vmcnt(19)
    ds_read_b128 v[28:31], v9 offset:0
    v_mfma_f32_16x16x32_bf16 v[104:107], v[124:127], a[176:179], v[104:107]
    s_waitcnt vmcnt(18)
    ds_read_b128 v[32:35], v9 offset:1024
    v_mfma_f32_16x16x32_bf16 v[104:107], v[128:131], a[180:183], v[104:107]
    s_waitcnt vmcnt(17)
    ds_read_b128 v[36:39], v9 offset:2048
    v_mfma_f32_16x16x32_bf16 v[104:107], v[132:135], a[184:187], v[104:107]
    s_waitcnt vmcnt(16)
    ds_read_b128 v[40:43], v9 offset:3072
    v_mfma_f32_16x16x32_bf16 v[104:107], v[136:139], a[188:191], v[104:107]
    s_add_u32 s31, s64, 65536
    v_mfma_f32_16x16x32_bf16 v[100:103], v[136:139], a[172:175], v[100:103]
    v_mfma_f32_16x16x32_bf16 v[100:103], v[132:135], a[168:171], v[100:103]
    v_mfma_f32_16x16x32_bf16 v[100:103], v[128:131], a[164:167], v[100:103]
    v_mfma_f32_16x16x32_bf16 v[100:103], v[124:127], a[160:163], v[100:103]
    v_mfma_f32_16x16x32_bf16 v[96:99], v[124:127], a[144:147], v[96:99]
    v_mfma_f32_16x16x32_bf16 v[96:99], v[128:131], a[148:151], v[96:99]
    v_mfma_f32_16x16x32_bf16 v[96:99], v[132:135], a[152:155], v[96:99]
    v_mfma_f32_16x16x32_bf16 v[96:99], v[136:139], a[156:159], v[96:99]
    v_mfma_f32_16x16x32_bf16 v[92:95], v[136:139], a[140:143], v[92:95]
    v_mfma_f32_16x16x32_bf16 v[92:95], v[132:135], a[136:139], v[92:95]
    v_mfma_f32_16x16x32_bf16 v[92:95], v[128:131], a[132:135], v[92:95]
    v_mfma_f32_16x16x32_bf16 v[92:95], v[124:127], a[128:131], v[92:95]
    v_mfma_f32_16x16x32_bf16 v[108:111], v[44:47], a[0:3], 0
    v_mfma_f32_16x16x32_bf16 v[108:111], v[48:51], a[4:7], v[108:111]
    v_mfma_f32_16x16x32_bf16 v[108:111], v[52:55], a[8:11], v[108:111]
    v_mfma_f32_16x16x32_bf16 v[108:111], v[56:59], a[12:15], v[108:111]
    v_mfma_f32_16x16x32_bf16 v[112:115], v[56:59], a[28:31], 0
    v_cvt_pk_bf16_f32 v236, v88, v89
    v_cvt_pk_bf16_f32 v237, v90, v91
    v_mfma_f32_16x16x32_bf16 v[112:115], v[52:55], a[24:27], v[112:115]
    v_cvt_pk_bf16_f32 v238, v104, v105
    v_cvt_pk_bf16_f32 v239, v106, v107
    v_mfma_f32_16x16x32_bf16 v[112:115], v[48:51], a[20:23], v[112:115]
    buffer_store_dwordx4 v[236:239], v252, s[24:27], s35 offen offset:0 sc1
    v_mfma_f32_16x16x32_bf16 v[112:115], v[44:47], a[16:19], v[112:115]
    v_cvt_pk_bf16_f32 v232, v84, v85
    v_cvt_pk_bf16_f32 v233, v86, v87
    v_mfma_f32_16x16x32_bf16 v[116:119], v[44:47], a[32:35], 0
    v_cvt_pk_bf16_f32 v234, v100, v101
    v_cvt_pk_bf16_f32 v235, v102, v103
    v_mfma_f32_16x16x32_bf16 v[116:119], v[48:51], a[36:39], v[116:119]
    v_mfma_f32_16x16x32_bf16 v[116:119], v[52:55], a[40:43], v[116:119]
    buffer_store_dwordx4 v[232:235], v252, s[24:27], s34 offen offset:0 sc1
    v_mfma_f32_16x16x32_bf16 v[116:119], v[56:59], a[44:47], v[116:119]
    v_cvt_pk_bf16_f32 v228, v80, v81
    v_cvt_pk_bf16_f32 v229, v82, v83
    v_mfma_f32_16x16x32_bf16 v[120:123], v[56:59], a[60:63], 0
    v_cvt_pk_bf16_f32 v230, v96, v97
    v_cvt_pk_bf16_f32 v231, v98, v99
    v_mfma_f32_16x16x32_bf16 v[120:123], v[52:55], a[56:59], v[120:123]
    v_mfma_f32_16x16x32_bf16 v[120:123], v[48:51], a[52:55], v[120:123]
    v_mfma_f32_16x16x32_bf16 v[120:123], v[44:47], a[48:51], v[120:123]
    buffer_store_dwordx4 v[228:231], v252, s[24:27], s33 offen offset:0 sc1
    v_mfma_f32_16x16x32_bf16 v[136:139], v[60:63], a[48:51], 0
    v_cvt_pk_bf16_f32 v224, v76, v77
    v_cvt_pk_bf16_f32 v225, v78, v79
    v_mfma_f32_16x16x32_bf16 v[136:139], v[64:67], a[52:55], v[136:139]
    v_cvt_pk_bf16_f32 v226, v92, v93
    v_cvt_pk_bf16_f32 v227, v94, v95
    v_mfma_f32_16x16x32_bf16 v[136:139], v[68:71], a[56:59], v[136:139]
    v_mfma_f32_16x16x32_bf16 v[136:139], v[72:75], a[60:63], v[136:139]
    buffer_store_dwordx4 v[224:227], v245, s[24:27], s32 offen offset:0 sc1
    v_mfma_f32_16x16x32_bf16 v[132:135], v[72:75], a[44:47], 0
    ds_write_b128 v246, v[224:227] offset:0
    v_mfma_f32_16x16x32_bf16 v[132:135], v[68:71], a[40:43], v[132:135]
    v_mfma_f32_16x16x32_bf16 v[132:135], v[64:67], a[36:39], v[132:135]
    v_mfma_f32_16x16x32_bf16 v[132:135], v[60:63], a[32:35], v[132:135]
    v_mfma_f32_16x16x32_bf16 v[128:131], v[60:63], a[16:19], 0
    buffer_load_dwordx4 v[44:47], v252, s[24:27], s31 offen offset:0 sc1
    v_mfma_f32_16x16x32_bf16 v[128:131], v[64:67], a[20:23], v[128:131]
    v_mfma_f32_16x16x32_bf16 v[128:131], v[68:71], a[24:27], v[128:131]
    v_mfma_f32_16x16x32_bf16 v[128:131], v[72:75], a[28:31], v[128:131]
    v_mfma_f32_16x16x32_bf16 v[124:127], v[72:75], a[12:15], 0
    v_mfma_f32_16x16x32_bf16 v[124:127], v[68:71], a[8:11], v[124:127]
    buffer_load_dwordx4 v[48:51], v252, s[24:27], s31 offen offset:1024 sc1
    v_mfma_f32_16x16x32_bf16 v[124:127], v[64:67], a[4:7], v[124:127]
    v_mfma_f32_16x16x32_bf16 v[124:127], v[60:63], a[0:3], v[124:127]
    v_mfma_f32_16x16x32_bf16 v[108:111], v[140:143], a[64:67], v[108:111]
    v_mfma_f32_16x16x32_bf16 v[108:111], v[144:147], a[68:71], v[108:111]
    buffer_load_dwordx4 v[52:55], v252, s[24:27], s31 offen offset:2048 sc1
    v_mfma_f32_16x16x32_bf16 v[108:111], v[148:151], a[72:75], v[108:111]
    v_mfma_f32_16x16x32_bf16 v[108:111], v[152:155], a[76:79], v[108:111]
    v_mfma_f32_16x16x32_bf16 v[112:115], v[152:155], a[92:95], v[112:115]
    v_mfma_f32_16x16x32_bf16 v[112:115], v[148:151], a[88:91], v[112:115]
    v_mfma_f32_16x16x32_bf16 v[112:115], v[144:147], a[84:87], v[112:115]
    buffer_load_dwordx4 v[56:59], v252, s[24:27], s31 offen offset:3072 sc1
    v_mfma_f32_16x16x32_bf16 v[112:115], v[140:143], a[80:83], v[112:115]
    s_add_u32 s31, s64, 81920
    v_mfma_f32_16x16x32_bf16 v[116:119], v[140:143], a[96:99], v[116:119]
    v_mfma_f32_16x16x32_bf16 v[116:119], v[144:147], a[100:103], v[116:119]
    v_mfma_f32_16x16x32_bf16 v[116:119], v[148:151], a[104:107], v[116:119]
    buffer_load_dwordx4 v[60:63], v252, s[24:27], s31 offen offset:0 sc1
    v_mfma_f32_16x16x32_bf16 v[116:119], v[152:155], a[108:111], v[116:119]
    v_mfma_f32_16x16x32_bf16 v[120:123], v[152:155], a[124:127], v[120:123]
    v_mfma_f32_16x16x32_bf16 v[120:123], v[148:151], a[120:123], v[120:123]
    v_mfma_f32_16x16x32_bf16 v[120:123], v[144:147], a[116:119], v[120:123]
    v_mfma_f32_16x16x32_bf16 v[120:123], v[140:143], a[112:115], v[120:123]
    buffer_load_dwordx4 v[64:67], v252, s[24:27], s31 offen offset:1024 sc1
    v_mfma_f32_16x16x32_bf16 v[136:139], v[156:159], a[112:115], v[136:139]
    v_mfma_f32_16x16x32_bf16 v[136:139], v[160:163], a[116:119], v[136:139]
    v_mfma_f32_16x16x32_bf16 v[136:139], v[164:167], a[120:123], v[136:139]
    v_mfma_f32_16x16x32_bf16 v[136:139], v[168:171], a[124:127], v[136:139]
    v_mfma_f32_16x16x32_bf16 v[132:135], v[168:171], a[108:111], v[132:135]
    buffer_load_dwordx4 v[68:71], v252, s[24:27], s31 offen offset:2048 sc1
    v_mfma_f32_16x16x32_bf16 v[132:135], v[164:167], a[104:107], v[132:135]
    v_mfma_f32_16x16x32_bf16 v[132:135], v[160:163], a[100:103], v[132:135]
    v_mfma_f32_16x16x32_bf16 v[132:135], v[156:159], a[96:99], v[132:135]
    v_mfma_f32_16x16x32_bf16 v[128:131], v[156:159], a[80:83], v[128:131]
    buffer_load_dwordx4 v[72:75], v252, s[24:27], s31 offen offset:3072 sc1
    v_mfma_f32_16x16x32_bf16 v[128:131], v[160:163], a[84:87], v[128:131]
    s_waitcnt vmcnt(27)
    ds_read_b128 v[140:143], v204 offset:0
    v_mfma_f32_16x16x32_bf16 v[128:131], v[164:167], a[88:91], v[128:131]
    s_waitcnt vmcnt(26)
    ds_read_b128 v[144:147], v204 offset:1024
    v_mfma_f32_16x16x32_bf16 v[128:131], v[168:171], a[92:95], v[128:131]
    s_waitcnt vmcnt(25)
    ds_read_b128 v[148:151], v204 offset:2048
    v_mfma_f32_16x16x32_bf16 v[124:127], v[168:171], a[76:79], v[124:127]
    s_waitcnt vmcnt(24)
    ds_read_b128 v[152:155], v204 offset:3072
    v_mfma_f32_16x16x32_bf16 v[124:127], v[164:167], a[72:75], v[124:127]
    s_add_u32 s31, s64, 86016
    v_mfma_f32_16x16x32_bf16 v[124:127], v[160:163], a[68:71], v[124:127]
    v_mfma_f32_16x16x32_bf16 v[124:127], v[156:159], a[64:67], v[124:127]
    buffer_load_dwordx4 v[156:159], v252, s[24:27], s31 offen offset:0 sc1
    v_mfma_f32_16x16x32_bf16 v[108:111], v[172:175], a[192:195], v[108:111]
    v_mfma_f32_16x16x32_bf16 v[108:111], v[176:179], a[196:199], v[108:111]
    v_mfma_f32_16x16x32_bf16 v[108:111], v[180:183], a[200:203], v[108:111]
    v_mfma_f32_16x16x32_bf16 v[108:111], v[184:187], a[204:207], v[108:111]
    buffer_load_dwordx4 v[160:163], v252, s[24:27], s31 offen offset:1024 sc1
    v_mfma_f32_16x16x32_bf16 v[112:115], v[184:187], a[220:223], v[112:115]
    v_mfma_f32_16x16x32_bf16 v[112:115], v[180:183], a[216:219], v[112:115]
    v_mfma_f32_16x16x32_bf16 v[112:115], v[176:179], a[212:215], v[112:115]
    v_mfma_f32_16x16x32_bf16 v[112:115], v[172:175], a[208:211], v[112:115]
    v_mfma_f32_16x16x32_bf16 v[116:119], v[172:175], a[224:227], v[116:119]
    buffer_load_dwordx4 v[164:167], v252, s[24:27], s31 offen offset:2048 sc1
    v_mfma_f32_16x16x32_bf16 v[116:119], v[176:179], a[228:231], v[116:119]
    v_mfma_f32_16x16x32_bf16 v[116:119], v[180:183], a[232:235], v[116:119]
    v_mfma_f32_16x16x32_bf16 v[116:119], v[184:187], a[236:239], v[116:119]
    v_mfma_f32_16x16x32_bf16 v[120:123], v[184:187], a[252:255], v[120:123]
    buffer_load_dwordx4 v[168:171], v252, s[24:27], s31 offen offset:3072 sc1
    v_mfma_f32_16x16x32_bf16 v[120:123], v[180:183], a[248:251], v[120:123]
    s_add_u32 s31, s64, 73728
    v_mfma_f32_16x16x32_bf16 v[120:123], v[176:179], a[244:247], v[120:123]
    v_mfma_f32_16x16x32_bf16 v[120:123], v[172:175], a[240:243], v[120:123]
    v_mfma_f32_16x16x32_bf16 v[136:139], v[188:191], a[240:243], v[136:139]
    v_mfma_f32_16x16x32_bf16 v[136:139], v[192:195], a[244:247], v[136:139]
    buffer_load_dwordx4 v[172:175], v252, s[24:27], s31 offen offset:0 sc1
    v_mfma_f32_16x16x32_bf16 v[136:139], v[196:199], a[248:251], v[136:139]
    v_mfma_f32_16x16x32_bf16 v[136:139], v[200:203], a[252:255], v[136:139]
    v_mfma_f32_16x16x32_bf16 v[132:135], v[200:203], a[236:239], v[132:135]
    v_mfma_f32_16x16x32_bf16 v[132:135], v[196:199], a[232:235], v[132:135]
    v_mfma_f32_16x16x32_bf16 v[132:135], v[192:195], a[228:231], v[132:135]
    buffer_load_dwordx4 v[176:179], v252, s[24:27], s31 offen offset:1024 sc1
    v_mfma_f32_16x16x32_bf16 v[132:135], v[188:191], a[224:227], v[132:135]
    v_mfma_f32_16x16x32_bf16 v[128:131], v[188:191], a[208:211], v[128:131]
    v_mfma_f32_16x16x32_bf16 v[128:131], v[192:195], a[212:215], v[128:131]
    v_mfma_f32_16x16x32_bf16 v[128:131], v[196:199], a[216:219], v[128:131]
    buffer_load_dwordx4 v[180:183], v252, s[24:27], s31 offen offset:2048 sc1
    v_mfma_f32_16x16x32_bf16 v[128:131], v[200:203], a[220:223], v[128:131]
    v_mfma_f32_16x16x32_bf16 v[124:127], v[200:203], a[204:207], v[124:127]
    v_mfma_f32_16x16x32_bf16 v[124:127], v[196:199], a[200:203], v[124:127]
    v_mfma_f32_16x16x32_bf16 v[124:127], v[192:195], a[196:199], v[124:127]
    v_mfma_f32_16x16x32_bf16 v[124:127], v[188:191], a[192:195], v[124:127]
    buffer_load_dwordx4 v[184:187], v252, s[24:27], s31 offen offset:3072 sc1
    s_waitcnt vmcnt(20)
    v_mfma_f32_16x16x32_bf16 v[108:111], v[12:15], a[128:131], v[108:111]
    s_add_u32 s31, s64, 90112
    v_mfma_f32_16x16x32_bf16 v[108:111], v[16:19], a[132:135], v[108:111]
    v_mfma_f32_16x16x32_bf16 v[108:111], v[20:23], a[136:139], v[108:111]
    v_mfma_f32_16x16x32_bf16 v[108:111], v[24:27], a[140:143], v[108:111]
    buffer_load_dwordx4 v[188:191], v252, s[24:27], s31 offen offset:0 sc1
    v_mfma_f32_16x16x32_bf16 v[112:115], v[24:27], a[156:159], v[112:115]
    v_mfma_f32_16x16x32_bf16 v[112:115], v[20:23], a[152:155], v[112:115]
    v_mfma_f32_16x16x32_bf16 v[112:115], v[16:19], a[148:151], v[112:115]
    v_mfma_f32_16x16x32_bf16 v[112:115], v[12:15], a[144:147], v[112:115]
    v_mfma_f32_16x16x32_bf16 v[116:119], v[12:15], a[160:163], v[116:119]
    buffer_load_dwordx4 v[192:195], v252, s[24:27], s31 offen offset:1024 sc1
    v_mfma_f32_16x16x32_bf16 v[116:119], v[16:19], a[164:167], v[116:119]
    v_mfma_f32_16x16x32_bf16 v[116:119], v[20:23], a[168:171], v[116:119]
    v_mfma_f32_16x16x32_bf16 v[116:119], v[24:27], a[172:175], v[116:119]
    v_mfma_f32_16x16x32_bf16 v[120:123], v[24:27], a[188:191], v[120:123]
    v_mfma_f32_16x16x32_bf16 v[120:123], v[20:23], a[184:187], v[120:123]
    buffer_load_dwordx4 v[196:199], v252, s[24:27], s31 offen offset:2048 sc1
    v_mfma_f32_16x16x32_bf16 v[120:123], v[16:19], a[180:183], v[120:123]
    v_mfma_f32_16x16x32_bf16 v[120:123], v[12:15], a[176:179], v[120:123]
    s_waitcnt lgkmcnt(5)
    v_mfma_f32_16x16x32_bf16 v[136:139], v[28:31], a[176:179], v[136:139]
    v_mfma_f32_16x16x32_bf16 v[136:139], v[32:35], a[180:183], v[136:139]
    buffer_load_dwordx4 v[200:203], v252, s[24:27], s31 offen offset:3072 sc1
    v_mfma_f32_16x16x32_bf16 v[136:139], v[36:39], a[184:187], v[136:139]
    ds_read_b128 v[12:15], v9 offset:16384
    v_mfma_f32_16x16x32_bf16 v[136:139], v[40:43], a[188:191], v[136:139]
    ds_read_b128 v[16:19], v9 offset:17408
    v_mfma_f32_16x16x32_bf16 v[132:135], v[40:43], a[172:175], v[132:135]
    ds_read_b128 v[20:23], v9 offset:18432
    v_mfma_f32_16x16x32_bf16 v[132:135], v[36:39], a[168:171], v[132:135]
    ds_read_b128 v[24:27], v9 offset:19456
    v_mfma_f32_16x16x32_bf16 v[132:135], v[32:35], a[164:167], v[132:135]
    s_add_u32 s31, s64, 94208
    v_mfma_f32_16x16x32_bf16 v[132:135], v[28:31], a[160:163], v[132:135]
    v_mfma_f32_16x16x32_bf16 v[128:131], v[28:31], a[144:147], v[128:131]
    v_mfma_f32_16x16x32_bf16 v[128:131], v[32:35], a[148:151], v[128:131]
    v_mfma_f32_16x16x32_bf16 v[128:131], v[36:39], a[152:155], v[128:131]
    v_mfma_f32_16x16x32_bf16 v[128:131], v[40:43], a[156:159], v[128:131]
    v_mfma_f32_16x16x32_bf16 v[124:127], v[40:43], a[140:143], v[124:127]
    v_mfma_f32_16x16x32_bf16 v[124:127], v[36:39], a[136:139], v[124:127]
    v_mfma_f32_16x16x32_bf16 v[124:127], v[32:35], a[132:135], v[124:127]
    v_mfma_f32_16x16x32_bf16 v[124:127], v[28:31], a[128:131], v[124:127]
    buffer_load_dwordx4 v[28:31], v252, s[24:27], s31 offen offset:0 sc1
    s_waitcnt vmcnt(17)
    v_mfma_f32_16x16x32_bf16 v[76:79], v[44:47], a[0:3], 0
    v_mfma_f32_16x16x32_bf16 v[76:79], v[48:51], a[4:7], v[76:79]
    v_mfma_f32_16x16x32_bf16 v[76:79], v[52:55], a[8:11], v[76:79]
    v_mfma_f32_16x16x32_bf16 v[76:79], v[56:59], a[12:15], v[76:79]
    buffer_load_dwordx4 v[32:35], v252, s[24:27], s31 offen offset:1024 sc1
    v_mfma_f32_16x16x32_bf16 v[80:83], v[56:59], a[28:31], 0
    v_cvt_pk_bf16_f32 v236, v120, v121
    v_cvt_pk_bf16_f32 v237, v122, v123
    v_mfma_f32_16x16x32_bf16 v[80:83], v[52:55], a[24:27], v[80:83]
    v_cvt_pk_bf16_f32 v238, v136, v137
    v_cvt_pk_bf16_f32 v239, v138, v139
    v_mfma_f32_16x16x32_bf16 v[80:83], v[48:51], a[20:23], v[80:83]
    v_mfma_f32_16x16x32_bf16 v[80:83], v[44:47], a[16:19], v[80:83]
    v_mfma_f32_16x16x32_bf16 v[84:87], v[44:47], a[32:35], 0
    buffer_store_dwordx4 v[236:239], v252, s[24:27], s35 offen offset:1024 sc1
    v_mfma_f32_16x16x32_bf16 v[84:87], v[48:51], a[36:39], v[84:87]
    v_cvt_pk_bf16_f32 v232, v116, v117
    v_cvt_pk_bf16_f32 v233, v118, v119
    v_mfma_f32_16x16x32_bf16 v[84:87], v[52:55], a[40:43], v[84:87]
    v_cvt_pk_bf16_f32 v234, v132, v133
    v_cvt_pk_bf16_f32 v235, v134, v135
    v_mfma_f32_16x16x32_bf16 v[84:87], v[56:59], a[44:47], v[84:87]
    v_mfma_f32_16x16x32_bf16 v[88:91], v[56:59], a[60:63], 0
    buffer_store_dwordx4 v[232:235], v252, s[24:27], s34 offen offset:1024 sc1
    v_mfma_f32_16x16x32_bf16 v[88:91], v[52:55], a[56:59], v[88:91]
    v_cvt_pk_bf16_f32 v228, v112, v113
    v_cvt_pk_bf16_f32 v229, v114, v115
    v_mfma_f32_16x16x32_bf16 v[88:91], v[48:51], a[52:55], v[88:91]
    v_cvt_pk_bf16_f32 v230, v128, v129
    v_cvt_pk_bf16_f32 v231, v130, v131
    v_mfma_f32_16x16x32_bf16 v[88:91], v[44:47], a[48:51], v[88:91]
    s_waitcnt vmcnt(16)
    v_mfma_f32_16x16x32_bf16 v[104:107], v[60:63], a[48:51], 0
    v_mfma_f32_16x16x32_bf16 v[104:107], v[64:67], a[52:55], v[104:107]
    buffer_store_dwordx4 v[228:231], v252, s[24:27], s33 offen offset:1024 sc1
    v_mfma_f32_16x16x32_bf16 v[104:107], v[68:71], a[56:59], v[104:107]
    v_cvt_pk_bf16_f32 v224, v108, v109
    v_cvt_pk_bf16_f32 v225, v110, v111
    v_mfma_f32_16x16x32_bf16 v[104:107], v[72:75], a[60:63], v[104:107]
    v_cvt_pk_bf16_f32 v226, v124, v125
    v_cvt_pk_bf16_f32 v227, v126, v127
    v_mfma_f32_16x16x32_bf16 v[100:103], v[72:75], a[44:47], 0
    v_mfma_f32_16x16x32_bf16 v[100:103], v[68:71], a[40:43], v[100:103]
    v_mfma_f32_16x16x32_bf16 v[100:103], v[64:67], a[36:39], v[100:103]
    buffer_store_dwordx4 v[224:227], v245, s[24:27], s32 offen offset:1024 sc1
    v_mfma_f32_16x16x32_bf16 v[100:103], v[60:63], a[32:35], v[100:103]
    ds_write_b128 v246, v[224:227] offset:1024
    v_mfma_f32_16x16x32_bf16 v[96:99], v[60:63], a[16:19], 0
    v_mfma_f32_16x16x32_bf16 v[96:99], v[64:67], a[20:23], v[96:99]
    v_mfma_f32_16x16x32_bf16 v[96:99], v[68:71], a[24:27], v[96:99]
    buffer_load_dwordx4 v[36:39], v252, s[24:27], s31 offen offset:2048 sc1
    v_mfma_f32_16x16x32_bf16 v[96:99], v[72:75], a[28:31], v[96:99]
    v_mfma_f32_16x16x32_bf16 v[92:95], v[72:75], a[12:15], 0
    v_mfma_f32_16x16x32_bf16 v[92:95], v[68:71], a[8:11], v[92:95]
    v_mfma_f32_16x16x32_bf16 v[92:95], v[64:67], a[4:7], v[92:95]
    v_mfma_f32_16x16x32_bf16 v[92:95], v[60:63], a[0:3], v[92:95]
    buffer_load_dwordx4 v[40:43], v252, s[24:27], s31 offen offset:3072 sc1
    s_waitcnt lgkmcnt(5)
    v_mfma_f32_16x16x32_bf16 v[76:79], v[140:143], a[64:67], v[76:79]
    s_add_u32 s31, s64, 98304
    v_mfma_f32_16x16x32_bf16 v[76:79], v[144:147], a[68:71], v[76:79]
    v_mfma_f32_16x16x32_bf16 v[76:79], v[148:151], a[72:75], v[76:79]
    v_mfma_f32_16x16x32_bf16 v[76:79], v[152:155], a[76:79], v[76:79]
    buffer_load_dwordx4 v[44:47], v252, s[24:27], s31 offen offset:0 sc1
    v_mfma_f32_16x16x32_bf16 v[80:83], v[152:155], a[92:95], v[80:83]
    v_mfma_f32_16x16x32_bf16 v[80:83], v[148:151], a[88:91], v[80:83]
    v_mfma_f32_16x16x32_bf16 v[80:83], v[144:147], a[84:87], v[80:83]
    v_mfma_f32_16x16x32_bf16 v[80:83], v[140:143], a[80:83], v[80:83]
    v_mfma_f32_16x16x32_bf16 v[84:87], v[140:143], a[96:99], v[84:87]
    buffer_load_dwordx4 v[48:51], v252, s[24:27], s31 offen offset:1024 sc1
    v_mfma_f32_16x16x32_bf16 v[84:87], v[144:147], a[100:103], v[84:87]
    v_mfma_f32_16x16x32_bf16 v[84:87], v[148:151], a[104:107], v[84:87]
    v_mfma_f32_16x16x32_bf16 v[84:87], v[152:155], a[108:111], v[84:87]
    v_mfma_f32_16x16x32_bf16 v[88:91], v[152:155], a[124:127], v[88:91]
    s_add_u32 s30, s38, 4194304
    v_mfma_f32_16x16x32_bf16 v[88:91], v[148:151], a[120:123], v[88:91]
    s_add_u32 s23, s22, 1
    buffer_load_dwordx4 v[52:55], v252, s[24:27], s31 offen offset:2048 sc1
    v_mfma_f32_16x16x32_bf16 v[88:91], v[144:147], a[116:119], v[88:91]
    s_and_b32 s23, s23, 7
    v_mfma_f32_16x16x32_bf16 v[88:91], v[140:143], a[112:115], v[88:91]
    s_lshl_b32 s23, s23, 21
    s_waitcnt vmcnt(19)
    v_mfma_f32_16x16x32_bf16 v[104:107], v[156:159], a[112:115], v[104:107]
    s_add_u32 s73, s23, s30
    v_mfma_f32_16x16x32_bf16 v[104:107], v[160:163], a[116:119], v[104:107]
    s_add_u32 s23, s22, 2
    buffer_load_dwordx4 v[56:59], v252, s[24:27], s31 offen offset:3072 sc1
    v_mfma_f32_16x16x32_bf16 v[104:107], v[164:167], a[120:123], v[104:107]
    s_and_b32 s23, s23, 7
    s_add_u32 s31, s64, 114688
    v_mfma_f32_16x16x32_bf16 v[104:107], v[168:171], a[124:127], v[104:107]
    s_lshl_b32 s23, s23, 21
    v_mfma_f32_16x16x32_bf16 v[100:103], v[168:171], a[108:111], v[100:103]
    s_add_u32 s74, s23, s30
    v_mfma_f32_16x16x32_bf16 v[100:103], v[164:167], a[104:107], v[100:103]
    s_add_u32 s23, s22, 3
    v_mfma_f32_16x16x32_bf16 v[100:103], v[160:163], a[100:103], v[100:103]
    s_and_b32 s23, s23, 7
    buffer_load_dwordx4 v[60:63], v252, s[24:27], s31 offen offset:0 sc1
    v_mfma_f32_16x16x32_bf16 v[100:103], v[156:159], a[96:99], v[100:103]
    s_lshl_b32 s23, s23, 21
    v_mfma_f32_16x16x32_bf16 v[96:99], v[156:159], a[80:83], v[96:99]
    s_add_u32 s75, s23, s30
    v_mfma_f32_16x16x32_bf16 v[96:99], v[160:163], a[84:87], v[96:99]
    s_add_u32 s23, s22, 4
    v_mfma_f32_16x16x32_bf16 v[96:99], v[164:167], a[88:91], v[96:99]
    s_and_b32 s23, s23, 7
    buffer_load_dwordx4 v[64:67], v252, s[24:27], s31 offen offset:1024 sc1
    v_mfma_f32_16x16x32_bf16 v[96:99], v[168:171], a[92:95], v[96:99]
    s_lshl_b32 s23, s23, 21
    v_mfma_f32_16x16x32_bf16 v[92:95], v[168:171], a[76:79], v[92:95]
    s_add_u32 s76, s23, s30
    v_mfma_f32_16x16x32_bf16 v[92:95], v[164:167], a[72:75], v[92:95]
    s_add_u32 s23, s22, 5
    v_mfma_f32_16x16x32_bf16 v[92:95], v[160:163], a[68:71], v[92:95]
    s_and_b32 s23, s23, 7
    v_mfma_f32_16x16x32_bf16 v[92:95], v[156:159], a[64:67], v[92:95]
    s_lshl_b32 s23, s23, 21
    buffer_load_dwordx4 v[68:71], v252, s[24:27], s31 offen offset:2048 sc1
    s_waitcnt vmcnt(19)
    v_mfma_f32_16x16x32_bf16 v[76:79], v[172:175], a[192:195], v[76:79]
    s_add_u32 s77, s23, s30
    v_mfma_f32_16x16x32_bf16 v[76:79], v[176:179], a[196:199], v[76:79]
    s_add_u32 s23, s22, 6
    v_mfma_f32_16x16x32_bf16 v[76:79], v[180:183], a[200:203], v[76:79]
    s_and_b32 s23, s23, 7
    v_mfma_f32_16x16x32_bf16 v[76:79], v[184:187], a[204:207], v[76:79]
    s_lshl_b32 s23, s23, 21
    v_mfma_f32_16x16x32_bf16 v[80:83], v[184:187], a[220:223], v[80:83]
    s_add_u32 s78, s23, s30
    buffer_load_dwordx4 v[72:75], v252, s[24:27], s31 offen offset:3072 sc1
    v_mfma_f32_16x16x32_bf16 v[80:83], v[180:183], a[216:219], v[80:83]
    s_add_u32 s23, s22, 7
    ds_read_b128 v[140:143], v204 offset:16384
    v_mfma_f32_16x16x32_bf16 v[80:83], v[176:179], a[212:215], v[80:83]
    s_and_b32 s23, s23, 7
    ds_read_b128 v[144:147], v204 offset:17408
    v_mfma_f32_16x16x32_bf16 v[80:83], v[172:175], a[208:211], v[80:83]
    s_lshl_b32 s23, s23, 21
    ds_read_b128 v[148:151], v204 offset:18432
    v_mfma_f32_16x16x32_bf16 v[84:87], v[172:175], a[224:227], v[84:87]
    s_add_u32 s79, s23, s30
    ds_read_b128 v[152:155], v204 offset:19456
    v_mfma_f32_16x16x32_bf16 v[84:87], v[176:179], a[228:231], v[84:87]
    s_mov_b32 s67, 0x101
    s_add_u32 s31, s64, 118784
    buffer_load_dwordx4 v[156:159], v252, s[24:27], s31 offen offset:0 sc1
    v_mfma_f32_16x16x32_bf16 v[84:87], v[180:183], a[232:235], v[84:87]
    s_mov_b32 s68, 0x101
    v_mfma_f32_16x16x32_bf16 v[84:87], v[184:187], a[236:239], v[84:87]
    s_mov_b32 s70, 0x8080
    v_mfma_f32_16x16x32_bf16 v[88:91], v[184:187], a[252:255], v[88:91]
    s_add_u32 s28, s45, 1
    v_lshl_add_u32 v5, v1, 13, v252
    v_add_u32 v5, 131072, v5
    v_mfma_f32_16x16x32_bf16 v[88:91], v[180:183], a[248:251], v[88:91]
    buffer_load_dwordx4 v[160:163], v252, s[24:27], s31 offen offset:1024 sc1
    v_mfma_f32_16x16x32_bf16 v[88:91], v[176:179], a[244:247], v[88:91]
    v_mfma_f32_16x16x32_bf16 v[88:91], v[172:175], a[240:243], v[88:91]
    s_waitcnt vmcnt(18)
    v_mfma_f32_16x16x32_bf16 v[104:107], v[188:191], a[240:243], v[104:107]
    v_mfma_f32_16x16x32_bf16 v[104:107], v[192:195], a[244:247], v[104:107]
    v_mfma_f32_16x16x32_bf16 v[104:107], v[196:199], a[248:251], v[104:107]
    buffer_load_dwordx4 v[164:167], v252, s[24:27], s31 offen offset:2048 sc1
    v_mfma_f32_16x16x32_bf16 v[104:107], v[200:203], a[252:255], v[104:107]
    v_mfma_f32_16x16x32_bf16 v[100:103], v[200:203], a[236:239], v[100:103]
    v_mfma_f32_16x16x32_bf16 v[100:103], v[196:199], a[232:235], v[100:103]
    v_mfma_f32_16x16x32_bf16 v[100:103], v[192:195], a[228:231], v[100:103]
    buffer_load_dwordx4 v[168:171], v252, s[24:27], s31 offen offset:3072 sc1
    v_mfma_f32_16x16x32_bf16 v[100:103], v[188:191], a[224:227], v[100:103]
    s_add_u32 s31, s64, 106496
    v_mfma_f32_16x16x32_bf16 v[96:99], v[188:191], a[208:211], v[96:99]
    v_mfma_f32_16x16x32_bf16 v[96:99], v[192:195], a[212:215], v[96:99]
    v_mfma_f32_16x16x32_bf16 v[96:99], v[196:199], a[216:219], v[96:99]
    v_mfma_f32_16x16x32_bf16 v[96:99], v[200:203], a[220:223], v[96:99]
    buffer_load_dwordx4 v[172:175], v252, s[24:27], s31 offen offset:0 sc1
    v_mfma_f32_16x16x32_bf16 v[92:95], v[200:203], a[204:207], v[92:95]
    v_mfma_f32_16x16x32_bf16 v[92:95], v[196:199], a[200:203], v[92:95]
    v_mfma_f32_16x16x32_bf16 v[92:95], v[192:195], a[196:199], v[92:95]
    v_mfma_f32_16x16x32_bf16 v[92:95], v[188:191], a[192:195], v[92:95]
    s_waitcnt lgkmcnt(5)
    v_mfma_f32_16x16x32_bf16 v[76:79], v[12:15], a[128:131], v[76:79]
    buffer_load_dwordx4 v[176:179], v252, s[24:27], s31 offen offset:1024 sc1
    v_mfma_f32_16x16x32_bf16 v[76:79], v[16:19], a[132:135], v[76:79]
    v_mfma_f32_16x16x32_bf16 v[76:79], v[20:23], a[136:139], v[76:79]
    v_mfma_f32_16x16x32_bf16 v[76:79], v[24:27], a[140:143], v[76:79]
    v_mfma_f32_16x16x32_bf16 v[80:83], v[24:27], a[156:159], v[80:83]
    buffer_load_dwordx4 v[180:183], v252, s[24:27], s31 offen offset:2048 sc1
    v_mfma_f32_16x16x32_bf16 v[80:83], v[20:23], a[152:155], v[80:83]
    v_mfma_f32_16x16x32_bf16 v[80:83], v[16:19], a[148:151], v[80:83]
    v_mfma_f32_16x16x32_bf16 v[80:83], v[12:15], a[144:147], v[80:83]
    v_mfma_f32_16x16x32_bf16 v[84:87], v[12:15], a[160:163], v[84:87]
    v_mfma_f32_16x16x32_bf16 v[84:87], v[16:19], a[164:167], v[84:87]
    buffer_load_dwordx4 v[184:187], v252, s[24:27], s31 offen offset:3072 sc1
    v_mfma_f32_16x16x32_bf16 v[84:87], v[20:23], a[168:171], v[84:87]
    s_add_u32 s31, s64, 122880
    v_mfma_f32_16x16x32_bf16 v[84:87], v[24:27], a[172:175], v[84:87]
    v_mfma_f32_16x16x32_bf16 v[88:91], v[24:27], a[188:191], v[88:91]
    v_mfma_f32_16x16x32_bf16 v[88:91], v[20:23], a[184:187], v[88:91]
    buffer_load_dwordx4 v[188:191], v252, s[24:27], s31 offen offset:0 sc1
    v_mfma_f32_16x16x32_bf16 v[88:91], v[16:19], a[180:183], v[88:91]
    v_mfma_f32_16x16x32_bf16 v[88:91], v[12:15], a[176:179], v[88:91]
    s_waitcnt vmcnt(17)
    v_mfma_f32_16x16x32_bf16 v[104:107], v[28:31], a[176:179], v[104:107]
    v_mfma_f32_16x16x32_bf16 v[104:107], v[32:35], a[180:183], v[104:107]
    v_mfma_f32_16x16x32_bf16 v[104:107], v[36:39], a[184:187], v[104:107]
    buffer_load_dwordx4 v[192:195], v252, s[24:27], s31 offen offset:1024 sc1
    v_mfma_f32_16x16x32_bf16 v[104:107], v[40:43], a[188:191], v[104:107]
    v_mfma_f32_16x16x32_bf16 v[100:103], v[40:43], a[172:175], v[100:103]
    v_mfma_f32_16x16x32_bf16 v[100:103], v[36:39], a[168:171], v[100:103]
    v_mfma_f32_16x16x32_bf16 v[100:103], v[32:35], a[164:167], v[100:103]
    v_mfma_f32_16x16x32_bf16 v[100:103], v[28:31], a[160:163], v[100:103]
    buffer_load_dwordx4 v[196:199], v252, s[24:27], s31 offen offset:2048 sc1
    v_mfma_f32_16x16x32_bf16 v[96:99], v[28:31], a[144:147], v[96:99]
    v_mfma_f32_16x16x32_bf16 v[96:99], v[32:35], a[148:151], v[96:99]
    v_mfma_f32_16x16x32_bf16 v[96:99], v[36:39], a[152:155], v[96:99]
    v_mfma_f32_16x16x32_bf16 v[96:99], v[40:43], a[156:159], v[96:99]
    buffer_load_dwordx4 v[200:203], v252, s[24:27], s31 offen offset:3072 sc1
    v_mfma_f32_16x16x32_bf16 v[92:95], v[40:43], a[140:143], v[92:95]
    s_barrier
    s_cmp_lg_u32 s19, 0
    s_cbranch_scc1 L_nfe
    buffer_store_dword v2, v243, s[24:27], s36 offen offset:0 sc1
L_nfe:
    v_mfma_f32_16x16x32_bf16 v[92:95], v[36:39], a[136:139], v[92:95]
    s_add_u32 s31, s64, 110592
    v_mfma_f32_16x16x32_bf16 v[92:95], v[32:35], a[132:135], v[92:95]
    v_mfma_f32_16x16x32_bf16 v[92:95], v[28:31], a[128:131], v[92:95]
    s_waitcnt vmcnt(16)
    v_mfma_f32_16x16x32_bf16 v[108:111], v[44:47], a[0:3], 0
    buffer_load_dwordx4 v[12:15], v252, s[24:27], s31 offen offset:0 sc1
    v_mfma_f32_16x16x32_bf16 v[108:111], v[48:51], a[4:7], v[108:111]
    v_mfma_f32_16x16x32_bf16 v[108:111], v[52:55], a[8:11], v[108:111]
    v_mfma_f32_16x16x32_bf16 v[108:111], v[56:59], a[12:15], v[108:111]
    v_mfma_f32_16x16x32_bf16 v[112:115], v[56:59], a[28:31], 0
    buffer_load_dwordx4 v[16:19], v252, s[24:27], s31 offen offset:1024 sc1
    v_mfma_f32_16x16x32_bf16 v[112:115], v[52:55], a[24:27], v[112:115]
    v_cvt_pk_bf16_f32 v236, v88, v89
    v_cvt_pk_bf16_f32 v237, v90, v91
    v_mfma_f32_16x16x32_bf16 v[112:115], v[48:51], a[20:23], v[112:115]
    v_cvt_pk_bf16_f32 v238, v104, v105
    v_cvt_pk_bf16_f32 v239, v106, v107
    v_mfma_f32_16x16x32_bf16 v[112:115], v[44:47], a[16:19], v[112:115]
    v_mfma_f32_16x16x32_bf16 v[116:119], v[44:47], a[32:35], 0
    v_mfma_f32_16x16x32_bf16 v[116:119], v[48:51], a[36:39], v[116:119]
    buffer_store_dwordx4 v[236:239], v252, s[24:27], s35 offen offset:2048 sc1
    v_mfma_f32_16x16x32_bf16 v[116:119], v[52:55], a[40:43], v[116:119]
    v_cvt_pk_bf16_f32 v232, v84, v85
    v_cvt_pk_bf16_f32 v233, v86, v87
    v_mfma_f32_16x16x32_bf16 v[116:119], v[56:59], a[44:47], v[116:119]
    v_cvt_pk_bf16_f32 v234, v100, v101
    v_cvt_pk_bf16_f32 v235, v102, v103
    v_mfma_f32_16x16x32_bf16 v[120:123], v[56:59], a[60:63], 0
    v_mfma_f32_16x16x32_bf16 v[120:123], v[52:55], a[56:59], v[120:123]
    v_mfma_f32_16x16x32_bf16 v[120:123], v[48:51], a[52:55], v[120:123]
    buffer_store_dwordx4 v[232:235], v252, s[24:27], s34 offen offset:2048 sc1
    v_mfma_f32_16x16x32_bf16 v[120:123], v[44:47], a[48:51], v[120:123]
    v_cvt_pk_bf16_f32 v228, v80, v81
    v_cvt_pk_bf16_f32 v229, v82, v83
    s_waitcnt vmcnt(16)
    v_mfma_f32_16x16x32_bf16 v[136:139], v[60:63], a[48:51], 0
    v_cvt_pk_bf16_f32 v230, v96, v97
    v_cvt_pk_bf16_f32 v231, v98, v99
    v_mfma_f32_16x16x32_bf16 v[136:139], v[64:67], a[52:55], v[136:139]
    v_mfma_f32_16x16x32_bf16 v[136:139], v[68:71], a[56:59], v[136:139]
    buffer_store_dwordx4 v[228:231], v252, s[24:27], s33 offen offset:2048 sc1
    v_mfma_f32_16x16x32_bf16 v[136:139], v[72:75], a[60:63], v[136:139]
    v_cvt_pk_bf16_f32 v224, v76, v77
    v_cvt_pk_bf16_f32 v225, v78, v79
    v_mfma_f32_16x16x32_bf16 v[132:135], v[72:75], a[44:47], 0
    v_cvt_pk_bf16_f32 v226, v92, v93
    v_cvt_pk_bf16_f32 v227, v94, v95
    v_mfma_f32_16x16x32_bf16 v[132:135], v[68:71], a[40:43], v[132:135]
    v_mfma_f32_16x16x32_bf16 v[132:135], v[64:67], a[36:39], v[132:135]
    v_mfma_f32_16x16x32_bf16 v[132:135], v[60:63], a[32:35], v[132:135]
    buffer_store_dwordx4 v[224:227], v245, s[24:27], s32 offen offset:2048 sc1
    v_mfma_f32_16x16x32_bf16 v[128:131], v[60:63], a[16:19], 0
    ds_write_b128 v246, v[224:227] offset:2048
    v_mfma_f32_16x16x32_bf16 v[128:131], v[64:67], a[20:23], v[128:131]
    v_mfma_f32_16x16x32_bf16 v[128:131], v[68:71], a[24:27], v[128:131]
    v_mfma_f32_16x16x32_bf16 v[128:131], v[72:75], a[28:31], v[128:131]
    buffer_load_dwordx4 v[20:23], v252, s[24:27], s31 offen offset:2048 sc1
    v_mfma_f32_16x16x32_bf16 v[124:127], v[72:75], a[12:15], 0
    v_mfma_f32_16x16x32_bf16 v[124:127], v[68:71], a[8:11], v[124:127]
    v_mfma_f32_16x16x32_bf16 v[124:127], v[64:67], a[4:7], v[124:127]
    v_mfma_f32_16x16x32_bf16 v[124:127], v[60:63], a[0:3], v[124:127]
    s_waitcnt lgkmcnt(1)
    v_mfma_f32_16x16x32_bf16 v[108:111], v[140:143], a[64:67], v[108:111]
    buffer_load_dwordx4 v[24:27], v252, s[24:27], s31 offen offset:3072 sc1
    v_mfma_f32_16x16x32_bf16 v[108:111], v[144:147], a[68:71], v[108:111]
    s_add_u32 s31, s64, 126976
    v_mfma_f32_16x16x32_bf16 v[108:111], v[148:151], a[72:75], v[108:111]
    v_mfma_f32_16x16x32_bf16 v[108:111], v[152:155], a[76:79], v[108:111]
    v_mfma_f32_16x16x32_bf16 v[112:115], v[152:155], a[92:95], v[112:115]
    v_mfma_f32_16x16x32_bf16 v[112:115], v[148:151], a[88:91], v[112:115]
    buffer_load_dwordx4 v[28:31], v252, s[24:27], s31 offen offset:0 sc1
    v_mfma_f32_16x16x32_bf16 v[112:115], v[144:147], a[84:87], v[112:115]
    v_mfma_f32_16x16x32_bf16 v[112:115], v[140:143], a[80:83], v[112:115]
    v_mfma_f32_16x16x32_bf16 v[116:119], v[140:143], a[96:99], v[116:119]
    v_mfma_f32_16x16x32_bf16 v[116:119], v[144:147], a[100:103], v[116:119]
    buffer_load_dwordx4 v[32:35], v252, s[24:27], s31 offen offset:1024 sc1
    v_mfma_f32_16x16x32_bf16 v[116:119], v[148:151], a[104:107], v[116:119]
    v_mfma_f32_16x16x32_bf16 v[116:119], v[152:155], a[108:111], v[116:119]
    v_mfma_f32_16x16x32_bf16 v[120:123], v[152:155], a[124:127], v[120:123]
    v_mfma_f32_16x16x32_bf16 v[120:123], v[148:151], a[120:123], v[120:123]
    v_mfma_f32_16x16x32_bf16 v[120:123], v[144:147], a[116:119], v[120:123]
    buffer_load_dwordx4 v[36:39], v252, s[24:27], s31 offen offset:2048 sc1
    v_mfma_f32_16x16x32_bf16 v[120:123], v[140:143], a[112:115], v[120:123]
    s_waitcnt vmcnt(19)
    v_mfma_f32_16x16x32_bf16 v[136:139], v[156:159], a[112:115], v[136:139]
    v_mfma_f32_16x16x32_bf16 v[136:139], v[160:163], a[116:119], v[136:139]
    v_mfma_f32_16x16x32_bf16 v[136:139], v[164:167], a[120:123], v[136:139]
    buffer_load_dwordx4 v[40:43], v252, s[24:27], s31 offen offset:3072 sc1
    v_mfma_f32_16x16x32_bf16 v[136:139], v[168:171], a[124:127], v[136:139]
    s_add_u32 s31, s93, 0
    v_mfma_f32_16x16x32_bf16 v[132:135], v[168:171], a[108:111], v[132:135]
    v_mfma_f32_16x16x32_bf16 v[132:135], v[164:167], a[104:107], v[132:135]
    v_mfma_f32_16x16x32_bf16 v[132:135], v[160:163], a[100:103], v[132:135]
    v_mfma_f32_16x16x32_bf16 v[132:135], v[156:159], a[96:99], v[132:135]
    v_mfma_f32_16x16x32_bf16 v[128:131], v[156:159], a[80:83], v[128:131]
    v_mfma_f32_16x16x32_bf16 v[128:131], v[160:163], a[84:87], v[128:131]
    v_mfma_f32_16x16x32_bf16 v[128:131], v[164:167], a[88:91], v[128:131]
L_pg10:
    s_cbranch_execz L_pgret
    v_mfma_f32_16x16x32_bf16 v[128:131], v[168:171], a[92:95], v[128:131]
    v_mfma_f32_16x16x32_bf16 v[124:127], v[168:171], a[76:79], v[124:127]
    v_mfma_f32_16x16x32_bf16 v[124:127], v[164:167], a[72:75], v[124:127]
    v_mfma_f32_16x16x32_bf16 v[124:127], v[160:163], a[68:71], v[124:127]
    v_mfma_f32_16x16x32_bf16 v[124:127], v[156:159], a[64:67], v[124:127]
    s_waitcnt vmcnt(16)
    v_mfma_f32_16x16x32_bf16 v[108:111], v[172:175], a[192:195], v[108:111]
    ds_read_b128 v[44:47], v5 offset:0
    v_mfma_f32_16x16x32_bf16 v[108:111], v[176:179], a[196:199], v[108:111]
    ds_read_b128 v[48:51], v5 offset:1024
    v_mfma_f32_16x16x32_bf16 v[108:111], v[180:183], a[200:203], v[108:111]
    ds_read_b128 v[52:55], v5 offset:2048
    v_mfma_f32_16x16x32_bf16 v[108:111], v[184:187], a[204:207], v[108:111]
    ds_read_b128 v[56:59], v5 offset:3072
    v_mfma_f32_16x16x32_bf16 v[112:115], v[184:187], a[220:223], v[112:115]
    ds_read_b128 v[60:63], v5 offset:4096
    v_mfma_f32_16x16x32_bf16 v[112:115], v[180:183], a[216:219], v[112:115]
    ds_read_b128 v[64:67], v5 offset:5120
    v_mfma_f32_16x16x32_bf16 v[112:115], v[176:179], a[212:215], v[112:115]
    ds_read_b128 v[68:71], v5 offset:6144
    v_mfma_f32_16x16x32_bf16 v[112:115], v[172:175], a[208:211], v[112:115]
    ds_read_b128 v[72:75], v5 offset:7168
    v_mfma_f32_16x16x32_bf16 v[116:119], v[172:175], a[224:227], v[116:119]
    v_mfma_f32_16x16x32_bf16 v[116:119], v[176:179], a[228:231], v[116:119]
    v_mfma_f32_16x16x32_bf16 v[116:119], v[180:183], a[232:235], v[116:119]
    v_mfma_f32_16x16x32_bf16 v[116:119], v[184:187], a[236:239], v[116:119]
    v_mfma_f32_16x16x32_bf16 v[120:123], v[184:187], a[252:255], v[120:123]
    v_mfma_f32_16x16x32_bf16 v[120:123], v[180:183], a[248:251], v[120:123]
    v_mfma_f32_16x16x32_bf16 v[120:123], v[176:179], a[244:247], v[120:123]
    s_waitcnt lgkmcnt(0)
    v_mfma_f32_16x16x32_bf16 v[120:123], v[172:175], a[240:243], v[120:123]
    s_cmp_lg_u32 s19, 0
    s_cbranch_scc1 L_ep
    s_load_dword s81, s[90:91], 128 glc
    s_load_dword s82, s[90:91], 256 glc
    s_load_dword s83, s[90:91], 384 glc
    s_load_dword s84, s[90:91], 512 glc
    s_load_dword s85, s[90:91], 640 glc
    s_load_dword s86, s[90:91], 768 glc
    s_load_dword s87, s[90:91], 896 glc
L_ep:
    v_add_f32 v44, v44, v52
    v_add_f32 v45, v45, v53
    s_waitcnt vmcnt(12)
    v_mfma_f32_16x16x32_bf16 v[136:139], v[188:191], a[240:243], v[136:139]
    v_add_f32 v46, v46, v54
    v_add_f32 v47, v47, v55
    v_mfma_f32_16x16x32_bf16 v[136:139], v[192:195], a[244:247], v[136:139]
    v_add_f32 v48, v48, v56
    v_add_f32 v49, v49, v57
    v_mfma_f32_16x16x32_bf16 v[136:139], v[196:199], a[248:251], v[136:139]
    v_add_f32 v50, v50, v58
    v_add_f32 v51, v51, v59
    v_mfma_f32_16x16x32_bf16 v[136:139], v[200:203], a[252:255], v[136:139]
    v_add_f32 v60, v60, v68
    v_add_f32 v61, v61, v69
    v_mfma_f32_16x16x32_bf16 v[132:135], v[200:203], a[236:239], v[132:135]
    v_add_f32 v62, v62, v70
    v_add_f32 v63, v63, v71
    v_mfma_f32_16x16x32_bf16 v[132:135], v[196:199], a[232:235], v[132:135]
    v_add_f32 v64, v64, v72
    v_add_f32 v65, v65, v73
    v_mfma_f32_16x16x32_bf16 v[132:135], v[192:195], a[228:231], v[132:135]
    v_add_f32 v66, v66, v74
    v_add_f32 v67, v67, v75
    v_mfma_f32_16x16x32_bf16 v[132:135], v[188:191], a[224:227], v[132:135]
    v_add_f32 v44, v44, v60
    v_add_f32 v45, v45, v61
    v_mfma_f32_16x16x32_bf16 v[128:131], v[188:191], a[208:211], v[128:131]
    v_add_f32 v46, v46, v62
    v_add_f32 v47, v47, v63
    v_mfma_f32_16x16x32_bf16 v[128:131], v[192:195], a[212:215], v[128:131]
    v_add_f32 v48, v48, v64
    v_add_f32 v49, v49, v65
    v_mfma_f32_16x16x32_bf16 v[128:131], v[196:199], a[216:219], v[128:131]
    v_add_f32 v50, v50, v66
    v_add_f32 v51, v51, v67
    v_mfma_f32_16x16x32_bf16 v[128:131], v[200:203], a[220:223], v[128:131]
    ds_write_b128 v5, v[44:47] offset:0
    v_mfma_f32_16x16x32_bf16 v[124:127], v[200:203], a[204:207], v[124:127]
    ds_write_b128 v5, v[48:51] offset:1024
    v_mfma_f32_16x16x32_bf16 v[124:127], v[196:199], a[200:203], v[124:127]
    v_mfma_f32_16x16x32_bf16 v[124:127], v[192:195], a[196:199], v[124:127]
    v_mfma_f32_16x16x32_bf16 v[124:127], v[188:191], a[192:195], v[124:127]
    s_waitcnt vmcnt(4)
    v_mfma_f32_16x16x32_bf16 v[108:111], v[12:15], a[128:131], v[108:111]
    v_mfma_f32_16x16x32_bf16 v[108:111], v[16:19], a[132:135], v[108:111]
    v_mfma_f32_16x16x32_bf16 v[108:111], v[20:23], a[136:139], v[108:111]
    v_mfma_f32_16x16x32_bf16 v[108:111], v[24:27], a[140:143], v[108:111]
    v_mfma_f32_16x16x32_bf16 v[112:115], v[24:27], a[156:159], v[112:115]
    v_mfma_f32_16x16x32_bf16 v[112:115], v[20:23], a[152:155], v[112:115]
    v_mfma_f32_16x16x32_bf16 v[112:115], v[16:19], a[148:151], v[112:115]
    v_mfma_f32_16x16x32_bf16 v[112:115], v[12:15], a[144:147], v[112:115]
    v_mfma_f32_16x16x32_bf16 v[116:119], v[12:15], a[160:163], v[116:119]
    v_mfma_f32_16x16x32_bf16 v[116:119], v[16:19], a[164:167], v[116:119]
    v_mfma_f32_16x16x32_bf16 v[116:119], v[20:23], a[168:171], v[116:119]
    v_mfma_f32_16x16x32_bf16 v[116:119], v[24:27], a[172:175], v[116:119]
    v_mfma_f32_16x16x32_bf16 v[120:123], v[24:27], a[188:191], v[120:123]
    v_mfma_f32_16x16x32_bf16 v[120:123], v[20:23], a[184:187], v[120:123]
    v_mfma_f32_16x16x32_bf16 v[120:123], v[16:19], a[180:183], v[120:123]
    v_mfma_f32_16x16x32_bf16 v[120:123], v[12:15], a[176:179], v[120:123]
    s_waitcnt vmcnt(0)
    v_mfma_f32_16x16x32_bf16 v[136:139], v[28:31], a[176:179], v[136:139]
    v_mfma_f32_16x16x32_bf16 v[136:139], v[32:35], a[180:183], v[136:139]
    v_mfma_f32_16x16x32_bf16 v[136:139], v[36:39], a[184:187], v[136:139]
    v_mfma_f32_16x16x32_bf16 v[136:139], v[40:43], a[188:191], v[136:139]
    v_mfma_f32_16x16x32_bf16 v[132:135], v[40:43], a[172:175], v[132:135]
    v_mfma_f32_16x16x32_bf16 v[132:135], v[36:39], a[168:171], v[132:135]
    v_mfma_f32_16x16x32_bf16 v[132:135], v[32:35], a[164:167], v[132:135]
    v_mfma_f32_16x16x32_bf16 v[132:135], v[28:31], a[160:163], v[132:135]
    v_mfma_f32_16x16x32_bf16 v[128:131], v[28:31], a[144:147], v[128:131]
    v_cvt_pk_bf16_f32 v236, v120, v121
    v_cvt_pk_bf16_f32 v237, v122, v123
    v_mfma_f32_16x16x32_bf16 v[128:131], v[32:35], a[148:151], v[128:131]
    v_cvt_pk_bf16_f32 v238, v136, v137
    v_cvt_pk_bf16_f32 v239, v138, v139
    v_mfma_f32_16x16x32_bf16 v[128:131], v[36:39], a[152:155], v[128:131]
    buffer_store_dwordx4 v[236:239], v252, s[24:27], s35 offen offset:3072 sc1
    v_mfma_f32_16x16x32_bf16 v[128:131], v[40:43], a[156:159], v[128:131]
    v_mfma_f32_16x16x32_bf16 v[124:127], v[40:43], a[140:143], v[124:127]
    v_cvt_pk_bf16_f32 v232, v116, v117
    v_cvt_pk_bf16_f32 v233, v118, v119
    v_mfma_f32_16x16x32_bf16 v[124:127], v[36:39], a[136:139], v[124:127]
    v_cvt_pk_bf16_f32 v234, v132, v133
    v_cvt_pk_bf16_f32 v235, v134, v135
    v_mfma_f32_16x16x32_bf16 v[124:127], v[32:35], a[132:135], v[124:127]
    buffer_store_dwordx4 v[232:235], v252, s[24:27], s34 offen offset:3072 sc1
    v_mfma_f32_16x16x32_bf16 v[124:127], v[28:31], a[128:131], v[124:127]
    s_nop 5
    v_cvt_pk_bf16_f32 v228, v112, v113
    v_cvt_pk_bf16_f32 v229, v114, v115
    v_cvt_pk_bf16_f32 v230, v128, v129
    v_cvt_pk_bf16_f32 v231, v130, v131
    buffer_store_dwordx4 v[228:231], v252, s[24:27], s33 offen offset:3072 sc1
    v_cvt_pk_bf16_f32 v224, v108, v109
    v_cvt_pk_bf16_f32 v225, v110, v111
    v_cvt_pk_bf16_f32 v226, v124, v125
    v_cvt_pk_bf16_f32 v227, v126, v127
    buffer_store_dwordx4 v[224:227], v245, s[24:27], s32 offen offset:3072 sc1
    ds_write_b128 v246, v[224:227] offset:3072
    v_mov_b32 v4, 16384
    ds_read_b128 v[12:15], v247 offset:0
    ds_read_b128 v[16:19], v247 offset:2048
    v_lshlrev_b32 v124, 16, v216
    v_and_b32 v125, 0xffff0000, v216
    v_lshlrev_b32 v126, 16, v217
    v_and_b32 v127, 0xffff0000, v217
    v_lshlrev_b32 v128, 16, v218
    v_and_b32 v129, 0xffff0000, v218
    v_lshlrev_b32 v130, 16, v219
    v_and_b32 v131, 0xffff0000, v219
    v_lshlrev_b32 v132, 16, v220
    v_and_b32 v133, 0xffff0000, v220
    v_lshlrev_b32 v134, 16, v221
    v_and_b32 v135, 0xffff0000, v221
    v_lshlrev_b32 v136, 16, v222
    v_and_b32 v137, 0xffff0000, v222
    v_lshlrev_b32 v138, 16, v223
    v_and_b32 v139, 0xffff0000, v223
    buffer_load_dwordx4 a[0:3], v252, s[24:27], s31 offen offset:0 sc1
    buffer_load_dwordx4 a[4:7], v252, s[24:27], s31 offen offset:1024 sc1
    buffer_load_dwordx4 a[8:11], v252, s[24:27], s31 offen offset:2048 sc1
    buffer_load_dwordx4 a[12:15], v252, s[24:27], s31 offen offset:3072 sc1
    s_add_u32 s31, s92, 0
    buffer_load_dwordx4 a[16:19], v252, s[24:27], s31 offen offset:0 sc1
    buffer_load_dwordx4 a[20:23], v252, s[24:27], s31 offen offset:1024 sc1
    buffer_load_dwordx4 a[24:27], v252, s[24:27], s31 offen offset:2048 sc1
    buffer_load_dwordx4 a[28:31], v252, s[24:27], s31 offen offset:3072 sc1
    s_add_u32 s31, s92, 32768
    buffer_load_dwordx4 a[32:35], v252, s[24:27], s31 offen offset:0 sc1
    s_waitcnt lgkmcnt(0)
    v_lshlrev_b32 v76, 16, v12
    v_and_b32 v77, 0xffff0000, v12
    v_lshlrev_b32 v78, 16, v13
    v_and_b32 v79, 0xffff0000, v13
    v_lshlrev_b32 v80, 16, v14
    v_and_b32 v81, 0xffff0000, v14
    v_lshlrev_b32 v82, 16, v15
    v_and_b32 v83, 0xffff0000, v15
    v_lshlrev_b32 v84, 16, v16
    v_and_b32 v85, 0xffff0000, v16
    v_lshlrev_b32 v86, 16, v17
    v_and_b32 v87, 0xffff0000, v17
    v_lshlrev_b32 v88, 16, v18
    v_and_b32 v89, 0xffff0000, v18
    v_lshlrev_b32 v90, 16, v19
    v_and_b32 v91, 0xffff0000, v19
    v_mov_b32 v2, s28
    s_cmp_lg_u32 s19, 0
    s_cbranch_scc1 L_rza
    s_sub_u32 s81, s81, s45
    s_cmp_eq_u32 s81, 1
    s_cselect_b32 s29, 514, 2
    s_cmp_lt_u32 s81, 2
    s_cselect_b32 s29, s29, 0
    s_or_b32 s68, s68, s29
    s_sub_u32 s82, s82, s45
    s_cmp_eq_u32 s82, 1
    s_cselect_b32 s29, 1028, 4
    s_cmp_lt_u32 s82, 2
    s_cselect_b32 s29, s29, 0
    s_or_b32 s68, s68, s29
    s_sub_u32 s83, s83, s45
    s_cmp_eq_u32 s83, 1
    s_cselect_b32 s29, 2056, 8
    s_cmp_lt_u32 s83, 2
    s_cselect_b32 s29, s29, 0
    s_or_b32 s68, s68, s29
    s_sub_u32 s84, s84, s45
    s_cmp_eq_u32 s84, 1
    s_cselect_b32 s29, 4112, 16
    s_cmp_lt_u32 s84, 2
    s_cselect_b32 s29, s29, 0
    s_or_b32 s68, s68, s29
    s_sub_u32 s85, s85, s45
    s_cmp_eq_u32 s85, 1
    s_cselect_b32 s29, 8224, 32
    s_cmp_lt_u32 s85, 2
    s_cselect_b32 s29, s29, 0
    s_or_b32 s68, s68, s29
    s_sub_u32 s86, s86, s45
    s_cmp_eq_u32 s86, 1
    s_cselect_b32 s29, 16448, 64
    s_cmp_lt_u32 s86, 2
    s_cselect_b32 s29, s29, 0
    s_or_b32 s68, s68, s29
    s_sub_u32 s87, s87, s45
    s_cmp_eq_u32 s87, 1
    s_cselect_b32 s29, s70, 0x80
    s_cmp_lt_u32 s87, 2
    s_cselect_b32 s29, s29, 0
    s_or_b32 s68, s68, s29
    v_mov_b32 v3, s68
    ds_write_b32 v4, v3
    s_waitcnt lgkmcnt(0)
L_rza:
    s_mov_b32 s28, 0
    s_waitcnt vmcnt(9)
    s_barrier
    s_cmp_lg_u32 s19, 0
    s_cbranch_scc1 L_nfa
    buffer_store_dword v2, v243, s[24:27], s36 offen offset:0 sc1
L_nfa:
    s_cmp_lg_u32 s19, 0
    s_cbranch_scc0 L_rna
L_rra:
    s_cmp_lg_u32 s19, 0
    s_cbranch_scc1 L_rla
    s_add_u32 s28, s28, 1
    s_cmp_gt_u32 s28, 0x80000
    s_cselect_b32 s68, 0xffff, s68
    s_waitcnt lgkmcnt(0)
    s_sub_u32 s81, s81, s45
    s_cmp_eq_u32 s81, 1
    s_cselect_b32 s29, 514, 2
    s_cmp_lt_u32 s81, 2
    s_cselect_b32 s29, s29, 0
    s_or_b32 s68, s68, s29
    s_sub_u32 s82, s82, s45
    s_cmp_eq_u32 s82, 1
    s_cselect_b32 s29, 1028, 4
    s_cmp_lt_u32 s82, 2
    s_cselect_b32 s29, s29, 0
    s_or_b32 s68, s68, s29
    s_sub_u32 s83, s83, s45
    s_cmp_eq_u32 s83, 1
    s_cselect_b32 s29, 2056, 8
    s_cmp_lt_u32 s83, 2
    s_cselect_b32 s29, s29, 0
    s_or_b32 s68, s68, s29
    s_sub_u32 s84, s84, s45
    s_cmp_eq_u32 s84, 1
    s_cselect_b32 s29, 4112, 16
    s_cmp_lt_u32 s84, 2
    s_cselect_b32 s29, s29, 0
    s_or_b32 s68, s68, s29
    s_sub_u32 s85, s85, s45
    s_cmp_eq_u32 s85, 1
    s_cselect_b32 s29, 8224, 32
    s_cmp_lt_u32 s85, 2
    s_cselect_b32 s29, s29, 0
    s_or_b32 s68, s68, s29
    s_sub_u32 s86, s86, s45
    s_cmp_eq_u32 s86, 1
    s_cselect_b32 s29, 16448, 64
    s_cmp_lt_u32 s86, 2
    s_cselect_b32 s29, s29, 0
    s_or_b32 s68, s68, s29
    s_sub_u32 s87, s87, s45
    s_cmp_eq_u32 s87, 1
    s_cselect_b32 s29, s70, 0x80
    s_cmp_lt_u32 s87, 2
    s_cselect_b32 s29, s29, 0
    s_or_b32 s68, s68, s29
    v_mov_b32 v3, s68
    ds_write_b32 v4, v3
L_rna:
    s_cmp_eq_u32 s68, 0xffff
    s_cbranch_scc1 L_ria
    s_load_dword s81, s[90:91], 128 glc
    s_load_dword s82, s[90:91], 256 glc
    s_load_dword s83, s[90:91], 384 glc
    s_load_dword s84, s[90:91], 512 glc
    s_load_dword s85, s[90:91], 640 glc
    s_load_dword s86, s[90:91], 768 glc
    s_load_dword s87, s[90:91], 896 glc
    s_branch L_ria
L_rla:
    ds_read_b32 v3, v4
    s_waitcnt lgkmcnt(0)
    v_readfirstlane_b32 s68, v3
    s_nop 1
L_ria:
    s_andn2_b32 s69, s68, s67
    s_cbranch_scc0 L_rra
    s_bitcmp1_b32 s69, 1
    s_cbranch_scc0 L_rsa10
    buffer_load_dwordx4 v[20:23], v241, s[24:27], s73 offen offset:0 sc1
L_rsa10:
    s_bitcmp1_b32 s69, 2
    s_cbranch_scc0 L_rsa20
    buffer_load_dwordx4 v[28:31], v241, s[24:27], s74 offen offset:0 sc1
L_rsa20:
    s_bitcmp1_b32 s69, 3
    s_cbranch_scc0 L_rsa30
    buffer_load_dwordx4 v[36:39], v241, s[24:27], s75 offen offset:0 sc1
L_rsa30:
    s_bitcmp1_b32 s69, 4
    s_cbranch_scc0 L_rsa40
    buffer_load_dwordx4 v[44:47], v241, s[24:27], s76 offen offset:0 sc1
L_rsa40:
    s_bitcmp1_b32 s69, 5
    s_cbranch_scc0 L_rsa50
    buffer_load_dwordx4 v[52:55], v241, s[24:27], s77 offen offset:0 sc1
L_rsa50:
    s_bitcmp1_b32 s69, 6
    s_cbranch_scc0 L_rsa60
    buffer_load_dwordx4 v[60:63], v241, s[24:27], s78 offen offset:0 sc1
L_rsa60:
    s_bitcmp1_b32 s69, 7
    s_cbranch_scc0 L_rsa70
    buffer_load_dwordx4 v[68:71], v241, s[24:27], s79 offen offset:0 sc1
L_rsa70:
    s_bitcmp1_b32 s69, 9
    s_cbranch_scc0 L_rsa11
    buffer_load_dwordx4 v[24:27], v241, s[24:27], s73 offen offset:2048 sc1
L_rsa11:
    s_bitcmp1_b32 s69, 10
    s_cbranch_scc0 L_rsa21
    buffer_load_dwordx4 v[32:35], v241, s[24:27], s74 offen offset:2048 sc1
L_rsa21:
    s_bitcmp1_b32 s69, 11
    s_cbranch_scc0 L_rsa31
    buffer_load_dwordx4 v[40:43], v241, s[24:27], s75 offen offset:2048 sc1
L_rsa31:
    s_bitcmp1_b32 s69, 12
    s_cbranch_scc0 L_rsa41
    buffer_load_dwordx4 v[48:51], v241, s[24:27], s76 offen offset:2048 sc1
L_rsa41:
    s_bitcmp1_b32 s69, 13
    s_cbranch_scc0 L_rsa51
    buffer_load_dwordx4 v[56:59], v241, s[24:27], s77 offen offset:2048 sc1
L_rsa51:
    s_bitcmp1_b32 s69, 14
    s_cbranch_scc0 L_rsa61
    buffer_load_dwordx4 v[64:67], v241, s[24:27], s78 offen offset:2048 sc1
L_rsa61:
    s_bitcmp1_b32 s69, 15
    s_cbranch_scc0 L_rsa71
    buffer_load_dwordx4 v[72:75], v241, s[24:27], s79 offen offset:2048 sc1
L_rsa71:
    s_or_b32 s67, s67, s69
    s_cmp_lg_u32 s67, 0xffff
    s_cbranch_scc1 L_rra
    v_add_u32 v9, 65536, v9
    v_add_u32 v10, 98304, v10
    s_lshl_b32 s71, s19, 13
    ds_read_b128 v[140:143], v242 offset:0
    ds_read_b128 v[144:147], v242 offset:16
    ds_read_b128 v[148:151], v242 offset:256
    ds_read_b128 v[152:155], v242 offset:272
    ds_read_b128 v[172:175], v242 offset:8192
    ds_read_b128 v[176:179], v242 offset:8208
    ds_read_b128 v[180:183], v242 offset:8448
    ds_read_b128 v[184:187], v242 offset:8464
    ds_read_b128 v[156:159], v242 offset:16384
    ds_read_b128 v[160:163], v242 offset:16400
    ds_read_b128 v[164:167], v242 offset:16640
    ds_read_b128 v[168:171], v242 offset:16656
    buffer_load_dwordx4 a[36:39], v252, s[24:27], s31 offen offset:1024 sc1
    buffer_load_dwordx4 a[40:43], v252, s[24:27], s31 offen offset:2048 sc1
    buffer_load_dwordx4 a[44:47], v252, s[24:27], s31 offen offset:3072 sc1
    s_add_u32 s31, s65, 0
    buffer_load_dwordx4 a[48:51], v252, s[24:27], s31 offen offset:0 sc1
    buffer_load_dwordx4 a[52:55], v252, s[24:27], s31 offen offset:1024 sc1
    buffer_load_dwordx4 a[56:59], v252, s[24:27], s31 offen offset:2048 sc1
    buffer_load_dwordx4 a[60:63], v252, s[24:27], s31 offen offset:3072 sc1
    s_add_u32 s31, s65, 32768
    buffer_load_dwordx4 a[64:67], v252, s[24:27], s31 offen offset:0 sc1
    buffer_load_dwordx4 a[68:71], v252, s[24:27], s31 offen offset:1024 sc1
    buffer_load_dwordx4 a[72:75], v252, s[24:27], s31 offen offset:2048 sc1
    buffer_load_dwordx4 a[76:79], v252, s[24:27], s31 offen offset:3072 sc1
    s_mov_b32 s28, 0x00003f80
    s_mov_b32 s29, 0x3f800000
    s_waitcnt vmcnt(11)
    v_dot2_f32_bf16 v76, v20, s28, v76
    v_dot2_f32_bf16 v77, v20, s29, v77
    v_dot2_f32_bf16 v78, v21, s28, v78
    v_dot2_f32_bf16 v79, v21, s29, v79
    v_dot2_f32_bf16 v80, v22, s28, v80
    v_dot2_f32_bf16 v81, v22, s29, v81
    v_dot2_f32_bf16 v82, v23, s28, v82
    v_dot2_f32_bf16 v83, v23, s29, v83
    v_dot2_f32_bf16 v84, v24, s28, v84
    v_dot2_f32_bf16 v85, v24, s29, v85
    v_dot2_f32_bf16 v86, v25, s28, v86
    v_dot2_f32_bf16 v87, v25, s29, v87
    v_dot2_f32_bf16 v88, v26, s28, v88
    v_dot2_f32_bf16 v89, v26, s29, v89
    v_dot2_f32_bf16 v90, v27, s28, v90
    v_dot2_f32_bf16 v91, v27, s29, v91
    v_dot2_f32_bf16 v76, v28, s28, v76
    v_dot2_f32_bf16 v77, v28, s29, v77
    v_dot2_f32_bf16 v78, v29, s28, v78
    v_dot2_f32_bf16 v79, v29, s29, v79
    v_dot2_f32_bf16 v80, v30, s28, v80
    v_dot2_f32_bf16 v81, v30, s29, v81
    v_dot2_f32_bf16 v82, v31, s28, v82
    v_dot2_f32_bf16 v83, v31, s29, v83
    v_dot2_f32_bf16 v84, v32, s28, v84
    v_dot2_f32_bf16 v85, v32, s29, v85
    v_dot2_f32_bf16 v86, v33, s28, v86
    v_dot2_f32_bf16 v87, v33, s29, v87
    v_dot2_f32_bf16 v88, v34, s28, v88
    v_dot2_f32_bf16 v89, v34, s29, v89
    v_dot2_f32_bf16 v90, v35, s28, v90
    v_dot2_f32_bf16 v91, v35, s29, v91
    v_dot2_f32_bf16 v76, v36, s28, v76
    v_dot2_f32_bf16 v77, v36, s29, v77
    v_dot2_f32_bf16 v78, v37, s28, v78
    v_dot2_f32_bf16 v79, v37, s29, v79
    v_dot2_f32_bf16 v80, v38, s28, v80
    v_dot2_f32_bf16 v81, v38, s29, v81
    v_dot2_f32_bf16 v82, v39, s28, v82
    v_dot2_f32_bf16 v83, v39, s29, v83
    v_dot2_f32_bf16 v84, v40, s28, v84
    v_dot2_f32_bf16 v85, v40, s29, v85
    v_dot2_f32_bf16 v86, v41, s28, v86
    v_dot2_f32_bf16 v87, v41, s29, v87
    v_dot2_f32_bf16 v88, v42, s28, v88
    v_dot2_f32_bf16 v89, v42, s29, v89
    v_dot2_f32_bf16 v90, v43, s28, v90
    v_dot2_f32_bf16 v91, v43, s29, v91
    v_dot2_f32_bf16 v76, v44, s28, v76
    v_dot2_f32_bf16 v77, v44, s29, v77
    v_dot2_f32_bf16 v78, v45, s28, v78
    v_dot2_f32_bf16 v79, v45, s29, v79
    v_dot2_f32_bf16 v80, v46, s28, v80
    v_dot2_f32_bf16 v81, v46, s29, v81
    v_dot2_f32_bf16 v82, v47, s28, v82
    v_dot2_f32_bf16 v83, v47, s29, v83
    v_dot2_f32_bf16 v84, v48, s28, v84
    v_dot2_f32_bf16 v85, v48, s29, v85
    v_dot2_f32_bf16 v86, v49, s28, v86
    v_dot2_f32_bf16 v87, v49, s29, v87
    v_dot2_f32_bf16 v88, v50, s28, v88
    v_dot2_f32_bf16 v89, v50, s29, v89
    v_dot2_f32_bf16 v90, v51, s28, v90
    v_dot2_f32_bf16 v91, v51, s29, v91
    v_dot2_f32_bf16 v76, v52, s28, v76
    v_dot2_f32_bf16 v77, v52, s29, v77
    v_dot2_f32_bf16 v78, v53, s28, v78
    v_dot2_f32_bf16 v79, v53, s29, v79
    v_dot2_f32_bf16 v80, v54, s28, v80
    v_dot2_f32_bf16 v81, v54, s29, v81
    v_dot2_f32_bf16 v82, v55, s28, v82
    v_dot2_f32_bf16 v83, v55, s29, v83
    v_dot2_f32_bf16 v84, v56, s28, v84
    v_dot2_f32_bf16 v85, v56, s29, v85
    v_dot2_f32_bf16 v86, v57, s28, v86
    v_dot2_f32_bf16 v87, v57, s29, v87
    v_dot2_f32_bf16 v88, v58, s28, v88
    v_dot2_f32_bf16 v89, v58, s29, v89
    v_dot2_f32_bf16 v90, v59, s28, v90
    v_dot2_f32_bf16 v91, v59, s29, v91
    v_dot2_f32_bf16 v76, v60, s28, v76
    v_dot2_f32_bf16 v77, v60, s29, v77
    v_dot2_f32_bf16 v78, v61, s28, v78
    v_dot2_f32_bf16 v79, v61, s29, v79
    v_dot2_f32_bf16 v80, v62, s28, v80
    v_dot2_f32_bf16 v81, v62, s29, v81
    v_dot2_f32_bf16 v82, v63, s28, v82
    v_dot2_f32_bf16 v83, v63, s29, v83
    v_dot2_f32_bf16 v84, v64, s28, v84
    v_dot2_f32_bf16 v85, v64, s29, v85
    v_dot2_f32_bf16 v86, v65, s28, v86
    v_dot2_f32_bf16 v87, v65, s29, v87
    v_dot2_f32_bf16 v88, v66, s28, v88
    v_dot2_f32_bf16 v89, v66, s29, v89
    v_dot2_f32_bf16 v90, v67, s28, v90
    v_dot2_f32_bf16 v91, v67, s29, v91
    v_dot2_f32_bf16 v76, v68, s28, v76
    v_dot2_f32_bf16 v77, v68, s29, v77
    v_dot2_f32_bf16 v78, v69, s28, v78
    v_dot2_f32_bf16 v79, v69, s29, v79
    v_dot2_f32_bf16 v80, v70, s28, v80
    v_dot2_f32_bf16 v81, v70, s29, v81
    v_dot2_f32_bf16 v82, v71, s28, v82
    v_dot2_f32_bf16 v83, v71, s29, v83
    v_dot2_f32_bf16 v84, v72, s28, v84
    v_dot2_f32_bf16 v85, v72, s29, v85
    v_dot2_f32_bf16 v86, v73, s28, v86
    v_dot2_f32_bf16 v87, v73, s29, v87
    v_dot2_f32_bf16 v88, v74, s28, v88
    v_dot2_f32_bf16 v89, v74, s29, v89
    v_dot2_f32_bf16 v90, v75, s28, v90
    v_dot2_f32_bf16 v91, v75, s29, v91
    s_waitcnt lgkmcnt(0)
    v_pk_fma_f32 v[124:125], v[140:141], v[76:77], v[124:125]
    v_pk_fma_f32 v[126:127], v[142:143], v[78:79], v[126:127]
    v_pk_fma_f32 v[128:129], v[144:145], v[80:81], v[128:129]
    v_pk_fma_f32 v[130:131], v[146:147], v[82:83], v[130:131]
    v_pk_fma_f32 v[132:133], v[148:149], v[84:85], v[132:133]
    v_pk_fma_f32 v[134:135], v[150:151], v[86:87], v[134:135]
    v_pk_fma_f32 v[136:137], v[152:153], v[88:89], v[136:137]
    v_pk_fma_f32 v[138:139], v[154:155], v[90:91], v[138:139]
    v_pk_add_f32 v[100:101], v[124:125], v[126:127]
    v_pk_mul_f32 v[102:103], v[124:125], v[124:125]
    v_pk_fma_f32 v[102:103], v[126:127], v[126:127], v[102:103]
    v_pk_add_f32 v[100:101], v[100:101], v[128:129]
    v_pk_fma_f32 v[102:103], v[128:129], v[128:129], v[102:103]
    v_pk_add_f32 v[100:101], v[100:101], v[130:131]
    v_pk_fma_f32 v[102:103], v[130:131], v[130:131], v[102:103]
    v_pk_add_f32 v[100:101], v[100:101], v[132:133]
    v_pk_fma_f32 v[102:103], v[132:133], v[132:133], v[102:103]
    v_pk_add_f32 v[100:101], v[100:101], v[134:135]
    v_pk_fma_f32 v[102:103], v[134:135], v[134:135], v[102:103]
    v_pk_add_f32 v[100:101], v[100:101], v[136:137]
    v_pk_fma_f32 v[102:103], v[136:137], v[136:137], v[102:103]
    v_pk_add_f32 v[100:101], v[100:101], v[138:139]
    v_pk_fma_f32 v[102:103], v[138:139], v[138:139], v[102:103]
    v_add_f32 v100, v100, v101
    v_add_f32 v102, v102, v103
    v_and_b32 v92, 7, v0
    v_lshlrev_b32 v92, 5, v92
    v_permlane32_swap_b32 v100, v102
    v_add_f32 v100, v100, v102
    v_add_u32 v103, 20480, v92
    v_lshrrev_b32 v93, 5, v0
    v_add_f32_dpp v100, v100, v100 row_ror:8 row_mask:0xf bank_mask:0xf
    v_mov_b32 v101, v100
    v_lshl_add_u32 v93, v93, 4, v103
    v_lshl_add_u32 v93, v1, 2, v93
    v_permlane16_swap_b32 v100, v101
    v_add_f32 v100, v100, v101
    ds_write_b32 v93, v100
    s_waitcnt lgkmcnt(0)
    s_barrier
    ds_read_b128 v[92:95], v103
    ds_read_b128 v[96:99], v103 offset:16
    s_waitcnt lgkmcnt(0)
    v_pk_add_f32 v[92:93], v[92:93], v[94:95]
    v_pk_add_f32 v[96:97], v[96:97], v[98:99]
    v_add_f32 v92, v92, v93
    v_add_f32 v96, v96, v97
    v_mul_f32 v92, 0x3b000000, v92
    v_mul_f32 v96, 0x3b000000, v96
    v_fma_f32 v96, -v92, v92, v96
    v_max_f32 v96, 0, v96
    v_add_f32 v96, 0x3727c5ac, v96
    v_rsq_f32 v94, v96
    s_nop 0
    v_mul_f32 v95, -v92, v94
    v_pk_fma_f32 v[104:105], v[124:125], v[94:95], v[94:95] op_sel:[0,0,1] op_sel_hi:[1,0,1]
    v_pk_fma_f32 v[106:107], v[126:127], v[94:95], v[94:95] op_sel:[0,0,1] op_sel_hi:[1,0,1]
    v_pk_fma_f32 v[108:109], v[128:129], v[94:95], v[94:95] op_sel:[0,0,1] op_sel_hi:[1,0,1]
    v_pk_fma_f32 v[110:111], v[130:131], v[94:95], v[94:95] op_sel:[0,0,1] op_sel_hi:[1,0,1]
    v_pk_fma_f32 v[112:113], v[132:133], v[94:95], v[94:95] op_sel:[0,0,1] op_sel_hi:[1,0,1]
    v_pk_fma_f32 v[114:115], v[134:135], v[94:95], v[94:95] op_sel:[0,0,1] op_sel_hi:[1,0,1]
    v_pk_fma_f32 v[116:117], v[136:137], v[94:95], v[94:95] op_sel:[0,0,1] op_sel_hi:[1,0,1]
    v_pk_fma_f32 v[118:119], v[138:139], v[94:95], v[94:95] op_sel:[0,0,1] op_sel_hi:[1,0,1]
    v_pk_fma_f32 v[104:105], v[104:105], v[156:157], v[172:173]
    v_pk_fma_f32 v[106:107], v[106:107], v[158:159], v[174:175]
    v_pk_fma_f32 v[108:109], v[108:109], v[160:161], v[176:177]
    v_pk_fma_f32 v[110:111], v[110:111], v[162:163], v[178:179]
    v_pk_fma_f32 v[112:113], v[112:113], v[164:165], v[180:181]
    v_pk_fma_f32 v[114:115], v[114:115], v[166:167], v[182:183]
    v_pk_fma_f32 v[116:117], v[116:117], v[168:169], v[184:185]
    v_pk_fma_f32 v[118:119], v[118:119], v[170:171], v[186:187]
    v_cvt_pk_bf16_f32 v12, v104, v105
    v_cvt_pk_bf16_f32 v13, v106, v107
    v_cvt_pk_bf16_f32 v14, v108, v109
    v_cvt_pk_bf16_f32 v15, v110, v111
    v_cvt_pk_bf16_f32 v16, v112, v113
    v_cvt_pk_bf16_f32 v17, v114, v115
    v_cvt_pk_bf16_f32 v18, v116, v117
    v_cvt_pk_bf16_f32 v19, v118, v119
    s_add_u32 s30, s38, 23068672
    buffer_store_dwordx4 v[12:15], v241, s[24:27], s30 offen offset:0 sc1
    buffer_store_dwordx4 v[16:19], v241, s[24:27], s30 offen offset:2048 sc1
    s_add_u32 s31, s65, 16384
    buffer_load_dwordx4 a[80:83], v252, s[24:27], s31 offen offset:0 sc1
    buffer_load_dwordx4 a[84:87], v252, s[24:27], s31 offen offset:1024 sc1
    buffer_load_dwordx4 a[88:91], v252, s[24:27], s31 offen offset:2048 sc1
    buffer_load_dwordx4 a[92:95], v252, s[24:27], s31 offen offset:3072 sc1
    s_add_u32 s31, s65, 49152
    buffer_load_dwordx4 a[96:99], v252, s[24:27], s31 offen offset:0 sc1
    buffer_load_dwordx4 a[100:103], v252, s[24:27], s31 offen offset:1024 sc1
    buffer_load_dwordx4 a[104:107], v252, s[24:27], s31 offen offset:2048 sc1
    buffer_load_dwordx4 a[108:111], v252, s[24:27], s31 offen offset:3072 sc1
    s_add_u32 s31, s93, 4096
    buffer_load_dwordx4 a[112:115], v252, s[24:27], s31 offen offset:0 sc1
    buffer_load_dwordx4 a[116:119], v252, s[24:27], s31 offen offset:1024 sc1
    buffer_load_dwordx4 a[120:123], v252, s[24:27], s31 offen offset:2048 sc1
    buffer_load_dwordx4 a[124:127], v252, s[24:27], s31 offen offset:3072 sc1
    s_add_u32 s31, s92, 4096
    buffer_load_dwordx4 v[140:143], v252, s[24:27], s31 offen offset:0 sc1
    buffer_load_dwordx4 v[144:147], v252, s[24:27], s31 offen offset:1024 sc1
    v_mov_b32 v2, s45
    s_waitcnt vmcnt(14)
    s_barrier
    s_cmp_lg_u32 s19, 0
    s_cbranch_scc1 L_nfb
    buffer_store_dword v2, v243, s[24:27], s36 offen offset:4 sc1
L_nfb:
    s_barrier
    buffer_load_dwordx4 v[148:151], v252, s[24:27], s31 offen offset:2048 sc1
    buffer_load_dwordx4 v[152:155], v252, s[24:27], s31 offen offset:3072 sc1
    s_add_u32 s31, s92, 36864
    buffer_load_dwordx4 v[156:159], v252, s[24:27], s31 offen offset:0 sc1
    buffer_load_dwordx4 v[160:163], v252, s[24:27], s31 offen offset:1024 sc1
    buffer_load_dwordx4 v[164:167], v252, s[24:27], s31 offen offset:2048 sc1
    buffer_load_dwordx4 v[168:171], v252, s[24:27], s31 offen offset:3072 sc1
    s_add_u32 s31, s65, 4096
    buffer_load_dwordx4 v[172:175], v252, s[24:27], s31 offen offset:0 sc1
L_pg11:
    s_cbranch_execz L_pgret
    buffer_load_dwordx4 v[176:179], v252, s[24:27], s31 offen offset:1024 sc1
    buffer_load_dwordx4 v[180:183], v252, s[24:27], s31 offen offset:2048 sc1
    buffer_load_dwordx4 v[184:187], v252, s[24:27], s31 offen offset:3072 sc1
    s_add_u32 s31, s65, 36864
    buffer_load_dwordx4 v[188:191], v252, s[24:27], s31 offen offset:0 sc1
    buffer_load_dwordx4 v[192:195], v252, s[24:27], s31 offen offset:1024 sc1
    s_cmp_lg_u32 s19, 0
    s_cbranch_scc1 L_pfb
    s_load_dword s81, s[90:91], 132 glc
    s_load_dword s82, s[90:91], 260 glc
    s_load_dword s83, s[90:91], 388 glc
    s_load_dword s84, s[90:91], 516 glc
    s_load_dword s85, s[90:91], 644 glc
    s_load_dword s86, s[90:91], 772 glc
    s_load_dword s87, s[90:91], 900 glc
L_pfb:
    buffer_load_dwordx4 v[196:199], v252, s[24:27], s31 offen offset:2048 sc1
    buffer_load_dwordx4 v[200:203], v252, s[24:27], s31 offen offset:3072 sc1
    s_add_u32 s31, s65, 20480
    buffer_load_dwordx4 v[204:207], v252, s[24:27], s31 offen offset:0 sc1
    buffer_load_dwordx4 v[208:211], v252, s[24:27], s31 offen offset:1024 sc1
    buffer_load_dwordx4 v[212:215], v252, s[24:27], s31 offen offset:2048 sc1
    buffer_load_dwordx4 v[216:219], v252, s[24:27], s31 offen offset:3072 sc1
    v_lshrrev_b32 v4, 5, v0
    v_lshlrev_b32 v4, 10, v4
    v_and_b32 v5, 31, v0
    v_lshl_add_u32 v4, v5, 4, v4
    v_add_u32 v248, 65536, v252
    s_bfe_u32 s23, s19, 0x10001
    s_and_b32 s28, s19, 1
    s_lshl_b32 s70, s23, 3
    s_lshl_b32 s71, s28, 9
    s_add_u32 s70, s70, s71
    s_add_u32 s70, s70, 90112
    v_add_u32 v220, s70, v4
    s_lshl_b32 s70, s23, 12
    s_lshl_b32 s71, s28, 3
    s_add_u32 s70, s70, s71
    s_add_u32 s70, s70, 16384
    v_add_u32 v221, s70, v248
    v_add_u32 v222, s17, v248
    s_waitcnt lgkmcnt(0)
    s_cmp_lg_u32 s19, 0
    s_cbranch_scc1 L_poutb
    s_mov_b32 s28, 0
    s_branch L_pcb
L_pollb:
    s_load_dword s81, s[90:91], 132 glc
    s_load_dword s82, s[90:91], 260 glc
    s_load_dword s83, s[90:91], 388 glc
    s_load_dword s84, s[90:91], 516 glc
    s_load_dword s85, s[90:91], 644 glc
    s_load_dword s86, s[90:91], 772 glc
    s_load_dword s87, s[90:91], 900 glc
L_pcb:
    s_add_u32 s28, s28, 1
    s_cmp_gt_u32 s28, 0x80000
    s_waitcnt lgkmcnt(0)
    s_cbranch_scc1 L_poutb
    s_cmp_lg_u32 s81, s45
    s_cbranch_scc1 L_pollb
    s_cmp_lg_u32 s82, s45
    s_cbranch_scc1 L_pollb
    s_cmp_lg_u32 s83, s45
    s_cbranch_scc1 L_pollb
    s_cmp_lg_u32 s84, s45
    s_cbranch_scc1 L_pollb
    s_cmp_lg_u32 s85, s45
    s_cbranch_scc1 L_pollb
    s_cmp_lg_u32 s86, s45
    s_cbranch_scc1 L_pollb
    s_cmp_lg_u32 s87, s45
    s_cbranch_scc1 L_pollb
L_poutb:
    s_barrier
    s_lshr_b32 s29, s22, 1
    s_xor_b32 s29, s29, s19
    s_lshl_b32 s30, s3, 2
    s_add_u32 s30, s30, s29
    s_lshl_b32 s30, s30, 14
    s_add_u32 s30, s30, 23068672
    s_lshl_b32 s29, s19, 10
    s_add_u32 m0, s29, 0
    s_nop 0
    buffer_load_dwordx4 v252, s[24:27], s30 offen sc1 lds
    s_add_u32 m0, s29, 4096
    s_add_u32 s30, s30, 1024
    buffer_load_dwordx4 v252, s[24:27], s30 offen sc1 lds
    s_add_u32 m0, s29, 8192
    s_add_u32 s30, s30, 1024
    buffer_load_dwordx4 v252, s[24:27], s30 offen sc1 lds
    s_add_u32 m0, s29, 12288
    s_add_u32 s30, s30, 1024
    buffer_load_dwordx4 v252, s[24:27], s30 offen sc1 lds
    s_add_u32 m0, s29, 16384
    s_add_u32 s30, s30, 1024
    buffer_load_dwordx4 v252, s[24:27], s30 offen sc1 lds
    s_add_u32 m0, s29, 20480
    s_add_u32 s30, s30, 1024
    buffer_load_dwordx4 v252, s[24:27], s30 offen sc1 lds
    s_add_u32 m0, s29, 24576
    s_add_u32 s30, s30, 1024
    buffer_load_dwordx4 v252, s[24:27], s30 offen sc1 lds
    s_add_u32 m0, s29, 28672
    s_add_u32 s30, s30, 1024
    buffer_load_dwordx4 v252, s[24:27], s30 offen sc1 lds
    s_add_u32 m0, s29, 32768
    s_add_u32 s30, s30, 1024
    buffer_load_dwordx4 v252, s[24:27], s30 offen sc1 lds
    s_add_u32 m0, s29, 36864
    s_add_u32 s30, s30, 1024
    buffer_load_dwordx4 v252, s[24:27], s30 offen sc1 lds
    s_add_u32 m0, s29, 40960
    s_add_u32 s30, s30, 1024
    buffer_load_dwordx4 v252, s[24:27], s30 offen sc1 lds
    s_add_u32 m0, s29, 45056
    s_add_u32 s30, s30, 1024
    buffer_load_dwordx4 v252, s[24:27], s30 offen sc1 lds
    s_add_u32 m0, s29, 49152
    s_add_u32 s30, s30, 1024
    buffer_load_dwordx4 v252, s[24:27], s30 offen sc1 lds
    s_add_u32 m0, s29, 53248
    s_add_u32 s30, s30, 1024
    buffer_load_dwordx4 v252, s[24:27], s30 offen sc1 lds
    s_add_u32 m0, s29, 57344
    s_add_u32 s30, s30, 1024
    buffer_load_dwordx4 v252, s[24:27], s30 offen sc1 lds
    s_add_u32 m0, s29, 61440
    s_add_u32 s30, s30, 1024
    buffer_load_dwordx4 v252, s[24:27], s30 offen sc1 lds
    s_waitcnt vmcnt(12)
    s_barrier
    ds_read_b128 a[128:131], v252 offset:0
    ds_read_b128 a[144:147], v252 offset:4096
    ds_read_b128 a[160:163], v252 offset:8192
    ds_read_b128 a[176:179], v252 offset:12288
    ds_read_b128 a[180:183], v252 offset:13312
    ds_read_b128 a[164:167], v252 offset:9216
    ds_read_b128 a[148:151], v252 offset:5120
    s_waitcnt lgkmcnt(6)
    v_mfma_f32_16x16x32_bf16 v[12:15], a[0:3], a[128:131], 0
    ds_read_b128 a[132:135], v252 offset:1024
    s_waitcnt lgkmcnt(6)
    v_mfma_f32_16x16x32_bf16 v[12:15], a[4:7], a[144:147], v[12:15]
    ds_read_b128 a[136:139], v252 offset:2048
    s_waitcnt lgkmcnt(6)
    v_mfma_f32_16x16x32_bf16 v[12:15], a[8:11], a[160:163], v[12:15]
    ds_read_b128 a[152:155], v252 offset:6144
    s_waitcnt lgkmcnt(6)
    v_mfma_f32_16x16x32_bf16 v[12:15], a[12:15], a[176:179], v[12:15]
    ds_read_b128 a[168:171], v252 offset:10240
    s_waitcnt lgkmcnt(6)
    v_mfma_f32_16x16x32_bf16 v[16:19], a[12:15], a[180:183], 0
    ds_read_b128 a[184:187], v252 offset:14336
    s_waitcnt lgkmcnt(6)
    v_mfma_f32_16x16x32_bf16 v[16:19], a[8:11], a[164:167], v[16:19]
    ds_read_b128 a[188:191], v252 offset:15360
    s_waitcnt lgkmcnt(6)
    v_mfma_f32_16x16x32_bf16 v[16:19], a[4:7], a[148:151], v[16:19]
    ds_read_b128 a[172:175], v252 offset:11264
    s_waitcnt lgkmcnt(6)
    v_mfma_f32_16x16x32_bf16 v[16:19], a[0:3], a[132:135], v[16:19]
    ds_read_b128 a[156:159], v252 offset:7168
    s_waitcnt lgkmcnt(6)
    v_mfma_f32_16x16x32_bf16 v[20:23], a[0:3], a[136:139], 0
    ds_read_b128 a[140:143], v252 offset:3072
    s_waitcnt lgkmcnt(6)
    v_mfma_f32_16x16x32_bf16 v[20:23], a[4:7], a[152:155], v[20:23]
    s_add_u32 s31, s65, 53248
    s_waitcnt lgkmcnt(5)
    v_mfma_f32_16x16x32_bf16 v[20:23], a[8:11], a[168:171], v[20:23]
    s_waitcnt lgkmcnt(4)
    v_mfma_f32_16x16x32_bf16 v[20:23], a[12:15], a[184:187], v[20:23]
    s_waitcnt lgkmcnt(3)
    v_mfma_f32_16x16x32_bf16 v[24:27], a[12:15], a[188:191], 0
    s_waitcnt lgkmcnt(2)
    v_mfma_f32_16x16x32_bf16 v[24:27], a[8:11], a[172:175], v[24:27]
    s_waitcnt lgkmcnt(1)
    v_mfma_f32_16x16x32_bf16 v[24:27], a[4:7], a[156:159], v[24:27]
    s_waitcnt lgkmcnt(0)
    v_mfma_f32_16x16x32_bf16 v[24:27], a[0:3], a[140:143], v[24:27]
    buffer_load_dwordx4 a[0:3], v252, s[24:27], s31 offen offset:0 sc1
    v_mfma_f32_16x16x32_bf16 v[40:43], a[16:19], a[140:143], 0
    v_mfma_f32_16x16x32_bf16 v[40:43], a[20:23], a[156:159], v[40:43]
    v_mfma_f32_16x16x32_bf16 v[40:43], a[24:27], a[172:175], v[40:43]
    v_mfma_f32_16x16x32_bf16 v[40:43], a[28:31], a[188:191], v[40:43]
    buffer_load_dwordx4 a[4:7], v252, s[24:27], s31 offen offset:1024 sc1
    v_mfma_f32_16x16x32_bf16 v[36:39], a[28:31], a[184:187], 0
    v_mfma_f32_16x16x32_bf16 v[36:39], a[24:27], a[168:171], v[36:39]
    v_mfma_f32_16x16x32_bf16 v[36:39], a[20:23], a[152:155], v[36:39]
    v_mfma_f32_16x16x32_bf16 v[36:39], a[16:19], a[136:139], v[36:39]
    buffer_load_dwordx4 a[8:11], v252, s[24:27], s31 offen offset:2048 sc1
    v_mfma_f32_16x16x32_bf16 v[32:35], a[16:19], a[132:135], 0
    v_mfma_f32_16x16x32_bf16 v[32:35], a[20:23], a[148:151], v[32:35]
    v_mfma_f32_16x16x32_bf16 v[32:35], a[24:27], a[164:167], v[32:35]
    v_mfma_f32_16x16x32_bf16 v[32:35], a[28:31], a[180:183], v[32:35]
    buffer_load_dwordx4 a[12:15], v252, s[24:27], s31 offen offset:3072 sc1
    v_mfma_f32_16x16x32_bf16 v[28:31], a[28:31], a[176:179], 0
    s_add_u32 s31, s93, 8192
    v_mfma_f32_16x16x32_bf16 v[28:31], a[24:27], a[160:163], v[28:31]
    v_mfma_f32_16x16x32_bf16 v[28:31], a[20:23], a[144:147], v[28:31]
    v_mfma_f32_16x16x32_bf16 v[28:31], a[16:19], a[128:131], v[28:31]
    buffer_load_dwordx4 a[16:19], v252, s[24:27], s31 offen offset:0 sc1
    v_mfma_f32_16x16x32_bf16 v[44:47], a[32:35], a[128:131], 0
    v_mfma_f32_16x16x32_bf16 v[44:47], a[36:39], a[144:147], v[44:47]
    v_mfma_f32_16x16x32_bf16 v[44:47], a[40:43], a[160:163], v[44:47]
    v_mfma_f32_16x16x32_bf16 v[44:47], a[44:47], a[176:179], v[44:47]
    buffer_load_dwordx4 a[20:23], v252, s[24:27], s31 offen offset:1024 sc1
    v_mfma_f32_16x16x32_bf16 v[48:51], a[44:47], a[180:183], 0
    v_mfma_f32_16x16x32_bf16 v[48:51], a[40:43], a[164:167], v[48:51]
    v_mfma_f32_16x16x32_bf16 v[48:51], a[36:39], a[148:151], v[48:51]
    v_mfma_f32_16x16x32_bf16 v[48:51], a[32:35], a[132:135], v[48:51]
    buffer_load_dwordx4 a[24:27], v252, s[24:27], s31 offen offset:2048 sc1
    v_mfma_f32_16x16x32_bf16 v[52:55], a[32:35], a[136:139], 0
    v_mfma_f32_16x16x32_bf16 v[52:55], a[36:39], a[152:155], v[52:55]
    v_mfma_f32_16x16x32_bf16 v[52:55], a[40:43], a[168:171], v[52:55]
    v_mfma_f32_16x16x32_bf16 v[52:55], a[44:47], a[184:187], v[52:55]
    buffer_load_dwordx4 a[28:31], v252, s[24:27], s31 offen offset:3072 sc1
    v_mfma_f32_16x16x32_bf16 v[56:59], a[44:47], a[188:191], 0
    s_add_u32 s31, s92, 8192
    v_mfma_f32_16x16x32_bf16 v[56:59], a[40:43], a[172:175], v[56:59]
    v_mfma_f32_16x16x32_bf16 v[56:59], a[36:39], a[156:159], v[56:59]
    v_mfma_f32_16x16x32_bf16 v[56:59], a[32:35], a[140:143], v[56:59]
    buffer_load_dwordx4 a[32:35], v252, s[24:27], s31 offen offset:0 sc1
    v_mfma_f32_16x16x32_bf16 v[72:75], a[48:51], a[140:143], 0
    v_mfma_f32_16x16x32_bf16 v[72:75], a[52:55], a[156:159], v[72:75]
    v_mfma_f32_16x16x32_bf16 v[72:75], a[56:59], a[172:175], v[72:75]
    v_mfma_f32_16x16x32_bf16 v[72:75], a[60:63], a[188:191], v[72:75]
    buffer_load_dwordx4 a[36:39], v252, s[24:27], s31 offen offset:1024 sc1
    v_mfma_f32_16x16x32_bf16 v[68:71], a[60:63], a[184:187], 0
    v_mfma_f32_16x16x32_bf16 v[68:71], a[56:59], a[168:171], v[68:71]
    v_mfma_f32_16x16x32_bf16 v[68:71], a[52:55], a[152:155], v[68:71]
    v_mfma_f32_16x16x32_bf16 v[68:71], a[48:51], a[136:139], v[68:71]
    buffer_load_dwordx4 a[40:43], v252, s[24:27], s31 offen offset:2048 sc1
    v_mfma_f32_16x16x32_bf16 v[64:67], a[48:51], a[132:135], 0
    s_waitcnt vmcnt(19)
    s_barrier
    v_mfma_f32_16x16x32_bf16 v[64:67], a[52:55], a[148:151], v[64:67]
    ds_read_b128 a[192:195], v252 offset:16384
    v_mfma_f32_16x16x32_bf16 v[64:67], a[56:59], a[164:167], v[64:67]
    ds_read_b128 a[208:211], v252 offset:20480
    v_mfma_f32_16x16x32_bf16 v[64:67], a[60:63], a[180:183], v[64:67]
    buffer_load_dwordx4 a[44:47], v252, s[24:27], s31 offen offset:3072 sc1
    v_mfma_f32_16x16x32_bf16 v[60:63], a[60:63], a[176:179], 0
    ds_read_b128 a[224:227], v252 offset:24576
    v_mfma_f32_16x16x32_bf16 v[60:63], a[56:59], a[160:163], v[60:63]
    ds_read_b128 a[240:243], v252 offset:28672
    v_mfma_f32_16x16x32_bf16 v[60:63], a[52:55], a[144:147], v[60:63]
    ds_read_b128 a[244:247], v252 offset:29696
    v_mfma_f32_16x16x32_bf16 v[60:63], a[48:51], a[128:131], v[60:63]
    s_add_u32 s31, s92, 40960
    buffer_load_dwordx4 a[48:51], v252, s[24:27], s31 offen offset:0 sc1
    v_mfma_f32_16x16x32_bf16 v[76:79], a[64:67], a[128:131], 0
    ds_read_b128 a[228:231], v252 offset:25600
    v_mfma_f32_16x16x32_bf16 v[76:79], a[68:71], a[144:147], v[76:79]
    ds_read_b128 a[212:215], v252 offset:21504
    v_mfma_f32_16x16x32_bf16 v[76:79], a[72:75], a[160:163], v[76:79]
    ds_read_b128 a[196:199], v252 offset:17408
    v_mfma_f32_16x16x32_bf16 v[76:79], a[76:79], a[176:179], v[76:79]
    buffer_load_dwordx4 a[52:55], v252, s[24:27], s31 offen offset:1024 sc1
    v_mfma_f32_16x16x32_bf16 v[80:83], a[76:79], a[180:183], 0
    ds_read_b128 a[200:203], v252 offset:18432
    v_mfma_f32_16x16x32_bf16 v[80:83], a[72:75], a[164:167], v[80:83]
    ds_read_b128 a[216:219], v252 offset:22528
    v_mfma_f32_16x16x32_bf16 v[80:83], a[68:71], a[148:151], v[80:83]
    ds_read_b128 a[232:235], v252 offset:26624
    v_mfma_f32_16x16x32_bf16 v[80:83], a[64:67], a[132:135], v[80:83]
    buffer_load_dwordx4 a[56:59], v252, s[24:27], s31 offen offset:2048 sc1
    v_mfma_f32_16x16x32_bf16 v[84:87], a[64:67], a[136:139], 0
    ds_read_b128 a[248:251], v252 offset:30720
    v_mfma_f32_16x16x32_bf16 v[84:87], a[68:71], a[152:155], v[84:87]
    ds_read_b128 a[252:255], v252 offset:31744
    v_mfma_f32_16x16x32_bf16 v[84:87], a[72:75], a[168:171], v[84:87]
    ds_read_b128 a[236:239], v252 offset:27648
    v_mfma_f32_16x16x32_bf16 v[84:87], a[76:79], a[184:187], v[84:87]
    buffer_load_dwordx4 a[60:63], v252, s[24:27], s31 offen offset:3072 sc1
    v_mfma_f32_16x16x32_bf16 v[88:91], a[76:79], a[188:191], 0
    ds_read_b128 a[220:223], v252 offset:23552
    v_mfma_f32_16x16x32_bf16 v[88:91], a[72:75], a[172:175], v[88:91]
    ds_read_b128 a[204:207], v252 offset:19456
    v_mfma_f32_16x16x32_bf16 v[88:91], a[68:71], a[156:159], v[88:91]
    s_add_u32 s31, s65, 8192
    v_mfma_f32_16x16x32_bf16 v[88:91], a[64:67], a[140:143], v[88:91]
    buffer_load_dwordx4 a[64:67], v252, s[24:27], s31 offen offset:0 sc1
    v_mfma_f32_16x16x32_bf16 v[104:107], a[80:83], a[140:143], 0
    v_mfma_f32_16x16x32_bf16 v[104:107], a[84:87], a[156:159], v[104:107]
    v_mfma_f32_16x16x32_bf16 v[104:107], a[88:91], a[172:175], v[104:107]
    v_mfma_f32_16x16x32_bf16 v[104:107], a[92:95], a[188:191], v[104:107]
    buffer_load_dwordx4 a[68:71], v252, s[24:27], s31 offen offset:1024 sc1
    v_mfma_f32_16x16x32_bf16 v[100:103], a[92:95], a[184:187], 0
    v_mfma_f32_16x16x32_bf16 v[100:103], a[88:91], a[168:171], v[100:103]
    v_mfma_f32_16x16x32_bf16 v[100:103], a[84:87], a[152:155], v[100:103]
    v_mfma_f32_16x16x32_bf16 v[100:103], a[80:83], a[136:139], v[100:103]
    buffer_load_dwordx4 a[72:75], v252, s[24:27], s31 offen offset:2048 sc1
    v_mfma_f32_16x16x32_bf16 v[96:99], a[80:83], a[132:135], 0
    v_mfma_f32_16x16x32_bf16 v[96:99], a[84:87], a[148:151], v[96:99]
    v_mfma_f32_16x16x32_bf16 v[96:99], a[88:91], a[164:167], v[96:99]
    v_mfma_f32_16x16x32_bf16 v[96:99], a[92:95], a[180:183], v[96:99]
    buffer_load_dwordx4 a[76:79], v252, s[24:27], s31 offen offset:3072 sc1
    v_mfma_f32_16x16x32_bf16 v[92:95], a[92:95], a[176:179], 0
    s_add_u32 s31, s65, 40960
    v_mfma_f32_16x16x32_bf16 v[92:95], a[88:91], a[160:163], v[92:95]
    v_mfma_f32_16x16x32_bf16 v[92:95], a[84:87], a[144:147], v[92:95]
    v_mfma_f32_16x16x32_bf16 v[92:95], a[80:83], a[128:131], v[92:95]
    buffer_load_dwordx4 a[80:83], v252, s[24:27], s31 offen offset:0 sc1
    v_mfma_f32_16x16x32_bf16 v[108:111], a[96:99], a[128:131], 0
    v_mfma_f32_16x16x32_bf16 v[108:111], a[100:103], a[144:147], v[108:111]
    v_mfma_f32_16x16x32_bf16 v[108:111], a[104:107], a[160:163], v[108:111]
    v_mfma_f32_16x16x32_bf16 v[108:111], a[108:111], a[176:179], v[108:111]
    buffer_load_dwordx4 a[84:87], v252, s[24:27], s31 offen offset:1024 sc1
    v_mfma_f32_16x16x32_bf16 v[112:115], a[108:111], a[180:183], 0
    v_mfma_f32_16x16x32_bf16 v[112:115], a[104:107], a[164:167], v[112:115]
    v_mfma_f32_16x16x32_bf16 v[112:115], a[100:103], a[148:151], v[112:115]
    v_mfma_f32_16x16x32_bf16 v[112:115], a[96:99], a[132:135], v[112:115]
    buffer_load_dwordx4 a[88:91], v252, s[24:27], s31 offen offset:2048 sc1
    v_mfma_f32_16x16x32_bf16 v[116:119], a[96:99], a[136:139], 0
    v_mfma_f32_16x16x32_bf16 v[116:119], a[100:103], a[152:155], v[116:119]
    v_mfma_f32_16x16x32_bf16 v[116:119], a[104:107], a[168:171], v[116:119]
    v_mfma_f32_16x16x32_bf16 v[116:119], a[108:111], a[184:187], v[116:119]
    buffer_load_dwordx4 a[92:95], v252, s[24:27], s31 offen offset:3072 sc1
    v_mfma_f32_16x16x32_bf16 v[120:123], a[108:111], a[188:191], 0
    s_add_u32 s31, s65, 24576
    v_mfma_f32_16x16x32_bf16 v[120:123], a[104:107], a[172:175], v[120:123]
    v_mfma_f32_16x16x32_bf16 v[120:123], a[100:103], a[156:159], v[120:123]
    v_mfma_f32_16x16x32_bf16 v[120:123], a[96:99], a[140:143], v[120:123]
    buffer_load_dwordx4 a[96:99], v252, s[24:27], s31 offen offset:0 sc1
    s_waitcnt lgkmcnt(12)
    v_mfma_f32_16x16x32_bf16 v[12:15], a[112:115], a[192:195], v[12:15]
    v_mfma_f32_16x16x32_bf16 v[12:15], a[116:119], a[208:211], v[12:15]
    v_mfma_f32_16x16x32_bf16 v[12:15], a[120:123], a[224:227], v[12:15]
    v_mfma_f32_16x16x32_bf16 v[12:15], a[124:127], a[240:243], v[12:15]
    buffer_load_dwordx4 a[100:103], v252, s[24:27], s31 offen offset:1024 sc1
    s_waitcnt lgkmcnt(8)
    v_mfma_f32_16x16x32_bf16 v[16:19], a[124:127], a[244:247], v[16:19]
    v_mfma_f32_16x16x32_bf16 v[16:19], a[120:123], a[228:231], v[16:19]
    v_mfma_f32_16x16x32_bf16 v[16:19], a[116:119], a[212:215], v[16:19]
    v_mfma_f32_16x16x32_bf16 v[16:19], a[112:115], a[196:199], v[16:19]
    buffer_load_dwordx4 a[104:107], v252, s[24:27], s31 offen offset:2048 sc1
    s_waitcnt lgkmcnt(4)
    v_mfma_f32_16x16x32_bf16 v[20:23], a[112:115], a[200:203], v[20:23]
    v_mfma_f32_16x16x32_bf16 v[20:23], a[116:119], a[216:219], v[20:23]
    v_mfma_f32_16x16x32_bf16 v[20:23], a[120:123], a[232:235], v[20:23]
    v_mfma_f32_16x16x32_bf16 v[20:23], a[124:127], a[248:251], v[20:23]
    buffer_load_dwordx4 a[108:111], v252, s[24:27], s31 offen offset:3072 sc1
    s_waitcnt lgkmcnt(0)
    v_mfma_f32_16x16x32_bf16 v[24:27], a[124:127], a[252:255], v[24:27]
    s_add_u32 s31, s65, 57344
    v_mfma_f32_16x16x32_bf16 v[24:27], a[120:123], a[236:239], v[24:27]
    v_mfma_f32_16x16x32_bf16 v[24:27], a[116:119], a[220:223], v[24:27]
    v_mfma_f32_16x16x32_bf16 v[24:27], a[112:115], a[204:207], v[24:27]
    buffer_load_dwordx4 a[112:115], v252, s[24:27], s31 offen offset:0 sc1
    v_mfma_f32_16x16x32_bf16 v[40:43], v[140:143], a[204:207], v[40:43]
    v_mfma_f32_16x16x32_bf16 v[40:43], v[144:147], a[220:223], v[40:43]
    v_mfma_f32_16x16x32_bf16 v[40:43], v[148:151], a[236:239], v[40:43]
    v_mfma_f32_16x16x32_bf16 v[40:43], v[152:155], a[252:255], v[40:43]
    buffer_load_dwordx4 a[116:119], v252, s[24:27], s31 offen offset:1024 sc1
    v_mfma_f32_16x16x32_bf16 v[36:39], v[152:155], a[248:251], v[36:39]
    v_mfma_f32_16x16x32_bf16 v[36:39], v[148:151], a[232:235], v[36:39]
    v_mfma_f32_16x16x32_bf16 v[36:39], v[144:147], a[216:219], v[36:39]
    v_mfma_f32_16x16x32_bf16 v[36:39], v[140:143], a[200:203], v[36:39]
    buffer_load_dwordx4 a[120:123], v252, s[24:27], s31 offen offset:2048 sc1
    v_mfma_f32_16x16x32_bf16 v[32:35], v[140:143], a[196:199], v[32:35]
    v_mfma_f32_16x16x32_bf16 v[32:35], v[144:147], a[212:215], v[32:35]
    v_mfma_f32_16x16x32_bf16 v[32:35], v[148:151], a[228:231], v[32:35]
    v_mfma_f32_16x16x32_bf16 v[32:35], v[152:155], a[244:247], v[32:35]
    buffer_load_dwordx4 a[124:127], v252, s[24:27], s31 offen offset:3072 sc1
    v_mfma_f32_16x16x32_bf16 v[28:31], v[152:155], a[240:243], v[28:31]
    s_add_u32 s31, s93, 12288
    v_mfma_f32_16x16x32_bf16 v[28:31], v[148:151], a[224:227], v[28:31]
    v_mfma_f32_16x16x32_bf16 v[28:31], v[144:147], a[208:211], v[28:31]
    v_mfma_f32_16x16x32_bf16 v[28:31], v[140:143], a[192:195], v[28:31]
    buffer_load_dwordx4 v[140:143], v252, s[24:27], s31 offen offset:0 sc1
    v_mfma_f32_16x16x32_bf16 v[44:47], v[156:159], a[192:195], v[44:47]
    v_mfma_f32_16x16x32_bf16 v[44:47], v[160:163], a[208:211], v[44:47]
    v_mfma_f32_16x16x32_bf16 v[44:47], v[164:167], a[224:227], v[44:47]
    v_mfma_f32_16x16x32_bf16 v[44:47], v[168:171], a[240:243], v[44:47]
    buffer_load_dwordx4 v[144:147], v252, s[24:27], s31 offen offset:1024 sc1
    v_mfma_f32_16x16x32_bf16 v[48:51], v[168:171], a[244:247], v[48:51]
    v_mfma_f32_16x16x32_bf16 v[48:51], v[164:167], a[228:231], v[48:51]
    v_mfma_f32_16x16x32_bf16 v[48:51], v[160:163], a[212:215], v[48:51]
    v_mfma_f32_16x16x32_bf16 v[48:51], v[156:159], a[196:199], v[48:51]
    buffer_load_dwordx4 v[148:151], v252, s[24:27], s31 offen offset:2048 sc1
    v_mfma_f32_16x16x32_bf16 v[52:55], v[156:159], a[200:203], v[52:55]
    v_mfma_f32_16x16x32_bf16 v[52:55], v[160:163], a[216:219], v[52:55]
    v_mfma_f32_16x16x32_bf16 v[52:55], v[164:167], a[232:235], v[52:55]
    v_mfma_f32_16x16x32_bf16 v[52:55], v[168:171], a[248:251], v[52:55]
    buffer_load_dwordx4 v[152:155], v252, s[24:27], s31 offen offset:3072 sc1
    v_mfma_f32_16x16x32_bf16 v[56:59], v[168:171], a[252:255], v[56:59]
    s_add_u32 s31, s92, 12288
    v_mfma_f32_16x16x32_bf16 v[56:59], v[164:167], a[236:239], v[56:59]
    v_mfma_f32_16x16x32_bf16 v[56:59], v[160:163], a[220:223], v[56:59]
    v_mfma_f32_16x16x32_bf16 v[56:59], v[156:159], a[204:207], v[56:59]
    buffer_load_dwordx4 v[156:159], v252, s[24:27], s31 offen offset:0 sc1
    v_mfma_f32_16x16x32_bf16 v[72:75], v[172:175], a[204:207], v[72:75]
    v_mfma_f32_16x16x32_bf16 v[72:75], v[176:179], a[220:223], v[72:75]
    v_mfma_f32_16x16x32_bf16 v[72:75], v[180:183], a[236:239], v[72:75]
    v_mfma_f32_16x16x32_bf16 v[72:75], v[184:187], a[252:255], v[72:75]
    buffer_load_dwordx4 v[160:163], v252, s[24:27], s31 offen offset:1024 sc1
    v_mfma_f32_16x16x32_bf16 v[68:71], v[184:187], a[248:251], v[68:71]
    v_mfma_f32_16x16x32_bf16 v[68:71], v[180:183], a[232:235], v[68:71]
    v_mfma_f32_16x16x32_bf16 v[68:71], v[176:179], a[216:219], v[68:71]
    v_mfma_f32_16x16x32_bf16 v[68:71], v[172:175], a[200:203], v[68:71]
    buffer_load_dwordx4 v[164:167], v252, s[24:27], s31 offen offset:2048 sc1
    v_mfma_f32_16x16x32_bf16 v[64:67], v[172:175], a[196:199], v[64:67]
    s_waitcnt vmcnt(43)
    s_barrier
    v_mfma_f32_16x16x32_bf16 v[64:67], v[176:179], a[212:215], v[64:67]
    v_mfma_f32_16x16x32_bf16 v[64:67], v[180:183], a[228:231], v[64:67]
    ds_read_b128 a[128:131], v252 offset:32768
    v_mfma_f32_16x16x32_bf16 v[64:67], v[184:187], a[244:247], v[64:67]
    buffer_load_dwordx4 v[168:171], v252, s[24:27], s31 offen offset:3072 sc1
    v_mfma_f32_16x16x32_bf16 v[60:63], v[184:187], a[240:243], v[60:63]
    ds_read_b128 a[144:147], v252 offset:36864
    v_mfma_f32_16x16x32_bf16 v[60:63], v[180:183], a[224:227], v[60:63]
    s_add_u32 s31, s92, 45056
    v_mfma_f32_16x16x32_bf16 v[60:63], v[176:179], a[208:211], v[60:63]
    ds_read_b128 a[160:163], v252 offset:40960
    v_mfma_f32_16x16x32_bf16 v[60:63], v[172:175], a[192:195], v[60:63]
    buffer_load_dwordx4 v[172:175], v252, s[24:27], s31 offen offset:0 sc1
    v_mfma_f32_16x16x32_bf16 v[76:79], v[188:191], a[192:195], v[76:79]
    ds_read_b128 a[176:179], v252 offset:45056
    v_mfma_f32_16x16x32_bf16 v[76:79], v[192:195], a[208:211], v[76:79]
    v_mfma_f32_16x16x32_bf16 v[76:79], v[196:199], a[224:227], v[76:79]
    ds_read_b128 a[180:183], v252 offset:46080
    v_mfma_f32_16x16x32_bf16 v[76:79], v[200:203], a[240:243], v[76:79]
    buffer_load_dwordx4 v[176:179], v252, s[24:27], s31 offen offset:1024 sc1
    v_mfma_f32_16x16x32_bf16 v[80:83], v[200:203], a[244:247], v[80:83]
    ds_read_b128 a[164:167], v252 offset:41984
    v_mfma_f32_16x16x32_bf16 v[80:83], v[196:199], a[228:231], v[80:83]
    v_mfma_f32_16x16x32_bf16 v[80:83], v[192:195], a[212:215], v[80:83]
    ds_read_b128 a[148:151], v252 offset:37888
    v_mfma_f32_16x16x32_bf16 v[80:83], v[188:191], a[196:199], v[80:83]
    buffer_load_dwordx4 v[180:183], v252, s[24:27], s31 offen offset:2048 sc1
    v_mfma_f32_16x16x32_bf16 v[84:87], v[188:191], a[200:203], v[84:87]
    ds_read_b128 a[132:135], v252 offset:33792
    v_mfma_f32_16x16x32_bf16 v[84:87], v[192:195], a[216:219], v[84:87]
    v_mfma_f32_16x16x32_bf16 v[84:87], v[196:199], a[232:235], v[84:87]
    ds_read_b128 a[136:139], v252 offset:34816
    v_mfma_f32_16x16x32_bf16 v[84:87], v[200:203], a[248:251], v[84:87]
    buffer_load_dwordx4 v[184:187], v252, s[24:27], s31 offen offset:3072 sc1
    v_mfma_f32_16x16x32_bf16 v[88:91], v[200:203], a[252:255], v[88:91]
    ds_read_b128 a[152:155], v252 offset:38912
    v_mfma_f32_16x16x32_bf16 v[88:91], v[196:199], a[236:239], v[88:91]
    s_add_u32 s31, s65, 12288
    v_mfma_f32_16x16x32_bf16 v[88:91], v[192:195], a[220:223], v[88:91]
    ds_read_b128 a[168:171], v252 offset:43008
    v_mfma_f32_16x16x32_bf16 v[88:91], v[188:191], a[204:207], v[88:91]
    buffer_load_dwordx4 v[188:191], v252, s[24:27], s31 offen offset:0 sc1
    v_mfma_f32_16x16x32_bf16 v[104:107], v[204:207], a[204:207], v[104:107]
    ds_read_b128 a[184:187], v252 offset:47104
    v_mfma_f32_16x16x32_bf16 v[104:107], v[208:211], a[220:223], v[104:107]
    v_mfma_f32_16x16x32_bf16 v[104:107], v[212:215], a[236:239], v[104:107]
    ds_read_b128 a[188:191], v252 offset:48128
    v_mfma_f32_16x16x32_bf16 v[104:107], v[216:219], a[252:255], v[104:107]
    buffer_load_dwordx4 v[192:195], v252, s[24:27], s31 offen offset:1024 sc1
    v_mfma_f32_16x16x32_bf16 v[100:103], v[216:219], a[248:251], v[100:103]
    ds_read_b128 a[172:175], v252 offset:44032
    v_mfma_f32_16x16x32_bf16 v[100:103], v[212:215], a[232:235], v[100:103]
    v_mfma_f32_16x16x32_bf16 v[100:103], v[208:211], a[216:219], v[100:103]
    ds_read_b128 a[156:159], v252 offset:39936
    v_mfma_f32_16x16x32_bf16 v[100:103], v[204:207], a[200:203], v[100:103]
    buffer_load_dwordx4 v[196:199], v252, s[24:27], s31 offen offset:2048 sc1
    v_mfma_f32_16x16x32_bf16 v[96:99], v[204:207], a[196:199], v[96:99]
    ds_read_b128 a[140:143], v252 offset:35840
    v_mfma_f32_16x16x32_bf16 v[96:99], v[208:211], a[212:215], v[96:99]
    v_mfma_f32_16x16x32_bf16 v[96:99], v[212:215], a[228:231], v[96:99]
    v_mfma_f32_16x16x32_bf16 v[96:99], v[216:219], a[244:247], v[96:99]
    buffer_load_dwordx4 v[200:203], v252, s[24:27], s31 offen offset:3072 sc1
    v_mfma_f32_16x16x32_bf16 v[92:95], v[216:219], a[240:243], v[92:95]
    s_add_u32 s31, s65, 45056
    v_mfma_f32_16x16x32_bf16 v[92:95], v[212:215], a[224:227], v[92:95]
    v_mfma_f32_16x16x32_bf16 v[92:95], v[208:211], a[208:211], v[92:95]
    v_mfma_f32_16x16x32_bf16 v[92:95], v[204:207], a[192:195], v[92:95]
    buffer_load_dwordx4 v[204:207], v252, s[24:27], s31 offen offset:0 sc1
    s_waitcnt vmcnt(45)
    v_mfma_f32_16x16x32_bf16 v[108:111], a[0:3], a[192:195], v[108:111]
    v_mfma_f32_16x16x32_bf16 v[108:111], a[4:7], a[208:211], v[108:111]
    v_mfma_f32_16x16x32_bf16 v[108:111], a[8:11], a[224:227], v[108:111]
    v_mfma_f32_16x16x32_bf16 v[108:111], a[12:15], a[240:243], v[108:111]
    buffer_load_dwordx4 v[208:211], v252, s[24:27], s31 offen offset:1024 sc1
    v_mfma_f32_16x16x32_bf16 v[112:115], a[12:15], a[244:247], v[112:115]
    v_mfma_f32_16x16x32_bf16 v[112:115], a[8:11], a[228:231], v[112:115]
    v_mfma_f32_16x16x32_bf16 v[112:115], a[4:7], a[212:215], v[112:115]
    v_mfma_f32_16x16x32_bf16 v[112:115], a[0:3], a[196:199], v[112:115]
    buffer_load_dwordx4 v[212:215], v252, s[24:27], s31 offen offset:2048 sc1
    v_mfma_f32_16x16x32_bf16 v[116:119], a[0:3], a[200:203], v[116:119]
    v_mfma_f32_16x16x32_bf16 v[116:119], a[4:7], a[216:219], v[116:119]
    v_mfma_f32_16x16x32_bf16 v[116:119], a[8:11], a[232:235], v[116:119]
    v_mfma_f32_16x16x32_bf16 v[116:119], a[12:15], a[248:251], v[116:119]
    buffer_load_dwordx4 v[216:219], v252, s[24:27], s31 offen offset:3072 sc1
    v_mfma_f32_16x16x32_bf16 v[120:123], a[12:15], a[252:255], v[120:123]
    s_add_u32 s31, s65, 28672
    v_mfma_f32_16x16x32_bf16 v[120:123], a[8:11], a[236:239], v[120:123]
    v_mfma_f32_16x16x32_bf16 v[120:123], a[4:7], a[220:223], v[120:123]
    v_mfma_f32_16x16x32_bf16 v[120:123], a[0:3], a[204:207], v[120:123]
    buffer_load_dwordx4 a[0:3], v252, s[24:27], s31 offen offset:0 sc1
    s_waitcnt vmcnt(45)
    s_waitcnt lgkmcnt(12)
    v_mfma_f32_16x16x32_bf16 v[12:15], a[16:19], a[128:131], v[12:15]
    v_mfma_f32_16x16x32_bf16 v[12:15], a[20:23], a[144:147], v[12:15]
    v_mfma_f32_16x16x32_bf16 v[12:15], a[24:27], a[160:163], v[12:15]
    v_mfma_f32_16x16x32_bf16 v[12:15], a[28:31], a[176:179], v[12:15]
    buffer_load_dwordx4 a[4:7], v252, s[24:27], s31 offen offset:1024 sc1
    s_waitcnt lgkmcnt(8)
    v_mfma_f32_16x16x32_bf16 v[16:19], a[28:31], a[180:183], v[16:19]
    v_mfma_f32_16x16x32_bf16 v[16:19], a[24:27], a[164:167], v[16:19]
    v_mfma_f32_16x16x32_bf16 v[16:19], a[20:23], a[148:151], v[16:19]
    v_mfma_f32_16x16x32_bf16 v[16:19], a[16:19], a[132:135], v[16:19]
    buffer_load_dwordx4 a[8:11], v252, s[24:27], s31 offen offset:2048 sc1
    s_waitcnt lgkmcnt(4)
    v_mfma_f32_16x16x32_bf16 v[20:23], a[16:19], a[136:139], v[20:23]
    v_mfma_f32_16x16x32_bf16 v[20:23], a[20:23], a[152:155], v[20:23]
    v_mfma_f32_16x16x32_bf16 v[20:23], a[24:27], a[168:171], v[20:23]
    v_mfma_f32_16x16x32_bf16 v[20:23], a[28:31], a[184:187], v[20:23]
    buffer_load_dwordx4 a[12:15], v252, s[24:27], s31 offen offset:3072 sc1
    s_waitcnt lgkmcnt(0)
    v_mfma_f32_16x16x32_bf16 v[24:27], a[28:31], a[188:191], v[24:27]
    s_add_u32 s31, s65, 61440
    v_mfma_f32_16x16x32_bf16 v[24:27], a[24:27], a[172:175], v[24:27]
    v_mfma_f32_16x16x32_bf16 v[24:27], a[20:23], a[156:159], v[24:27]
    v_mfma_f32_16x16x32_bf16 v[24:27], a[16:19], a[140:143], v[24:27]
    buffer_load_dwordx4 a[16:19], v252, s[24:27], s31 offen offset:0 sc1
    s_waitcnt vmcnt(45)
    v_mfma_f32_16x16x32_bf16 v[40:43], a[32:35], a[140:143], v[40:43]
    v_mfma_f32_16x16x32_bf16 v[40:43], a[36:39], a[156:159], v[40:43]
    v_mfma_f32_16x16x32_bf16 v[40:43], a[40:43], a[172:175], v[40:43]
    v_mfma_f32_16x16x32_bf16 v[40:43], a[44:47], a[188:191], v[40:43]
    buffer_load_dwordx4 a[20:23], v252, s[24:27], s31 offen offset:1024 sc1
    v_mfma_f32_16x16x32_bf16 v[36:39], a[44:47], a[184:187], v[36:39]
    v_mfma_f32_16x16x32_bf16 v[36:39], a[40:43], a[168:171], v[36:39]
    v_mfma_f32_16x16x32_bf16 v[36:39], a[36:39], a[152:155], v[36:39]
    v_mfma_f32_16x16x32_bf16 v[36:39], a[32:35], a[136:139], v[36:39]
    buffer_load_dwordx4 a[24:27], v252, s[24:27], s31 offen offset:2048 sc1
    v_mfma_f32_16x16x32_bf16 v[32:35], a[32:35], a[132:135], v[32:35]
    v_mfma_f32_16x16x32_bf16 v[32:35], a[36:39], a[148:151], v[32:35]
    v_mfma_f32_16x16x32_bf16 v[32:35], a[40:43], a[164:167], v[32:35]
    v_mfma_f32_16x16x32_bf16 v[32:35], a[44:47], a[180:183], v[32:35]
    buffer_load_dwordx4 a[28:31], v252, s[24:27], s31 offen offset:3072 sc1
    v_mfma_f32_16x16x32_bf16 v[28:31], a[44:47], a[176:179], v[28:31]
    s_add_u32 s31, s66, 0
    v_mfma_f32_16x16x32_bf16 v[28:31], a[40:43], a[160:163], v[28:31]
    v_mfma_f32_16x16x32_bf16 v[28:31], a[36:39], a[144:147], v[28:31]
    v_mfma_f32_16x16x32_bf16 v[28:31], a[32:35], a[128:131], v[28:31]
    buffer_load_dwordx4 a[32:35], v252, s[24:27], s31 offen offset:0 sc1
    s_waitcnt vmcnt(45)
    v_mfma_f32_16x16x32_bf16 v[44:47], a[48:51], a[128:131], v[44:47]
    v_mfma_f32_16x16x32_bf16 v[44:47], a[52:55], a[144:147], v[44:47]
    v_mfma_f32_16x16x32_bf16 v[44:47], a[56:59], a[160:163], v[44:47]
    v_mfma_f32_16x16x32_bf16 v[44:47], a[60:63], a[176:179], v[44:47]
    buffer_load_dwordx4 a[36:39], v252, s[24:27], s31 offen offset:1024 sc1
    v_mfma_f32_16x16x32_bf16 v[48:51], a[60:63], a[180:183], v[48:51]
    v_mfma_f32_16x16x32_bf16 v[48:51], a[56:59], a[164:167], v[48:51]
    v_mfma_f32_16x16x32_bf16 v[48:51], a[52:55], a[148:151], v[48:51]
    v_mfma_f32_16x16x32_bf16 v[48:51], a[48:51], a[132:135], v[48:51]
    buffer_load_dwordx4 a[40:43], v252, s[24:27], s31 offen offset:2048 sc1
    v_mfma_f32_16x16x32_bf16 v[52:55], a[48:51], a[136:139], v[52:55]
L_pg12:
    s_cbranch_execz L_pgret
    v_mfma_f32_16x16x32_bf16 v[52:55], a[52:55], a[152:155], v[52:55]
    v_mfma_f32_16x16x32_bf16 v[52:55], a[56:59], a[168:171], v[52:55]
    v_mfma_f32_16x16x32_bf16 v[52:55], a[60:63], a[184:187], v[52:55]
    buffer_load_dwordx4 a[44:47], v252, s[24:27], s31 offen offset:3072 sc1
    v_mfma_f32_16x16x32_bf16 v[56:59], a[60:63], a[188:191], v[56:59]
    s_add_u32 s31, s66, 4096
    v_mfma_f32_16x16x32_bf16 v[56:59], a[56:59], a[172:175], v[56:59]
    v_mfma_f32_16x16x32_bf16 v[56:59], a[52:55], a[156:159], v[56:59]
    v_mfma_f32_16x16x32_bf16 v[56:59], a[48:51], a[140:143], v[56:59]
    buffer_load_dwordx4 a[48:51], v252, s[24:27], s31 offen offset:0 sc1
    s_waitcnt vmcnt(45)
    v_mfma_f32_16x16x32_bf16 v[72:75], a[64:67], a[140:143], v[72:75]
    v_mfma_f32_16x16x32_bf16 v[72:75], a[68:71], a[156:159], v[72:75]
    v_mfma_f32_16x16x32_bf16 v[72:75], a[72:75], a[172:175], v[72:75]
    v_mfma_f32_16x16x32_bf16 v[72:75], a[76:79], a[188:191], v[72:75]
    buffer_load_dwordx4 a[52:55], v252, s[24:27], s31 offen offset:1024 sc1
    v_mfma_f32_16x16x32_bf16 v[68:71], a[76:79], a[184:187], v[68:71]
    v_mfma_f32_16x16x32_bf16 v[68:71], a[72:75], a[168:171], v[68:71]
    v_mfma_f32_16x16x32_bf16 v[68:71], a[68:71], a[152:155], v[68:71]
    v_mfma_f32_16x16x32_bf16 v[68:71], a[64:67], a[136:139], v[68:71]
    buffer_load_dwordx4 a[56:59], v252, s[24:27], s31 offen offset:2048 sc1
    v_mfma_f32_16x16x32_bf16 v[64:67], a[64:67], a[132:135], v[64:67]
    s_barrier
    v_mfma_f32_16x16x32_bf16 v[64:67], a[68:71], a[148:151], v[64:67]
    v_mfma_f32_16x16x32_bf16 v[64:67], a[72:75], a[164:167], v[64:67]
    ds_read_b128 a[192:195], v252 offset:49152
    v_mfma_f32_16x16x32_bf16 v[64:67], a[76:79], a[180:183], v[64:67]
    buffer_load_dwordx4 a[60:63], v252, s[24:27], s31 offen offset:3072 sc1
    v_mfma_f32_16x16x32_bf16 v[60:63], a[76:79], a[176:179], v[60:63]
    ds_read_b128 a[208:211], v252 offset:53248
    v_mfma_f32_16x16x32_bf16 v[60:63], a[72:75], a[160:163], v[60:63]
    s_add_u32 s31, s66, 8192
    v_mfma_f32_16x16x32_bf16 v[60:63], a[68:71], a[144:147], v[60:63]
    ds_read_b128 a[224:227], v252 offset:57344
    v_mfma_f32_16x16x32_bf16 v[60:63], a[64:67], a[128:131], v[60:63]
    buffer_load_dwordx4 a[64:67], v252, s[24:27], s31 offen offset:0 sc1
    s_waitcnt vmcnt(45)
    v_mfma_f32_16x16x32_bf16 v[76:79], a[80:83], a[128:131], v[76:79]
    ds_read_b128 a[240:243], v252 offset:61440
    v_mfma_f32_16x16x32_bf16 v[76:79], a[84:87], a[144:147], v[76:79]
    v_mfma_f32_16x16x32_bf16 v[76:79], a[88:91], a[160:163], v[76:79]
    ds_read_b128 a[244:247], v252 offset:62464
    v_mfma_f32_16x16x32_bf16 v[76:79], a[92:95], a[176:179], v[76:79]
    buffer_load_dwordx4 a[68:71], v252, s[24:27], s31 offen offset:1024 sc1
    v_mfma_f32_16x16x32_bf16 v[80:83], a[92:95], a[180:183], v[80:83]
    ds_read_b128 a[228:231], v252 offset:58368
    v_mfma_f32_16x16x32_bf16 v[80:83], a[88:91], a[164:167], v[80:83]
    v_mfma_f32_16x16x32_bf16 v[80:83], a[84:87], a[148:151], v[80:83]
    ds_read_b128 a[212:215], v252 offset:54272
    v_mfma_f32_16x16x32_bf16 v[80:83], a[80:83], a[132:135], v[80:83]
    buffer_load_dwordx4 a[72:75], v252, s[24:27], s31 offen offset:2048 sc1
    v_mfma_f32_16x16x32_bf16 v[84:87], a[80:83], a[136:139], v[84:87]
    ds_read_b128 a[196:199], v252 offset:50176
    v_mfma_f32_16x16x32_bf16 v[84:87], a[84:87], a[152:155], v[84:87]
    v_mfma_f32_16x16x32_bf16 v[84:87], a[88:91], a[168:171], v[84:87]
    ds_read_b128 a[200:203], v252 offset:51200
    v_mfma_f32_16x16x32_bf16 v[84:87], a[92:95], a[184:187], v[84:87]
    buffer_load_dwordx4 a[76:79], v252, s[24:27], s31 offen offset:3072 sc1
    v_mfma_f32_16x16x32_bf16 v[88:91], a[92:95], a[188:191], v[88:91]
    ds_read_b128 a[216:219], v252 offset:55296
    v_mfma_f32_16x16x32_bf16 v[88:91], a[88:91], a[172:175], v[88:91]
    s_add_u32 s31, s66, 12288
    v_mfma_f32_16x16x32_bf16 v[88:91], a[84:87], a[156:159], v[88:91]
    ds_read_b128 a[232:235], v252 offset:59392
    v_mfma_f32_16x16x32_bf16 v[88:91], a[80:83], a[140:143], v[88:91]
    buffer_load_dwordx4 a[80:83], v252, s[24:27], s31 offen offset:0 sc1
    s_waitcnt vmcnt(45)
    v_mfma_f32_16x16x32_bf16 v[104:107], a[96:99], a[140:143], v[104:107]
    ds_read_b128 a[248:251], v252 offset:63488
    v_mfma_f32_16x16x32_bf16 v[104:107], a[100:103], a[156:159], v[104:107]
    v_mfma_f32_16x16x32_bf16 v[104:107], a[104:107], a[172:175], v[104:107]
    ds_read_b128 a[252:255], v252 offset:64512
    v_mfma_f32_16x16x32_bf16 v[104:107], a[108:111], a[188:191], v[104:107]
    buffer_load_dwordx4 a[84:87], v252, s[24:27], s31 offen offset:1024 sc1
    v_mfma_f32_16x16x32_bf16 v[100:103], a[108:111], a[184:187], v[100:103]
    ds_read_b128 a[236:239], v252 offset:60416
    v_mfma_f32_16x16x32_bf16 v[100:103], a[104:107], a[168:171], v[100:103]
    v_mfma_f32_16x16x32_bf16 v[100:103], a[100:103], a[152:155], v[100:103]
    ds_read_b128 a[220:223], v252 offset:56320
    v_mfma_f32_16x16x32_bf16 v[100:103], a[96:99], a[136:139], v[100:103]
    buffer_load_dwordx4 a[88:91], v252, s[24:27], s31 offen offset:2048 sc1
    v_mfma_f32_16x16x32_bf16 v[96:99], a[96:99], a[132:135], v[96:99]
    ds_read_b128 a[204:207], v252 offset:52224
    v_mfma_f32_16x16x32_bf16 v[96:99], a[100:103], a[148:151], v[96:99]
    v_mfma_f32_16x16x32_bf16 v[96:99], a[104:107], a[164:167], v[96:99]
    v_mfma_f32_16x16x32_bf16 v[96:99], a[108:111], a[180:183], v[96:99]
    buffer_load_dwordx4 a[92:95], v252, s[24:27], s31 offen offset:3072 sc1
    v_mfma_f32_16x16x32_bf16 v[92:95], a[108:111], a[176:179], v[92:95]
    s_add_u32 s31, s66, 16384
    v_mfma_f32_16x16x32_bf16 v[92:95], a[104:107], a[160:163], v[92:95]
    v_mfma_f32_16x16x32_bf16 v[92:95], a[100:103], a[144:147], v[92:95]
    v_mfma_f32_16x16x32_bf16 v[92:95], a[96:99], a[128:131], v[92:95]
    buffer_load_dwordx4 a[96:99], v252, s[24:27], s31 offen offset:0 sc1
    s_waitcnt vmcnt(45)
    v_mfma_f32_16x16x32_bf16 v[108:111], a[112:115], a[128:131], v[108:111]
    v_mfma_f32_16x16x32_bf16 v[108:111], a[116:119], a[144:147], v[108:111]
    v_mfma_f32_16x16x32_bf16 v[108:111], a[120:123], a[160:163], v[108:111]
    v_mfma_f32_16x16x32_bf16 v[108:111], a[124:127], a[176:179], v[108:111]
    buffer_load_dwordx4 a[100:103], v252, s[24:27], s31 offen offset:1024 sc1
    v_mfma_f32_16x16x32_bf16 v[112:115], a[124:127], a[180:183], v[112:115]
    v_mfma_f32_16x16x32_bf16 v[112:115], a[120:123], a[164:167], v[112:115]
    v_mfma_f32_16x16x32_bf16 v[112:115], a[116:119], a[148:151], v[112:115]
    v_mfma_f32_16x16x32_bf16 v[112:115], a[112:115], a[132:135], v[112:115]
    buffer_load_dwordx4 a[104:107], v252, s[24:27], s31 offen offset:2048 sc1
    v_mfma_f32_16x16x32_bf16 v[116:119], a[112:115], a[136:139], v[116:119]
    v_mfma_f32_16x16x32_bf16 v[116:119], a[116:119], a[152:155], v[116:119]
    v_mfma_f32_16x16x32_bf16 v[116:119], a[120:123], a[168:171], v[116:119]
    v_mfma_f32_16x16x32_bf16 v[116:119], a[124:127], a[184:187], v[116:119]
    buffer_load_dwordx4 a[108:111], v252, s[24:27], s31 offen offset:3072 sc1
    v_mfma_f32_16x16x32_bf16 v[120:123], a[124:127], a[188:191], v[120:123]
    s_add_u32 s31, s66, 20480
    v_mfma_f32_16x16x32_bf16 v[120:123], a[120:123], a[172:175], v[120:123]
    v_mfma_f32_16x16x32_bf16 v[120:123], a[116:119], a[156:159], v[120:123]
    v_mfma_f32_16x16x32_bf16 v[120:123], a[112:115], a[140:143], v[120:123]
    buffer_load_dwordx4 a[112:115], v252, s[24:27], s31 offen offset:0 sc1
    s_waitcnt vmcnt(45)
    s_waitcnt lgkmcnt(12)
    v_mfma_f32_16x16x32_bf16 v[12:15], v[140:143], a[192:195], v[12:15]
    v_mfma_f32_16x16x32_bf16 v[12:15], v[144:147], a[208:211], v[12:15]
    v_mfma_f32_16x16x32_bf16 v[12:15], v[148:151], a[224:227], v[12:15]
    v_mfma_f32_16x16x32_bf16 v[12:15], v[152:155], a[240:243], v[12:15]
    buffer_load_dwordx4 a[116:119], v252, s[24:27], s31 offen offset:1024 sc1
    s_waitcnt lgkmcnt(8)
    v_mfma_f32_16x16x32_bf16 v[16:19], v[152:155], a[244:247], v[16:19]
    v_mfma_f32_16x16x32_bf16 v[16:19], v[148:151], a[228:231], v[16:19]
    v_mfma_f32_16x16x32_bf16 v[16:19], v[144:147], a[212:215], v[16:19]
    v_mfma_f32_16x16x32_bf16 v[16:19], v[140:143], a[196:199], v[16:19]
    buffer_load_dwordx4 a[120:123], v252, s[24:27], s31 offen offset:2048 sc1
    s_waitcnt lgkmcnt(4)
    v_mfma_f32_16x16x32_bf16 v[20:23], v[140:143], a[200:203], v[20:23]
    v_mfma_f32_16x16x32_bf16 v[20:23], v[144:147], a[216:219], v[20:23]
    v_mfma_f32_16x16x32_bf16 v[20:23], v[148:151], a[232:235], v[20:23]
    v_mfma_f32_16x16x32_bf16 v[20:23], v[152:155], a[248:251], v[20:23]
    buffer_load_dwordx4 a[124:127], v252, s[24:27], s31 offen offset:3072 sc1
    s_waitcnt lgkmcnt(0)
    v_mfma_f32_16x16x32_bf16 v[24:27], v[152:155], a[252:255], v[24:27]
    s_add_u32 s31, s66, 24576
    v_mfma_f32_16x16x32_bf16 v[24:27], v[148:151], a[236:239], v[24:27]
    v_mfma_f32_16x16x32_bf16 v[24:27], v[144:147], a[220:223], v[24:27]
    v_mfma_f32_16x16x32_bf16 v[24:27], v[140:143], a[204:207], v[24:27]
    buffer_load_dwordx4 v[140:143], v252, s[24:27], s31 offen offset:0 sc1
    s_waitcnt vmcnt(45)
    v_mfma_f32_16x16x32_bf16 v[40:43], v[156:159], a[204:207], v[40:43]
    v_permlane32_swap_b32 v12, v16
    v_mfma_f32_16x16x32_bf16 v[40:43], v[160:163], a[220:223], v[40:43]
    v_permlane32_swap_b32 v13, v17
    v_mfma_f32_16x16x32_bf16 v[40:43], v[164:167], a[236:239], v[40:43]
    v_permlane32_swap_b32 v14, v18
    v_mfma_f32_16x16x32_bf16 v[40:43], v[168:171], a[252:255], v[40:43]
    buffer_load_dwordx4 v[144:147], v252, s[24:27], s31 offen offset:1024 sc1
    v_mfma_f32_16x16x32_bf16 v[36:39], v[168:171], a[248:251], v[36:39]
    v_permlane32_swap_b32 v15, v19
    v_mfma_f32_16x16x32_bf16 v[36:39], v[164:167], a[232:235], v[36:39]
    v_max_f32 v12, 0, v12
    v_max_f32 v13, 0, v13
    v_mfma_f32_16x16x32_bf16 v[36:39], v[160:163], a[216:219], v[36:39]
    v_max_f32 v14, 0, v14
    v_max_f32 v15, 0, v15
    v_mfma_f32_16x16x32_bf16 v[36:39], v[156:159], a[200:203], v[36:39]
    buffer_load_dwordx4 v[148:151], v252, s[24:27], s31 offen offset:2048 sc1
    v_mfma_f32_16x16x32_bf16 v[32:35], v[156:159], a[196:199], v[32:35]
    v_mul_f32 v12, v12, v16
    v_mul_f32 v13, v13, v17
    v_mfma_f32_16x16x32_bf16 v[32:35], v[160:163], a[212:215], v[32:35]
    v_mul_f32 v14, v14, v18
    v_mul_f32 v15, v15, v19
    v_mfma_f32_16x16x32_bf16 v[32:35], v[164:167], a[228:231], v[32:35]
    v_cvt_pk_bf16_f32 v12, v12, v13
    v_cvt_pk_bf16_f32 v13, v14, v15
    v_mfma_f32_16x16x32_bf16 v[32:35], v[168:171], a[244:247], v[32:35]
    buffer_load_dwordx4 v[152:155], v252, s[24:27], s31 offen offset:3072 sc1
    v_mfma_f32_16x16x32_bf16 v[28:31], v[168:171], a[240:243], v[28:31]
    s_add_u32 s31, s66, 28672
    ds_write_b64 v220, v[12:13] offset:0
    v_mfma_f32_16x16x32_bf16 v[28:31], v[164:167], a[224:227], v[28:31]
    v_permlane32_swap_b32 v20, v24
    v_mfma_f32_16x16x32_bf16 v[28:31], v[160:163], a[208:211], v[28:31]
    v_permlane32_swap_b32 v21, v25
    v_mfma_f32_16x16x32_bf16 v[28:31], v[156:159], a[192:195], v[28:31]
    buffer_load_dwordx4 v[156:159], v252, s[24:27], s31 offen offset:0 sc1
    s_waitcnt vmcnt(45)
    v_mfma_f32_16x16x32_bf16 v[44:47], v[172:175], a[192:195], v[44:47]
    v_permlane32_swap_b32 v22, v26
    v_mfma_f32_16x16x32_bf16 v[44:47], v[176:179], a[208:211], v[44:47]
    v_permlane32_swap_b32 v23, v27
    v_mfma_f32_16x16x32_bf16 v[44:47], v[180:183], a[224:227], v[44:47]
    v_max_f32 v20, 0, v20
    v_max_f32 v21, 0, v21
    v_mfma_f32_16x16x32_bf16 v[44:47], v[184:187], a[240:243], v[44:47]
    buffer_load_dwordx4 v[160:163], v252, s[24:27], s31 offen offset:1024 sc1
    v_mfma_f32_16x16x32_bf16 v[48:51], v[184:187], a[244:247], v[48:51]
    v_max_f32 v22, 0, v22
    v_max_f32 v23, 0, v23
    v_mfma_f32_16x16x32_bf16 v[48:51], v[180:183], a[228:231], v[48:51]
    v_mul_f32 v20, v20, v24
    v_mul_f32 v21, v21, v25
    v_mfma_f32_16x16x32_bf16 v[48:51], v[176:179], a[212:215], v[48:51]
    v_mul_f32 v22, v22, v26
    v_mul_f32 v23, v23, v27
    v_mfma_f32_16x16x32_bf16 v[48:51], v[172:175], a[196:199], v[48:51]
    buffer_load_dwordx4 v[164:167], v252, s[24:27], s31 offen offset:2048 sc1
    v_mfma_f32_16x16x32_bf16 v[52:55], v[172:175], a[200:203], v[52:55]
    v_cvt_pk_bf16_f32 v20, v20, v21
    v_cvt_pk_bf16_f32 v21, v22, v23
    v_mfma_f32_16x16x32_bf16 v[52:55], v[176:179], a[216:219], v[52:55]
    ds_write_b64 v220, v[20:21] offset:2048
    v_max_f32 v40, 0, v40
    v_mfma_f32_16x16x32_bf16 v[52:55], v[180:183], a[232:235], v[52:55]
    v_max_f32 v41, 0, v41
    v_max_f32 v42, 0, v42
    v_mfma_f32_16x16x32_bf16 v[52:55], v[184:187], a[248:251], v[52:55]
    buffer_load_dwordx4 v[168:171], v252, s[24:27], s31 offen offset:3072 sc1
    v_mfma_f32_16x16x32_bf16 v[56:59], v[184:187], a[252:255], v[56:59]
    s_add_u32 s31, s66, 32768
    v_max_f32 v43, 0, v43
    v_max_f32 v36, 0, v36
    v_mfma_f32_16x16x32_bf16 v[56:59], v[180:183], a[236:239], v[56:59]
    v_max_f32 v37, 0, v37
    v_max_f32 v38, 0, v38
    v_mfma_f32_16x16x32_bf16 v[56:59], v[176:179], a[220:223], v[56:59]
    v_max_f32 v39, 0, v39
    v_max_f32 v32, 0, v32
    v_mfma_f32_16x16x32_bf16 v[56:59], v[172:175], a[204:207], v[56:59]
    buffer_load_dwordx4 v[172:175], v252, s[24:27], s31 offen offset:0 sc1
    s_waitcnt vmcnt(45)
    v_mfma_f32_16x16x32_bf16 v[72:75], v[188:191], a[204:207], v[72:75]
    v_max_f32 v33, 0, v33
    v_max_f32 v34, 0, v34
    v_mfma_f32_16x16x32_bf16 v[72:75], v[192:195], a[220:223], v[72:75]
    v_max_f32 v35, 0, v35
    v_max_f32 v28, 0, v28
    v_mfma_f32_16x16x32_bf16 v[72:75], v[196:199], a[236:239], v[72:75]
    v_max_f32 v29, 0, v29
    v_max_f32 v30, 0, v30
    v_mfma_f32_16x16x32_bf16 v[72:75], v[200:203], a[252:255], v[72:75]
    buffer_load_dwordx4 v[176:179], v252, s[24:27], s31 offen offset:1024 sc1
    v_mfma_f32_16x16x32_bf16 v[68:71], v[200:203], a[248:251], v[68:71]
    v_max_f32 v31, 0, v31
    v_mul_f32 v28, v28, v44
    v_mfma_f32_16x16x32_bf16 v[68:71], v[196:199], a[232:235], v[68:71]
    v_mul_f32 v29, v29, v45
    v_mul_f32 v30, v30, v46
    v_mfma_f32_16x16x32_bf16 v[68:71], v[192:195], a[216:219], v[68:71]
    v_mul_f32 v31, v31, v47
    v_cvt_pk_bf16_f32 v28, v28, v29
    v_mfma_f32_16x16x32_bf16 v[68:71], v[188:191], a[200:203], v[68:71]
    buffer_load_dwordx4 v[180:183], v252, s[24:27], s31 offen offset:2048 sc1
    v_mfma_f32_16x16x32_bf16 v[64:67], v[188:191], a[196:199], v[64:67]
    v_cvt_pk_bf16_f32 v29, v30, v31
    v_mfma_f32_16x16x32_bf16 v[64:67], v[192:195], a[212:215], v[64:67]
    ds_write_b64 v221, v[28:29] offset:0
    v_mul_f32 v32, v32, v48
    v_mfma_f32_16x16x32_bf16 v[64:67], v[196:199], a[228:231], v[64:67]
    v_mul_f32 v33, v33, v49
    v_mul_f32 v34, v34, v50
    v_mfma_f32_16x16x32_bf16 v[64:67], v[200:203], a[244:247], v[64:67]
    buffer_load_dwordx4 v[184:187], v252, s[24:27], s31 offen offset:3072 sc1
    v_mfma_f32_16x16x32_bf16 v[60:63], v[200:203], a[240:243], v[60:63]
    s_add_u32 s31, s66, 36864
    v_mul_f32 v35, v35, v51
    v_cvt_pk_bf16_f32 v32, v32, v33
    v_mfma_f32_16x16x32_bf16 v[60:63], v[196:199], a[224:227], v[60:63]
    v_cvt_pk_bf16_f32 v33, v34, v35
    v_mfma_f32_16x16x32_bf16 v[60:63], v[192:195], a[208:211], v[60:63]
    ds_write_b64 v221, v[32:33] offset:1024
    v_mul_f32 v36, v36, v52
    v_mfma_f32_16x16x32_bf16 v[60:63], v[188:191], a[192:195], v[60:63]
    buffer_load_dwordx4 v[188:191], v252, s[24:27], s31 offen offset:0 sc1
    s_waitcnt vmcnt(45)
    v_mfma_f32_16x16x32_bf16 v[76:79], v[204:207], a[192:195], v[76:79]
    v_mul_f32 v37, v37, v53
    v_mul_f32 v38, v38, v54
    v_mfma_f32_16x16x32_bf16 v[76:79], v[208:211], a[208:211], v[76:79]
    v_mul_f32 v39, v39, v55
    v_cvt_pk_bf16_f32 v36, v36, v37
    v_mfma_f32_16x16x32_bf16 v[76:79], v[212:215], a[224:227], v[76:79]
    v_cvt_pk_bf16_f32 v37, v38, v39
    v_mfma_f32_16x16x32_bf16 v[76:79], v[216:219], a[240:243], v[76:79]
    buffer_load_dwordx4 v[192:195], v252, s[24:27], s31 offen offset:1024 sc1
    v_mfma_f32_16x16x32_bf16 v[80:83], v[216:219], a[244:247], v[80:83]
    ds_write_b64 v221, v[36:37] offset:2048
    v_mul_f32 v40, v40, v56
    v_mfma_f32_16x16x32_bf16 v[80:83], v[212:215], a[228:231], v[80:83]
    v_mul_f32 v41, v41, v57
    v_mul_f32 v42, v42, v58
    v_mfma_f32_16x16x32_bf16 v[80:83], v[208:211], a[212:215], v[80:83]
    v_mul_f32 v43, v43, v59
    v_cvt_pk_bf16_f32 v40, v40, v41
    v_mfma_f32_16x16x32_bf16 v[80:83], v[204:207], a[196:199], v[80:83]
    buffer_load_dwordx4 v[196:199], v252, s[24:27], s31 offen offset:2048 sc1
    v_mfma_f32_16x16x32_bf16 v[84:87], v[204:207], a[200:203], v[84:87]
    v_cvt_pk_bf16_f32 v41, v42, v43
    v_mfma_f32_16x16x32_bf16 v[84:87], v[208:211], a[216:219], v[84:87]
    ds_write_b64 v221, v[40:41] offset:3072
    v_max_f32 v72, 0, v72
    v_mfma_f32_16x16x32_bf16 v[84:87], v[212:215], a[232:235], v[84:87]
    v_max_f32 v73, 0, v73
    v_max_f32 v74, 0, v74
    v_mfma_f32_16x16x32_bf16 v[84:87], v[216:219], a[248:251], v[84:87]
    buffer_load_dwordx4 v[200:203], v252, s[24:27], s31 offen offset:3072 sc1
    v_mfma_f32_16x16x32_bf16 v[88:91], v[216:219], a[252:255], v[88:91]
    s_add_u32 s31, s66, 40960
    v_max_f32 v75, 0, v75
    v_max_f32 v68, 0, v68
    v_mfma_f32_16x16x32_bf16 v[88:91], v[212:215], a[236:239], v[88:91]
    v_max_f32 v69, 0, v69
    v_max_f32 v70, 0, v70
    v_mfma_f32_16x16x32_bf16 v[88:91], v[208:211], a[220:223], v[88:91]
    v_max_f32 v71, 0, v71
    v_max_f32 v64, 0, v64
    v_mfma_f32_16x16x32_bf16 v[88:91], v[204:207], a[204:207], v[88:91]
    buffer_load_dwordx4 v[204:207], v252, s[24:27], s31 offen offset:0 sc1
    s_waitcnt vmcnt(45)
    v_mfma_f32_16x16x32_bf16 v[104:107], a[0:3], a[204:207], v[104:107]
    v_max_f32 v65, 0, v65
    v_max_f32 v66, 0, v66
    v_mfma_f32_16x16x32_bf16 v[104:107], a[4:7], a[220:223], v[104:107]
    v_max_f32 v67, 0, v67
    v_max_f32 v60, 0, v60
    v_mfma_f32_16x16x32_bf16 v[104:107], a[8:11], a[236:239], v[104:107]
    v_max_f32 v61, 0, v61
    v_max_f32 v62, 0, v62
    v_mfma_f32_16x16x32_bf16 v[104:107], a[12:15], a[252:255], v[104:107]
    buffer_load_dwordx4 v[208:211], v252, s[24:27], s31 offen offset:1024 sc1
    v_mfma_f32_16x16x32_bf16 v[100:103], a[12:15], a[248:251], v[100:103]
    v_max_f32 v63, 0, v63
    v_mul_f32 v60, v60, v76
    v_mfma_f32_16x16x32_bf16 v[100:103], a[8:11], a[232:235], v[100:103]
    v_mul_f32 v61, v61, v77
    v_mul_f32 v62, v62, v78
    v_mfma_f32_16x16x32_bf16 v[100:103], a[4:7], a[216:219], v[100:103]
    v_mul_f32 v63, v63, v79
    v_cvt_pk_bf16_f32 v60, v60, v61
    v_mfma_f32_16x16x32_bf16 v[100:103], a[0:3], a[200:203], v[100:103]
    buffer_load_dwordx4 v[212:215], v252, s[24:27], s31 offen offset:2048 sc1
    v_mfma_f32_16x16x32_bf16 v[96:99], a[0:3], a[196:199], v[96:99]
    v_cvt_pk_bf16_f32 v61, v62, v63
    v_mfma_f32_16x16x32_bf16 v[96:99], a[4:7], a[212:215], v[96:99]
    ds_write_b64 v222, v[60:61] offset:0
    v_mul_f32 v64, v64, v80
    v_mfma_f32_16x16x32_bf16 v[96:99], a[8:11], a[228:231], v[96:99]
    v_mul_f32 v65, v65, v81
    v_mul_f32 v66, v66, v82
    v_mfma_f32_16x16x32_bf16 v[96:99], a[12:15], a[244:247], v[96:99]
    buffer_load_dwordx4 v[216:219], v252, s[24:27], s31 offen offset:3072 sc1
    v_mfma_f32_16x16x32_bf16 v[92:95], a[12:15], a[240:243], v[92:95]
    s_add_u32 s31, s66, 45056
    v_mul_f32 v67, v67, v83
    v_cvt_pk_bf16_f32 v64, v64, v65
    v_mfma_f32_16x16x32_bf16 v[92:95], a[8:11], a[224:227], v[92:95]
    v_cvt_pk_bf16_f32 v65, v66, v67
    v_mfma_f32_16x16x32_bf16 v[92:95], a[4:7], a[208:211], v[92:95]
    ds_write_b64 v222, v[64:65] offset:1024
    v_mul_f32 v68, v68, v84
    v_mfma_f32_16x16x32_bf16 v[92:95], a[0:3], a[192:195], v[92:95]
    buffer_load_dwordx4 a[0:3], v252, s[24:27], s31 offen offset:0 sc1
    s_waitcnt vmcnt(45)
    v_mfma_f32_16x16x32_bf16 v[108:111], a[16:19], a[192:195], v[108:111]
    v_mul_f32 v69, v69, v85
    v_mul_f32 v70, v70, v86
    v_mfma_f32_16x16x32_bf16 v[108:111], a[20:23], a[208:211], v[108:111]
    v_mul_f32 v71, v71, v87
    v_cvt_pk_bf16_f32 v68, v68, v69
    v_mfma_f32_16x16x32_bf16 v[108:111], a[24:27], a[224:227], v[108:111]
    v_cvt_pk_bf16_f32 v69, v70, v71
    v_mfma_f32_16x16x32_bf16 v[108:111], a[28:31], a[240:243], v[108:111]
    buffer_load_dwordx4 a[4:7], v252, s[24:27], s31 offen offset:1024 sc1
    v_mfma_f32_16x16x32_bf16 v[112:115], a[28:31], a[244:247], v[112:115]
    ds_write_b64 v222, v[68:69] offset:2048
    v_mul_f32 v72, v72, v88
    v_mfma_f32_16x16x32_bf16 v[112:115], a[24:27], a[228:231], v[112:115]
    v_mul_f32 v73, v73, v89
    v_mul_f32 v74, v74, v90
    v_mfma_f32_16x16x32_bf16 v[112:115], a[20:23], a[212:215], v[112:115]
    v_mul_f32 v75, v75, v91
    v_cvt_pk_bf16_f32 v72, v72, v73
    v_mfma_f32_16x16x32_bf16 v[112:115], a[16:19], a[196:199], v[112:115]
    buffer_load_dwordx4 a[8:11], v252, s[24:27], s31 offen offset:2048 sc1
    v_mfma_f32_16x16x32_bf16 v[116:119], a[16:19], a[200:203], v[116:119]
    v_cvt_pk_bf16_f32 v73, v74, v75
    v_mfma_f32_16x16x32_bf16 v[116:119], a[20:23], a[216:219], v[116:119]
    ds_write_b64 v222, v[72:73] offset:3072
    v_max_f32 v104, 0, v104
    v_mfma_f32_16x16x32_bf16 v[116:119], a[24:27], a[232:235], v[116:119]
    v_max_f32 v105, 0, v105
    v_max_f32 v106, 0, v106
    v_mfma_f32_16x16x32_bf16 v[116:119], a[28:31], a[248:251], v[116:119]
    buffer_load_dwordx4 a[12:15], v252, s[24:27], s31 offen offset:3072 sc1
    v_mfma_f32_16x16x32_bf16 v[120:123], a[28:31], a[252:255], v[120:123]
    s_add_u32 s31, s66, 49152
    v_max_f32 v107, 0, v107
    v_max_f32 v100, 0, v100
    v_mfma_f32_16x16x32_bf16 v[120:123], a[24:27], a[236:239], v[120:123]
    v_max_f32 v101, 0, v101
    v_max_f32 v102, 0, v102
    v_mfma_f32_16x16x32_bf16 v[120:123], a[20:23], a[220:223], v[120:123]
    v_max_f32 v103, 0, v103
    v_max_f32 v96, 0, v96
    v_mfma_f32_16x16x32_bf16 v[120:123], a[16:19], a[204:207], v[120:123]
    buffer_load_dwordx4 a[16:19], v252, s[24:27], s31 offen offset:0 sc1
    v_max_f32 v97, 0, v97
    v_max_f32 v98, 0, v98
    v_max_f32 v99, 0, v99
    v_max_f32 v92, 0, v92
    v_max_f32 v93, 0, v93
    v_max_f32 v94, 0, v94
    v_max_f32 v95, 0, v95
    v_mul_f32 v92, v92, v108
    v_mul_f32 v93, v93, v109
    v_mul_f32 v94, v94, v110
    v_mul_f32 v95, v95, v111
    v_cvt_pk_bf16_f32 v92, v92, v93
    v_cvt_pk_bf16_f32 v93, v94, v95
    ds_write_b64 v222, v[92:93] offset:8
    v_mul_f32 v96, v96, v112
    v_mul_f32 v97, v97, v113
    v_mul_f32 v98, v98, v114
    v_mul_f32 v99, v99, v115
    v_cvt_pk_bf16_f32 v96, v96, v97
    v_cvt_pk_bf16_f32 v97, v98, v99
    ds_write_b64 v222, v[96:97] offset:1032
    v_mul_f32 v100, v100, v116
    v_mul_f32 v101, v101, v117
    v_mul_f32 v102, v102, v118
    v_mul_f32 v103, v103, v119
    v_cvt_pk_bf16_f32 v100, v100, v101
    v_cvt_pk_bf16_f32 v101, v102, v103
    ds_write_b64 v222, v[100:101] offset:2056
    s_nop 0
    v_mul_f32 v104, v104, v120
    v_mul_f32 v105, v105, v121
    v_mul_f32 v106, v106, v122
    v_mul_f32 v107, v107, v123
    v_cvt_pk_bf16_f32 v104, v104, v105
    v_cvt_pk_bf16_f32 v105, v106, v107
    ds_write_b64 v222, v[104:105] offset:3080
    s_waitcnt lgkmcnt(0)
    s_barrier
    ds_read_b128 a[128:131], v248 offset:0
    ds_read_b128 a[144:147], v248 offset:4096
    ds_read_b128 a[160:163], v248 offset:8192
    ds_read_b128 a[176:179], v248 offset:12288
    ds_read_b128 a[192:195], v248 offset:16384
    ds_read_b128 a[208:211], v248 offset:20480
    ds_read_b128 a[224:227], v248 offset:24576
    s_add_u32 s32, s32, 31457280
    s_add_u32 s33, s33, 31457280
    s_add_u32 s34, s34, 31457280
    s_add_u32 s35, s35, 31457280
    v_mov_b32 v2, s45
    s_waitcnt vmcnt(42)
    s_waitcnt lgkmcnt(6)
    v_mfma_f32_16x16x32_bf16 v[12:15], a[32:35], a[128:131], 0
    ds_read_b128 a[228:231], v248 offset:25600
    s_waitcnt lgkmcnt(6)
    v_mfma_f32_16x16x32_bf16 v[12:15], a[36:39], a[144:147], v[12:15]
    ds_read_b128 a[212:215], v248 offset:21504
    s_waitcnt lgkmcnt(6)
    v_mfma_f32_16x16x32_bf16 v[12:15], a[40:43], a[160:163], v[12:15]
    ds_read_b128 a[196:199], v248 offset:17408
    s_waitcnt lgkmcnt(6)
    v_mfma_f32_16x16x32_bf16 v[12:15], a[44:47], a[176:179], v[12:15]
    ds_read_b128 a[180:183], v248 offset:13312
    s_waitcnt lgkmcnt(6)
    v_mfma_f32_16x16x32_bf16 v[12:15], a[48:51], a[192:195], v[12:15]
    ds_read_b128 a[164:167], v248 offset:9216
    s_waitcnt lgkmcnt(6)
    v_mfma_f32_16x16x32_bf16 v[12:15], a[52:55], a[208:211], v[12:15]
    ds_read_b128 a[148:151], v248 offset:5120
    s_waitcnt lgkmcnt(6)
    v_mfma_f32_16x16x32_bf16 v[12:15], a[56:59], a[224:227], v[12:15]
    ds_read_b128 a[132:135], v248 offset:1024
    s_waitcnt lgkmcnt(6)
    v_mfma_f32_16x16x32_bf16 v[16:19], a[56:59], a[228:231], 0
    ds_read_b128 a[136:139], v248 offset:2048
    s_waitcnt lgkmcnt(6)
    v_mfma_f32_16x16x32_bf16 v[16:19], a[52:55], a[212:215], v[16:19]
    ds_read_b128 a[152:155], v248 offset:6144
    s_waitcnt lgkmcnt(6)
    v_mfma_f32_16x16x32_bf16 v[16:19], a[48:51], a[196:199], v[16:19]
    ds_read_b128 a[168:171], v248 offset:10240
    s_waitcnt lgkmcnt(6)
    v_mfma_f32_16x16x32_bf16 v[16:19], a[44:47], a[180:183], v[16:19]
    ds_read_b128 a[184:187], v248 offset:14336
    s_waitcnt lgkmcnt(6)
    v_mfma_f32_16x16x32_bf16 v[16:19], a[40:43], a[164:167], v[16:19]
    ds_read_b128 a[200:203], v248 offset:18432
    s_waitcnt lgkmcnt(6)
    v_mfma_f32_16x16x32_bf16 v[16:19], a[36:39], a[148:151], v[16:19]
    ds_read_b128 a[216:219], v248 offset:22528
    s_waitcnt lgkmcnt(6)
    v_mfma_f32_16x16x32_bf16 v[16:19], a[32:35], a[132:135], v[16:19]
    ds_read_b128 a[232:235], v248 offset:26624
    s_waitcnt lgkmcnt(6)
    v_mfma_f32_16x16x32_bf16 v[20:23], a[32:35], a[136:139], 0
    ds_read_b128 a[236:239], v248 offset:27648
    s_waitcnt lgkmcnt(6)
    v_mfma_f32_16x16x32_bf16 v[20:23], a[36:39], a[152:155], v[20:23]
    ds_read_b128 a[220:223], v248 offset:23552
    s_waitcnt lgkmcnt(6)
    v_mfma_f32_16x16x32_bf16 v[20:23], a[40:43], a[168:171], v[20:23]
    ds_read_b128 a[204:207], v248 offset:19456
    s_waitcnt lgkmcnt(6)
    v_mfma_f32_16x16x32_bf16 v[20:23], a[44:47], a[184:187], v[20:23]
    ds_read_b128 a[188:191], v248 offset:15360
    s_waitcnt lgkmcnt(6)
    v_mfma_f32_16x16x32_bf16 v[20:23], a[48:51], a[200:203], v[20:23]
    ds_read_b128 a[172:175], v248 offset:11264
    s_waitcnt lgkmcnt(6)
    v_mfma_f32_16x16x32_bf16 v[20:23], a[52:55], a[216:219], v[20:23]
    ds_read_b128 a[156:159], v248 offset:7168
    s_waitcnt lgkmcnt(6)
    v_mfma_f32_16x16x32_bf16 v[20:23], a[56:59], a[232:235], v[20:23]
    ds_read_b128 a[140:143], v248 offset:3072
    s_waitcnt lgkmcnt(6)
    v_mfma_f32_16x16x32_bf16 v[24:27], a[56:59], a[236:239], 0
    buffer_load_dwordx4 a[20:23], v252, s[24:27], s31 offen offset:1024 sc1
    s_waitcnt lgkmcnt(5)
    v_mfma_f32_16x16x32_bf16 v[24:27], a[52:55], a[220:223], v[24:27]
    ds_read_b128 v[92:95], v242 offset:24576
    s_waitcnt lgkmcnt(5)
    v_mfma_f32_16x16x32_bf16 v[24:27], a[48:51], a[204:207], v[24:27]
    ds_read_b128 v[96:99], v242 offset:24592
    s_waitcnt lgkmcnt(5)
    v_mfma_f32_16x16x32_bf16 v[24:27], a[44:47], a[188:191], v[24:27]
    buffer_load_dwordx4 a[24:27], v252, s[24:27], s31 offen offset:2048 sc1
    s_waitcnt lgkmcnt(4)
    v_mfma_f32_16x16x32_bf16 v[24:27], a[40:43], a[172:175], v[24:27]
    ds_read_b128 v[100:103], v242 offset:24832
    s_waitcnt lgkmcnt(4)
    v_mfma_f32_16x16x32_bf16 v[24:27], a[36:39], a[156:159], v[24:27]
    ds_read_b128 v[104:107], v242 offset:24848
    s_waitcnt lgkmcnt(4)
    v_mfma_f32_16x16x32_bf16 v[24:27], a[32:35], a[140:143], v[24:27]
    buffer_load_dwordx4 a[28:31], v252, s[24:27], s31 offen offset:3072 sc1
    s_waitcnt vmcnt(38)
    v_mfma_f32_16x16x32_bf16 v[40:43], a[60:63], a[140:143], 0
    s_add_u32 s31, s66, 53248
    v_mfma_f32_16x16x32_bf16 v[40:43], a[64:67], a[156:159], v[40:43]
    v_mfma_f32_16x16x32_bf16 v[40:43], a[68:71], a[172:175], v[40:43]
    buffer_load_dwordx4 a[32:35], v252, s[24:27], s31 offen offset:0 sc1
    v_mfma_f32_16x16x32_bf16 v[40:43], a[72:75], a[188:191], v[40:43]
    v_mfma_f32_16x16x32_bf16 v[40:43], a[76:79], a[204:207], v[40:43]
    v_mfma_f32_16x16x32_bf16 v[40:43], a[80:83], a[220:223], v[40:43]
    buffer_load_dwordx4 a[36:39], v252, s[24:27], s31 offen offset:1024 sc1
    v_mfma_f32_16x16x32_bf16 v[40:43], a[84:87], a[236:239], v[40:43]
    v_mfma_f32_16x16x32_bf16 v[36:39], a[84:87], a[232:235], 0
    v_mfma_f32_16x16x32_bf16 v[36:39], a[80:83], a[216:219], v[36:39]
    buffer_load_dwordx4 a[40:43], v252, s[24:27], s31 offen offset:2048 sc1
    v_mfma_f32_16x16x32_bf16 v[36:39], a[76:79], a[200:203], v[36:39]
    v_mfma_f32_16x16x32_bf16 v[36:39], a[72:75], a[184:187], v[36:39]
    v_mfma_f32_16x16x32_bf16 v[36:39], a[68:71], a[168:171], v[36:39]
    buffer_load_dwordx4 a[44:47], v252, s[24:27], s31 offen offset:3072 sc1
    v_mfma_f32_16x16x32_bf16 v[36:39], a[64:67], a[152:155], v[36:39]
    v_mfma_f32_16x16x32_bf16 v[36:39], a[60:63], a[136:139], v[36:39]
    v_mfma_f32_16x16x32_bf16 v[32:35], a[60:63], a[132:135], 0
    v_mfma_f32_16x16x32_bf16 v[32:35], a[64:67], a[148:151], v[32:35]
    v_mfma_f32_16x16x32_bf16 v[32:35], a[68:71], a[164:167], v[32:35]
    v_mfma_f32_16x16x32_bf16 v[32:35], a[72:75], a[180:183], v[32:35]
    v_mfma_f32_16x16x32_bf16 v[32:35], a[76:79], a[196:199], v[32:35]
    v_mfma_f32_16x16x32_bf16 v[32:35], a[80:83], a[212:215], v[32:35]
    v_mfma_f32_16x16x32_bf16 v[32:35], a[84:87], a[228:231], v[32:35]
    v_mfma_f32_16x16x32_bf16 v[28:31], a[84:87], a[224:227], 0
    v_mfma_f32_16x16x32_bf16 v[28:31], a[80:83], a[208:211], v[28:31]
    v_mfma_f32_16x16x32_bf16 v[28:31], a[76:79], a[192:195], v[28:31]
    v_mfma_f32_16x16x32_bf16 v[28:31], a[72:75], a[176:179], v[28:31]
    v_mfma_f32_16x16x32_bf16 v[28:31], a[68:71], a[160:163], v[28:31]
    v_mfma_f32_16x16x32_bf16 v[28:31], a[64:67], a[144:147], v[28:31]
    v_mfma_f32_16x16x32_bf16 v[28:31], a[60:63], a[128:131], v[28:31]
    s_waitcnt vmcnt(35)
    v_mfma_f32_16x16x32_bf16 v[44:47], a[88:91], a[128:131], 0
    v_mfma_f32_16x16x32_bf16 v[44:47], a[92:95], a[144:147], v[44:47]
    v_mfma_f32_16x16x32_bf16 v[44:47], a[96:99], a[160:163], v[44:47]
    v_mfma_f32_16x16x32_bf16 v[44:47], a[100:103], a[176:179], v[44:47]
    v_mfma_f32_16x16x32_bf16 v[44:47], a[104:107], a[192:195], v[44:47]
    v_cvt_pk_bf16_f32 v88, v24, v25
    v_cvt_pk_bf16_f32 v89, v26, v27
    v_mfma_f32_16x16x32_bf16 v[44:47], a[108:111], a[208:211], v[44:47]
    v_cvt_pk_bf16_f32 v90, v40, v41
    v_cvt_pk_bf16_f32 v91, v42, v43
    v_mfma_f32_16x16x32_bf16 v[44:47], a[112:115], a[224:227], v[44:47]
    buffer_store_dwordx4 v[88:91], v252, s[24:27], s35 offen offset:0 sc1
    v_mfma_f32_16x16x32_bf16 v[48:51], a[112:115], a[228:231], 0
    v_cvt_pk_bf16_f32 v84, v20, v21
    v_cvt_pk_bf16_f32 v85, v22, v23
    v_mfma_f32_16x16x32_bf16 v[48:51], a[108:111], a[212:215], v[48:51]
    v_cvt_pk_bf16_f32 v86, v36, v37
    v_cvt_pk_bf16_f32 v87, v38, v39
    v_mfma_f32_16x16x32_bf16 v[48:51], a[104:107], a[196:199], v[48:51]
    buffer_store_dwordx4 v[84:87], v252, s[24:27], s34 offen offset:0 sc1
    v_mfma_f32_16x16x32_bf16 v[48:51], a[100:103], a[180:183], v[48:51]
    v_cvt_pk_bf16_f32 v80, v16, v17
    v_cvt_pk_bf16_f32 v81, v18, v19
    v_mfma_f32_16x16x32_bf16 v[48:51], a[96:99], a[164:167], v[48:51]
    v_cvt_pk_bf16_f32 v82, v32, v33
    v_cvt_pk_bf16_f32 v83, v34, v35
    v_mfma_f32_16x16x32_bf16 v[48:51], a[92:95], a[148:151], v[48:51]
L_pg13:
    s_cbranch_execz L_pgret
    buffer_store_dwordx4 v[80:83], v252, s[24:27], s33 offen offset:0 sc1
    v_mfma_f32_16x16x32_bf16 v[48:51], a[88:91], a[132:135], v[48:51]
    v_cvt_pk_bf16_f32 v76, v12, v13
    v_cvt_pk_bf16_f32 v77, v14, v15
    v_mfma_f32_16x16x32_bf16 v[52:55], a[88:91], a[136:139], 0
    v_cvt_pk_bf16_f32 v78, v28, v29
    v_cvt_pk_bf16_f32 v79, v30, v31
    v_mfma_f32_16x16x32_bf16 v[52:55], a[92:95], a[152:155], v[52:55]
    buffer_store_dwordx4 v[76:79], v245, s[24:27], s32 offen offset:0 sc1
    v_mfma_f32_16x16x32_bf16 v[52:55], a[96:99], a[168:171], v[52:55]
    ds_write_b128 v246, v[76:79] offset:0
    v_mfma_f32_16x16x32_bf16 v[52:55], a[100:103], a[184:187], v[52:55]
    v_mfma_f32_16x16x32_bf16 v[52:55], a[104:107], a[200:203], v[52:55]
    v_mfma_f32_16x16x32_bf16 v[52:55], a[108:111], a[216:219], v[52:55]
    v_mfma_f32_16x16x32_bf16 v[52:55], a[112:115], a[232:235], v[52:55]
    v_mfma_f32_16x16x32_bf16 v[56:59], a[112:115], a[236:239], 0
    v_mfma_f32_16x16x32_bf16 v[56:59], a[108:111], a[220:223], v[56:59]
    v_mfma_f32_16x16x32_bf16 v[56:59], a[104:107], a[204:207], v[56:59]
    v_mfma_f32_16x16x32_bf16 v[56:59], a[100:103], a[188:191], v[56:59]
    v_mfma_f32_16x16x32_bf16 v[56:59], a[96:99], a[172:175], v[56:59]
    v_mfma_f32_16x16x32_bf16 v[56:59], a[92:95], a[156:159], v[56:59]
    v_mfma_f32_16x16x32_bf16 v[56:59], a[88:91], a[140:143], v[56:59]
    s_waitcnt vmcnt(32)
    v_mfma_f32_16x16x32_bf16 v[72:75], a[116:119], a[140:143], 0
    v_mfma_f32_16x16x32_bf16 v[72:75], a[120:123], a[156:159], v[72:75]
    v_mfma_f32_16x16x32_bf16 v[72:75], a[124:127], a[172:175], v[72:75]
    v_mfma_f32_16x16x32_bf16 v[72:75], v[140:143], a[188:191], v[72:75]
    v_mfma_f32_16x16x32_bf16 v[72:75], v[144:147], a[204:207], v[72:75]
    v_mfma_f32_16x16x32_bf16 v[72:75], v[148:151], a[220:223], v[72:75]
    v_mfma_f32_16x16x32_bf16 v[72:75], v[152:155], a[236:239], v[72:75]
    v_mfma_f32_16x16x32_bf16 v[68:71], v[152:155], a[232:235], 0
    v_mfma_f32_16x16x32_bf16 v[68:71], v[148:151], a[216:219], v[68:71]
    v_mfma_f32_16x16x32_bf16 v[68:71], v[144:147], a[200:203], v[68:71]
    v_mfma_f32_16x16x32_bf16 v[68:71], v[140:143], a[184:187], v[68:71]
    v_mfma_f32_16x16x32_bf16 v[68:71], a[124:127], a[168:171], v[68:71]
    v_mfma_f32_16x16x32_bf16 v[68:71], a[120:123], a[152:155], v[68:71]
    v_mfma_f32_16x16x32_bf16 v[68:71], a[116:119], a[136:139], v[68:71]
    v_mfma_f32_16x16x32_bf16 v[64:67], a[116:119], a[132:135], 0
    v_mfma_f32_16x16x32_bf16 v[64:67], a[120:123], a[148:151], v[64:67]
    v_mfma_f32_16x16x32_bf16 v[64:67], a[124:127], a[164:167], v[64:67]
    v_mfma_f32_16x16x32_bf16 v[64:67], v[140:143], a[180:183], v[64:67]
    v_mfma_f32_16x16x32_bf16 v[64:67], v[144:147], a[196:199], v[64:67]
    v_mfma_f32_16x16x32_bf16 v[64:67], v[148:151], a[212:215], v[64:67]
    v_mfma_f32_16x16x32_bf16 v[64:67], v[152:155], a[228:231], v[64:67]
    v_mfma_f32_16x16x32_bf16 v[60:63], v[152:155], a[224:227], 0
    v_mfma_f32_16x16x32_bf16 v[60:63], v[148:151], a[208:211], v[60:63]
    v_mfma_f32_16x16x32_bf16 v[60:63], v[144:147], a[192:195], v[60:63]
    v_mfma_f32_16x16x32_bf16 v[60:63], v[140:143], a[176:179], v[60:63]
    v_mfma_f32_16x16x32_bf16 v[60:63], a[124:127], a[160:163], v[60:63]
    v_mfma_f32_16x16x32_bf16 v[60:63], a[120:123], a[144:147], v[60:63]
    v_mfma_f32_16x16x32_bf16 v[60:63], a[116:119], a[128:131], v[60:63]
    s_waitcnt vmcnt(25)
    v_mfma_f32_16x16x32_bf16 v[12:15], v[156:159], a[128:131], 0
    v_mfma_f32_16x16x32_bf16 v[12:15], v[160:163], a[144:147], v[12:15]
    v_mfma_f32_16x16x32_bf16 v[12:15], v[164:167], a[160:163], v[12:15]
    v_mfma_f32_16x16x32_bf16 v[12:15], v[168:171], a[176:179], v[12:15]
    v_mfma_f32_16x16x32_bf16 v[12:15], v[172:175], a[192:195], v[12:15]
    v_cvt_pk_bf16_f32 v88, v56, v57
    v_cvt_pk_bf16_f32 v89, v58, v59
    v_mfma_f32_16x16x32_bf16 v[12:15], v[176:179], a[208:211], v[12:15]
    v_cvt_pk_bf16_f32 v90, v72, v73
    v_cvt_pk_bf16_f32 v91, v74, v75
    v_mfma_f32_16x16x32_bf16 v[12:15], v[180:183], a[224:227], v[12:15]
    buffer_store_dwordx4 v[88:91], v252, s[24:27], s35 offen offset:1024 sc1
    v_mfma_f32_16x16x32_bf16 v[16:19], v[180:183], a[228:231], 0
    v_cvt_pk_bf16_f32 v84, v52, v53
    v_cvt_pk_bf16_f32 v85, v54, v55
    v_mfma_f32_16x16x32_bf16 v[16:19], v[176:179], a[212:215], v[16:19]
    v_cvt_pk_bf16_f32 v86, v68, v69
    v_cvt_pk_bf16_f32 v87, v70, v71
    v_mfma_f32_16x16x32_bf16 v[16:19], v[172:175], a[196:199], v[16:19]
    buffer_store_dwordx4 v[84:87], v252, s[24:27], s34 offen offset:1024 sc1
    v_mfma_f32_16x16x32_bf16 v[16:19], v[168:171], a[180:183], v[16:19]
    v_cvt_pk_bf16_f32 v80, v48, v49
    v_cvt_pk_bf16_f32 v81, v50, v51
    v_mfma_f32_16x16x32_bf16 v[16:19], v[164:167], a[164:167], v[16:19]
    v_cvt_pk_bf16_f32 v82, v64, v65
    v_cvt_pk_bf16_f32 v83, v66, v67
    v_mfma_f32_16x16x32_bf16 v[16:19], v[160:163], a[148:151], v[16:19]
    buffer_store_dwordx4 v[80:83], v252, s[24:27], s33 offen offset:1024 sc1
    v_mfma_f32_16x16x32_bf16 v[16:19], v[156:159], a[132:135], v[16:19]
    v_cvt_pk_bf16_f32 v76, v44, v45
    v_cvt_pk_bf16_f32 v77, v46, v47
    v_mfma_f32_16x16x32_bf16 v[20:23], v[156:159], a[136:139], 0
    v_cvt_pk_bf16_f32 v78, v60, v61
    v_cvt_pk_bf16_f32 v79, v62, v63
    v_mfma_f32_16x16x32_bf16 v[20:23], v[160:163], a[152:155], v[20:23]
    buffer_store_dwordx4 v[76:79], v245, s[24:27], s32 offen offset:1024 sc1
    v_mfma_f32_16x16x32_bf16 v[20:23], v[164:167], a[168:171], v[20:23]
    ds_write_b128 v246, v[76:79] offset:1024
    v_mfma_f32_16x16x32_bf16 v[20:23], v[168:171], a[184:187], v[20:23]
    v_mfma_f32_16x16x32_bf16 v[20:23], v[172:175], a[200:203], v[20:23]
    v_mfma_f32_16x16x32_bf16 v[20:23], v[176:179], a[216:219], v[20:23]
    v_mfma_f32_16x16x32_bf16 v[20:23], v[180:183], a[232:235], v[20:23]
    v_mfma_f32_16x16x32_bf16 v[24:27], v[180:183], a[236:239], 0
    v_mfma_f32_16x16x32_bf16 v[24:27], v[176:179], a[220:223], v[24:27]
    v_mfma_f32_16x16x32_bf16 v[24:27], v[172:175], a[204:207], v[24:27]
    v_mfma_f32_16x16x32_bf16 v[24:27], v[168:171], a[188:191], v[24:27]
    v_mfma_f32_16x16x32_bf16 v[24:27], v[164:167], a[172:175], v[24:27]
    v_mfma_f32_16x16x32_bf16 v[24:27], v[160:163], a[156:159], v[24:27]
    v_mfma_f32_16x16x32_bf16 v[24:27], v[156:159], a[140:143], v[24:27]
    s_waitcnt vmcnt(22)
    v_mfma_f32_16x16x32_bf16 v[40:43], v[184:187], a[140:143], 0
    v_mfma_f32_16x16x32_bf16 v[40:43], v[188:191], a[156:159], v[40:43]
    v_mfma_f32_16x16x32_bf16 v[40:43], v[192:195], a[172:175], v[40:43]
    v_mfma_f32_16x16x32_bf16 v[40:43], v[196:199], a[188:191], v[40:43]
    v_mfma_f32_16x16x32_bf16 v[40:43], v[200:203], a[204:207], v[40:43]
    v_mfma_f32_16x16x32_bf16 v[40:43], v[204:207], a[220:223], v[40:43]
    v_mfma_f32_16x16x32_bf16 v[40:43], v[208:211], a[236:239], v[40:43]
    v_mfma_f32_16x16x32_bf16 v[36:39], v[208:211], a[232:235], 0
    v_mfma_f32_16x16x32_bf16 v[36:39], v[204:207], a[216:219], v[36:39]
    v_mfma_f32_16x16x32_bf16 v[36:39], v[200:203], a[200:203], v[36:39]
    v_mfma_f32_16x16x32_bf16 v[36:39], v[196:199], a[184:187], v[36:39]
    v_mfma_f32_16x16x32_bf16 v[36:39], v[192:195], a[168:171], v[36:39]
    v_mfma_f32_16x16x32_bf16 v[36:39], v[188:191], a[152:155], v[36:39]
    v_mfma_f32_16x16x32_bf16 v[36:39], v[184:187], a[136:139], v[36:39]
    v_mfma_f32_16x16x32_bf16 v[32:35], v[184:187], a[132:135], 0
    v_mfma_f32_16x16x32_bf16 v[32:35], v[188:191], a[148:151], v[32:35]
    v_mfma_f32_16x16x32_bf16 v[32:35], v[192:195], a[164:167], v[32:35]
    v_mfma_f32_16x16x32_bf16 v[32:35], v[196:199], a[180:183], v[32:35]
    v_mfma_f32_16x16x32_bf16 v[32:35], v[200:203], a[196:199], v[32:35]
    v_mfma_f32_16x16x32_bf16 v[32:35], v[204:207], a[212:215], v[32:35]
    v_mfma_f32_16x16x32_bf16 v[32:35], v[208:211], a[228:231], v[32:35]
    v_mfma_f32_16x16x32_bf16 v[28:31], v[208:211], a[224:227], 0
    v_mfma_f32_16x16x32_bf16 v[28:31], v[204:207], a[208:211], v[28:31]
    v_mfma_f32_16x16x32_bf16 v[28:31], v[200:203], a[192:195], v[28:31]
    v_mfma_f32_16x16x32_bf16 v[28:31], v[196:199], a[176:179], v[28:31]
    v_mfma_f32_16x16x32_bf16 v[28:31], v[192:195], a[160:163], v[28:31]
    v_mfma_f32_16x16x32_bf16 v[28:31], v[188:191], a[144:147], v[28:31]
    v_mfma_f32_16x16x32_bf16 v[28:31], v[184:187], a[128:131], v[28:31]
    s_waitcnt vmcnt(15)
    v_mfma_f32_16x16x32_bf16 v[44:47], v[212:215], a[128:131], 0
    v_mfma_f32_16x16x32_bf16 v[44:47], v[216:219], a[144:147], v[44:47]
    v_mfma_f32_16x16x32_bf16 v[44:47], a[0:3], a[160:163], v[44:47]
    v_mfma_f32_16x16x32_bf16 v[44:47], a[4:7], a[176:179], v[44:47]
    v_mfma_f32_16x16x32_bf16 v[44:47], a[8:11], a[192:195], v[44:47]
    v_cvt_pk_bf16_f32 v88, v24, v25
    v_cvt_pk_bf16_f32 v89, v26, v27
    v_mfma_f32_16x16x32_bf16 v[44:47], a[12:15], a[208:211], v[44:47]
    v_cvt_pk_bf16_f32 v90, v40, v41
    v_cvt_pk_bf16_f32 v91, v42, v43
    v_mfma_f32_16x16x32_bf16 v[44:47], a[16:19], a[224:227], v[44:47]
    buffer_store_dwordx4 v[88:91], v252, s[24:27], s35 offen offset:2048 sc1
    v_mfma_f32_16x16x32_bf16 v[48:51], a[16:19], a[228:231], 0
    s_waitcnt vmcnt(1)
    s_barrier
    s_cmp_lg_u32 s19, 0
    s_cbranch_scc1 L_nfc
    buffer_store_dword v2, v243, s[24:27], s36 offen offset:8 sc1
L_nfc:
    v_mfma_f32_16x16x32_bf16 v[48:51], a[12:15], a[212:215], v[48:51]
    v_cvt_pk_bf16_f32 v84, v20, v21
    v_cvt_pk_bf16_f32 v85, v22, v23
    v_mfma_f32_16x16x32_bf16 v[48:51], a[8:11], a[196:199], v[48:51]
    v_cvt_pk_bf16_f32 v86, v36, v37
    v_cvt_pk_bf16_f32 v87, v38, v39
    v_mfma_f32_16x16x32_bf16 v[48:51], a[4:7], a[180:183], v[48:51]
    buffer_store_dwordx4 v[84:87], v252, s[24:27], s34 offen offset:2048 sc1
    v_mfma_f32_16x16x32_bf16 v[48:51], a[0:3], a[164:167], v[48:51]
    v_cvt_pk_bf16_f32 v80, v16, v17
    v_cvt_pk_bf16_f32 v81, v18, v19
    v_mfma_f32_16x16x32_bf16 v[48:51], v[216:219], a[148:151], v[48:51]
    v_cvt_pk_bf16_f32 v82, v32, v33
    v_cvt_pk_bf16_f32 v83, v34, v35
    v_mfma_f32_16x16x32_bf16 v[48:51], v[212:215], a[132:135], v[48:51]
    buffer_store_dwordx4 v[80:83], v252, s[24:27], s33 offen offset:2048 sc1
    v_mfma_f32_16x16x32_bf16 v[52:55], v[212:215], a[136:139], 0
    v_cvt_pk_bf16_f32 v76, v12, v13
    v_cvt_pk_bf16_f32 v77, v14, v15
    v_mfma_f32_16x16x32_bf16 v[52:55], v[216:219], a[152:155], v[52:55]
    v_cvt_pk_bf16_f32 v78, v28, v29
    v_cvt_pk_bf16_f32 v79, v30, v31
    v_mfma_f32_16x16x32_bf16 v[52:55], a[0:3], a[168:171], v[52:55]
    buffer_store_dwordx4 v[76:79], v245, s[24:27], s32 offen offset:2048 sc1
    v_mfma_f32_16x16x32_bf16 v[52:55], a[4:7], a[184:187], v[52:55]
    ds_write_b128 v246, v[76:79] offset:2048
    v_mfma_f32_16x16x32_bf16 v[52:55], a[8:11], a[200:203], v[52:55]
    v_mfma_f32_16x16x32_bf16 v[52:55], a[12:15], a[216:219], v[52:55]
    v_mfma_f32_16x16x32_bf16 v[52:55], a[16:19], a[232:235], v[52:55]
    v_mfma_f32_16x16x32_bf16 v[56:59], a[16:19], a[236:239], 0
    v_mfma_f32_16x16x32_bf16 v[56:59], a[12:15], a[220:223], v[56:59]
    v_mfma_f32_16x16x32_bf16 v[56:59], a[8:11], a[204:207], v[56:59]
    v_mfma_f32_16x16x32_bf16 v[56:59], a[4:7], a[188:191], v[56:59]
    v_mfma_f32_16x16x32_bf16 v[56:59], a[0:3], a[172:175], v[56:59]
    v_mfma_f32_16x16x32_bf16 v[56:59], v[216:219], a[156:159], v[56:59]
    v_mfma_f32_16x16x32_bf16 v[56:59], v[212:215], a[140:143], v[56:59]
    v_mfma_f32_16x16x32_bf16 v[72:75], a[20:23], a[140:143], 0
    v_mfma_f32_16x16x32_bf16 v[72:75], a[24:27], a[156:159], v[72:75]
    v_mfma_f32_16x16x32_bf16 v[72:75], a[28:31], a[172:175], v[72:75]
    v_mfma_f32_16x16x32_bf16 v[72:75], a[32:35], a[188:191], v[72:75]
    v_mfma_f32_16x16x32_bf16 v[72:75], a[36:39], a[204:207], v[72:75]
    v_mfma_f32_16x16x32_bf16 v[72:75], a[40:43], a[220:223], v[72:75]
    v_mfma_f32_16x16x32_bf16 v[72:75], a[44:47], a[236:239], v[72:75]
    v_mfma_f32_16x16x32_bf16 v[68:71], a[44:47], a[232:235], 0
    v_mfma_f32_16x16x32_bf16 v[68:71], a[40:43], a[216:219], v[68:71]
    v_mfma_f32_16x16x32_bf16 v[68:71], a[36:39], a[200:203], v[68:71]
    v_mfma_f32_16x16x32_bf16 v[68:71], a[32:35], a[184:187], v[68:71]
    v_mfma_f32_16x16x32_bf16 v[68:71], a[28:31], a[168:171], v[68:71]
    v_cvt_pk_bf16_f32 v88, v56, v57
    v_cvt_pk_bf16_f32 v89, v58, v59
    v_mfma_f32_16x16x32_bf16 v[68:71], a[24:27], a[152:155], v[68:71]
    v_cvt_pk_bf16_f32 v90, v72, v73
    v_cvt_pk_bf16_f32 v91, v74, v75
    v_mfma_f32_16x16x32_bf16 v[68:71], a[20:23], a[136:139], v[68:71]
    buffer_store_dwordx4 v[88:91], v252, s[24:27], s35 offen offset:3072 sc1
    v_mfma_f32_16x16x32_bf16 v[64:67], a[20:23], a[132:135], 0
    v_mfma_f32_16x16x32_bf16 v[64:67], a[24:27], a[148:151], v[64:67]
    v_mfma_f32_16x16x32_bf16 v[64:67], a[28:31], a[164:167], v[64:67]
    v_mfma_f32_16x16x32_bf16 v[64:67], a[32:35], a[180:183], v[64:67]
    v_mfma_f32_16x16x32_bf16 v[64:67], a[36:39], a[196:199], v[64:67]
    v_cvt_pk_bf16_f32 v84, v52, v53
    v_cvt_pk_bf16_f32 v85, v54, v55
    v_mfma_f32_16x16x32_bf16 v[64:67], a[40:43], a[212:215], v[64:67]
    v_cvt_pk_bf16_f32 v86, v68, v69
    v_cvt_pk_bf16_f32 v87, v70, v71
    v_mfma_f32_16x16x32_bf16 v[64:67], a[44:47], a[228:231], v[64:67]
    buffer_store_dwordx4 v[84:87], v252, s[24:27], s34 offen offset:3072 sc1
    v_mfma_f32_16x16x32_bf16 v[60:63], a[44:47], a[224:227], 0
    v_mfma_f32_16x16x32_bf16 v[60:63], a[40:43], a[208:211], v[60:63]
    v_mfma_f32_16x16x32_bf16 v[60:63], a[36:39], a[192:195], v[60:63]
    v_mfma_f32_16x16x32_bf16 v[60:63], a[32:35], a[176:179], v[60:63]
    v_mfma_f32_16x16x32_bf16 v[60:63], a[28:31], a[160:163], v[60:63]
    v_cvt_pk_bf16_f32 v80, v48, v49
    v_cvt_pk_bf16_f32 v81, v50, v51
    v_mfma_f32_16x16x32_bf16 v[60:63], a[24:27], a[144:147], v[60:63]
    v_cvt_pk_bf16_f32 v82, v64, v65
    v_cvt_pk_bf16_f32 v83, v66, v67
    v_mfma_f32_16x16x32_bf16 v[60:63], a[20:23], a[128:131], v[60:63]
    buffer_store_dwordx4 v[80:83], v252, s[24:27], s33 offen offset:3072 sc1
    s_nop 5
    v_cvt_pk_bf16_f32 v76, v44, v45
    v_cvt_pk_bf16_f32 v77, v46, v47
    v_cvt_pk_bf16_f32 v78, v60, v61
    v_cvt_pk_bf16_f32 v79, v62, v63
    buffer_store_dwordx4 v[76:79], v245, s[24:27], s32 offen offset:3072 sc1
    ds_write_b128 v246, v[76:79] offset:3072
    ds_read_b128 v[140:143], v247 offset:0
    ds_read_b128 v[144:147], v247 offset:2048
    v_bfe_u32 v4, v0, 3, 1
    v_mul_u32_u24 v4, 24, v4
    v_add_u32 v6, v4, v240
    s_waitcnt lgkmcnt(0)
    v_lshlrev_b32 v12, 16, v140
    v_and_b32 v13, 0xffff0000, v140
    v_lshlrev_b32 v14, 16, v141
    v_and_b32 v15, 0xffff0000, v141
    v_lshlrev_b32 v16, 16, v142
    v_and_b32 v17, 0xffff0000, v142
    v_lshlrev_b32 v18, 16, v143
    v_and_b32 v19, 0xffff0000, v143
    v_lshlrev_b32 v20, 16, v144
    v_and_b32 v21, 0xffff0000, v144
    v_lshlrev_b32 v22, 16, v145
    v_and_b32 v23, 0xffff0000, v145
    v_lshlrev_b32 v24, 16, v146
    v_and_b32 v25, 0xffff0000, v146
    v_lshlrev_b32 v26, 16, v147
    v_and_b32 v27, 0xffff0000, v147
    s_add_u32 s30, s38, 35651584
    s_add_u32 s29, s22, 1
    s_and_b32 s29, s29, 7
    s_lshl_b32 s29, s29, 21
    s_add_u32 s73, s29, s30
    s_add_u32 s29, s22, 2
    s_and_b32 s29, s29, 7
    s_lshl_b32 s29, s29, 21
    s_add_u32 s74, s29, s30
    s_add_u32 s29, s22, 3
    s_and_b32 s29, s29, 7
    s_lshl_b32 s29, s29, 21
    s_add_u32 s75, s29, s30
    s_add_u32 s29, s22, 4
    s_and_b32 s29, s29, 7
    s_lshl_b32 s29, s29, 21
    s_add_u32 s76, s29, s30
    s_add_u32 s29, s22, 5
    s_and_b32 s29, s29, 7
    s_lshl_b32 s29, s29, 21
    s_add_u32 s77, s29, s30
    s_add_u32 s29, s22, 6
    s_and_b32 s29, s29, 7
    s_lshl_b32 s29, s29, 21
    s_add_u32 s78, s29, s30
    s_add_u32 s29, s22, 7
    s_and_b32 s29, s29, 7
    s_lshl_b32 s29, s29, 21
    s_add_u32 s79, s29, s30
    s_cmp_lg_u32 s19, 0
    s_cbranch_scc1 L_apc
    s_load_dword s81, s[90:91], 136 glc
    s_load_dword s82, s[90:91], 264 glc
    s_load_dword s83, s[90:91], 392 glc
    s_load_dword s84, s[90:91], 520 glc
    s_load_dword s85, s[90:91], 648 glc
    s_load_dword s86, s[90:91], 776 glc
    s_load_dword s87, s[90:91], 904 glc
L_apc:
    s_waitcnt vmcnt(0)
    s_barrier
    s_cmp_lg_u32 s19, 0
    s_cbranch_scc1 L_nfd
    buffer_store_dword v2, v243, s[24:27], s36 offen offset:12 sc1
L_nfd:
    s_waitcnt lgkmcnt(0)
    s_cmp_lg_u32 s19, 0
    s_cbranch_scc1 L_poutc
    s_mov_b32 s28, 0
    s_branch L_pcc
L_pollc:
    s_load_dword s81, s[90:91], 136 glc
    s_load_dword s82, s[90:91], 264 glc
    s_load_dword s83, s[90:91], 392 glc
    s_load_dword s84, s[90:91], 520 glc
    s_load_dword s85, s[90:91], 648 glc
    s_load_dword s86, s[90:91], 776 glc
    s_load_dword s87, s[90:91], 904 glc
L_pcc:
    s_add_u32 s28, s28, 1
    s_cmp_gt_u32 s28, 0x80000
    s_waitcnt lgkmcnt(0)
    s_cbranch_scc1 L_poutc
    s_cmp_lg_u32 s81, s45
    s_cbranch_scc1 L_pollc
    s_cmp_lg_u32 s82, s45
    s_cbranch_scc1 L_pollc
    s_cmp_lg_u32 s83, s45
    s_cbranch_scc1 L_pollc
    s_cmp_lg_u32 s84, s45
    s_cbranch_scc1 L_pollc
    s_cmp_lg_u32 s85, s45
    s_cbranch_scc1 L_pollc
    s_cmp_lg_u32 s86, s45
    s_cbranch_scc1 L_pollc
    s_cmp_lg_u32 s87, s45
    s_cbranch_scc1 L_pollc
L_poutc:
    s_barrier
    buffer_load_dwordx4 v[148:151], v241, s[24:27], s73 offen offset:0 sc1
    buffer_load_dwordx4 v[156:159], v241, s[24:27], s74 offen offset:0 sc1
    buffer_load_dwordx4 v[164:167], v241, s[24:27], s75 offen offset:0 sc1
    buffer_load_dwordx4 v[172:175], v241, s[24:27], s76 offen offset:0 sc1
    buffer_load_dwordx4 v[180:183], v241, s[24:27], s77 offen offset:0 sc1
    buffer_load_dwordx4 v[188:191], v241, s[24:27], s78 offen offset:0 sc1
    buffer_load_dwordx4 v[196:199], v241, s[24:27], s79 offen offset:0 sc1
    s_waitcnt lgkmcnt(0)
    s_cmp_lg_u32 s19, 0
    s_cbranch_scc1 L_poutd
    s_mov_b32 s28, 0
L_polld:
    s_load_dword s81, s[90:91], 140 glc
    s_load_dword s82, s[90:91], 268 glc
    s_load_dword s83, s[90:91], 396 glc
    s_load_dword s84, s[90:91], 524 glc
    s_load_dword s85, s[90:91], 652 glc
    s_load_dword s86, s[90:91], 780 glc
    s_load_dword s87, s[90:91], 908 glc
L_pcd:
    s_add_u32 s28, s28, 1
    s_cmp_gt_u32 s28, 0x80000
    s_waitcnt lgkmcnt(0)
    s_cbranch_scc1 L_poutd
    s_cmp_lg_u32 s81, s45
    s_cbranch_scc1 L_polld
    s_cmp_lg_u32 s82, s45
    s_cbranch_scc1 L_polld
    s_cmp_lg_u32 s83, s45
    s_cbranch_scc1 L_polld
    s_cmp_lg_u32 s84, s45
    s_cbranch_scc1 L_polld
    s_cmp_lg_u32 s85, s45
    s_cbranch_scc1 L_polld
    s_cmp_lg_u32 s86, s45
    s_cbranch_scc1 L_polld
    s_cmp_lg_u32 s87, s45
    s_cbranch_scc1 L_polld
L_poutd:
    s_barrier
    buffer_load_dwordx4 v[152:155], v241, s[24:27], s73 offen offset:2048 sc1
    buffer_load_dwordx4 v[160:163], v241, s[24:27], s74 offen offset:2048 sc1
    buffer_load_dwordx4 v[168:171], v241, s[24:27], s75 offen offset:2048 sc1
    buffer_load_dwordx4 v[176:179], v241, s[24:27], s76 offen offset:2048 sc1
    buffer_load_dwordx4 v[184:187], v241, s[24:27], s77 offen offset:2048 sc1
    buffer_load_dwordx4 v[192:195], v241, s[24:27], s78 offen offset:2048 sc1
    buffer_load_dwordx4 v[200:203], v241, s[24:27], s79 offen offset:2048 sc1
    s_mov_b32 s28, 0x00003f80
    s_mov_b32 s29, 0x3f800000
    s_waitcnt vmcnt(13)
    v_dot2_f32_bf16 v12, v148, s28, v12
    v_dot2_f32_bf16 v13, v148, s29, v13
    v_dot2_f32_bf16 v14, v149, s28, v14
    v_dot2_f32_bf16 v15, v149, s29, v15
    v_dot2_f32_bf16 v16, v150, s28, v16
    v_dot2_f32_bf16 v17, v150, s29, v17
    v_dot2_f32_bf16 v18, v151, s28, v18
    v_dot2_f32_bf16 v19, v151, s29, v19
    s_waitcnt vmcnt(12)
    v_dot2_f32_bf16 v12, v156, s28, v12
    v_dot2_f32_bf16 v13, v156, s29, v13
    v_dot2_f32_bf16 v14, v157, s28, v14
    v_dot2_f32_bf16 v15, v157, s29, v15
    v_dot2_f32_bf16 v16, v158, s28, v16
    v_dot2_f32_bf16 v17, v158, s29, v17
    v_dot2_f32_bf16 v18, v159, s28, v18
    v_dot2_f32_bf16 v19, v159, s29, v19
    s_waitcnt vmcnt(11)
    v_dot2_f32_bf16 v12, v164, s28, v12
    v_dot2_f32_bf16 v13, v164, s29, v13
    v_dot2_f32_bf16 v14, v165, s28, v14
    v_dot2_f32_bf16 v15, v165, s29, v15
    v_dot2_f32_bf16 v16, v166, s28, v16
    v_dot2_f32_bf16 v17, v166, s29, v17
    v_dot2_f32_bf16 v18, v167, s28, v18
    v_dot2_f32_bf16 v19, v167, s29, v19
    s_waitcnt vmcnt(10)
    v_dot2_f32_bf16 v12, v172, s28, v12
    v_dot2_f32_bf16 v13, v172, s29, v13
    v_dot2_f32_bf16 v14, v173, s28, v14
    v_dot2_f32_bf16 v15, v173, s29, v15
    v_dot2_f32_bf16 v16, v174, s28, v16
    v_dot2_f32_bf16 v17, v174, s29, v17
    v_dot2_f32_bf16 v18, v175, s28, v18
    v_dot2_f32_bf16 v19, v175, s29, v19
    s_waitcnt vmcnt(9)
    v_dot2_f32_bf16 v12, v180, s28, v12
    v_dot2_f32_bf16 v13, v180, s29, v13
    v_dot2_f32_bf16 v14, v181, s28, v14
    v_dot2_f32_bf16 v15, v181, s29, v15
    v_dot2_f32_bf16 v16, v182, s28, v16
    v_dot2_f32_bf16 v17, v182, s29, v17
    v_dot2_f32_bf16 v18, v183, s28, v18
    v_dot2_f32_bf16 v19, v183, s29, v19
    s_waitcnt vmcnt(8)
    v_dot2_f32_bf16 v12, v188, s28, v12
    v_dot2_f32_bf16 v13, v188, s29, v13
    v_dot2_f32_bf16 v14, v189, s28, v14
    v_dot2_f32_bf16 v15, v189, s29, v15
    v_dot2_f32_bf16 v16, v190, s28, v16
    v_dot2_f32_bf16 v17, v190, s29, v17
    v_dot2_f32_bf16 v18, v191, s28, v18
    v_dot2_f32_bf16 v19, v191, s29, v19
    s_waitcnt vmcnt(7)
    v_dot2_f32_bf16 v12, v196, s28, v12
    v_dot2_f32_bf16 v13, v196, s29, v13
    v_dot2_f32_bf16 v14, v197, s28, v14
    v_dot2_f32_bf16 v15, v197, s29, v15
    v_dot2_f32_bf16 v16, v198, s28, v16
    v_dot2_f32_bf16 v17, v198, s29, v17
    v_dot2_f32_bf16 v18, v199, s28, v18
    v_dot2_f32_bf16 v19, v199, s29, v19
    s_nop 1
    v_pk_fma_f32 v[124:125], v[92:93], v[12:13], v[124:125]
    v_pk_fma_f32 v[126:127], v[94:95], v[14:15], v[126:127]
    v_pk_fma_f32 v[128:129], v[96:97], v[16:17], v[128:129]
    v_pk_fma_f32 v[130:131], v[98:99], v[18:19], v[130:131]
    v_cvt_pk_bf16_f32 v140, v124, v125
    v_cvt_pk_bf16_f32 v141, v126, v127
    v_cvt_pk_bf16_f32 v142, v128, v129
    v_cvt_pk_bf16_f32 v143, v130, v131
    v_mov_b32 v4, v142
    v_mov_b32 v5, v143
    v_mov_b32_dpp v142, v140 row_ror:8 row_mask:0xf bank_mask:0x3
    v_mov_b32_dpp v143, v141 row_ror:8 row_mask:0xf bank_mask:0x3
    v_mov_b32_dpp v140, v4 row_ror:8 row_mask:0xf bank_mask:0xc
    v_mov_b32_dpp v141, v5 row_ror:8 row_mask:0xf bank_mask:0xc
    buffer_store_dwordx4 v[140:143], v6, s[56:59], s39 offen offset:0
    s_waitcnt vmcnt(7)
    v_dot2_f32_bf16 v20, v152, s28, v20
    v_dot2_f32_bf16 v21, v152, s29, v21
    v_dot2_f32_bf16 v22, v153, s28, v22
    v_dot2_f32_bf16 v23, v153, s29, v23
    v_dot2_f32_bf16 v24, v154, s28, v24
    v_dot2_f32_bf16 v25, v154, s29, v25
    v_dot2_f32_bf16 v26, v155, s28, v26
    v_dot2_f32_bf16 v27, v155, s29, v27
    s_waitcnt vmcnt(6)
    v_dot2_f32_bf16 v20, v160, s28, v20
    v_dot2_f32_bf16 v21, v160, s29, v21
    v_dot2_f32_bf16 v22, v161, s28, v22
    v_dot2_f32_bf16 v23, v161, s29, v23
    v_dot2_f32_bf16 v24, v162, s28, v24
    v_dot2_f32_bf16 v25, v162, s29, v25
    v_dot2_f32_bf16 v26, v163, s28, v26
    v_dot2_f32_bf16 v27, v163, s29, v27
    s_waitcnt vmcnt(5)
    v_dot2_f32_bf16 v20, v168, s28, v20
    v_dot2_f32_bf16 v21, v168, s29, v21
    v_dot2_f32_bf16 v22, v169, s28, v22
    v_dot2_f32_bf16 v23, v169, s29, v23
    v_dot2_f32_bf16 v24, v170, s28, v24
    v_dot2_f32_bf16 v25, v170, s29, v25
    v_dot2_f32_bf16 v26, v171, s28, v26
    v_dot2_f32_bf16 v27, v171, s29, v27
    s_waitcnt vmcnt(4)
    v_dot2_f32_bf16 v20, v176, s28, v20
    v_dot2_f32_bf16 v21, v176, s29, v21
    v_dot2_f32_bf16 v22, v177, s28, v22
    v_dot2_f32_bf16 v23, v177, s29, v23
    v_dot2_f32_bf16 v24, v178, s28, v24
    v_dot2_f32_bf16 v25, v178, s29, v25
    v_dot2_f32_bf16 v26, v179, s28, v26
    v_dot2_f32_bf16 v27, v179, s29, v27
    s_waitcnt vmcnt(3)
    v_dot2_f32_bf16 v20, v184, s28, v20
    v_dot2_f32_bf16 v21, v184, s29, v21
    v_dot2_f32_bf16 v22, v185, s28, v22
    v_dot2_f32_bf16 v23, v185, s29, v23
    v_dot2_f32_bf16 v24, v186, s28, v24
    v_dot2_f32_bf16 v25, v186, s29, v25
    v_dot2_f32_bf16 v26, v187, s28, v26
    v_dot2_f32_bf16 v27, v187, s29, v27
    s_waitcnt vmcnt(2)
    v_dot2_f32_bf16 v20, v192, s28, v20
    v_dot2_f32_bf16 v21, v192, s29, v21
    v_dot2_f32_bf16 v22, v193, s28, v22
    v_dot2_f32_bf16 v23, v193, s29, v23
    v_dot2_f32_bf16 v24, v194, s28, v24
    v_dot2_f32_bf16 v25, v194, s29, v25
    v_dot2_f32_bf16 v26, v195, s28, v26
    v_dot2_f32_bf16 v27, v195, s29, v27
    s_waitcnt vmcnt(1)
    v_dot2_f32_bf16 v20, v200, s28, v20
    v_dot2_f32_bf16 v21, v200, s29, v21
    v_dot2_f32_bf16 v22, v201, s28, v22
    v_dot2_f32_bf16 v23, v201, s29, v23
    v_dot2_f32_bf16 v24, v202, s28, v24
    v_dot2_f32_bf16 v25, v202, s29, v25
    v_dot2_f32_bf16 v26, v203, s28, v26
    v_dot2_f32_bf16 v27, v203, s29, v27
    s_nop 1
    v_pk_fma_f32 v[132:133], v[100:101], v[20:21], v[132:133]
    v_pk_fma_f32 v[134:135], v[102:103], v[22:23], v[134:135]
    v_pk_fma_f32 v[136:137], v[104:105], v[24:25], v[136:137]
    v_pk_fma_f32 v[138:139], v[106:107], v[26:27], v[138:139]
    v_cvt_pk_bf16_f32 v144, v132, v133
    v_cvt_pk_bf16_f32 v145, v134, v135
    v_cvt_pk_bf16_f32 v146, v136, v137
    v_cvt_pk_bf16_f32 v147, v138, v139
    v_mov_b32 v4, v146
    v_mov_b32 v5, v147
    v_mov_b32_dpp v146, v144 row_ror:8 row_mask:0xf bank_mask:0x3
    v_mov_b32_dpp v147, v145 row_ror:8 row_mask:0xf bank_mask:0x3
    v_mov_b32_dpp v144, v4 row_ror:8 row_mask:0xf bank_mask:0xc
    v_mov_b32_dpp v145, v5 row_ror:8 row_mask:0xf bank_mask:0xc
    buffer_store_dwordx4 v[144:147], v6, s[56:59], s39 offen offset:128
L_end:
    s_endpgm
L_hook:
    s_mov_b32 s28, 0
L_pchk:
    buffer_load_dwordx4 v[228:231], v252, s[24:27], s21 offen sc1
    s_waitcnt vmcnt(0)
    v_xor_b32 v2, v238, v228
    v_bitop3_b32 v2, v2, v229, v238 bitop3:0xf6
    v_bitop3_b32 v2, v2, v230, v238 bitop3:0xf6
    v_bitop3_b32 v2, v2, v231, v238 bitop3:0xf6
    v_cmp_ne_u32 vcc, 0, v2
    s_add_u32 s28, s28, 1
    s_cmp_gt_u32 s28, 0x40000
    s_cbranch_scc1 L_back
    s_cbranch_vccnz L_pchk
    s_branch L_back
L_fallback:
    s_waitcnt vmcnt(0) lgkmcnt(0)
    s_barrier
    s_mov_b32 s8, s46
    s_mov_b32 s9, s47
    s_mov_b32 s10, 0x80000
    s_mov_b32 s11, 0x20000
    s_mov_b32 s12, s48
    s_mov_b32 s13, s49
    s_mov_b32 s14, 0x80000
    s_mov_b32 s15, 0x20000
    s_mov_b32 s30, 16384
    s_mov_b32 s16, 0
    v_and_b32 v2, 15, v0
    v_lshrrev_b32 v3, 4, v0
    v_lshl_add_u32 v4, v1, 4, v3
    v_lshlrev_b32 v4, 8, v4
    v_xor_b32 v5, v2, v3
    v_lshl_add_u32 v216, v5, 4, v4
    v_xor_b32 v217, 64, v216
    v_xor_b32 v218, 128, v216
    v_xor_b32 v219, 192, v216
    v_lshlrev_b32 v5, 1, v3
    v_xor_b32 v5, v2, v5
    v_lshl_add_u32 v220, v5, 4, v4
    v_xor_b32 v221, 128, v220
    v_mov_b32 v222, v220
    v_mov_b32 v223, v221
    s_mov_b64 s[60:61], s[40:41]
    s_mov_b32 s62, 0
    s_mov_b32 s74, 2147483648
    s_mov_b32 s75, 2147483648
    s_mov_b32 s76, 2147483648
    s_mov_b32 s77, 2147483648
    s_mov_b32 s78, 0
    s_mov_b32 s79, 0
    v_mov_b32 v232, 131072
    v_mov_b32 v236, 131072
    v_mov_b32 v233, 0
    v_mov_b32 v172, 0xff800000
    v_mov_b32 v176, 0xff800000
    v_mov_b32 v180, 0xff800000
    v_mov_b32 v184, 0xff800000
    s_mov_b32 s18, 32
L_fbloop:
    s_add_u32 m0, s17, 0
    s_nop 0
    buffer_load_dwordx4 v216, s[8:11], s16 offen offset:0 nt lds
    buffer_load_dwordx4 v217, s[8:11], s16 offen offset:1024 nt lds
    buffer_load_dwordx4 v218, s[8:11], s16 offen offset:2048 nt lds
    buffer_load_dwordx4 v219, s[8:11], s16 offen offset:3072 nt lds
    s_add_u32 s16, s16, s30
    s_waitcnt vmcnt(0)
    s_barrier
    ds_read_b128 a[128:131], v204 offset:0
    ds_read_b128 a[132:135], v205 offset:0
    ds_read_b128 a[136:139], v206 offset:0
    ds_read_b128 a[140:143], v207 offset:0
    ds_read_b128 a[144:147], v204 offset:4096
    ds_read_b128 a[148:151], v205 offset:4096
    ds_read_b128 a[152:155], v206 offset:4096
    ds_read_b128 a[156:159], v207 offset:4096
    s_waitcnt lgkmcnt(0)
    ds_read_b128 a[160:163], v204 offset:8192
    ds_read_b128 a[164:167], v205 offset:8192
    ds_read_b128 a[168:171], v206 offset:8192
    ds_read_b128 a[172:175], v207 offset:8192
    ds_read_b128 a[176:179], v204 offset:12288
    ds_read_b128 a[180:183], v205 offset:12288
    ds_read_b128 a[184:187], v206 offset:12288
    ds_read_b128 a[188:191], v207 offset:12288
    s_waitcnt lgkmcnt(0)
    s_barrier
    v_mfma_f32_16x16x32_bf16 v[76:79], a[128:131], v[12:15], 0
    v_mfma_f32_16x16x32_bf16 v[76:79], a[132:135], v[16:19], v[76:79]
    v_mfma_f32_16x16x32_bf16 v[76:79], a[136:139], v[20:23], v[76:79]
    v_mfma_f32_16x16x32_bf16 v[76:79], a[140:143], v[24:27], v[76:79]
    v_mfma_f32_16x16x32_bf16 v[80:83], a[128:131], v[28:31], 0
    v_mfma_f32_16x16x32_bf16 v[80:83], a[132:135], v[32:35], v[80:83]
    v_mfma_f32_16x16x32_bf16 v[80:83], a[136:139], v[36:39], v[80:83]
    v_mfma_f32_16x16x32_bf16 v[80:83], a[140:143], v[40:43], v[80:83]
    v_mfma_f32_16x16x32_bf16 v[108:111], a[128:131], v[44:47], 0
    v_mfma_f32_16x16x32_bf16 v[108:111], a[132:135], v[48:51], v[108:111]
    v_mfma_f32_16x16x32_bf16 v[108:111], a[136:139], v[52:55], v[108:111]
    v_mfma_f32_16x16x32_bf16 v[108:111], a[140:143], v[56:59], v[108:111]
    v_mfma_f32_16x16x32_bf16 v[112:115], a[128:131], v[60:63], 0
    v_mfma_f32_16x16x32_bf16 v[112:115], a[132:135], v[64:67], v[112:115]
    v_mfma_f32_16x16x32_bf16 v[112:115], a[136:139], v[68:71], v[112:115]
    v_mfma_f32_16x16x32_bf16 v[112:115], a[140:143], v[72:75], v[112:115]
    v_mfma_f32_16x16x32_bf16 v[84:87], a[144:147], v[12:15], 0
    v_mfma_f32_16x16x32_bf16 v[84:87], a[148:151], v[16:19], v[84:87]
    v_mfma_f32_16x16x32_bf16 v[84:87], a[152:155], v[20:23], v[84:87]
    v_mfma_f32_16x16x32_bf16 v[84:87], a[156:159], v[24:27], v[84:87]
    v_mfma_f32_16x16x32_bf16 v[88:91], a[144:147], v[28:31], 0
    v_mfma_f32_16x16x32_bf16 v[88:91], a[148:151], v[32:35], v[88:91]
    v_mfma_f32_16x16x32_bf16 v[88:91], a[152:155], v[36:39], v[88:91]
    v_mfma_f32_16x16x32_bf16 v[88:91], a[156:159], v[40:43], v[88:91]
    v_mfma_f32_16x16x32_bf16 v[116:119], a[144:147], v[44:47], 0
    v_mfma_f32_16x16x32_bf16 v[116:119], a[148:151], v[48:51], v[116:119]
    v_mfma_f32_16x16x32_bf16 v[116:119], a[152:155], v[52:55], v[116:119]
    v_mfma_f32_16x16x32_bf16 v[116:119], a[156:159], v[56:59], v[116:119]
    v_mfma_f32_16x16x32_bf16 v[120:123], a[144:147], v[60:63], 0
    v_mfma_f32_16x16x32_bf16 v[120:123], a[148:151], v[64:67], v[120:123]
    v_mfma_f32_16x16x32_bf16 v[120:123], a[152:155], v[68:71], v[120:123]
    v_mfma_f32_16x16x32_bf16 v[120:123], a[156:159], v[72:75], v[120:123]
    v_mfma_f32_16x16x32_bf16 v[92:95], a[160:163], v[12:15], 0
    v_mfma_f32_16x16x32_bf16 v[92:95], a[164:167], v[16:19], v[92:95]
    v_mfma_f32_16x16x32_bf16 v[92:95], a[168:171], v[20:23], v[92:95]
    v_mfma_f32_16x16x32_bf16 v[92:95], a[172:175], v[24:27], v[92:95]
    v_mfma_f32_16x16x32_bf16 v[96:99], a[160:163], v[28:31], 0
    v_mfma_f32_16x16x32_bf16 v[96:99], a[164:167], v[32:35], v[96:99]
    v_mfma_f32_16x16x32_bf16 v[96:99], a[168:171], v[36:39], v[96:99]
    v_mfma_f32_16x16x32_bf16 v[96:99], a[172:175], v[40:43], v[96:99]
    v_mfma_f32_16x16x32_bf16 v[124:127], a[160:163], v[44:47], 0
    v_mfma_f32_16x16x32_bf16 v[124:127], a[164:167], v[48:51], v[124:127]
    v_mfma_f32_16x16x32_bf16 v[124:127], a[168:171], v[52:55], v[124:127]
    v_mfma_f32_16x16x32_bf16 v[124:127], a[172:175], v[56:59], v[124:127]
    v_mfma_f32_16x16x32_bf16 v[128:131], a[160:163], v[60:63], 0
    v_mfma_f32_16x16x32_bf16 v[128:131], a[164:167], v[64:67], v[128:131]
    v_mfma_f32_16x16x32_bf16 v[128:131], a[168:171], v[68:71], v[128:131]
    v_mfma_f32_16x16x32_bf16 v[128:131], a[172:175], v[72:75], v[128:131]
    v_mfma_f32_16x16x32_bf16 v[100:103], a[176:179], v[12:15], 0
    v_mfma_f32_16x16x32_bf16 v[100:103], a[180:183], v[16:19], v[100:103]
    v_mfma_f32_16x16x32_bf16 v[100:103], a[184:187], v[20:23], v[100:103]
    v_mfma_f32_16x16x32_bf16 v[100:103], a[188:191], v[24:27], v[100:103]
    v_mfma_f32_16x16x32_bf16 v[104:107], a[176:179], v[28:31], 0
    v_mfma_f32_16x16x32_bf16 v[104:107], a[180:183], v[32:35], v[104:107]
    v_mfma_f32_16x16x32_bf16 v[104:107], a[184:187], v[36:39], v[104:107]
    v_mfma_f32_16x16x32_bf16 v[104:107], a[188:191], v[40:43], v[104:107]
    v_mfma_f32_16x16x32_bf16 v[132:135], a[176:179], v[44:47], 0
    v_mfma_f32_16x16x32_bf16 v[132:135], a[180:183], v[48:51], v[132:135]
    v_mfma_f32_16x16x32_bf16 v[132:135], a[184:187], v[52:55], v[132:135]
    v_mfma_f32_16x16x32_bf16 v[132:135], a[188:191], v[56:59], v[132:135]
    v_mfma_f32_16x16x32_bf16 v[136:139], a[176:179], v[60:63], 0
    v_mfma_f32_16x16x32_bf16 v[136:139], a[180:183], v[64:67], v[136:139]
    v_mfma_f32_16x16x32_bf16 v[136:139], a[184:187], v[68:71], v[136:139]
    v_mfma_f32_16x16x32_bf16 v[136:139], a[188:191], v[72:75], v[136:139]
    s_nop 7
    v_max3_f32 v172, v172, v76, v77
    v_max3_f32 v172, v172, v78, v79
    v_max3_f32 v176, v176, v80, v81
    v_max3_f32 v176, v176, v82, v83
    v_max3_f32 v180, v180, v108, v109
    v_max3_f32 v180, v180, v110, v111
    v_max3_f32 v184, v184, v112, v113
    v_max3_f32 v184, v184, v114, v115
    v_max3_f32 v172, v172, v84, v85
    v_max3_f32 v172, v172, v86, v87
    v_max3_f32 v176, v176, v88, v89
    v_max3_f32 v176, v176, v90, v91
    v_max3_f32 v180, v180, v116, v117
    v_max3_f32 v180, v180, v118, v119
    v_max3_f32 v184, v184, v120, v121
    v_max3_f32 v184, v184, v122, v123
    v_max3_f32 v172, v172, v92, v93
    v_max3_f32 v172, v172, v94, v95
    v_max3_f32 v176, v176, v96, v97
    v_max3_f32 v176, v176, v98, v99
    v_max3_f32 v180, v180, v124, v125
    v_max3_f32 v180, v180, v126, v127
    v_max3_f32 v184, v184, v128, v129
    v_max3_f32 v184, v184, v130, v131
    v_max3_f32 v172, v172, v100, v101
    v_max3_f32 v172, v172, v102, v103
    v_max3_f32 v176, v176, v104, v105
    v_max3_f32 v176, v176, v106, v107
    v_max3_f32 v180, v180, v132, v133
    v_max3_f32 v180, v180, v134, v135
    v_max3_f32 v184, v184, v136, v137
    v_max3_f32 v184, v184, v138, v139
    s_sub_u32 s18, s18, 1
    s_cmp_lg_u32 s18, 0
    s_cbranch_scc1 L_fbloop
    s_mov_b32 s16, 0
    s_mov_b32 s44, 1
    s_add_u32 m0, s17, 0
    s_nop 0
    buffer_load_dwordx4 v216, s[8:11], s16 offen offset:0 nt lds
    buffer_load_dwordx4 v217, s[8:11], s16 offen offset:1024 nt lds
    buffer_load_dwordx4 v218, s[8:11], s16 offen offset:2048 nt lds
    buffer_load_dwordx4 v219, s[8:11], s16 offen offset:3072 nt lds
    s_add_u32 m0, s17, 65536
    s_nop 0
    buffer_load_dwordx4 v220, s[12:15], s16 offen offset:0 nt lds
    buffer_load_dwordx4 v221, s[12:15], s16 offen offset:1024 nt lds
    buffer_load_dwordx4 v222, s[12:15], s16 offen offset:2048 nt lds
    buffer_load_dwordx4 v223, s[12:15], s16 offen offset:3072 nt lds
    s_add_u32 s16, s16, s30
    s_add_u32 m0, s17, 16384
    s_nop 0
    buffer_load_dwordx4 v216, s[8:11], s16 offen offset:0 nt lds
    buffer_load_dwordx4 v217, s[8:11], s16 offen offset:1024 nt lds
    buffer_load_dwordx4 v218, s[8:11], s16 offen offset:2048 nt lds
    buffer_load_dwordx4 v219, s[8:11], s16 offen offset:3072 nt lds
    s_add_u32 m0, s17, 81920
    s_nop 0
    buffer_load_dwordx4 v220, s[12:15], s16 offen offset:0 nt lds
    buffer_load_dwordx4 v221, s[12:15], s16 offen offset:1024 nt lds
    buffer_load_dwordx4 v222, s[12:15], s16 offen offset:2048 nt lds
    buffer_load_dwordx4 v223, s[12:15], s16 offen offset:3072 nt lds
    s_add_u32 s16, s16, s30
    v_mov_b32 v192, 0
    v_mov_b32 v193, 0
    v_mov_b32 v194, 0
    v_mov_b32 v195, 0
    v_mov_b32 v196, 0
    v_mov_b32 v197, 0
    v_mov_b32 v198, 0
    v_mov_b32 v199, 0
    v_mov_b32 v200, 0
    v_mov_b32 v201, 0
    v_mov_b32 v202, 0
    v_mov_b32 v203, 0
    v_mov_b32 v248, 0
    v_mov_b32 v249, 0
    v_mov_b32 v250, 0
    v_mov_b32 v251, 0
    v_bfe_i32 v11, v0, 0, 1
    v_and_b32 v11, 0xaaaaaaaa, v11
    v_or_b32 v11, 0x44444444, v11
    v_mov_b32 v188, 0x3f803f80
    v_mov_b32 v189, 0x3f803f80
    v_mov_b32 v190, 0x3f803f80
    v_mov_b32 v191, 0x3f803f80
    v_accvgpr_write_b32 a92, s33
    v_accvgpr_write_b32 a93, s33
    v_accvgpr_write_b32 a94, s33
    v_accvgpr_write_b32 a95, s33
    s_waitcnt vmcnt(8)
    s_barrier
    ds_read_b128 a[128:131], v204 offset:0
    ds_read_b128 a[132:135], v205 offset:0
    ds_read_b128 a[136:139], v206 offset:0
    ds_read_b128 a[140:143], v207 offset:0
    ds_read_b128 a[144:147], v204 offset:4096
    ds_read_b128 a[148:151], v205 offset:4096
    ds_read_b128 a[152:155], v206 offset:4096
    ds_read_b128 a[156:159], v207 offset:4096
    ds_read_b128 a[160:163], v204 offset:8192
    ds_read_b128 a[164:167], v205 offset:8192
    ds_read_b128 a[168:171], v206 offset:8192
    ds_read_b128 a[172:175], v207 offset:8192
    ds_read_b128 a[176:179], v204 offset:12288
    ds_read_b128 a[180:183], v205 offset:12288
    ds_read_b128 a[184:187], v206 offset:12288
    s_branch L_entry
L_codeend:
.section .rodata,"a"
.p2align 6
.amdhsa_kernel adaLN_cond__gqa_block_cached__glu_gated_reglu__prompt_kernel
  .amdhsa_next_free_vgpr 512
  .amdhsa_next_free_sgpr 102
  .amdhsa_accum_offset 256
  .amdhsa_group_segment_fixed_size 0
  .amdhsa_kernarg_size 112
  .amdhsa_user_sgpr_count 2
  .amdhsa_user_sgpr_kernarg_segment_ptr 1
  .amdhsa_system_sgpr_workgroup_id_x 1
  .amdhsa_float_denorm_mode_32 3
  .amdhsa_ieee_mode 0
.end_amdhsa_kernel
```
